```python
import torch

def _softmax(x, axis=-1):
    return torch.softmax(x, dim=axis)

def _gelu(x):
    return torch.nn.functional.gelu(x, approximate='tanh')

def _silu(x):
    return torch.nn.functional.silu(x)

def _sigmoid(x):
    return torch.sigmoid(x)

def _layernorm(x, axis=-1, eps=1e-05):
    m = x.mean(dim=axis, keepdim=True)
    v = x.var(dim=axis, keepdim=True, unbiased=False)
    return (x - m) / torch.sqrt(v + eps)

def _scatter_add(tgt, idx, src, axis=0):
    return tgt.clone().index_add_(axis, idx, src)

def _segment_sum(src, seg, n):
    out = torch.zeros((n,) + src.shape[1:], dtype=src.dtype)
    return out.index_add_(0, seg, src)

def _pad(x, pw):
    flat = tuple((v for pair in reversed(pw) for v in pair))
    return torch.nn.functional.pad(x, flat)
kernel_name = 'parallel_sum__memory_aug_recurrent_mem_tr__mixer_gmlp__prompt'

def setup_inputs():

    _w = lambda a: (lambda t: t.to(torch.bfloat16) if t.is_floating_point() else t)(torch.as_tensor(a))

    def _A_setup():
        B, S, Dm = (1, 2048, 512)
        H, Dh = (32, 128)
        M, seg = (8, 32)
        seg = min(seg, S)
        S = S // seg * seg
        return {'x': _w((lambda *s: torch.randn(*s, dtype=torch.bfloat16) * 0.05)(B, S, Dm)), 'mem0': _w((lambda *s: torch.randn(*s, dtype=torch.bfloat16) * 1.6)(B, M, Dm)), 'Wq': _w((lambda *s: torch.randn(*s, dtype=torch.bfloat16) * 0.8)(Dm, H, Dh) * Dm ** (-0.5)), 'Wk': _w((lambda *s: torch.randn(*s, dtype=torch.bfloat16) * 0.8)(Dm, H, Dh) * Dm ** (-0.5)), 'Wv': _w((lambda *s: torch.randn(*s, dtype=torch.bfloat16) * 1.6)(Dm, H, Dh) * Dm ** (-0.5)), 'Wo': _w((lambda *s: torch.randn(*s, dtype=torch.bfloat16) * 1.6)(H, Dh, Dm) * (H * Dh) ** (-0.5)), 'seg_len': seg}
    _A_in = _A_setup()

    def _B_setup():
        B, S, D, F = (1, 2048, 512, 1792)
        Fh = F // 2
        return {'x': _w((lambda *s: torch.randn(*s, dtype=torch.bfloat16) * 0.05)(B, S, D)), 'w_in': _w((lambda *s: torch.randn(*s, dtype=torch.bfloat16) * 0.2)(D, 2 * Fh)), 'w_sp': _w(0.01 * (lambda *s: torch.randn(*s, dtype=torch.bfloat16) * 0.2)(S, S)), 'b_sp': _w(1.0 + 0.01 * (lambda *s: torch.randn(*s, dtype=torch.bfloat16) * 0.05)(S)), 'w_out': _w((lambda *s: torch.randn(*s, dtype=torch.bfloat16) * 0.05)(Fh, D))}
    _B_in = _B_setup()
    return {'A_x': _A_in['x'], 'A_mem0': _A_in['mem0'], 'A_Wq': _A_in['Wq'], 'A_Wk': _A_in['Wk'], 'A_Wv': _A_in['Wv'], 'A_Wo': _A_in['Wo'], 'A_seg_len': _A_in['seg_len'], 'B_x': _B_in['x'], 'B_w_in': _B_in['w_in'], 'B_w_sp': _B_in['w_sp'], 'B_b_sp': _B_in['b_sp'], 'B_w_out': _B_in['w_out']}

def reference(A_x, A_mem0, A_Wq, A_Wk, A_Wv, A_Wo, A_seg_len, B_x, B_w_in, B_w_sp, B_b_sp, B_w_out):

    def _A_ref(x, mem0, Wq, Wk, Wv, Wo, seg_len):
        B, S, Dm = x.shape
        H, Dh = (Wq.shape[1], Wq.shape[2])
        M = mem0.shape[1]
        scale = Dh ** (-0.5)
        n_seg = S // seg_len
        L = M + seg_len
        idx = torch.arange(L)
        mask = (idx[:, None] < M) | (idx[:, None] >= idx[None, :])
        mem = mem0
        outs = []
        for s in range(n_seg):
            xs = x[:, s * seg_len:(s + 1) * seg_len, :].clone()
            h = torch.concatenate([mem, xs], axis=1)
            q = torch.einsum('btd,dhe->bhte', h, Wq)
            k = torch.einsum('btd,dhe->bhte', h, Wk)
            v = torch.einsum('btd,dhe->bhte', h, Wv)
            scores = torch.einsum('bhqe,bhke->bhqk', q, k) * scale
            scores = torch.where(mask[None, None], scores, -1000000000.0)
            p = _softmax(scores, axis=-1)
            o = torch.einsum('bhqk,bhke->bhqe', p, v)
            o = torch.einsum('bhte,hed->btd', o, Wo)
            mem = o[:, :M, :].clone()
            outs.append(o[:, M:, :])
        return torch.concatenate(outs, axis=1)

    def _B_ref(x, w_in, w_sp, b_sp, w_out):
        B, S, D = x.shape
        F = w_in.shape[-1]
        Fh = F // 2
        z = _gelu(torch.einsum('bsd,df->bsf', x, w_in))
        z1 = z[..., :Fh].clone()
        z2 = _layernorm(z[..., Fh:], axis=-1)
        g = torch.einsum('ts,bsf->btf', w_sp, z2) + b_sp[None, :, None]
        return torch.einsum('bsf,fd->bsd', z1 * g, w_out)
    x = A_x
    xn = _layernorm(x, axis=-1)
    return x + _A_ref(xn, A_mem0, A_Wq, A_Wk, A_Wv, A_Wo, A_seg_len) + _B_ref(xn, B_w_in, B_w_sp, B_b_sp, B_w_out)
```

```asm
; @launch kernel=prep_kernel grid=(160,1,1) block=(256,1,1) lds=0
; @launch kernel=main_kernel grid=(256,1,1) block=(256,1,1) lds=162368
.amdgcn_target "amdgcn-amd-amdhsa--gfx950"
.text
.globl prep_kernel
.p2align 8
.type prep_kernel,@function
prep_kernel:

s_cmp_ge_u32 s2, 160
s_cbranch_scc1 L_prep_exit
s_load_dwordx2 s[4:5], s[0:1], 0
s_load_dwordx2 s[6:7], s[0:1], 112
s_load_dwordx2 s[20:21], s[0:1], 8
s_waitcnt lgkmcnt(0)
s_mov_b32 s8, s4
s_and_b32 s9, s5, 0xffff
s_mov_b32 s10, 0x200000
s_mov_b32 s11, 0x00020000
s_mov_b32 s12, s6
s_and_b32 s13, s7, 0xffff
s_mov_b32 s14, 0x10000000
s_mov_b32 s15, 0x00020000
s_mov_b32 s16, s20
s_and_b32 s17, s21, 0xffff
s_mov_b32 s18, 0x2000
s_mov_b32 s19, 0x00020000
s_cmp_ge_u32 s2, 128
s_cbranch_scc1 L_prep_fill
v_lshrrev_b32 v1, 4, v0
v_and_b32 v2, 15, v0
s_lshl_b32 s3, s2, 14
v_lshlrev_b32 v3, 10, v1
v_lshl_add_u32 v3, v2, 4, v3
buffer_load_dwordx4 v[8:11], v3, s[8:11], s3 offen
buffer_load_dwordx4 v[12:15], v3, s[8:11], s3 offen offset:256
buffer_load_dwordx4 v[16:19], v3, s[8:11], s3 offen offset:512
buffer_load_dwordx4 v[20:23], v3, s[8:11], s3 offen offset:768
s_mov_b32 s22, 0xffff0000
s_waitcnt vmcnt(0)
v_lshlrev_b32 v32, 16, v8
v_and_b32 v33, s22, v8
v_lshlrev_b32 v34, 16, v9
v_and_b32 v35, s22, v9
v_lshlrev_b32 v36, 16, v10
v_and_b32 v37, s22, v10
v_lshlrev_b32 v38, 16, v11
v_and_b32 v39, s22, v11
v_lshlrev_b32 v40, 16, v12
v_and_b32 v41, s22, v12
v_lshlrev_b32 v42, 16, v13
v_and_b32 v43, s22, v13
v_lshlrev_b32 v44, 16, v14
v_and_b32 v45, s22, v14
v_lshlrev_b32 v46, 16, v15
v_and_b32 v47, s22, v15
v_lshlrev_b32 v48, 16, v16
v_and_b32 v49, s22, v16
v_lshlrev_b32 v50, 16, v17
v_and_b32 v51, s22, v17
v_lshlrev_b32 v52, 16, v18
v_and_b32 v53, s22, v18
v_lshlrev_b32 v54, 16, v19
v_and_b32 v55, s22, v19
v_lshlrev_b32 v56, 16, v20
v_and_b32 v57, s22, v20
v_lshlrev_b32 v58, 16, v21
v_and_b32 v59, s22, v21
v_lshlrev_b32 v60, 16, v22
v_and_b32 v61, s22, v22
v_lshlrev_b32 v62, 16, v23
v_and_b32 v63, s22, v23
v_add_f32 v4, v32, v33
v_add_f32 v4, v4, v34
v_add_f32 v4, v4, v35
v_add_f32 v4, v4, v36
v_add_f32 v4, v4, v37
v_add_f32 v4, v4, v38
v_add_f32 v4, v4, v39
v_add_f32 v4, v4, v40
v_add_f32 v4, v4, v41
v_add_f32 v4, v4, v42
v_add_f32 v4, v4, v43
v_add_f32 v4, v4, v44
v_add_f32 v4, v4, v45
v_add_f32 v4, v4, v46
v_add_f32 v4, v4, v47
v_add_f32 v4, v4, v48
v_add_f32 v4, v4, v49
v_add_f32 v4, v4, v50
v_add_f32 v4, v4, v51
v_add_f32 v4, v4, v52
v_add_f32 v4, v4, v53
v_add_f32 v4, v4, v54
v_add_f32 v4, v4, v55
v_add_f32 v4, v4, v56
v_add_f32 v4, v4, v57
v_add_f32 v4, v4, v58
v_add_f32 v4, v4, v59
v_add_f32 v4, v4, v60
v_add_f32 v4, v4, v61
v_add_f32 v4, v4, v62
v_add_f32 v4, v4, v63
s_nop 1
v_add_f32_dpp v4, v4, v4 quad_perm:[1,0,3,2] row_mask:0xf bank_mask:0xf
s_nop 1
v_add_f32_dpp v4, v4, v4 quad_perm:[2,3,0,1] row_mask:0xf bank_mask:0xf
s_nop 1
v_add_f32_dpp v4, v4, v4 row_half_mirror row_mask:0xf bank_mask:0xf
s_nop 1
v_add_f32_dpp v4, v4, v4 row_mirror row_mask:0xf bank_mask:0xf
v_mul_f32 v4, 0x3b000000, v4
v_sub_f32 v32, v32, v4
v_sub_f32 v33, v33, v4
v_sub_f32 v34, v34, v4
v_sub_f32 v35, v35, v4
v_sub_f32 v36, v36, v4
v_sub_f32 v37, v37, v4
v_sub_f32 v38, v38, v4
v_sub_f32 v39, v39, v4
v_sub_f32 v40, v40, v4
v_sub_f32 v41, v41, v4
v_sub_f32 v42, v42, v4
v_sub_f32 v43, v43, v4
v_sub_f32 v44, v44, v4
v_sub_f32 v45, v45, v4
v_sub_f32 v46, v46, v4
v_sub_f32 v47, v47, v4
v_sub_f32 v48, v48, v4
v_sub_f32 v49, v49, v4
v_sub_f32 v50, v50, v4
v_sub_f32 v51, v51, v4
v_sub_f32 v52, v52, v4
v_sub_f32 v53, v53, v4
v_sub_f32 v54, v54, v4
v_sub_f32 v55, v55, v4
v_sub_f32 v56, v56, v4
v_sub_f32 v57, v57, v4
v_sub_f32 v58, v58, v4
v_sub_f32 v59, v59, v4
v_sub_f32 v60, v60, v4
v_sub_f32 v61, v61, v4
v_sub_f32 v62, v62, v4
v_sub_f32 v63, v63, v4
v_mul_f32 v5, v32, v32
v_fmac_f32 v5, v33, v33
v_fmac_f32 v5, v34, v34
v_fmac_f32 v5, v35, v35
v_fmac_f32 v5, v36, v36
v_fmac_f32 v5, v37, v37
v_fmac_f32 v5, v38, v38
v_fmac_f32 v5, v39, v39
v_fmac_f32 v5, v40, v40
v_fmac_f32 v5, v41, v41
v_fmac_f32 v5, v42, v42
v_fmac_f32 v5, v43, v43
v_fmac_f32 v5, v44, v44
v_fmac_f32 v5, v45, v45
v_fmac_f32 v5, v46, v46
v_fmac_f32 v5, v47, v47
v_fmac_f32 v5, v48, v48
v_fmac_f32 v5, v49, v49
v_fmac_f32 v5, v50, v50
v_fmac_f32 v5, v51, v51
v_fmac_f32 v5, v52, v52
v_fmac_f32 v5, v53, v53
v_fmac_f32 v5, v54, v54
v_fmac_f32 v5, v55, v55
v_fmac_f32 v5, v56, v56
v_fmac_f32 v5, v57, v57
v_fmac_f32 v5, v58, v58
v_fmac_f32 v5, v59, v59
v_fmac_f32 v5, v60, v60
v_fmac_f32 v5, v61, v61
v_fmac_f32 v5, v62, v62
v_fmac_f32 v5, v63, v63
s_nop 1
v_add_f32_dpp v5, v5, v5 quad_perm:[1,0,3,2] row_mask:0xf bank_mask:0xf
s_nop 1
v_add_f32_dpp v5, v5, v5 quad_perm:[2,3,0,1] row_mask:0xf bank_mask:0xf
s_nop 1
v_add_f32_dpp v5, v5, v5 row_half_mirror row_mask:0xf bank_mask:0xf
s_nop 1
v_add_f32_dpp v5, v5, v5 row_mirror row_mask:0xf bank_mask:0xf
v_mov_b32 v6, 0x3727c5ac
v_fmac_f32 v6, 0x3b000000, v5
v_rsq_f32 v6, v6
s_nop 0
v_mul_f32 v32, v32, v6
v_mul_f32 v33, v33, v6
v_cvt_pk_bf16_f32 v8, v32, v33
v_mul_f32 v34, v34, v6
v_mul_f32 v35, v35, v6
v_cvt_pk_bf16_f32 v9, v34, v35
v_mul_f32 v36, v36, v6
v_mul_f32 v37, v37, v6
v_cvt_pk_bf16_f32 v10, v36, v37
v_mul_f32 v38, v38, v6
v_mul_f32 v39, v39, v6
v_cvt_pk_bf16_f32 v11, v38, v39
v_mul_f32 v40, v40, v6
v_mul_f32 v41, v41, v6
v_cvt_pk_bf16_f32 v12, v40, v41
v_mul_f32 v42, v42, v6
v_mul_f32 v43, v43, v6
v_cvt_pk_bf16_f32 v13, v42, v43
v_mul_f32 v44, v44, v6
v_mul_f32 v45, v45, v6
v_cvt_pk_bf16_f32 v14, v44, v45
v_mul_f32 v46, v46, v6
v_mul_f32 v47, v47, v6
v_cvt_pk_bf16_f32 v15, v46, v47
v_mul_f32 v48, v48, v6
v_mul_f32 v49, v49, v6
v_cvt_pk_bf16_f32 v16, v48, v49
v_mul_f32 v50, v50, v6
v_mul_f32 v51, v51, v6
v_cvt_pk_bf16_f32 v17, v50, v51
v_mul_f32 v52, v52, v6
v_mul_f32 v53, v53, v6
v_cvt_pk_bf16_f32 v18, v52, v53
v_mul_f32 v54, v54, v6
v_mul_f32 v55, v55, v6
v_cvt_pk_bf16_f32 v19, v54, v55
v_mul_f32 v56, v56, v6
v_mul_f32 v57, v57, v6
v_cvt_pk_bf16_f32 v20, v56, v57
v_mul_f32 v58, v58, v6
v_mul_f32 v59, v59, v6
v_cvt_pk_bf16_f32 v21, v58, v59
v_mul_f32 v60, v60, v6
v_mul_f32 v61, v61, v6
v_cvt_pk_bf16_f32 v22, v60, v61
v_mul_f32 v62, v62, v6
v_mul_f32 v63, v63, v6
v_cvt_pk_bf16_f32 v23, v62, v63
v_lshrrev_b32 v4, 2, v2
v_lshlrev_b32 v4, 10, v4
v_and_b32 v5, 3, v2
v_lshl_add_u32 v4, v5, 8, v4
v_lshl_add_u32 v4, v1, 4, v4
s_add_u32 s3, s3, 0
s_add_u32 s22, s3, 4096
s_add_u32 s23, s3, 8192
s_add_u32 s24, s3, 12288
buffer_store_dwordx4 v[8:11], v4, s[12:15], s3 offen
buffer_store_dwordx4 v[12:15], v4, s[12:15], s22 offen
buffer_store_dwordx4 v[16:19], v4, s[12:15], s23 offen
buffer_store_dwordx4 v[20:23], v4, s[12:15], s24 offen
s_branch L_prep_exit
L_prep_fill:
s_sub_u32 s3, s2, 128
v_lshlrev_b32 v1, 4, v0
v_mov_b32 v4, -1
v_mov_b32 v5, -1
v_mov_b32 v6, -1
v_mov_b32 v7, -1
s_lshl_b32 s22, s3, 14
s_add_u32 s23, s22, 2105344
s_add_u32 s22, s22, 3145728
buffer_store_dwordx4 v[4:7], v1, s[12:15], s22 offen
buffer_store_dwordx4 v[4:7], v1, s[12:15], s23 offen
s_add_u32 s22, s22, 4096
s_add_u32 s23, s23, 4096
buffer_store_dwordx4 v[4:7], v1, s[12:15], s22 offen
buffer_store_dwordx4 v[4:7], v1, s[12:15], s23 offen
s_add_u32 s22, s22, 4096
s_add_u32 s23, s23, 4096
buffer_store_dwordx4 v[4:7], v1, s[12:15], s22 offen
buffer_store_dwordx4 v[4:7], v1, s[12:15], s23 offen
s_add_u32 s22, s22, 4096
s_add_u32 s23, s23, 4096
buffer_store_dwordx4 v[4:7], v1, s[12:15], s22 offen
buffer_store_dwordx4 v[4:7], v1, s[12:15], s23 offen
s_add_u32 s22, s22, 4096
s_add_u32 s23, s23, 4096
s_cmp_lg_u32 s3, 0
s_cbranch_scc1 L_prep_exit
v_mov_b32 v4, 0
v_mov_b32 v5, 0
v_mov_b32 v6, 0
v_mov_b32 v7, 0
s_mov_b32 s22, 4194304
buffer_store_dwordx4 v[4:7], v1, s[12:15], s22 offen
s_add_u32 s22, s22, 4096
buffer_store_dwordx4 v[4:7], v1, s[12:15], s22 offen
s_add_u32 s22, s22, 4096
buffer_store_dwordx4 v[4:7], v1, s[12:15], s22 offen
s_add_u32 s22, s22, 4096
buffer_store_dwordx4 v[4:7], v1, s[12:15], s22 offen
s_add_u32 s22, s22, 4096
buffer_store_dwordx4 v[4:7], v1, s[12:15], s22 offen
s_add_u32 s22, s22, 4096
buffer_store_dwordx4 v[4:7], v1, s[12:15], s22 offen
s_add_u32 s22, s22, 4096
buffer_store_dwordx4 v[4:7], v1, s[12:15], s22 offen
s_add_u32 s22, s22, 4096
buffer_store_dwordx4 v[4:7], v1, s[12:15], s22 offen
s_add_u32 s22, s22, 4096
buffer_store_dwordx4 v[4:7], v1, s[12:15], s22 offen
s_add_u32 s22, s22, 4096
buffer_store_dwordx4 v[4:7], v1, s[12:15], s22 offen
s_add_u32 s22, s22, 4096
buffer_store_dwordx4 v[4:7], v1, s[12:15], s22 offen
s_add_u32 s22, s22, 4096
buffer_store_dwordx4 v[4:7], v1, s[12:15], s22 offen
s_add_u32 s22, s22, 4096
buffer_store_dwordx4 v[4:7], v1, s[12:15], s22 offen
s_add_u32 s22, s22, 4096
buffer_store_dwordx4 v[4:7], v1, s[12:15], s22 offen
s_add_u32 s22, s22, 4096
buffer_store_dwordx4 v[4:7], v1, s[12:15], s22 offen
s_add_u32 s22, s22, 4096
buffer_store_dwordx4 v[4:7], v1, s[12:15], s22 offen
s_add_u32 s22, s22, 4096
v_add_u32 v2, 0, v0
v_and_b32 v3, 1, v2
v_bfe_u32 v8, v2, 1, 2
v_bfe_u32 v9, v2, 5, 2
v_bfe_u32 v10, v2, 3, 1
v_lshl_add_u32 v9, v9, 1, v10
v_bfe_u32 v10, v2, 4, 1
v_lshrrev_b32 v11, 7, v2
v_lshlrev_b32 v12, 10, v9
v_lshl_add_u32 v12, v11, 7, v12
v_lshl_add_u32 v12, v8, 5, v12
v_lshl_add_u32 v12, v3, 4, v12
v_lshl_add_u32 v12, v10, 3, v12
buffer_load_dwordx2 v[14:15], v12, s[16:19], 0 offen
v_lshlrev_b32 v2, 3, v2
s_mov_b32 s22, 2097152
s_mov_b32 s23, 0xfffffffe
s_waitcnt vmcnt(0)
v_min_u32 v14, s23, v14
v_min_u32 v15, s23, v15
buffer_store_dwordx2 v[14:15], v2, s[12:15], s22 offen
v_add_u32 v2, 256, v0
v_and_b32 v3, 1, v2
v_bfe_u32 v8, v2, 1, 2
v_bfe_u32 v9, v2, 5, 2
v_bfe_u32 v10, v2, 3, 1
v_lshl_add_u32 v9, v9, 1, v10
v_bfe_u32 v10, v2, 4, 1
v_lshrrev_b32 v11, 7, v2
v_lshlrev_b32 v12, 10, v9
v_lshl_add_u32 v12, v11, 7, v12
v_lshl_add_u32 v12, v8, 5, v12
v_lshl_add_u32 v12, v3, 4, v12
v_lshl_add_u32 v12, v10, 3, v12
buffer_load_dwordx2 v[14:15], v12, s[16:19], 0 offen
v_lshlrev_b32 v2, 3, v2
s_mov_b32 s22, 2097152
s_mov_b32 s23, 0xfffffffe
s_waitcnt vmcnt(0)
v_min_u32 v14, s23, v14
v_min_u32 v15, s23, v15
buffer_store_dwordx2 v[14:15], v2, s[12:15], s22 offen
v_add_u32 v2, 512, v0
v_and_b32 v3, 1, v2
v_bfe_u32 v8, v2, 1, 2
v_bfe_u32 v9, v2, 5, 2
v_bfe_u32 v10, v2, 3, 1
v_lshl_add_u32 v9, v9, 1, v10
v_bfe_u32 v10, v2, 4, 1
v_lshrrev_b32 v11, 7, v2
v_lshlrev_b32 v12, 10, v9
v_lshl_add_u32 v12, v11, 7, v12
v_lshl_add_u32 v12, v8, 5, v12
v_lshl_add_u32 v12, v3, 4, v12
v_lshl_add_u32 v12, v10, 3, v12
buffer_load_dwordx2 v[14:15], v12, s[16:19], 0 offen
v_lshlrev_b32 v2, 3, v2
s_mov_b32 s22, 2097152
s_mov_b32 s23, 0xfffffffe
s_waitcnt vmcnt(0)
v_min_u32 v14, s23, v14
v_min_u32 v15, s23, v15
buffer_store_dwordx2 v[14:15], v2, s[12:15], s22 offen
v_add_u32 v2, 768, v0
v_and_b32 v3, 1, v2
v_bfe_u32 v8, v2, 1, 2
v_bfe_u32 v9, v2, 5, 2
v_bfe_u32 v10, v2, 3, 1
v_lshl_add_u32 v9, v9, 1, v10
v_bfe_u32 v10, v2, 4, 1
v_lshrrev_b32 v11, 7, v2
v_lshlrev_b32 v12, 10, v9
v_lshl_add_u32 v12, v11, 7, v12
v_lshl_add_u32 v12, v8, 5, v12
v_lshl_add_u32 v12, v3, 4, v12
v_lshl_add_u32 v12, v10, 3, v12
buffer_load_dwordx2 v[14:15], v12, s[16:19], 0 offen
v_lshlrev_b32 v2, 3, v2
s_mov_b32 s22, 2097152
s_mov_b32 s23, 0xfffffffe
s_waitcnt vmcnt(0)
v_min_u32 v14, s23, v14
v_min_u32 v15, s23, v15
buffer_store_dwordx2 v[14:15], v2, s[12:15], s22 offen
L_prep_exit:
s_waitcnt vmcnt(0)
s_endpgm
.globl main_kernel
.p2align 8
.type main_kernel,@function
main_kernel:

s_cmp_lt_u32 s2, 256
s_cbranch_scc1 L_m_start
s_endpgm
L_m_start:
s_mov_b32 s92, 0
s_mov_b32 s93, 0
s_load_dwordx2 s[80:81], s[0:1], 112
v_lshrrev_b32 v34, 6, v0
s_nop 0
v_readfirstlane_b32 s29, v34
s_nop 3
s_getreg_b32 s3, hwreg(HW_REG_XCC_ID)
s_and_b32 s3, s3, 7
s_mov_b32 s89, 0
s_waitcnt lgkmcnt(0)
s_mov_b32 s84, s80
s_and_b32 s85, s81, 0xffff
s_mov_b32 s86, 0x10000000
s_mov_b32 s87, 0x00020000
s_cmp_lg_u32 s3, 0
s_cbranch_scc1 L_m_work
s_cmp_lg_u32 s29, 0
s_cbranch_scc1 AT_1
v_mov_b32 v2, 0
v_mov_b32 v4, 1
s_mov_b32 s28, 4194304
s_mov_b64 exec, 1
buffer_atomic_add v4, v2, s[84:87], s28 offen sc0 sc1
v_mov_b32 v3, 162304
s_waitcnt vmcnt(0)
ds_write_b32 v3, v4
s_mov_b64 exec, -1
s_waitcnt lgkmcnt(0)
AT_1:
s_barrier
v_mov_b32 v3, 162304
ds_read_b32 v4, v3
s_waitcnt lgkmcnt(0)
v_readfirstlane_b32 s28, v4
s_barrier
s_cmp_ge_u32 s28, 32
s_cbranch_scc1 L_m_work
s_mov_b32 s31, 0
L_m_chain:
s_load_dwordx4 s[72:75], s[0:1], 16
s_load_dwordx4 s[76:79], s[0:1], 32
s_waitcnt lgkmcnt(0)
s_mov_b32 s8, s72
s_and_b32 s9, s73, 0xffff
s_mov_b32 s10, 0x400000
s_mov_b32 s11, 0x00020000
s_mov_b32 s12, s74
s_and_b32 s13, s75, 0xffff
s_mov_b32 s14, 0x400000
s_mov_b32 s15, 0x00020000
s_mov_b32 s16, s76
s_and_b32 s17, s77, 0xffff
s_mov_b32 s18, 0x400000
s_mov_b32 s19, 0x00020000
s_mov_b32 s20, s78
s_and_b32 s21, s79, 0xffff
s_mov_b32 s22, 0x400000
s_mov_b32 s23, 0x00020000
s_mov_b32 s24, s80
s_and_b32 s25, s81, 0xffff
s_mov_b32 s26, 0x10000000
s_mov_b32 s27, 0x00020000
v_lshrrev_b32 v124, 6, v0
v_and_b32 v125, 63, v0
s_nop 0
v_readfirstlane_b32 s29, v124
v_and_b32 v126, 15, v125
v_lshrrev_b32 v127, 4, v125
v_lshlrev_b32 v1, 4, v125
s_mov_b32 s40, 0x05040100
s_mov_b32 s41, 0x07060302
s_mov_b32 s50, 0x33333333
s_mov_b32 s51, 0x33333333
s_mov_b32 s53, 0x3e0293ee
s_mov_b32 s54, 0xfffffffe
s_lshl_b32 s42, s29, 11
v_lshlrev_b32 v2, 6, v126
v_lshl_add_u32 v2, v127, 4, v2
v_add_u32 v2, s42, v2
s_lshl_b32 s42, s29, 11
s_add_u32 s42, s42, 147456
v_add_u32 v3, s42, v1
s_lshl_b32 s42, s29, 1
s_add_u32 s42, s42, 2
s_and_b32 s42, s42, 7
s_lshl_b32 s42, s42, 10
s_add_u32 s42, s42, 147456
v_add_u32 v4, s42, v1
s_lshl_b32 s42, s29, 1
s_add_u32 s42, s42, 4
s_and_b32 s42, s42, 7
s_lshl_b32 s42, s42, 10
s_add_u32 s42, s42, 147456
v_add_u32 v5, s42, v1
s_lshl_b32 s42, s29, 1
s_add_u32 s42, s42, 6
s_and_b32 s42, s42, 7
s_lshl_b32 s42, s42, 10
s_add_u32 s42, s42, 147456
v_add_u32 v6, s42, v1
v_mov_b32 v7, 0xeeee
v_mov_b32 v120, 0x4444
v_cndmask_b32 v7, v7, v120, s[50:51]
v_lshlrev_b32 v120, 1, v127
v_and_b32 v121, 7, v126
v_lshrrev_b32 v121, 1, v121
v_lshlrev_b32 v121, 4, v121
v_lshrrev_b32 v122, 3, v126
v_lshl_add_u32 v121, v122, 3, v121
v_and_b32 v122, 1, v126
v_lshl_add_u32 v121, v122, 2, v121
v_mul_u32_u24 v8, 272, v120
v_add_u32 v8, v8, v121
s_lshl_b32 s42, s29, 6
s_add_u32 s42, s42, 155648
v_add_u32 v8, s42, v8
v_lshl_add_u32 v10, v120, 6, v121
s_lshl_b32 s42, s29, 9
v_add_u32 v10, s42, v10
v_lshrrev_b32 v122, 2, v126
v_lshlrev_b32 v122, 1, v122
v_and_b32 v123, 1, v126
v_add_u32 v122, v122, v123
v_mul_u32_u24 v9, 272, v122
v_lshl_add_u32 v9, v127, 4, v9
v_add_u32 v9, 155648, v9
s_lshr_b32 s42, s29, 1
s_lshl_b32 s42, s42, 10
s_and_b32 s43, s29, 1
s_lshl_b32 s43, s43, 3
s_add_u32 s42, s42, s43
s_add_u32 s42, s42, 160256
v_add_u32 v11, s42, v1
v_lshlrev_b32 v12, 15, v120
v_lshl_add_u32 v12, v126, 4, v12
s_lshl_b32 s42, s29, 13
s_lshl_b32 s43, s28, 8
s_add_u32 s42, s42, s43
v_add_u32 v12, s42, v12
v_and_b32 v122, 1, v126
v_lshlrev_b32 v122, 4, v122
v_mov_b32 v13, 0x3f80
v_lshlrev_b32 v13, v122, v13
v_lshrrev_b32 v122, 3, v126
v_lshlrev_b32 v14, 10, v122
v_and_b32 v122, 1, v127
v_lshl_add_u32 v14, v122, 7, v14
v_bfe_u32 v122, v126, 1, 2
v_lshl_add_u32 v14, v122, 4, v14
v_and_b32 v122, 1, v126
v_lshl_add_u32 v14, v122, 3, v14
s_and_b32 s42, s28, 3
s_lshl_b32 s42, s42, 11
s_lshr_b32 s43, s28, 3
s_lshl_b32 s43, s43, 8
s_add_u32 s42, s42, s43
s_bfe_u32 s43, s28, 0x10002
s_lshl_b32 s43, s43, 6
s_add_u32 s42, s42, s43
v_add_u32 v14, s42, v14
s_lshl_b32 s42, s29, 15
v_add_u32 v15, s42, v1
v_lshlrev_b32 v12, 16, v127
v_lshl_add_u32 v12, v126, 4, v12
s_lshl_b32 s42, s29, 14
s_lshl_b32 s43, s28, 8
s_add_u32 s42, s42, s43
v_add_u32 v12, s42, v12
v_lshrrev_b32 v122, 3, v126
v_lshlrev_b32 v14, 10, v122
v_and_b32 v122, 1, v127
v_lshl_add_u32 v14, v122, 6, v14
v_bfe_u32 v122, v126, 1, 2
v_lshl_add_u32 v14, v122, 4, v14
v_and_b32 v122, 1, v126
v_lshl_add_u32 v14, v122, 3, v14
s_bfe_u32 s42, s28, 0x20001
s_lshl_b32 s42, s42, 11
s_lshr_b32 s43, s28, 3
s_lshl_b32 s43, s43, 8
s_add_u32 s42, s42, s43
s_and_b32 s43, s28, 1
s_lshl_b32 s43, s43, 7
s_add_u32 s42, s42, s43
v_add_u32 v14, s42, v14
v_add_u32 v13, 131072, v1
s_lshl_b32 s42, s29, 1
s_add_u32 s42, s42, 0
s_and_b32 s42, s42, 7
s_lshl_b32 s32, s42, 19
s_lshl_b32 s42, s29, 1
s_add_u32 s42, s42, 1
s_and_b32 s42, s42, 7
s_lshl_b32 s33, s42, 19
s_lshl_b32 s42, s29, 1
s_add_u32 s42, s42, 2
s_and_b32 s42, s42, 7
s_lshl_b32 s34, s42, 19
s_lshl_b32 s42, s29, 1
s_add_u32 s42, s42, 3
s_and_b32 s42, s42, 7
s_lshl_b32 s35, s42, 19
s_lshl_b32 s42, s29, 1
s_add_u32 s42, s42, 4
s_and_b32 s42, s42, 7
s_lshl_b32 s36, s42, 19
s_lshl_b32 s42, s29, 1
s_add_u32 s42, s42, 5
s_and_b32 s42, s42, 7
s_lshl_b32 s37, s42, 19
s_lshl_b32 s42, s29, 1
s_add_u32 s42, s42, 6
s_and_b32 s42, s42, 7
s_lshl_b32 s38, s42, 19
s_lshl_b32 s42, s29, 1
s_add_u32 s42, s42, 7
s_and_b32 s42, s42, 7
s_lshl_b32 s39, s42, 19
v_lshlrev_b32 v120, 16, v127
v_lshl_add_u32 v120, v126, 2, v120
s_lshl_b32 s42, s28, 8
s_lshl_b32 s43, s29, 6
s_add_u32 s42, s42, s43
v_add_u32 v120, s42, v120
v_and_b32 v121, 1, v127
v_lshlrev_b32 v121, 15, v121
v_lshrrev_b32 v122, 1, v127
v_lshl_add_u32 v121, v122, 13, v121
v_lshl_add_u32 v121, v126, 4, v121
s_lshl_b32 s42, s28, 17
s_lshl_b32 s43, s29, 8
s_add_u32 s42, s42, s43
v_add_u32 v121, s42, v121
s_add_u32 s42, s32, 0
buffer_load_dword v16, v120, s[8:11], s42 offen
s_add_u32 s43, s32, 8192
buffer_load_dword v17, v120, s[8:11], s43 offen
s_add_u32 s44, s32, 32768
buffer_load_dword v18, v120, s[8:11], s44 offen
s_add_u32 s42, s32, 40960
buffer_load_dword v19, v120, s[8:11], s42 offen
s_add_u32 s43, s32, 16384
buffer_load_dword v20, v120, s[8:11], s43 offen
s_add_u32 s44, s32, 24576
buffer_load_dword v21, v120, s[8:11], s44 offen
s_add_u32 s42, s32, 49152
buffer_load_dword v22, v120, s[8:11], s42 offen
s_add_u32 s43, s32, 57344
buffer_load_dword v23, v120, s[8:11], s43 offen
s_add_u32 s44, s32, 262144
buffer_load_dword v24, v120, s[8:11], s44 offen
s_add_u32 s42, s32, 270336
buffer_load_dword v25, v120, s[8:11], s42 offen
s_add_u32 s43, s32, 294912
buffer_load_dword v26, v120, s[8:11], s43 offen
s_add_u32 s44, s32, 303104
buffer_load_dword v27, v120, s[8:11], s44 offen
s_add_u32 s42, s32, 278528
buffer_load_dword v28, v120, s[8:11], s42 offen
s_add_u32 s43, s32, 286720
buffer_load_dword v29, v120, s[8:11], s43 offen
s_add_u32 s44, s32, 311296
buffer_load_dword v30, v120, s[8:11], s44 offen
s_add_u32 s42, s32, 319488
buffer_load_dword v31, v120, s[8:11], s42 offen
s_add_u32 s42, s33, 0
buffer_load_dword v32, v120, s[8:11], s42 offen
s_add_u32 s43, s33, 8192
buffer_load_dword v33, v120, s[8:11], s43 offen
s_add_u32 s44, s33, 32768
buffer_load_dword v34, v120, s[8:11], s44 offen
s_add_u32 s42, s33, 40960
buffer_load_dword v35, v120, s[8:11], s42 offen
s_add_u32 s43, s33, 16384
buffer_load_dword v36, v120, s[8:11], s43 offen
s_add_u32 s44, s33, 24576
buffer_load_dword v37, v120, s[8:11], s44 offen
s_add_u32 s42, s33, 49152
buffer_load_dword v38, v120, s[8:11], s42 offen
s_add_u32 s43, s33, 57344
buffer_load_dword v39, v120, s[8:11], s43 offen
s_add_u32 s44, s33, 262144
buffer_load_dword v40, v120, s[8:11], s44 offen
s_add_u32 s42, s33, 270336
buffer_load_dword v41, v120, s[8:11], s42 offen
s_add_u32 s43, s33, 294912
buffer_load_dword v42, v120, s[8:11], s43 offen
s_add_u32 s44, s33, 303104
buffer_load_dword v43, v120, s[8:11], s44 offen
s_add_u32 s42, s33, 278528
buffer_load_dword v44, v120, s[8:11], s42 offen
s_add_u32 s43, s33, 286720
buffer_load_dword v45, v120, s[8:11], s43 offen
s_add_u32 s44, s33, 311296
buffer_load_dword v46, v120, s[8:11], s44 offen
s_add_u32 s42, s33, 319488
buffer_load_dword v47, v120, s[8:11], s42 offen
s_add_u32 s42, s34, 0
buffer_load_dword v48, v120, s[8:11], s42 offen
s_add_u32 s43, s34, 8192
buffer_load_dword v49, v120, s[8:11], s43 offen
s_add_u32 s44, s34, 32768
buffer_load_dword v50, v120, s[8:11], s44 offen
s_add_u32 s42, s34, 40960
buffer_load_dword v51, v120, s[8:11], s42 offen
s_add_u32 s43, s34, 16384
buffer_load_dword v52, v120, s[8:11], s43 offen
s_add_u32 s44, s34, 24576
buffer_load_dword v53, v120, s[8:11], s44 offen
s_add_u32 s42, s34, 49152
buffer_load_dword v54, v120, s[8:11], s42 offen
s_add_u32 s43, s34, 57344
buffer_load_dword v55, v120, s[8:11], s43 offen
s_add_u32 s44, s34, 262144
buffer_load_dword v56, v120, s[8:11], s44 offen
s_add_u32 s42, s34, 270336
buffer_load_dword v57, v120, s[8:11], s42 offen
s_add_u32 s43, s34, 294912
buffer_load_dword v58, v120, s[8:11], s43 offen
s_add_u32 s44, s34, 303104
buffer_load_dword v59, v120, s[8:11], s44 offen
s_add_u32 s42, s34, 278528
buffer_load_dword v60, v120, s[8:11], s42 offen
s_add_u32 s43, s34, 286720
buffer_load_dword v61, v120, s[8:11], s43 offen
s_add_u32 s44, s34, 311296
buffer_load_dword v62, v120, s[8:11], s44 offen
s_add_u32 s42, s34, 319488
buffer_load_dword v63, v120, s[8:11], s42 offen
s_add_u32 s42, s35, 0
buffer_load_dword v64, v120, s[8:11], s42 offen
s_add_u32 s43, s35, 8192
buffer_load_dword v65, v120, s[8:11], s43 offen
s_add_u32 s44, s35, 32768
buffer_load_dword v66, v120, s[8:11], s44 offen
s_add_u32 s42, s35, 40960
buffer_load_dword v67, v120, s[8:11], s42 offen
s_add_u32 s43, s35, 16384
buffer_load_dword v68, v120, s[8:11], s43 offen
s_add_u32 s44, s35, 24576
buffer_load_dword v69, v120, s[8:11], s44 offen
s_add_u32 s42, s35, 49152
buffer_load_dword v70, v120, s[8:11], s42 offen
s_add_u32 s43, s35, 57344
buffer_load_dword v71, v120, s[8:11], s43 offen
s_add_u32 s44, s35, 262144
buffer_load_dword v72, v120, s[8:11], s44 offen
s_add_u32 s42, s35, 270336
buffer_load_dword v73, v120, s[8:11], s42 offen
s_add_u32 s43, s35, 294912
buffer_load_dword v74, v120, s[8:11], s43 offen
s_add_u32 s44, s35, 303104
buffer_load_dword v75, v120, s[8:11], s44 offen
s_add_u32 s42, s35, 278528
buffer_load_dword v76, v120, s[8:11], s42 offen
s_add_u32 s43, s35, 286720
buffer_load_dword v77, v120, s[8:11], s43 offen
s_add_u32 s44, s35, 311296
buffer_load_dword v78, v120, s[8:11], s44 offen
s_add_u32 s42, s35, 319488
buffer_load_dword v79, v120, s[8:11], s42 offen
s_waitcnt vmcnt(48)
v_perm_b32 v84, v17, v16, s40
v_accvgpr_write_b32 a0, v84
v_perm_b32 v85, v17, v16, s41
v_accvgpr_write_b32 a64, v85
v_perm_b32 v86, v19, v18, s40
v_accvgpr_write_b32 a1, v86
v_perm_b32 v87, v19, v18, s41
v_accvgpr_write_b32 a65, v87
v_perm_b32 v88, v21, v20, s40
v_accvgpr_write_b32 a2, v88
v_perm_b32 v89, v21, v20, s41
v_accvgpr_write_b32 a66, v89
v_perm_b32 v90, v23, v22, s40
v_accvgpr_write_b32 a3, v90
v_perm_b32 v91, v23, v22, s41
v_accvgpr_write_b32 a67, v91
v_perm_b32 v84, v25, v24, s40
v_accvgpr_write_b32 a4, v84
v_perm_b32 v85, v25, v24, s41
v_accvgpr_write_b32 a68, v85
v_perm_b32 v86, v27, v26, s40
v_accvgpr_write_b32 a5, v86
v_perm_b32 v87, v27, v26, s41
v_accvgpr_write_b32 a69, v87
v_perm_b32 v88, v29, v28, s40
v_accvgpr_write_b32 a6, v88
v_perm_b32 v89, v29, v28, s41
v_accvgpr_write_b32 a70, v89
v_perm_b32 v90, v31, v30, s40
v_accvgpr_write_b32 a7, v90
v_perm_b32 v91, v31, v30, s41
v_accvgpr_write_b32 a71, v91
s_add_u32 s42, s36, 0
buffer_load_dword v16, v120, s[8:11], s42 offen
s_add_u32 s43, s36, 8192
buffer_load_dword v17, v120, s[8:11], s43 offen
s_add_u32 s44, s36, 32768
buffer_load_dword v18, v120, s[8:11], s44 offen
s_add_u32 s42, s36, 40960
buffer_load_dword v19, v120, s[8:11], s42 offen
s_add_u32 s43, s36, 16384
buffer_load_dword v20, v120, s[8:11], s43 offen
s_add_u32 s44, s36, 24576
buffer_load_dword v21, v120, s[8:11], s44 offen
s_add_u32 s42, s36, 49152
buffer_load_dword v22, v120, s[8:11], s42 offen
s_add_u32 s43, s36, 57344
buffer_load_dword v23, v120, s[8:11], s43 offen
s_add_u32 s44, s36, 262144
buffer_load_dword v24, v120, s[8:11], s44 offen
s_add_u32 s42, s36, 270336
buffer_load_dword v25, v120, s[8:11], s42 offen
s_add_u32 s43, s36, 294912
buffer_load_dword v26, v120, s[8:11], s43 offen
s_add_u32 s44, s36, 303104
buffer_load_dword v27, v120, s[8:11], s44 offen
s_add_u32 s42, s36, 278528
buffer_load_dword v28, v120, s[8:11], s42 offen
s_add_u32 s43, s36, 286720
buffer_load_dword v29, v120, s[8:11], s43 offen
s_add_u32 s44, s36, 311296
buffer_load_dword v30, v120, s[8:11], s44 offen
s_add_u32 s42, s36, 319488
buffer_load_dword v31, v120, s[8:11], s42 offen
s_waitcnt vmcnt(48)
v_perm_b32 v84, v33, v32, s40
v_accvgpr_write_b32 a8, v84
v_perm_b32 v85, v33, v32, s41
v_accvgpr_write_b32 a72, v85
v_perm_b32 v86, v35, v34, s40
v_accvgpr_write_b32 a9, v86
v_perm_b32 v87, v35, v34, s41
v_accvgpr_write_b32 a73, v87
v_perm_b32 v88, v37, v36, s40
v_accvgpr_write_b32 a10, v88
v_perm_b32 v89, v37, v36, s41
v_accvgpr_write_b32 a74, v89
v_perm_b32 v90, v39, v38, s40
v_accvgpr_write_b32 a11, v90
v_perm_b32 v91, v39, v38, s41
v_accvgpr_write_b32 a75, v91
v_perm_b32 v84, v41, v40, s40
v_accvgpr_write_b32 a12, v84
v_perm_b32 v85, v41, v40, s41
v_accvgpr_write_b32 a76, v85
v_perm_b32 v86, v43, v42, s40
v_accvgpr_write_b32 a13, v86
v_perm_b32 v87, v43, v42, s41
v_accvgpr_write_b32 a77, v87
v_perm_b32 v88, v45, v44, s40
v_accvgpr_write_b32 a14, v88
v_perm_b32 v89, v45, v44, s41
v_accvgpr_write_b32 a78, v89
v_perm_b32 v90, v47, v46, s40
v_accvgpr_write_b32 a15, v90
v_perm_b32 v91, v47, v46, s41
v_accvgpr_write_b32 a79, v91
s_add_u32 s42, s37, 0
buffer_load_dword v32, v120, s[8:11], s42 offen
s_add_u32 s43, s37, 8192
buffer_load_dword v33, v120, s[8:11], s43 offen
s_add_u32 s44, s37, 32768
buffer_load_dword v34, v120, s[8:11], s44 offen
s_add_u32 s42, s37, 40960
buffer_load_dword v35, v120, s[8:11], s42 offen
s_add_u32 s43, s37, 16384
buffer_load_dword v36, v120, s[8:11], s43 offen
s_add_u32 s44, s37, 24576
buffer_load_dword v37, v120, s[8:11], s44 offen
s_add_u32 s42, s37, 49152
buffer_load_dword v38, v120, s[8:11], s42 offen
s_add_u32 s43, s37, 57344
buffer_load_dword v39, v120, s[8:11], s43 offen
s_add_u32 s44, s37, 262144
buffer_load_dword v40, v120, s[8:11], s44 offen
s_add_u32 s42, s37, 270336
buffer_load_dword v41, v120, s[8:11], s42 offen
s_add_u32 s43, s37, 294912
buffer_load_dword v42, v120, s[8:11], s43 offen
s_add_u32 s44, s37, 303104
buffer_load_dword v43, v120, s[8:11], s44 offen
s_add_u32 s42, s37, 278528
buffer_load_dword v44, v120, s[8:11], s42 offen
s_add_u32 s43, s37, 286720
buffer_load_dword v45, v120, s[8:11], s43 offen
s_add_u32 s44, s37, 311296
buffer_load_dword v46, v120, s[8:11], s44 offen
s_add_u32 s42, s37, 319488
buffer_load_dword v47, v120, s[8:11], s42 offen
s_waitcnt vmcnt(48)
v_perm_b32 v84, v49, v48, s40
v_accvgpr_write_b32 a16, v84
v_perm_b32 v85, v49, v48, s41
v_accvgpr_write_b32 a80, v85
v_perm_b32 v86, v51, v50, s40
v_accvgpr_write_b32 a17, v86
v_perm_b32 v87, v51, v50, s41
v_accvgpr_write_b32 a81, v87
v_perm_b32 v88, v53, v52, s40
v_accvgpr_write_b32 a18, v88
v_perm_b32 v89, v53, v52, s41
v_accvgpr_write_b32 a82, v89
v_perm_b32 v90, v55, v54, s40
v_accvgpr_write_b32 a19, v90
v_perm_b32 v91, v55, v54, s41
v_accvgpr_write_b32 a83, v91
v_perm_b32 v84, v57, v56, s40
v_accvgpr_write_b32 a20, v84
v_perm_b32 v85, v57, v56, s41
v_accvgpr_write_b32 a84, v85
v_perm_b32 v86, v59, v58, s40
v_accvgpr_write_b32 a21, v86
v_perm_b32 v87, v59, v58, s41
v_accvgpr_write_b32 a85, v87
v_perm_b32 v88, v61, v60, s40
v_accvgpr_write_b32 a22, v88
v_perm_b32 v89, v61, v60, s41
v_accvgpr_write_b32 a86, v89
v_perm_b32 v90, v63, v62, s40
v_accvgpr_write_b32 a23, v90
v_perm_b32 v91, v63, v62, s41
v_accvgpr_write_b32 a87, v91
s_add_u32 s42, s38, 0
buffer_load_dword v48, v120, s[8:11], s42 offen
s_add_u32 s43, s38, 8192
buffer_load_dword v49, v120, s[8:11], s43 offen
s_add_u32 s44, s38, 32768
buffer_load_dword v50, v120, s[8:11], s44 offen
s_add_u32 s42, s38, 40960
buffer_load_dword v51, v120, s[8:11], s42 offen
s_add_u32 s43, s38, 16384
buffer_load_dword v52, v120, s[8:11], s43 offen
s_add_u32 s44, s38, 24576
buffer_load_dword v53, v120, s[8:11], s44 offen
s_add_u32 s42, s38, 49152
buffer_load_dword v54, v120, s[8:11], s42 offen
s_add_u32 s43, s38, 57344
buffer_load_dword v55, v120, s[8:11], s43 offen
s_add_u32 s44, s38, 262144
buffer_load_dword v56, v120, s[8:11], s44 offen
s_add_u32 s42, s38, 270336
buffer_load_dword v57, v120, s[8:11], s42 offen
s_add_u32 s43, s38, 294912
buffer_load_dword v58, v120, s[8:11], s43 offen
s_add_u32 s44, s38, 303104
buffer_load_dword v59, v120, s[8:11], s44 offen
s_add_u32 s42, s38, 278528
buffer_load_dword v60, v120, s[8:11], s42 offen
s_add_u32 s43, s38, 286720
buffer_load_dword v61, v120, s[8:11], s43 offen
s_add_u32 s44, s38, 311296
buffer_load_dword v62, v120, s[8:11], s44 offen
s_add_u32 s42, s38, 319488
buffer_load_dword v63, v120, s[8:11], s42 offen
s_waitcnt vmcnt(48)
v_perm_b32 v84, v65, v64, s40
v_accvgpr_write_b32 a24, v84
v_perm_b32 v85, v65, v64, s41
v_accvgpr_write_b32 a88, v85
v_perm_b32 v86, v67, v66, s40
v_accvgpr_write_b32 a25, v86
v_perm_b32 v87, v67, v66, s41
v_accvgpr_write_b32 a89, v87
v_perm_b32 v88, v69, v68, s40
v_accvgpr_write_b32 a26, v88
v_perm_b32 v89, v69, v68, s41
v_accvgpr_write_b32 a90, v89
v_perm_b32 v90, v71, v70, s40
v_accvgpr_write_b32 a27, v90
v_perm_b32 v91, v71, v70, s41
v_accvgpr_write_b32 a91, v91
v_perm_b32 v84, v73, v72, s40
v_accvgpr_write_b32 a28, v84
v_perm_b32 v85, v73, v72, s41
v_accvgpr_write_b32 a92, v85
v_perm_b32 v86, v75, v74, s40
v_accvgpr_write_b32 a29, v86
v_perm_b32 v87, v75, v74, s41
v_accvgpr_write_b32 a93, v87
v_perm_b32 v88, v77, v76, s40
v_accvgpr_write_b32 a30, v88
v_perm_b32 v89, v77, v76, s41
v_accvgpr_write_b32 a94, v89
v_perm_b32 v90, v79, v78, s40
v_accvgpr_write_b32 a31, v90
v_perm_b32 v91, v79, v78, s41
v_accvgpr_write_b32 a95, v91
s_add_u32 s42, s39, 0
buffer_load_dword v64, v120, s[8:11], s42 offen
s_add_u32 s43, s39, 8192
buffer_load_dword v65, v120, s[8:11], s43 offen
s_add_u32 s44, s39, 32768
buffer_load_dword v66, v120, s[8:11], s44 offen
s_add_u32 s42, s39, 40960
buffer_load_dword v67, v120, s[8:11], s42 offen
s_add_u32 s43, s39, 16384
buffer_load_dword v68, v120, s[8:11], s43 offen
s_add_u32 s44, s39, 24576
buffer_load_dword v69, v120, s[8:11], s44 offen
s_add_u32 s42, s39, 49152
buffer_load_dword v70, v120, s[8:11], s42 offen
s_add_u32 s43, s39, 57344
buffer_load_dword v71, v120, s[8:11], s43 offen
s_add_u32 s44, s39, 262144
buffer_load_dword v72, v120, s[8:11], s44 offen
s_add_u32 s42, s39, 270336
buffer_load_dword v73, v120, s[8:11], s42 offen
s_add_u32 s43, s39, 294912
buffer_load_dword v74, v120, s[8:11], s43 offen
s_add_u32 s44, s39, 303104
buffer_load_dword v75, v120, s[8:11], s44 offen
s_add_u32 s42, s39, 278528
buffer_load_dword v76, v120, s[8:11], s42 offen
s_add_u32 s43, s39, 286720
buffer_load_dword v77, v120, s[8:11], s43 offen
s_add_u32 s44, s39, 311296
buffer_load_dword v78, v120, s[8:11], s44 offen
s_add_u32 s42, s39, 319488
buffer_load_dword v79, v120, s[8:11], s42 offen
s_waitcnt vmcnt(48)
v_perm_b32 v84, v17, v16, s40
v_accvgpr_write_b32 a32, v84
v_perm_b32 v85, v17, v16, s41
v_accvgpr_write_b32 a96, v85
v_perm_b32 v86, v19, v18, s40
v_accvgpr_write_b32 a33, v86
v_perm_b32 v87, v19, v18, s41
v_accvgpr_write_b32 a97, v87
v_perm_b32 v88, v21, v20, s40
v_accvgpr_write_b32 a34, v88
v_perm_b32 v89, v21, v20, s41
v_accvgpr_write_b32 a98, v89
v_perm_b32 v90, v23, v22, s40
v_accvgpr_write_b32 a35, v90
v_perm_b32 v91, v23, v22, s41
v_accvgpr_write_b32 a99, v91
v_perm_b32 v84, v25, v24, s40
v_accvgpr_write_b32 a36, v84
v_perm_b32 v85, v25, v24, s41
v_accvgpr_write_b32 a100, v85
v_perm_b32 v86, v27, v26, s40
v_accvgpr_write_b32 a37, v86
v_perm_b32 v87, v27, v26, s41
v_accvgpr_write_b32 a101, v87
v_perm_b32 v88, v29, v28, s40
v_accvgpr_write_b32 a38, v88
v_perm_b32 v89, v29, v28, s41
v_accvgpr_write_b32 a102, v89
v_perm_b32 v90, v31, v30, s40
v_accvgpr_write_b32 a39, v90
v_perm_b32 v91, v31, v30, s41
v_accvgpr_write_b32 a103, v91
s_add_u32 s42, s32, 0
buffer_load_dword v16, v120, s[12:15], s42 offen
s_add_u32 s43, s32, 8192
buffer_load_dword v17, v120, s[12:15], s43 offen
s_add_u32 s44, s32, 32768
buffer_load_dword v18, v120, s[12:15], s44 offen
s_add_u32 s42, s32, 40960
buffer_load_dword v19, v120, s[12:15], s42 offen
s_add_u32 s43, s32, 16384
buffer_load_dword v20, v120, s[12:15], s43 offen
s_add_u32 s44, s32, 24576
buffer_load_dword v21, v120, s[12:15], s44 offen
s_add_u32 s42, s32, 49152
buffer_load_dword v22, v120, s[12:15], s42 offen
s_add_u32 s43, s32, 57344
buffer_load_dword v23, v120, s[12:15], s43 offen
s_add_u32 s44, s32, 262144
buffer_load_dword v24, v120, s[12:15], s44 offen
s_add_u32 s42, s32, 270336
buffer_load_dword v25, v120, s[12:15], s42 offen
s_add_u32 s43, s32, 294912
buffer_load_dword v26, v120, s[12:15], s43 offen
s_add_u32 s44, s32, 303104
buffer_load_dword v27, v120, s[12:15], s44 offen
s_add_u32 s42, s32, 278528
buffer_load_dword v28, v120, s[12:15], s42 offen
s_add_u32 s43, s32, 286720
buffer_load_dword v29, v120, s[12:15], s43 offen
s_add_u32 s44, s32, 311296
buffer_load_dword v30, v120, s[12:15], s44 offen
s_add_u32 s42, s32, 319488
buffer_load_dword v31, v120, s[12:15], s42 offen
s_waitcnt vmcnt(48)
v_perm_b32 v84, v33, v32, s40
v_accvgpr_write_b32 a40, v84
v_perm_b32 v85, v33, v32, s41
v_accvgpr_write_b32 a104, v85
v_perm_b32 v86, v35, v34, s40
v_accvgpr_write_b32 a41, v86
v_perm_b32 v87, v35, v34, s41
v_accvgpr_write_b32 a105, v87
v_perm_b32 v88, v37, v36, s40
v_accvgpr_write_b32 a42, v88
v_perm_b32 v89, v37, v36, s41
v_accvgpr_write_b32 a106, v89
v_perm_b32 v90, v39, v38, s40
v_accvgpr_write_b32 a43, v90
v_perm_b32 v91, v39, v38, s41
v_accvgpr_write_b32 a107, v91
v_perm_b32 v84, v41, v40, s40
v_accvgpr_write_b32 a44, v84
v_perm_b32 v85, v41, v40, s41
v_accvgpr_write_b32 a108, v85
v_perm_b32 v86, v43, v42, s40
v_accvgpr_write_b32 a45, v86
v_perm_b32 v87, v43, v42, s41
v_accvgpr_write_b32 a109, v87
v_perm_b32 v88, v45, v44, s40
v_accvgpr_write_b32 a46, v88
v_perm_b32 v89, v45, v44, s41
v_accvgpr_write_b32 a110, v89
v_perm_b32 v90, v47, v46, s40
v_accvgpr_write_b32 a47, v90
v_perm_b32 v91, v47, v46, s41
v_accvgpr_write_b32 a111, v91
s_add_u32 s42, s33, 0
buffer_load_dword v32, v120, s[12:15], s42 offen
s_add_u32 s43, s33, 8192
buffer_load_dword v33, v120, s[12:15], s43 offen
s_add_u32 s44, s33, 32768
buffer_load_dword v34, v120, s[12:15], s44 offen
s_add_u32 s42, s33, 40960
buffer_load_dword v35, v120, s[12:15], s42 offen
s_add_u32 s43, s33, 16384
buffer_load_dword v36, v120, s[12:15], s43 offen
s_add_u32 s44, s33, 24576
buffer_load_dword v37, v120, s[12:15], s44 offen
s_add_u32 s42, s33, 49152
buffer_load_dword v38, v120, s[12:15], s42 offen
s_add_u32 s43, s33, 57344
buffer_load_dword v39, v120, s[12:15], s43 offen
s_add_u32 s44, s33, 262144
buffer_load_dword v40, v120, s[12:15], s44 offen
s_add_u32 s42, s33, 270336
buffer_load_dword v41, v120, s[12:15], s42 offen
s_add_u32 s43, s33, 294912
buffer_load_dword v42, v120, s[12:15], s43 offen
s_add_u32 s44, s33, 303104
buffer_load_dword v43, v120, s[12:15], s44 offen
s_add_u32 s42, s33, 278528
buffer_load_dword v44, v120, s[12:15], s42 offen
s_add_u32 s43, s33, 286720
buffer_load_dword v45, v120, s[12:15], s43 offen
s_add_u32 s44, s33, 311296
buffer_load_dword v46, v120, s[12:15], s44 offen
s_add_u32 s42, s33, 319488
buffer_load_dword v47, v120, s[12:15], s42 offen
s_waitcnt vmcnt(48)
v_perm_b32 v84, v49, v48, s40
v_accvgpr_write_b32 a48, v84
v_perm_b32 v85, v49, v48, s41
v_accvgpr_write_b32 a112, v85
v_perm_b32 v86, v51, v50, s40
v_accvgpr_write_b32 a49, v86
v_perm_b32 v87, v51, v50, s41
v_accvgpr_write_b32 a113, v87
v_perm_b32 v88, v53, v52, s40
v_accvgpr_write_b32 a50, v88
v_perm_b32 v89, v53, v52, s41
v_accvgpr_write_b32 a114, v89
v_perm_b32 v90, v55, v54, s40
v_accvgpr_write_b32 a51, v90
v_perm_b32 v91, v55, v54, s41
v_accvgpr_write_b32 a115, v91
v_perm_b32 v84, v57, v56, s40
v_accvgpr_write_b32 a52, v84
v_perm_b32 v85, v57, v56, s41
v_accvgpr_write_b32 a116, v85
v_perm_b32 v86, v59, v58, s40
v_accvgpr_write_b32 a53, v86
v_perm_b32 v87, v59, v58, s41
v_accvgpr_write_b32 a117, v87
v_perm_b32 v88, v61, v60, s40
v_accvgpr_write_b32 a54, v88
v_perm_b32 v89, v61, v60, s41
v_accvgpr_write_b32 a118, v89
v_perm_b32 v90, v63, v62, s40
v_accvgpr_write_b32 a55, v90
v_perm_b32 v91, v63, v62, s41
v_accvgpr_write_b32 a119, v91
s_add_u32 s42, s34, 0
buffer_load_dword v48, v120, s[12:15], s42 offen
s_add_u32 s43, s34, 8192
buffer_load_dword v49, v120, s[12:15], s43 offen
s_add_u32 s44, s34, 32768
buffer_load_dword v50, v120, s[12:15], s44 offen
s_add_u32 s42, s34, 40960
buffer_load_dword v51, v120, s[12:15], s42 offen
s_add_u32 s43, s34, 16384
buffer_load_dword v52, v120, s[12:15], s43 offen
s_add_u32 s44, s34, 24576
buffer_load_dword v53, v120, s[12:15], s44 offen
s_add_u32 s42, s34, 49152
buffer_load_dword v54, v120, s[12:15], s42 offen
s_add_u32 s43, s34, 57344
buffer_load_dword v55, v120, s[12:15], s43 offen
s_add_u32 s44, s34, 262144
buffer_load_dword v56, v120, s[12:15], s44 offen
s_add_u32 s42, s34, 270336
buffer_load_dword v57, v120, s[12:15], s42 offen
s_add_u32 s43, s34, 294912
buffer_load_dword v58, v120, s[12:15], s43 offen
s_add_u32 s44, s34, 303104
buffer_load_dword v59, v120, s[12:15], s44 offen
s_add_u32 s42, s34, 278528
buffer_load_dword v60, v120, s[12:15], s42 offen
s_add_u32 s43, s34, 286720
buffer_load_dword v61, v120, s[12:15], s43 offen
s_add_u32 s44, s34, 311296
buffer_load_dword v62, v120, s[12:15], s44 offen
s_add_u32 s42, s34, 319488
buffer_load_dword v63, v120, s[12:15], s42 offen
s_waitcnt vmcnt(48)
v_perm_b32 v84, v65, v64, s40
v_accvgpr_write_b32 a56, v84
v_perm_b32 v85, v65, v64, s41
v_accvgpr_write_b32 a120, v85
v_perm_b32 v86, v67, v66, s40
v_accvgpr_write_b32 a57, v86
v_perm_b32 v87, v67, v66, s41
v_accvgpr_write_b32 a121, v87
v_perm_b32 v88, v69, v68, s40
v_accvgpr_write_b32 a58, v88
v_perm_b32 v89, v69, v68, s41
v_accvgpr_write_b32 a122, v89
v_perm_b32 v90, v71, v70, s40
v_accvgpr_write_b32 a59, v90
v_perm_b32 v91, v71, v70, s41
v_accvgpr_write_b32 a123, v91
v_perm_b32 v84, v73, v72, s40
v_accvgpr_write_b32 a60, v84
v_perm_b32 v85, v73, v72, s41
v_accvgpr_write_b32 a124, v85
v_perm_b32 v86, v75, v74, s40
v_accvgpr_write_b32 a61, v86
v_perm_b32 v87, v75, v74, s41
v_accvgpr_write_b32 a125, v87
v_perm_b32 v88, v77, v76, s40
v_accvgpr_write_b32 a62, v88
v_perm_b32 v89, v77, v76, s41
v_accvgpr_write_b32 a126, v89
v_perm_b32 v90, v79, v78, s40
v_accvgpr_write_b32 a63, v90
v_perm_b32 v91, v79, v78, s41
v_accvgpr_write_b32 a127, v91
s_add_u32 s42, s35, 0
buffer_load_dword v64, v120, s[12:15], s42 offen
s_add_u32 s43, s35, 8192
buffer_load_dword v65, v120, s[12:15], s43 offen
s_add_u32 s44, s35, 32768
buffer_load_dword v66, v120, s[12:15], s44 offen
s_add_u32 s42, s35, 40960
buffer_load_dword v67, v120, s[12:15], s42 offen
s_add_u32 s43, s35, 16384
buffer_load_dword v68, v120, s[12:15], s43 offen
s_add_u32 s44, s35, 24576
buffer_load_dword v69, v120, s[12:15], s44 offen
s_add_u32 s42, s35, 49152
buffer_load_dword v70, v120, s[12:15], s42 offen
s_add_u32 s43, s35, 57344
buffer_load_dword v71, v120, s[12:15], s43 offen
s_add_u32 s44, s35, 262144
buffer_load_dword v72, v120, s[12:15], s44 offen
s_add_u32 s42, s35, 270336
buffer_load_dword v73, v120, s[12:15], s42 offen
s_add_u32 s43, s35, 294912
buffer_load_dword v74, v120, s[12:15], s43 offen
s_add_u32 s44, s35, 303104
buffer_load_dword v75, v120, s[12:15], s44 offen
s_add_u32 s42, s35, 278528
buffer_load_dword v76, v120, s[12:15], s42 offen
s_add_u32 s43, s35, 286720
buffer_load_dword v77, v120, s[12:15], s43 offen
s_add_u32 s44, s35, 311296
buffer_load_dword v78, v120, s[12:15], s44 offen
s_add_u32 s42, s35, 319488
buffer_load_dword v79, v120, s[12:15], s42 offen
s_waitcnt vmcnt(48)
v_perm_b32 v84, v17, v16, s40
v_accvgpr_write_b32 a128, v84
v_perm_b32 v85, v17, v16, s41
v_accvgpr_write_b32 a192, v85
v_perm_b32 v86, v19, v18, s40
v_accvgpr_write_b32 a129, v86
v_perm_b32 v87, v19, v18, s41
v_accvgpr_write_b32 a193, v87
v_perm_b32 v88, v21, v20, s40
v_accvgpr_write_b32 a130, v88
v_perm_b32 v89, v21, v20, s41
v_accvgpr_write_b32 a194, v89
v_perm_b32 v90, v23, v22, s40
v_accvgpr_write_b32 a131, v90
v_perm_b32 v91, v23, v22, s41
v_accvgpr_write_b32 a195, v91
v_perm_b32 v84, v25, v24, s40
v_accvgpr_write_b32 a132, v84
v_perm_b32 v85, v25, v24, s41
v_accvgpr_write_b32 a196, v85
v_perm_b32 v86, v27, v26, s40
v_accvgpr_write_b32 a133, v86
v_perm_b32 v87, v27, v26, s41
v_accvgpr_write_b32 a197, v87
v_perm_b32 v88, v29, v28, s40
v_accvgpr_write_b32 a134, v88
v_perm_b32 v89, v29, v28, s41
v_accvgpr_write_b32 a198, v89
v_perm_b32 v90, v31, v30, s40
v_accvgpr_write_b32 a135, v90
v_perm_b32 v91, v31, v30, s41
v_accvgpr_write_b32 a199, v91
s_add_u32 s42, s36, 0
buffer_load_dword v16, v120, s[12:15], s42 offen
s_add_u32 s43, s36, 8192
buffer_load_dword v17, v120, s[12:15], s43 offen
s_add_u32 s44, s36, 32768
buffer_load_dword v18, v120, s[12:15], s44 offen
s_add_u32 s42, s36, 40960
buffer_load_dword v19, v120, s[12:15], s42 offen
s_add_u32 s43, s36, 16384
buffer_load_dword v20, v120, s[12:15], s43 offen
s_add_u32 s44, s36, 24576
buffer_load_dword v21, v120, s[12:15], s44 offen
s_add_u32 s42, s36, 49152
buffer_load_dword v22, v120, s[12:15], s42 offen
s_add_u32 s43, s36, 57344
buffer_load_dword v23, v120, s[12:15], s43 offen
s_add_u32 s44, s36, 262144
buffer_load_dword v24, v120, s[12:15], s44 offen
s_add_u32 s42, s36, 270336
buffer_load_dword v25, v120, s[12:15], s42 offen
s_add_u32 s43, s36, 294912
buffer_load_dword v26, v120, s[12:15], s43 offen
s_add_u32 s44, s36, 303104
buffer_load_dword v27, v120, s[12:15], s44 offen
s_add_u32 s42, s36, 278528
buffer_load_dword v28, v120, s[12:15], s42 offen
s_add_u32 s43, s36, 286720
buffer_load_dword v29, v120, s[12:15], s43 offen
s_add_u32 s44, s36, 311296
buffer_load_dword v30, v120, s[12:15], s44 offen
s_add_u32 s42, s36, 319488
buffer_load_dword v31, v120, s[12:15], s42 offen
s_waitcnt vmcnt(48)
v_perm_b32 v84, v33, v32, s40
v_accvgpr_write_b32 a136, v84
v_perm_b32 v85, v33, v32, s41
v_accvgpr_write_b32 a200, v85
v_perm_b32 v86, v35, v34, s40
v_accvgpr_write_b32 a137, v86
v_perm_b32 v87, v35, v34, s41
v_accvgpr_write_b32 a201, v87
v_perm_b32 v88, v37, v36, s40
v_accvgpr_write_b32 a138, v88
v_perm_b32 v89, v37, v36, s41
v_accvgpr_write_b32 a202, v89
v_perm_b32 v90, v39, v38, s40
v_accvgpr_write_b32 a139, v90
v_perm_b32 v91, v39, v38, s41
v_accvgpr_write_b32 a203, v91
v_perm_b32 v84, v41, v40, s40
v_accvgpr_write_b32 a140, v84
v_perm_b32 v85, v41, v40, s41
v_accvgpr_write_b32 a204, v85
v_perm_b32 v86, v43, v42, s40
v_accvgpr_write_b32 a141, v86
v_perm_b32 v87, v43, v42, s41
v_accvgpr_write_b32 a205, v87
v_perm_b32 v88, v45, v44, s40
v_accvgpr_write_b32 a142, v88
v_perm_b32 v89, v45, v44, s41
v_accvgpr_write_b32 a206, v89
v_perm_b32 v90, v47, v46, s40
v_accvgpr_write_b32 a143, v90
v_perm_b32 v91, v47, v46, s41
v_accvgpr_write_b32 a207, v91
s_add_u32 s42, s37, 0
buffer_load_dword v32, v120, s[12:15], s42 offen
s_add_u32 s43, s37, 8192
buffer_load_dword v33, v120, s[12:15], s43 offen
s_add_u32 s44, s37, 32768
buffer_load_dword v34, v120, s[12:15], s44 offen
s_add_u32 s42, s37, 40960
buffer_load_dword v35, v120, s[12:15], s42 offen
s_add_u32 s43, s37, 16384
buffer_load_dword v36, v120, s[12:15], s43 offen
s_add_u32 s44, s37, 24576
buffer_load_dword v37, v120, s[12:15], s44 offen
s_add_u32 s42, s37, 49152
buffer_load_dword v38, v120, s[12:15], s42 offen
s_add_u32 s43, s37, 57344
buffer_load_dword v39, v120, s[12:15], s43 offen
s_add_u32 s44, s37, 262144
buffer_load_dword v40, v120, s[12:15], s44 offen
s_add_u32 s42, s37, 270336
buffer_load_dword v41, v120, s[12:15], s42 offen
s_add_u32 s43, s37, 294912
buffer_load_dword v42, v120, s[12:15], s43 offen
s_add_u32 s44, s37, 303104
buffer_load_dword v43, v120, s[12:15], s44 offen
s_add_u32 s42, s37, 278528
buffer_load_dword v44, v120, s[12:15], s42 offen
s_add_u32 s43, s37, 286720
buffer_load_dword v45, v120, s[12:15], s43 offen
s_add_u32 s44, s37, 311296
buffer_load_dword v46, v120, s[12:15], s44 offen
s_add_u32 s42, s37, 319488
buffer_load_dword v47, v120, s[12:15], s42 offen
s_waitcnt vmcnt(48)
v_perm_b32 v84, v49, v48, s40
v_accvgpr_write_b32 a144, v84
v_perm_b32 v85, v49, v48, s41
v_accvgpr_write_b32 a208, v85
v_perm_b32 v86, v51, v50, s40
v_accvgpr_write_b32 a145, v86
v_perm_b32 v87, v51, v50, s41
v_accvgpr_write_b32 a209, v87
v_perm_b32 v88, v53, v52, s40
v_accvgpr_write_b32 a146, v88
v_perm_b32 v89, v53, v52, s41
v_accvgpr_write_b32 a210, v89
v_perm_b32 v90, v55, v54, s40
v_accvgpr_write_b32 a147, v90
v_perm_b32 v91, v55, v54, s41
v_accvgpr_write_b32 a211, v91
v_perm_b32 v84, v57, v56, s40
v_accvgpr_write_b32 a148, v84
v_perm_b32 v85, v57, v56, s41
v_accvgpr_write_b32 a212, v85
v_perm_b32 v86, v59, v58, s40
v_accvgpr_write_b32 a149, v86
v_perm_b32 v87, v59, v58, s41
v_accvgpr_write_b32 a213, v87
v_perm_b32 v88, v61, v60, s40
v_accvgpr_write_b32 a150, v88
v_perm_b32 v89, v61, v60, s41
v_accvgpr_write_b32 a214, v89
v_perm_b32 v90, v63, v62, s40
v_accvgpr_write_b32 a151, v90
v_perm_b32 v91, v63, v62, s41
v_accvgpr_write_b32 a215, v91
s_add_u32 s42, s38, 0
buffer_load_dword v48, v120, s[12:15], s42 offen
s_add_u32 s43, s38, 8192
buffer_load_dword v49, v120, s[12:15], s43 offen
s_add_u32 s44, s38, 32768
buffer_load_dword v50, v120, s[12:15], s44 offen
s_add_u32 s42, s38, 40960
buffer_load_dword v51, v120, s[12:15], s42 offen
s_add_u32 s43, s38, 16384
buffer_load_dword v52, v120, s[12:15], s43 offen
s_add_u32 s44, s38, 24576
buffer_load_dword v53, v120, s[12:15], s44 offen
s_add_u32 s42, s38, 49152
buffer_load_dword v54, v120, s[12:15], s42 offen
s_add_u32 s43, s38, 57344
buffer_load_dword v55, v120, s[12:15], s43 offen
s_add_u32 s44, s38, 262144
buffer_load_dword v56, v120, s[12:15], s44 offen
s_add_u32 s42, s38, 270336
buffer_load_dword v57, v120, s[12:15], s42 offen
s_add_u32 s43, s38, 294912
buffer_load_dword v58, v120, s[12:15], s43 offen
s_add_u32 s44, s38, 303104
buffer_load_dword v59, v120, s[12:15], s44 offen
s_add_u32 s42, s38, 278528
buffer_load_dword v60, v120, s[12:15], s42 offen
s_add_u32 s43, s38, 286720
buffer_load_dword v61, v120, s[12:15], s43 offen
s_add_u32 s44, s38, 311296
buffer_load_dword v62, v120, s[12:15], s44 offen
s_add_u32 s42, s38, 319488
buffer_load_dword v63, v120, s[12:15], s42 offen
s_waitcnt vmcnt(48)
v_perm_b32 v84, v65, v64, s40
v_accvgpr_write_b32 a152, v84
v_perm_b32 v85, v65, v64, s41
v_accvgpr_write_b32 a216, v85
v_perm_b32 v86, v67, v66, s40
v_accvgpr_write_b32 a153, v86
v_perm_b32 v87, v67, v66, s41
v_accvgpr_write_b32 a217, v87
v_perm_b32 v88, v69, v68, s40
v_accvgpr_write_b32 a154, v88
v_perm_b32 v89, v69, v68, s41
v_accvgpr_write_b32 a218, v89
v_perm_b32 v90, v71, v70, s40
v_accvgpr_write_b32 a155, v90
v_perm_b32 v91, v71, v70, s41
v_accvgpr_write_b32 a219, v91
v_perm_b32 v84, v73, v72, s40
v_accvgpr_write_b32 a156, v84
v_perm_b32 v85, v73, v72, s41
v_accvgpr_write_b32 a220, v85
v_perm_b32 v86, v75, v74, s40
v_accvgpr_write_b32 a157, v86
v_perm_b32 v87, v75, v74, s41
v_accvgpr_write_b32 a221, v87
v_perm_b32 v88, v77, v76, s40
v_accvgpr_write_b32 a158, v88
v_perm_b32 v89, v77, v76, s41
v_accvgpr_write_b32 a222, v89
v_perm_b32 v90, v79, v78, s40
v_accvgpr_write_b32 a159, v90
v_perm_b32 v91, v79, v78, s41
v_accvgpr_write_b32 a223, v91
s_add_u32 s42, s39, 0
buffer_load_dword v64, v120, s[12:15], s42 offen
s_add_u32 s43, s39, 8192
buffer_load_dword v65, v120, s[12:15], s43 offen
s_add_u32 s44, s39, 32768
buffer_load_dword v66, v120, s[12:15], s44 offen
s_add_u32 s42, s39, 40960
buffer_load_dword v67, v120, s[12:15], s42 offen
s_add_u32 s43, s39, 16384
buffer_load_dword v68, v120, s[12:15], s43 offen
s_add_u32 s44, s39, 24576
buffer_load_dword v69, v120, s[12:15], s44 offen
s_add_u32 s42, s39, 49152
buffer_load_dword v70, v120, s[12:15], s42 offen
s_add_u32 s43, s39, 57344
buffer_load_dword v71, v120, s[12:15], s43 offen
s_add_u32 s44, s39, 262144
buffer_load_dword v72, v120, s[12:15], s44 offen
s_add_u32 s42, s39, 270336
buffer_load_dword v73, v120, s[12:15], s42 offen
s_add_u32 s43, s39, 294912
buffer_load_dword v74, v120, s[12:15], s43 offen
s_add_u32 s44, s39, 303104
buffer_load_dword v75, v120, s[12:15], s44 offen
s_add_u32 s42, s39, 278528
buffer_load_dword v76, v120, s[12:15], s42 offen
s_add_u32 s43, s39, 286720
buffer_load_dword v77, v120, s[12:15], s43 offen
s_add_u32 s44, s39, 311296
buffer_load_dword v78, v120, s[12:15], s44 offen
s_add_u32 s42, s39, 319488
buffer_load_dword v79, v120, s[12:15], s42 offen
s_waitcnt vmcnt(48)
v_perm_b32 v84, v17, v16, s40
v_accvgpr_write_b32 a160, v84
v_perm_b32 v85, v17, v16, s41
v_accvgpr_write_b32 a224, v85
v_perm_b32 v86, v19, v18, s40
v_accvgpr_write_b32 a161, v86
v_perm_b32 v87, v19, v18, s41
v_accvgpr_write_b32 a225, v87
v_perm_b32 v88, v21, v20, s40
v_accvgpr_write_b32 a162, v88
v_perm_b32 v89, v21, v20, s41
v_accvgpr_write_b32 a226, v89
v_perm_b32 v90, v23, v22, s40
v_accvgpr_write_b32 a163, v90
v_perm_b32 v91, v23, v22, s41
v_accvgpr_write_b32 a227, v91
v_perm_b32 v84, v25, v24, s40
v_accvgpr_write_b32 a164, v84
v_perm_b32 v85, v25, v24, s41
v_accvgpr_write_b32 a228, v85
v_perm_b32 v86, v27, v26, s40
v_accvgpr_write_b32 a165, v86
v_perm_b32 v87, v27, v26, s41
v_accvgpr_write_b32 a229, v87
v_perm_b32 v88, v29, v28, s40
v_accvgpr_write_b32 a166, v88
v_perm_b32 v89, v29, v28, s41
v_accvgpr_write_b32 a230, v89
v_perm_b32 v90, v31, v30, s40
v_accvgpr_write_b32 a167, v90
v_perm_b32 v91, v31, v30, s41
v_accvgpr_write_b32 a231, v91
s_add_u32 s42, s32, 0
buffer_load_dword v16, v120, s[16:19], s42 offen
s_add_u32 s43, s32, 8192
buffer_load_dword v17, v120, s[16:19], s43 offen
s_add_u32 s44, s32, 32768
buffer_load_dword v18, v120, s[16:19], s44 offen
s_add_u32 s42, s32, 40960
buffer_load_dword v19, v120, s[16:19], s42 offen
s_add_u32 s43, s32, 16384
buffer_load_dword v20, v120, s[16:19], s43 offen
s_add_u32 s44, s32, 24576
buffer_load_dword v21, v120, s[16:19], s44 offen
s_add_u32 s42, s32, 49152
buffer_load_dword v22, v120, s[16:19], s42 offen
s_add_u32 s43, s32, 57344
buffer_load_dword v23, v120, s[16:19], s43 offen
s_add_u32 s44, s32, 262144
buffer_load_dword v24, v120, s[16:19], s44 offen
s_add_u32 s42, s32, 270336
buffer_load_dword v25, v120, s[16:19], s42 offen
s_add_u32 s43, s32, 294912
buffer_load_dword v26, v120, s[16:19], s43 offen
s_add_u32 s44, s32, 303104
buffer_load_dword v27, v120, s[16:19], s44 offen
s_add_u32 s42, s32, 278528
buffer_load_dword v28, v120, s[16:19], s42 offen
s_add_u32 s43, s32, 286720
buffer_load_dword v29, v120, s[16:19], s43 offen
s_add_u32 s44, s32, 311296
buffer_load_dword v30, v120, s[16:19], s44 offen
s_add_u32 s42, s32, 319488
buffer_load_dword v31, v120, s[16:19], s42 offen
s_waitcnt vmcnt(48)
v_perm_b32 v84, v33, v32, s40
v_accvgpr_write_b32 a168, v84
v_perm_b32 v85, v33, v32, s41
v_accvgpr_write_b32 a232, v85
v_perm_b32 v86, v35, v34, s40
v_accvgpr_write_b32 a169, v86
v_perm_b32 v87, v35, v34, s41
v_accvgpr_write_b32 a233, v87
v_perm_b32 v88, v37, v36, s40
v_accvgpr_write_b32 a170, v88
v_perm_b32 v89, v37, v36, s41
v_accvgpr_write_b32 a234, v89
v_perm_b32 v90, v39, v38, s40
v_accvgpr_write_b32 a171, v90
v_perm_b32 v91, v39, v38, s41
v_accvgpr_write_b32 a235, v91
v_perm_b32 v84, v41, v40, s40
v_accvgpr_write_b32 a172, v84
v_perm_b32 v85, v41, v40, s41
v_accvgpr_write_b32 a236, v85
v_perm_b32 v86, v43, v42, s40
v_accvgpr_write_b32 a173, v86
v_perm_b32 v87, v43, v42, s41
v_accvgpr_write_b32 a237, v87
v_perm_b32 v88, v45, v44, s40
v_accvgpr_write_b32 a174, v88
v_perm_b32 v89, v45, v44, s41
v_accvgpr_write_b32 a238, v89
v_perm_b32 v90, v47, v46, s40
v_accvgpr_write_b32 a175, v90
v_perm_b32 v91, v47, v46, s41
v_accvgpr_write_b32 a239, v91
s_add_u32 s42, s33, 0
buffer_load_dword v32, v120, s[16:19], s42 offen
s_add_u32 s43, s33, 8192
buffer_load_dword v33, v120, s[16:19], s43 offen
s_add_u32 s44, s33, 32768
buffer_load_dword v34, v120, s[16:19], s44 offen
s_add_u32 s42, s33, 40960
buffer_load_dword v35, v120, s[16:19], s42 offen
s_add_u32 s43, s33, 16384
buffer_load_dword v36, v120, s[16:19], s43 offen
s_add_u32 s44, s33, 24576
buffer_load_dword v37, v120, s[16:19], s44 offen
s_add_u32 s42, s33, 49152
buffer_load_dword v38, v120, s[16:19], s42 offen
s_add_u32 s43, s33, 57344
buffer_load_dword v39, v120, s[16:19], s43 offen
s_add_u32 s44, s33, 262144
buffer_load_dword v40, v120, s[16:19], s44 offen
s_add_u32 s42, s33, 270336
buffer_load_dword v41, v120, s[16:19], s42 offen
s_add_u32 s43, s33, 294912
buffer_load_dword v42, v120, s[16:19], s43 offen
s_add_u32 s44, s33, 303104
buffer_load_dword v43, v120, s[16:19], s44 offen
s_add_u32 s42, s33, 278528
buffer_load_dword v44, v120, s[16:19], s42 offen
s_add_u32 s43, s33, 286720
buffer_load_dword v45, v120, s[16:19], s43 offen
s_add_u32 s44, s33, 311296
buffer_load_dword v46, v120, s[16:19], s44 offen
s_add_u32 s42, s33, 319488
buffer_load_dword v47, v120, s[16:19], s42 offen
s_waitcnt vmcnt(48)
v_perm_b32 v84, v49, v48, s40
v_accvgpr_write_b32 a176, v84
v_perm_b32 v85, v49, v48, s41
v_accvgpr_write_b32 a240, v85
v_perm_b32 v86, v51, v50, s40
v_accvgpr_write_b32 a177, v86
v_perm_b32 v87, v51, v50, s41
v_accvgpr_write_b32 a241, v87
v_perm_b32 v88, v53, v52, s40
v_accvgpr_write_b32 a178, v88
v_perm_b32 v89, v53, v52, s41
v_accvgpr_write_b32 a242, v89
v_perm_b32 v90, v55, v54, s40
v_accvgpr_write_b32 a179, v90
v_perm_b32 v91, v55, v54, s41
v_accvgpr_write_b32 a243, v91
v_perm_b32 v84, v57, v56, s40
v_accvgpr_write_b32 a180, v84
v_perm_b32 v85, v57, v56, s41
v_accvgpr_write_b32 a244, v85
v_perm_b32 v86, v59, v58, s40
v_accvgpr_write_b32 a181, v86
v_perm_b32 v87, v59, v58, s41
v_accvgpr_write_b32 a245, v87
v_perm_b32 v88, v61, v60, s40
v_accvgpr_write_b32 a182, v88
v_perm_b32 v89, v61, v60, s41
v_accvgpr_write_b32 a246, v89
v_perm_b32 v90, v63, v62, s40
v_accvgpr_write_b32 a183, v90
v_perm_b32 v91, v63, v62, s41
v_accvgpr_write_b32 a247, v91
s_add_u32 s42, s34, 0
buffer_load_dword v48, v120, s[16:19], s42 offen
s_add_u32 s43, s34, 8192
buffer_load_dword v49, v120, s[16:19], s43 offen
s_add_u32 s44, s34, 32768
buffer_load_dword v50, v120, s[16:19], s44 offen
s_add_u32 s42, s34, 40960
buffer_load_dword v51, v120, s[16:19], s42 offen
s_add_u32 s43, s34, 16384
buffer_load_dword v52, v120, s[16:19], s43 offen
s_add_u32 s44, s34, 24576
buffer_load_dword v53, v120, s[16:19], s44 offen
s_add_u32 s42, s34, 49152
buffer_load_dword v54, v120, s[16:19], s42 offen
s_add_u32 s43, s34, 57344
buffer_load_dword v55, v120, s[16:19], s43 offen
s_add_u32 s44, s34, 262144
buffer_load_dword v56, v120, s[16:19], s44 offen
s_add_u32 s42, s34, 270336
buffer_load_dword v57, v120, s[16:19], s42 offen
s_add_u32 s43, s34, 294912
buffer_load_dword v58, v120, s[16:19], s43 offen
s_add_u32 s44, s34, 303104
buffer_load_dword v59, v120, s[16:19], s44 offen
s_add_u32 s42, s34, 278528
buffer_load_dword v60, v120, s[16:19], s42 offen
s_add_u32 s43, s34, 286720
buffer_load_dword v61, v120, s[16:19], s43 offen
s_add_u32 s44, s34, 311296
buffer_load_dword v62, v120, s[16:19], s44 offen
s_add_u32 s42, s34, 319488
buffer_load_dword v63, v120, s[16:19], s42 offen
s_waitcnt vmcnt(48)
v_perm_b32 v84, v65, v64, s40
v_accvgpr_write_b32 a184, v84
v_perm_b32 v85, v65, v64, s41
v_accvgpr_write_b32 a248, v85
v_perm_b32 v86, v67, v66, s40
v_accvgpr_write_b32 a185, v86
v_perm_b32 v87, v67, v66, s41
v_accvgpr_write_b32 a249, v87
v_perm_b32 v88, v69, v68, s40
v_accvgpr_write_b32 a186, v88
v_perm_b32 v89, v69, v68, s41
v_accvgpr_write_b32 a250, v89
v_perm_b32 v90, v71, v70, s40
v_accvgpr_write_b32 a187, v90
v_perm_b32 v91, v71, v70, s41
v_accvgpr_write_b32 a251, v91
v_perm_b32 v84, v73, v72, s40
v_accvgpr_write_b32 a188, v84
v_perm_b32 v85, v73, v72, s41
v_accvgpr_write_b32 a252, v85
v_perm_b32 v86, v75, v74, s40
v_accvgpr_write_b32 a189, v86
v_perm_b32 v87, v75, v74, s41
v_accvgpr_write_b32 a253, v87
v_perm_b32 v88, v77, v76, s40
v_accvgpr_write_b32 a190, v88
v_perm_b32 v89, v77, v76, s41
v_accvgpr_write_b32 a254, v89
v_perm_b32 v90, v79, v78, s40
v_accvgpr_write_b32 a191, v90
v_perm_b32 v91, v79, v78, s41
v_accvgpr_write_b32 a255, v91
s_add_u32 s42, s35, 0
buffer_load_dword v64, v120, s[16:19], s42 offen
s_add_u32 s43, s35, 8192
buffer_load_dword v65, v120, s[16:19], s43 offen
s_add_u32 s44, s35, 32768
buffer_load_dword v66, v120, s[16:19], s44 offen
s_add_u32 s42, s35, 40960
buffer_load_dword v67, v120, s[16:19], s42 offen
s_add_u32 s43, s35, 16384
buffer_load_dword v68, v120, s[16:19], s43 offen
s_add_u32 s44, s35, 24576
buffer_load_dword v69, v120, s[16:19], s44 offen
s_add_u32 s42, s35, 49152
buffer_load_dword v70, v120, s[16:19], s42 offen
s_add_u32 s43, s35, 57344
buffer_load_dword v71, v120, s[16:19], s43 offen
s_add_u32 s44, s35, 262144
buffer_load_dword v72, v120, s[16:19], s44 offen
s_add_u32 s42, s35, 270336
buffer_load_dword v73, v120, s[16:19], s42 offen
s_add_u32 s43, s35, 294912
buffer_load_dword v74, v120, s[16:19], s43 offen
s_add_u32 s44, s35, 303104
buffer_load_dword v75, v120, s[16:19], s44 offen
s_add_u32 s42, s35, 278528
buffer_load_dword v76, v120, s[16:19], s42 offen
s_add_u32 s43, s35, 286720
buffer_load_dword v77, v120, s[16:19], s43 offen
s_add_u32 s44, s35, 311296
buffer_load_dword v78, v120, s[16:19], s44 offen
s_add_u32 s42, s35, 319488
buffer_load_dword v79, v120, s[16:19], s42 offen
s_waitcnt vmcnt(48)
v_perm_b32 v128, v17, v16, s40
v_perm_b32 v192, v17, v16, s41
v_perm_b32 v129, v19, v18, s40
v_perm_b32 v193, v19, v18, s41
v_perm_b32 v130, v21, v20, s40
v_perm_b32 v194, v21, v20, s41
v_perm_b32 v131, v23, v22, s40
v_perm_b32 v195, v23, v22, s41
v_perm_b32 v132, v25, v24, s40
v_perm_b32 v196, v25, v24, s41
v_perm_b32 v133, v27, v26, s40
v_perm_b32 v197, v27, v26, s41
v_perm_b32 v134, v29, v28, s40
v_perm_b32 v198, v29, v28, s41
v_perm_b32 v135, v31, v30, s40
v_perm_b32 v199, v31, v30, s41
s_add_u32 s42, s36, 0
buffer_load_dword v16, v120, s[16:19], s42 offen
s_add_u32 s43, s36, 8192
buffer_load_dword v17, v120, s[16:19], s43 offen
s_add_u32 s44, s36, 32768
buffer_load_dword v18, v120, s[16:19], s44 offen
s_add_u32 s42, s36, 40960
buffer_load_dword v19, v120, s[16:19], s42 offen
s_add_u32 s43, s36, 16384
buffer_load_dword v20, v120, s[16:19], s43 offen
s_add_u32 s44, s36, 24576
buffer_load_dword v21, v120, s[16:19], s44 offen
s_add_u32 s42, s36, 49152
buffer_load_dword v22, v120, s[16:19], s42 offen
s_add_u32 s43, s36, 57344
buffer_load_dword v23, v120, s[16:19], s43 offen
s_add_u32 s44, s36, 262144
buffer_load_dword v24, v120, s[16:19], s44 offen
s_add_u32 s42, s36, 270336
buffer_load_dword v25, v120, s[16:19], s42 offen
s_add_u32 s43, s36, 294912
buffer_load_dword v26, v120, s[16:19], s43 offen
s_add_u32 s44, s36, 303104
buffer_load_dword v27, v120, s[16:19], s44 offen
s_add_u32 s42, s36, 278528
buffer_load_dword v28, v120, s[16:19], s42 offen
s_add_u32 s43, s36, 286720
buffer_load_dword v29, v120, s[16:19], s43 offen
s_add_u32 s44, s36, 311296
buffer_load_dword v30, v120, s[16:19], s44 offen
s_add_u32 s42, s36, 319488
buffer_load_dword v31, v120, s[16:19], s42 offen
s_waitcnt vmcnt(48)
v_perm_b32 v136, v33, v32, s40
v_perm_b32 v200, v33, v32, s41
v_perm_b32 v137, v35, v34, s40
v_perm_b32 v201, v35, v34, s41
v_perm_b32 v138, v37, v36, s40
v_perm_b32 v202, v37, v36, s41
v_perm_b32 v139, v39, v38, s40
v_perm_b32 v203, v39, v38, s41
v_perm_b32 v140, v41, v40, s40
v_perm_b32 v204, v41, v40, s41
v_perm_b32 v141, v43, v42, s40
v_perm_b32 v205, v43, v42, s41
v_perm_b32 v142, v45, v44, s40
v_perm_b32 v206, v45, v44, s41
v_perm_b32 v143, v47, v46, s40
v_perm_b32 v207, v47, v46, s41
s_add_u32 s42, s37, 0
buffer_load_dword v32, v120, s[16:19], s42 offen
s_add_u32 s43, s37, 8192
buffer_load_dword v33, v120, s[16:19], s43 offen
s_add_u32 s44, s37, 32768
buffer_load_dword v34, v120, s[16:19], s44 offen
s_add_u32 s42, s37, 40960
buffer_load_dword v35, v120, s[16:19], s42 offen
s_add_u32 s43, s37, 16384
buffer_load_dword v36, v120, s[16:19], s43 offen
s_add_u32 s44, s37, 24576
buffer_load_dword v37, v120, s[16:19], s44 offen
s_add_u32 s42, s37, 49152
buffer_load_dword v38, v120, s[16:19], s42 offen
s_add_u32 s43, s37, 57344
buffer_load_dword v39, v120, s[16:19], s43 offen
s_add_u32 s44, s37, 262144
buffer_load_dword v40, v120, s[16:19], s44 offen
s_add_u32 s42, s37, 270336
buffer_load_dword v41, v120, s[16:19], s42 offen
s_add_u32 s43, s37, 294912
buffer_load_dword v42, v120, s[16:19], s43 offen
s_add_u32 s44, s37, 303104
buffer_load_dword v43, v120, s[16:19], s44 offen
s_add_u32 s42, s37, 278528
buffer_load_dword v44, v120, s[16:19], s42 offen
s_add_u32 s43, s37, 286720
buffer_load_dword v45, v120, s[16:19], s43 offen
s_add_u32 s44, s37, 311296
buffer_load_dword v46, v120, s[16:19], s44 offen
s_add_u32 s42, s37, 319488
buffer_load_dword v47, v120, s[16:19], s42 offen
s_waitcnt vmcnt(48)
v_perm_b32 v144, v49, v48, s40
v_perm_b32 v208, v49, v48, s41
v_perm_b32 v145, v51, v50, s40
v_perm_b32 v209, v51, v50, s41
v_perm_b32 v146, v53, v52, s40
v_perm_b32 v210, v53, v52, s41
v_perm_b32 v147, v55, v54, s40
v_perm_b32 v211, v55, v54, s41
v_perm_b32 v148, v57, v56, s40
v_perm_b32 v212, v57, v56, s41
v_perm_b32 v149, v59, v58, s40
v_perm_b32 v213, v59, v58, s41
v_perm_b32 v150, v61, v60, s40
v_perm_b32 v214, v61, v60, s41
v_perm_b32 v151, v63, v62, s40
v_perm_b32 v215, v63, v62, s41
s_add_u32 s42, s38, 0
buffer_load_dword v48, v120, s[16:19], s42 offen
s_add_u32 s43, s38, 8192
buffer_load_dword v49, v120, s[16:19], s43 offen
s_add_u32 s44, s38, 32768
buffer_load_dword v50, v120, s[16:19], s44 offen
s_add_u32 s42, s38, 40960
buffer_load_dword v51, v120, s[16:19], s42 offen
s_add_u32 s43, s38, 16384
buffer_load_dword v52, v120, s[16:19], s43 offen
s_add_u32 s44, s38, 24576
buffer_load_dword v53, v120, s[16:19], s44 offen
s_add_u32 s42, s38, 49152
buffer_load_dword v54, v120, s[16:19], s42 offen
s_add_u32 s43, s38, 57344
buffer_load_dword v55, v120, s[16:19], s43 offen
s_add_u32 s44, s38, 262144
buffer_load_dword v56, v120, s[16:19], s44 offen
s_add_u32 s42, s38, 270336
buffer_load_dword v57, v120, s[16:19], s42 offen
s_add_u32 s43, s38, 294912
buffer_load_dword v58, v120, s[16:19], s43 offen
s_add_u32 s44, s38, 303104
buffer_load_dword v59, v120, s[16:19], s44 offen
s_add_u32 s42, s38, 278528
buffer_load_dword v60, v120, s[16:19], s42 offen
s_add_u32 s43, s38, 286720
buffer_load_dword v61, v120, s[16:19], s43 offen
s_add_u32 s44, s38, 311296
buffer_load_dword v62, v120, s[16:19], s44 offen
s_add_u32 s42, s38, 319488
buffer_load_dword v63, v120, s[16:19], s42 offen
s_waitcnt vmcnt(48)
v_perm_b32 v152, v65, v64, s40
v_perm_b32 v216, v65, v64, s41
v_perm_b32 v153, v67, v66, s40
v_perm_b32 v217, v67, v66, s41
v_perm_b32 v154, v69, v68, s40
v_perm_b32 v218, v69, v68, s41
v_perm_b32 v155, v71, v70, s40
v_perm_b32 v219, v71, v70, s41
v_perm_b32 v156, v73, v72, s40
v_perm_b32 v220, v73, v72, s41
v_perm_b32 v157, v75, v74, s40
v_perm_b32 v221, v75, v74, s41
v_perm_b32 v158, v77, v76, s40
v_perm_b32 v222, v77, v76, s41
v_perm_b32 v159, v79, v78, s40
v_perm_b32 v223, v79, v78, s41
s_add_u32 s42, s39, 0
buffer_load_dword v64, v120, s[16:19], s42 offen
s_add_u32 s43, s39, 8192
buffer_load_dword v65, v120, s[16:19], s43 offen
s_add_u32 s44, s39, 32768
buffer_load_dword v66, v120, s[16:19], s44 offen
s_add_u32 s42, s39, 40960
buffer_load_dword v67, v120, s[16:19], s42 offen
s_add_u32 s43, s39, 16384
buffer_load_dword v68, v120, s[16:19], s43 offen
s_add_u32 s44, s39, 24576
buffer_load_dword v69, v120, s[16:19], s44 offen
s_add_u32 s42, s39, 49152
buffer_load_dword v70, v120, s[16:19], s42 offen
s_add_u32 s43, s39, 57344
buffer_load_dword v71, v120, s[16:19], s43 offen
s_add_u32 s44, s39, 262144
buffer_load_dword v72, v120, s[16:19], s44 offen
s_add_u32 s42, s39, 270336
buffer_load_dword v73, v120, s[16:19], s42 offen
s_add_u32 s43, s39, 294912
buffer_load_dword v74, v120, s[16:19], s43 offen
s_add_u32 s44, s39, 303104
buffer_load_dword v75, v120, s[16:19], s44 offen
s_add_u32 s42, s39, 278528
buffer_load_dword v76, v120, s[16:19], s42 offen
s_add_u32 s43, s39, 286720
buffer_load_dword v77, v120, s[16:19], s43 offen
s_add_u32 s44, s39, 311296
buffer_load_dword v78, v120, s[16:19], s44 offen
s_add_u32 s42, s39, 319488
buffer_load_dword v79, v120, s[16:19], s42 offen
s_waitcnt vmcnt(48)
v_perm_b32 v160, v17, v16, s40
v_perm_b32 v224, v17, v16, s41
v_perm_b32 v161, v19, v18, s40
v_perm_b32 v225, v19, v18, s41
v_perm_b32 v162, v21, v20, s40
v_perm_b32 v226, v21, v20, s41
v_perm_b32 v163, v23, v22, s40
v_perm_b32 v227, v23, v22, s41
v_perm_b32 v164, v25, v24, s40
v_perm_b32 v228, v25, v24, s41
v_perm_b32 v165, v27, v26, s40
v_perm_b32 v229, v27, v26, s41
v_perm_b32 v166, v29, v28, s40
v_perm_b32 v230, v29, v28, s41
v_perm_b32 v167, v31, v30, s40
v_perm_b32 v231, v31, v30, s41
s_waitcnt vmcnt(32)
v_perm_b32 v168, v33, v32, s40
v_perm_b32 v232, v33, v32, s41
v_perm_b32 v169, v35, v34, s40
v_perm_b32 v233, v35, v34, s41
v_perm_b32 v170, v37, v36, s40
v_perm_b32 v234, v37, v36, s41
v_perm_b32 v171, v39, v38, s40
v_perm_b32 v235, v39, v38, s41
v_perm_b32 v172, v41, v40, s40
v_perm_b32 v236, v41, v40, s41
v_perm_b32 v173, v43, v42, s40
v_perm_b32 v237, v43, v42, s41
v_perm_b32 v174, v45, v44, s40
v_perm_b32 v238, v45, v44, s41
v_perm_b32 v175, v47, v46, s40
v_perm_b32 v239, v47, v46, s41
s_waitcnt vmcnt(16)
v_perm_b32 v176, v49, v48, s40
v_perm_b32 v240, v49, v48, s41
v_perm_b32 v177, v51, v50, s40
v_perm_b32 v241, v51, v50, s41
v_perm_b32 v178, v53, v52, s40
v_perm_b32 v242, v53, v52, s41
v_perm_b32 v179, v55, v54, s40
v_perm_b32 v243, v55, v54, s41
v_perm_b32 v180, v57, v56, s40
v_perm_b32 v244, v57, v56, s41
v_perm_b32 v181, v59, v58, s40
v_perm_b32 v245, v59, v58, s41
v_perm_b32 v182, v61, v60, s40
v_perm_b32 v246, v61, v60, s41
v_perm_b32 v183, v63, v62, s40
v_perm_b32 v247, v63, v62, s41
s_waitcnt vmcnt(0)
v_perm_b32 v184, v65, v64, s40
v_perm_b32 v248, v65, v64, s41
v_perm_b32 v185, v67, v66, s40
v_perm_b32 v249, v67, v66, s41
v_perm_b32 v186, v69, v68, s40
v_perm_b32 v250, v69, v68, s41
v_perm_b32 v187, v71, v70, s40
v_perm_b32 v251, v71, v70, s41
v_perm_b32 v188, v73, v72, s40
v_perm_b32 v252, v73, v72, s41
v_perm_b32 v189, v75, v74, s40
v_perm_b32 v253, v75, v74, s41
v_perm_b32 v190, v77, v76, s40
v_perm_b32 v254, v77, v76, s41
v_perm_b32 v191, v79, v78, s40
v_perm_b32 v255, v79, v78, s41
s_mov_b32 s42, 0
buffer_load_dwordx4 v[16:19], v121, s[20:23], s42 offen
s_mov_b32 s43, 1024
buffer_load_dwordx4 v[20:23], v121, s[20:23], s43 offen
s_mov_b32 s44, 2048
buffer_load_dwordx4 v[24:27], v121, s[20:23], s44 offen
s_mov_b32 s42, 3072
buffer_load_dwordx4 v[28:31], v121, s[20:23], s42 offen
s_mov_b32 s43, 4096
buffer_load_dwordx4 v[32:35], v121, s[20:23], s43 offen
s_mov_b32 s44, 5120
buffer_load_dwordx4 v[36:39], v121, s[20:23], s44 offen
s_mov_b32 s42, 6144
buffer_load_dwordx4 v[40:43], v121, s[20:23], s42 offen
s_mov_b32 s43, 7168
buffer_load_dwordx4 v[44:47], v121, s[20:23], s43 offen
s_mov_b32 s42, 16384
buffer_load_dwordx4 v[48:51], v121, s[20:23], s42 offen
s_mov_b32 s43, 17408
buffer_load_dwordx4 v[52:55], v121, s[20:23], s43 offen
s_mov_b32 s44, 18432
buffer_load_dwordx4 v[56:59], v121, s[20:23], s44 offen
s_mov_b32 s42, 19456
buffer_load_dwordx4 v[60:63], v121, s[20:23], s42 offen
s_mov_b32 s43, 20480
buffer_load_dwordx4 v[64:67], v121, s[20:23], s43 offen
s_mov_b32 s44, 21504
buffer_load_dwordx4 v[68:71], v121, s[20:23], s44 offen
s_mov_b32 s42, 22528
buffer_load_dwordx4 v[72:75], v121, s[20:23], s42 offen
s_mov_b32 s43, 23552
buffer_load_dwordx4 v[76:79], v121, s[20:23], s43 offen
s_waitcnt vmcnt(8)
v_perm_b32 v84, v20, v16, s40
v_perm_b32 v85, v28, v24, s40
v_perm_b32 v86, v36, v32, s40
v_perm_b32 v87, v44, v40, s40
ds_write_b128 v15, v[84:87] offset:0
v_perm_b32 v88, v20, v16, s41
v_perm_b32 v89, v28, v24, s41
v_perm_b32 v90, v36, v32, s41
v_perm_b32 v91, v44, v40, s41
ds_write_b128 v15, v[88:91] offset:4096
v_perm_b32 v84, v21, v17, s40
v_perm_b32 v85, v29, v25, s40
v_perm_b32 v86, v37, v33, s40
v_perm_b32 v87, v45, v41, s40
ds_write_b128 v15, v[84:87] offset:8192
v_perm_b32 v88, v21, v17, s41
v_perm_b32 v89, v29, v25, s41
v_perm_b32 v90, v37, v33, s41
v_perm_b32 v91, v45, v41, s41
ds_write_b128 v15, v[88:91] offset:12288
v_perm_b32 v84, v22, v18, s40
v_perm_b32 v85, v30, v26, s40
v_perm_b32 v86, v38, v34, s40
v_perm_b32 v87, v46, v42, s40
ds_write_b128 v15, v[84:87] offset:16384
v_perm_b32 v88, v22, v18, s41
v_perm_b32 v89, v30, v26, s41
v_perm_b32 v90, v38, v34, s41
v_perm_b32 v91, v46, v42, s41
ds_write_b128 v15, v[88:91] offset:20480
v_perm_b32 v84, v23, v19, s40
v_perm_b32 v85, v31, v27, s40
v_perm_b32 v86, v39, v35, s40
v_perm_b32 v87, v47, v43, s40
ds_write_b128 v15, v[84:87] offset:24576
v_perm_b32 v88, v23, v19, s41
v_perm_b32 v89, v31, v27, s41
v_perm_b32 v90, v39, v35, s41
v_perm_b32 v91, v47, v43, s41
ds_write_b128 v15, v[88:91] offset:28672
s_nop 1
s_mov_b32 s42, 65536
buffer_load_dwordx4 v[16:19], v121, s[20:23], s42 offen
s_mov_b32 s43, 66560
buffer_load_dwordx4 v[20:23], v121, s[20:23], s43 offen
s_mov_b32 s44, 67584
buffer_load_dwordx4 v[24:27], v121, s[20:23], s44 offen
s_mov_b32 s42, 68608
buffer_load_dwordx4 v[28:31], v121, s[20:23], s42 offen
s_mov_b32 s43, 69632
buffer_load_dwordx4 v[32:35], v121, s[20:23], s43 offen
s_mov_b32 s44, 70656
buffer_load_dwordx4 v[36:39], v121, s[20:23], s44 offen
s_mov_b32 s42, 71680
buffer_load_dwordx4 v[40:43], v121, s[20:23], s42 offen
s_mov_b32 s43, 72704
buffer_load_dwordx4 v[44:47], v121, s[20:23], s43 offen
s_waitcnt vmcnt(8)
v_perm_b32 v84, v52, v48, s40
v_perm_b32 v85, v60, v56, s40
v_perm_b32 v86, v68, v64, s40
v_perm_b32 v87, v76, v72, s40
ds_write_b128 v15, v[84:87] offset:1024
v_perm_b32 v88, v52, v48, s41
v_perm_b32 v89, v60, v56, s41
v_perm_b32 v90, v68, v64, s41
v_perm_b32 v91, v76, v72, s41
ds_write_b128 v15, v[88:91] offset:5120
v_perm_b32 v84, v53, v49, s40
v_perm_b32 v85, v61, v57, s40
v_perm_b32 v86, v69, v65, s40
v_perm_b32 v87, v77, v73, s40
ds_write_b128 v15, v[84:87] offset:9216
v_perm_b32 v88, v53, v49, s41
v_perm_b32 v89, v61, v57, s41
v_perm_b32 v90, v69, v65, s41
v_perm_b32 v91, v77, v73, s41
ds_write_b128 v15, v[88:91] offset:13312
v_perm_b32 v84, v54, v50, s40
v_perm_b32 v85, v62, v58, s40
v_perm_b32 v86, v70, v66, s40
v_perm_b32 v87, v78, v74, s40
ds_write_b128 v15, v[84:87] offset:17408
v_perm_b32 v88, v54, v50, s41
v_perm_b32 v89, v62, v58, s41
v_perm_b32 v90, v70, v66, s41
v_perm_b32 v91, v78, v74, s41
ds_write_b128 v15, v[88:91] offset:21504
v_perm_b32 v84, v55, v51, s40
v_perm_b32 v85, v63, v59, s40
v_perm_b32 v86, v71, v67, s40
v_perm_b32 v87, v79, v75, s40
ds_write_b128 v15, v[84:87] offset:25600
v_perm_b32 v88, v55, v51, s41
v_perm_b32 v89, v63, v59, s41
v_perm_b32 v90, v71, v67, s41
v_perm_b32 v91, v79, v75, s41
ds_write_b128 v15, v[88:91] offset:29696
s_nop 1
s_mov_b32 s42, 81920
buffer_load_dwordx4 v[48:51], v121, s[20:23], s42 offen
s_mov_b32 s43, 82944
buffer_load_dwordx4 v[52:55], v121, s[20:23], s43 offen
s_mov_b32 s44, 83968
buffer_load_dwordx4 v[56:59], v121, s[20:23], s44 offen
s_mov_b32 s42, 84992
buffer_load_dwordx4 v[60:63], v121, s[20:23], s42 offen
s_mov_b32 s43, 86016
buffer_load_dwordx4 v[64:67], v121, s[20:23], s43 offen
s_mov_b32 s44, 87040
buffer_load_dwordx4 v[68:71], v121, s[20:23], s44 offen
s_mov_b32 s42, 88064
buffer_load_dwordx4 v[72:75], v121, s[20:23], s42 offen
s_mov_b32 s43, 89088
buffer_load_dwordx4 v[76:79], v121, s[20:23], s43 offen
s_waitcnt vmcnt(8)
v_perm_b32 v84, v20, v16, s40
v_perm_b32 v85, v28, v24, s40
v_perm_b32 v86, v36, v32, s40
v_perm_b32 v87, v44, v40, s40
ds_write_b128 v15, v[84:87] offset:2048
v_perm_b32 v88, v20, v16, s41
v_perm_b32 v89, v28, v24, s41
v_perm_b32 v90, v36, v32, s41
v_perm_b32 v91, v44, v40, s41
ds_write_b128 v15, v[88:91] offset:6144
v_perm_b32 v84, v21, v17, s40
v_perm_b32 v85, v29, v25, s40
v_perm_b32 v86, v37, v33, s40
v_perm_b32 v87, v45, v41, s40
ds_write_b128 v15, v[84:87] offset:10240
v_perm_b32 v88, v21, v17, s41
v_perm_b32 v89, v29, v25, s41
v_perm_b32 v90, v37, v33, s41
v_perm_b32 v91, v45, v41, s41
ds_write_b128 v15, v[88:91] offset:14336
v_perm_b32 v84, v22, v18, s40
v_perm_b32 v85, v30, v26, s40
v_perm_b32 v86, v38, v34, s40
v_perm_b32 v87, v46, v42, s40
ds_write_b128 v15, v[84:87] offset:18432
v_perm_b32 v88, v22, v18, s41
v_perm_b32 v89, v30, v26, s41
v_perm_b32 v90, v38, v34, s41
v_perm_b32 v91, v46, v42, s41
ds_write_b128 v15, v[88:91] offset:22528
v_perm_b32 v84, v23, v19, s40
v_perm_b32 v85, v31, v27, s40
v_perm_b32 v86, v39, v35, s40
v_perm_b32 v87, v47, v43, s40
ds_write_b128 v15, v[84:87] offset:26624
v_perm_b32 v88, v23, v19, s41
v_perm_b32 v89, v31, v27, s41
v_perm_b32 v90, v39, v35, s41
v_perm_b32 v91, v47, v43, s41
ds_write_b128 v15, v[88:91] offset:30720
s_waitcnt vmcnt(0)
v_perm_b32 v84, v52, v48, s40
v_perm_b32 v85, v60, v56, s40
v_perm_b32 v86, v68, v64, s40
v_perm_b32 v87, v76, v72, s40
ds_write_b128 v15, v[84:87] offset:3072
v_perm_b32 v88, v52, v48, s41
v_perm_b32 v89, v60, v56, s41
v_perm_b32 v90, v68, v64, s41
v_perm_b32 v91, v76, v72, s41
ds_write_b128 v15, v[88:91] offset:7168
v_perm_b32 v84, v53, v49, s40
v_perm_b32 v85, v61, v57, s40
v_perm_b32 v86, v69, v65, s40
v_perm_b32 v87, v77, v73, s40
ds_write_b128 v15, v[84:87] offset:11264
v_perm_b32 v88, v53, v49, s41
v_perm_b32 v89, v61, v57, s41
v_perm_b32 v90, v69, v65, s41
v_perm_b32 v91, v77, v73, s41
ds_write_b128 v15, v[88:91] offset:15360
v_perm_b32 v84, v54, v50, s40
v_perm_b32 v85, v62, v58, s40
v_perm_b32 v86, v70, v66, s40
v_perm_b32 v87, v78, v74, s40
ds_write_b128 v15, v[84:87] offset:19456
v_perm_b32 v88, v54, v50, s41
v_perm_b32 v89, v62, v58, s41
v_perm_b32 v90, v70, v66, s41
v_perm_b32 v91, v78, v74, s41
ds_write_b128 v15, v[88:91] offset:23552
v_perm_b32 v84, v55, v51, s40
v_perm_b32 v85, v63, v59, s40
v_perm_b32 v86, v71, v67, s40
v_perm_b32 v87, v79, v75, s40
ds_write_b128 v15, v[84:87] offset:27648
v_perm_b32 v88, v55, v51, s41
v_perm_b32 v89, v63, v59, s41
v_perm_b32 v90, v71, v67, s41
v_perm_b32 v91, v79, v75, s41
ds_write_b128 v15, v[88:91] offset:31744
s_waitcnt lgkmcnt(0)
s_cmp_lg_u32 s31, 0
s_cbranch_scc1 L_m_go
s_cmp_lg_u32 s29, 3
s_cbranch_scc1 L_m_wl
v_mov_b32 v16, 4195840
v_mov_b32 v17, 1
s_mov_b64 exec, 1
buffer_atomic_add v17, v16, s[84:87], 0 offen sc1
s_mov_b64 exec, -1
L_m_wl:
v_mov_b32 v16, 4194304
s_mov_b32 s52, 0
L_m_cnt:
buffer_load_dword v17, v16, s[84:87], 0 offen sc1
s_add_u32 s52, s52, 1
s_waitcnt vmcnt(0)
v_readfirstlane_b32 s42, v17
s_mov_b32 s43, 1
s_cmp_ge_u32 s42, 32
s_cbranch_scc1 L_m_dec
s_mov_b32 s43, 2
s_cmp_gt_u32 s52, 200
s_cbranch_scc1 L_m_dec
s_sleep 8
s_branch L_m_cnt
L_m_dec:
v_mov_b32 v16, 4195328
v_mov_b32 v18, s43
v_mov_b32 v19, 0
s_mov_b64 exec, 1
buffer_atomic_cmpswap v[18:19], v16, s[84:87], 0 offen sc0 sc1
s_waitcnt vmcnt(0)
v_readfirstlane_b32 s42, v18
s_mov_b64 exec, -1
s_cmp_eq_u32 s42, 0
s_cselect_b32 s42, s43, s42
s_cmp_eq_u32 s42, 1
s_cbranch_scc1 L_m_go
s_barrier
s_branch L_m_work
L_m_go:
s_cmp_lg_u32 s31, 0
s_cbranch_scc1 L_m_slow
s_mov_b32 s30, 0
s_mov_b32 s32, s53
s_mov_b32 s33, s53
s_mov_b32 s70, 0
s_mov_b32 s45, 2097152
s_mov_b32 s46, 3145728
s_lshl_b32 s42, s28, 14
s_lshl_b32 s43, s29, 11
s_add_u32 s42, s42, s43
s_add_u32 s47, s42, 33554432
s_lshl_b32 s42, s28, 11
s_add_u32 s48, s42, 5242880
s_lshl_b32 s42, s28, 12
s_lshl_b32 s43, s29, 10
s_add_u32 s42, s42, s43
s_add_u32 s49, s42, 9437184
s_lshl_b32 s42, s29, 11
s_add_u32 s68, s42, 131072
s_add_u32 s69, s42, 139264
v_mov_b32 v72, 4196352
s_mov_b32 s43, 0
WF_9:
buffer_load_dword v73, v72, s[24:27], 0 offen sc1
s_add_u32 s43, s43, 1
s_waitcnt vmcnt(0)
v_readfirstlane_b32 s42, v73
s_cmp_ge_u32 s42, 64
s_cbranch_scc1 WFd_10
s_cmp_gt_u32 s43, 400000
s_cbranch_scc1 WFd_10
s_sleep 1
s_branch WF_9
WFd_10:
s_mov_b32 m0, s68
s_nop 0
buffer_load_dwordx4 v1, s[24:27], s47 offen sc1 lds
buffer_load_dwordx4 v1, s[24:27], s47 offen offset:1024 sc1 lds
s_waitcnt vmcnt(0)
s_barrier
v_mov_b64 v[48:49], 0
v_mov_b64 v[50:51], 0
v_mov_b64 v[52:53], 0
v_mov_b64 v[54:55], 0
v_mov_b64 v[56:57], 0
v_mov_b64 v[58:59], 0
v_mov_b64 v[60:61], 0
v_mov_b64 v[62:63], 0
v_mov_b64 v[64:65], 0
v_mov_b64 v[66:67], 0
v_mov_b64 v[68:69], 0
v_mov_b64 v[70:71], 0
CH_step_2:
s_mov_b32 s71, 0
s_mov_b64 s[4:5], -1
s_mov_b64 s[6:7], -1
CH_poll_3:
s_mov_b64 exec, s[4:5]
buffer_load_dwordx4 v[16:19], v2, s[24:27], s45 offen sc1
s_mov_b64 exec, s[6:7]
buffer_load_dwordx4 v[20:23], v2, s[24:27], s45 offen offset:1024 sc1
s_mov_b64 exec, -1
s_add_u32 s71, s71, 1
s_waitcnt vmcnt(1)
v_max3_u32 v72, v16, v17, v18
v_max_u32 v72, v72, v19
v_cmp_eq_u32 s[4:5], -1, v72
s_waitcnt vmcnt(0)
v_max3_u32 v73, v20, v21, v22
v_max_u32 v73, v73, v23
v_cmp_eq_u32 s[6:7], -1, v73
s_cmp_gt_u32 s71, 300000
s_cbranch_scc1 CH_pok_6
s_or_b64 vcc, s[4:5], s[6:7]
s_cbranch_scc1 CH_poll_3
CH_pok_6:
ds_write_b128 v3, v[16:19]
ds_write_b128 v3, v[20:23] offset:1024
v_smfmac_f32_16x16x64_bf16 v[48:51], v[16:19], a[0:7], v7
s_add_u32 s42, s47, 8192
s_add_u32 s43, s47, 524288
s_mov_b32 m0, s69
v_smfmac_f32_16x16x64_bf16 v[52:55], v[16:19], a[64:71], v7
v_smfmac_f32_16x16x64_bf16 v[48:51], v[20:23], a[8:15], v7
v_smfmac_f32_16x16x64_bf16 v[52:55], v[20:23], a[72:79], v7
s_waitcnt lgkmcnt(0)
s_barrier
v_smfmac_f32_16x16x64_bf16 v[56:59], v[16:19], a[128:135], v7
ds_read_b128 v[24:27], v4 offset:0
v_smfmac_f32_16x16x64_bf16 v[60:63], v[16:19], a[192:199], v7
ds_read_b128 v[28:31], v4 offset:1024
v_smfmac_f32_16x16x64_bf16 v[56:59], v[20:23], a[136:143], v7
ds_read_b128 v[32:35], v5 offset:0
v_smfmac_f32_16x16x64_bf16 v[60:63], v[20:23], a[200:207], v7
ds_read_b128 v[36:39], v5 offset:1024
v_smfmac_f32_16x16x64_bf16 v[64:67], v[16:19], v[128:135], v7
ds_read_b128 v[40:43], v6 offset:0
v_smfmac_f32_16x16x64_bf16 v[68:71], v[16:19], v[192:199], v7
ds_read_b128 v[44:47], v6 offset:1024
v_smfmac_f32_16x16x64_bf16 v[64:67], v[20:23], v[136:143], v7
buffer_load_dwordx4 v[120:123], v1, s[24:27], s42 offen sc1
v_smfmac_f32_16x16x64_bf16 v[68:71], v[20:23], v[200:207], v7
buffer_load_dwordx4 v[124:127], v1, s[24:27], s42 offen offset:1024 sc1
s_waitcnt lgkmcnt(5)
v_smfmac_f32_16x16x64_bf16 v[48:51], v[24:27], a[16:23], v7
v_smfmac_f32_16x16x64_bf16 v[52:55], v[24:27], a[80:87], v7
s_waitcnt lgkmcnt(4)
v_smfmac_f32_16x16x64_bf16 v[48:51], v[28:31], a[24:31], v7
buffer_load_dwordx4 v1, s[24:27], s43 offen sc1 lds
v_smfmac_f32_16x16x64_bf16 v[52:55], v[28:31], a[88:95], v7
s_waitcnt lgkmcnt(3)
v_smfmac_f32_16x16x64_bf16 v[48:51], v[32:35], a[32:39], v7
v_smfmac_f32_16x16x64_bf16 v[52:55], v[32:35], a[96:103], v7
s_waitcnt lgkmcnt(2)
v_smfmac_f32_16x16x64_bf16 v[48:51], v[36:39], a[40:47], v7
buffer_load_dwordx4 v1, s[24:27], s43 offen offset:1024 sc1 lds
v_smfmac_f32_16x16x64_bf16 v[52:55], v[36:39], a[104:111], v7
s_waitcnt lgkmcnt(1)
v_smfmac_f32_16x16x64_bf16 v[48:51], v[40:43], a[48:55], v7
v_smfmac_f32_16x16x64_bf16 v[52:55], v[40:43], a[112:119], v7
s_waitcnt lgkmcnt(0)
v_smfmac_f32_16x16x64_bf16 v[48:51], v[44:47], a[56:63], v7
v_smfmac_f32_16x16x64_bf16 v[52:55], v[44:47], a[120:127], v7
s_cmp_lg_u32 s29, 1
s_cbranch_scc1 PG_11
s_cmp_eq_u32 s30, 0
s_cbranch_scc1 PG_11
s_sub_u32 s44, s30, 1
s_lshr_b32 s44, s44, 1
s_lshl_b32 s44, s44, 7
s_add_u32 s44, s44, 4199424
v_mov_b32 v72, 0
v_mov_b32 v73, 1
s_mov_b64 exec, 1
buffer_atomic_add v73, v72, s[24:27], s44 offen sc1
s_mov_b64 exec, -1
PG_11:
v_smfmac_f32_16x16x64_bf16 v[56:59], v[24:27], a[144:151], v7
ds_read_b128 v[88:91], v13 offset:0
v_smfmac_f32_16x16x64_bf16 v[60:63], v[24:27], a[208:215], v7
ds_read_b128 v[92:95], v13 offset:1024
v_pk_add_f32 v[48:49], v[48:49], v[50:51]
v_smfmac_f32_16x16x64_bf16 v[56:59], v[28:31], a[152:159], v7
ds_read_b128 v[96:99], v13 offset:2048
v_pk_add_f32 v[52:53], v[52:53], v[54:55]
v_smfmac_f32_16x16x64_bf16 v[60:63], v[28:31], a[216:223], v7
v_cvt_pk_bf16_f32 v48, v48, v52
ds_write_b32 v8, v48 offset:0
v_smfmac_f32_16x16x64_bf16 v[56:59], v[32:35], a[160:167], v7
v_cvt_pk_bf16_f32 v49, v49, v53
ds_write_b32 v8, v49 offset:272
v_smfmac_f32_16x16x64_bf16 v[60:63], v[32:35], a[224:231], v7
ds_read_b128 v[100:103], v13 offset:3072
v_smfmac_f32_16x16x64_bf16 v[56:59], v[36:39], a[168:175], v7
ds_read_b128 v[104:107], v15 offset:0
v_smfmac_f32_16x16x64_bf16 v[60:63], v[36:39], a[232:239], v7
ds_read_b128 v[108:111], v15 offset:1024
v_smfmac_f32_16x16x64_bf16 v[56:59], v[40:43], a[176:183], v7
ds_read_b128 v[112:115], v15 offset:4096
v_smfmac_f32_16x16x64_bf16 v[60:63], v[40:43], a[240:247], v7
ds_read_b128 v[116:119], v15 offset:5120
v_smfmac_f32_16x16x64_bf16 v[56:59], v[44:47], a[184:191], v7
ds_read_b128 v[16:19], v13 offset:4096
v_smfmac_f32_16x16x64_bf16 v[60:63], v[44:47], a[248:255], v7
ds_read_b128 v[20:23], v13 offset:5120
v_smfmac_f32_16x16x64_bf16 v[64:67], v[24:27], v[144:151], v7
v_smfmac_f32_16x16x64_bf16 v[68:71], v[24:27], v[208:215], v7
v_pk_add_f32 v[56:57], v[56:57], v[58:59]
v_smfmac_f32_16x16x64_bf16 v[64:67], v[28:31], v[152:159], v7
v_pk_add_f32 v[60:61], v[60:61], v[62:63]
v_smfmac_f32_16x16x64_bf16 v[68:71], v[28:31], v[216:223], v7
v_cvt_pk_bf16_f32 v56, v56, v60
ds_write_b32 v8, v56 offset:2176
v_smfmac_f32_16x16x64_bf16 v[64:67], v[32:35], v[160:167], v7
v_cvt_pk_bf16_f32 v57, v57, v61
ds_write_b32 v8, v57 offset:2448
v_smfmac_f32_16x16x64_bf16 v[68:71], v[32:35], v[224:231], v7
s_waitcnt lgkmcnt(0)
s_barrier
v_smfmac_f32_16x16x64_bf16 v[64:67], v[36:39], v[168:175], v7
ds_read_b128 v[72:75], v9 offset:0
v_smfmac_f32_16x16x64_bf16 v[68:71], v[36:39], v[232:239], v7
ds_read_b128 v[76:79], v9 offset:64
buffer_store_dword v56, v10, s[24:27], s48 offen sc1
v_smfmac_f32_16x16x64_bf16 v[64:67], v[40:43], v[176:183], v7
ds_read_b128 v[80:83], v9 offset:128
v_smfmac_f32_16x16x64_bf16 v[68:71], v[40:43], v[240:247], v7
ds_read_b128 v[84:87], v9 offset:192
buffer_store_dword v57, v10, s[24:27], s48 offen offset:64 sc1
v_smfmac_f32_16x16x64_bf16 v[64:67], v[44:47], v[184:191], v7
ds_read_b128 v[24:27], v13 offset:6144
v_smfmac_f32_16x16x64_bf16 v[68:71], v[44:47], v[248:255], v7
ds_read_b128 v[28:31], v13 offset:7168
s_waitcnt lgkmcnt(5)
v_mfma_f32_16x16x32_bf16 v[48:51], v[88:91], v[72:75], 0
ds_read_b128 v[88:91], v9 offset:2176
s_waitcnt lgkmcnt(5)
v_mfma_f32_16x16x32_bf16 v[48:51], v[92:95], v[76:79], v[48:51]
ds_read_b128 v[92:95], v9 offset:2240
s_waitcnt lgkmcnt(5)
v_mfma_f32_16x16x32_bf16 v[48:51], v[96:99], v[80:83], v[48:51]
ds_read_b128 v[96:99], v9 offset:2304
v_cvt_pk_bf16_f32 v64, v64, v65
v_cvt_pk_bf16_f32 v65, v66, v67
s_waitcnt lgkmcnt(5)
v_mfma_f32_16x16x32_bf16 v[48:51], v[100:103], v[84:87], v[48:51]
ds_read_b128 v[100:103], v9 offset:2368
v_cvt_pk_bf16_f32 v66, v68, v69
v_cvt_pk_bf16_f32 v67, v70, v71
v_mfma_f32_16x16x32_bf16 v[52:55], v[16:19], v[72:75], 0
ds_read_b128 v[32:35], v15 offset:2048
v_xor_b32 v13, 0x2000, v13
v_mfma_f32_16x16x32_bf16 v[52:55], v[20:23], v[76:79], v[52:55]
ds_read_b128 v[36:39], v15 offset:3072
s_waitcnt lgkmcnt(7)
v_mfma_f32_16x16x32_bf16 v[52:55], v[24:27], v[80:83], v[52:55]
ds_read_b128 v[40:43], v15 offset:6144
v_max3_f32 v68, v48, v49, v50
s_waitcnt lgkmcnt(7)
v_mfma_f32_16x16x32_bf16 v[52:55], v[28:31], v[84:87], v[52:55]
ds_read_b128 v[44:47], v15 offset:7168
buffer_store_dwordx4 v[64:67], v1, s[24:27], s49 offen sc1
s_cmp_eq_u32 s30, 63
s_cbranch_scc1 CH_done_5
s_waitcnt lgkmcnt(4)
v_mfma_f32_16x16x32_bf16 v[60:63], v[88:91], v[72:75], 0
v_mov_b64 v[16:17], 0
v_mov_b64 v[18:19], 0
v_mfma_f32_16x16x32_bf16 v[60:63], v[92:95], v[76:79], v[60:63]
v_mov_b64 v[20:21], 0
v_mov_b64 v[22:23], 0
v_mfma_f32_16x16x32_bf16 v[60:63], v[96:99], v[80:83], v[60:63]
v_max3_f32 v69, v51, v52, v53
v_max3_f32 v68, v68, v54, v55
v_mfma_f32_16x16x32_bf16 v[60:63], v[100:103], v[84:87], v[60:63]
v_max_f32 v68, v68, v69
v_mov_b64 v[24:25], 0
v_mov_b64 v[26:27], 0
v_mov_b64 v[28:29], 0
v_mov_b64 v[30:31], 0
v_mov_b64 v[88:89], 0
v_mov_b64 v[90:91], 0
v_mov_b64 v[92:93], 0
v_max3_f32 v68, v68, v60, v61
v_mov_b32 v69, v68
v_mov_b64 v[94:95], 0
v_mov_b64 v[96:97], 0
v_permlane16_swap_b32 v68, v69
v_max_f32 v68, v68, v69
v_mov_b32 v69, v68
v_mov_b64 v[98:99], 0
s_add_u32 s47, s47, 524288
v_permlane32_swap_b32 v68, v69
v_max_f32 v68, v68, v69
v_mul_f32 v68, s53, v68
v_pk_fma_f32 v[60:61], v[60:61], s[32:33], v[68:69] op_sel_hi:[1,1,0] neg_lo:[0,0,1] neg_hi:[0,0,1]
v_pk_fma_f32 v[48:49], v[48:49], s[32:33], v[68:69] op_sel_hi:[1,1,0] neg_lo:[0,0,1] neg_hi:[0,0,1]
v_pk_fma_f32 v[50:51], v[50:51], s[32:33], v[68:69] op_sel_hi:[1,1,0] neg_lo:[0,0,1] neg_hi:[0,0,1]
v_exp_f32 v60, v60
v_exp_f32 v61, v61
v_pk_fma_f32 v[52:53], v[52:53], s[32:33], v[68:69] op_sel_hi:[1,1,0] neg_lo:[0,0,1] neg_hi:[0,0,1]
v_pk_fma_f32 v[54:55], v[54:55], s[32:33], v[68:69] op_sel_hi:[1,1,0] neg_lo:[0,0,1] neg_hi:[0,0,1]
v_cvt_pk_bf16_f32 v56, v60, v61
v_cvt_pk_bf16_f32 v57, v60, v61
v_exp_f32 v48, v48
v_exp_f32 v49, v49
v_mfma_f32_16x16x16_bf16 v[100:103], v[64:65], v[56:57], 0
ds_read_b128 v[72:75], v15 offset:8192
v_exp_f32 v50, v50
v_exp_f32 v51, v51
v_pk_add_f32 v[70:71], v[60:61], v[48:49]
v_mfma_f32_16x16x16_bf16 v[60:63], v[66:67], v[56:57], 0
ds_read_b128 v[76:79], v15 offset:9216
v_exp_f32 v52, v52
v_exp_f32 v53, v53
v_exp_f32 v54, v54
v_exp_f32 v55, v55
v_pk_add_f32 v[68:69], v[50:51], v[52:53]
v_cvt_pk_bf16_f32 v48, v48, v49
v_cvt_pk_bf16_f32 v49, v50, v51
v_cvt_pk_bf16_f32 v50, v52, v53
v_cvt_pk_bf16_f32 v51, v54, v55
v_pk_add_f32 v[70:71], v[70:71], v[54:55]
s_waitcnt vmcnt(5)
v_mfma_f32_16x16x32_bf16 v[100:103], v[120:123], v[48:51], v[100:103]
ds_read_b128 v[80:83], v15 offset:12288
v_pk_add_f32 v[70:71], v[70:71], v[68:69]
v_mfma_f32_16x16x32_bf16 v[60:63], v[124:127], v[48:51], v[60:63]
ds_read_b128 v[84:87], v15 offset:13312
v_add_f32 v70, v70, v71
v_mov_b32 v71, v70
v_add_u32 v52, 160256, v1
s_xor_b32 s69, s69, 0x2000
v_permlane16_swap_b32 v70, v71
v_add_f32 v70, v70, v71
v_mov_b32 v71, v70
v_cndmask_b32 v56, v101, v100, s[50:51]
v_cndmask_b32 v58, v103, v102, s[50:51]
v_permlane32_swap_b32 v70, v71
v_add_f32 v70, v70, v71
v_rcp_f32 v70, v70
v_cndmask_b32 v57, v61, v60, s[50:51]
v_cndmask_b32 v59, v63, v62, s[50:51]
v_pk_mul_f32 v[56:57], v[56:57], v[70:71] op_sel_hi:[1,0]
v_pk_mul_f32 v[58:59], v[58:59], v[70:71] op_sel_hi:[1,0]
v_cvt_pk_bf16_f32 v48, v56, v57
v_cvt_pk_bf16_f32 v49, v58, v59
ds_write_b64 v11, v[48:49]
v_mov_b64 v[100:101], 0
v_mov_b64 v[102:103], 0
s_add_u32 s42, s46, 8192
s_waitcnt lgkmcnt(0)
s_barrier
ds_read_b128 v[120:123], v52
ds_read_b128 v[124:127], v52 offset:1024
ds_read_b128 v[56:59], v15 offset:10240
ds_read_b128 v[60:63], v15 offset:11264
ds_read_b128 v[64:67], v15 offset:14336
ds_read_b128 v[68:71], v15 offset:15360
s_waitcnt lgkmcnt(5)
v_smfmac_f32_16x16x64_bf16 v[16:19], v[120:123], v[104:111], v7
ds_read_b128 v[104:107], v15 offset:16384
ds_read_b128 v[108:111], v15 offset:17408
v_smfmac_f32_16x16x64_bf16 v[20:23], v[120:123], v[112:119], v7
ds_read_b128 v[112:115], v15 offset:20480
ds_read_b128 v[116:119], v15 offset:21504
s_waitcnt lgkmcnt(8)
v_smfmac_f32_16x16x64_bf16 v[16:19], v[124:127], v[32:39], v7
ds_read_b128 v[32:35], v15 offset:18432
ds_read_b128 v[36:39], v15 offset:19456
v_smfmac_f32_16x16x64_bf16 v[20:23], v[124:127], v[40:47], v7
ds_read_b128 v[40:43], v15 offset:22528
ds_read_b128 v[44:47], v15 offset:23552
v_smfmac_f32_16x16x64_bf16 v[24:27], v[120:123], v[72:79], v7
ds_read_b128 v[72:75], v15 offset:24576
v_smfmac_f32_16x16x64_bf16 v[28:31], v[120:123], v[80:87], v7
ds_read_b128 v[76:79], v15 offset:25600
v_pk_add_f32 v[16:17], v[16:17], v[18:19]
s_waitcnt lgkmcnt(12)
v_smfmac_f32_16x16x64_bf16 v[24:27], v[124:127], v[56:63], v7
ds_read_b128 v[80:83], v15 offset:28672
v_pk_add_f32 v[20:21], v[20:21], v[22:23]
s_waitcnt lgkmcnt(11)
v_smfmac_f32_16x16x64_bf16 v[28:31], v[124:127], v[64:71], v7
ds_read_b128 v[84:87], v15 offset:29696
v_cvt_pk_bf16_f32 v48, v16, v20
s_waitcnt lgkmcnt(10)
v_smfmac_f32_16x16x64_bf16 v[88:91], v[120:123], v[104:111], v7
ds_read_b128 v[56:59], v15 offset:26624
v_cvt_pk_bf16_f32 v50, v17, v21
s_waitcnt lgkmcnt(9)
v_smfmac_f32_16x16x64_bf16 v[92:95], v[120:123], v[112:119], v7
ds_read_b128 v[60:63], v15 offset:27648
v_bfi_b32 v48, 1, s70, v48
s_waitcnt lgkmcnt(8)
v_smfmac_f32_16x16x64_bf16 v[88:91], v[124:127], v[32:39], v7
ds_read_b128 v[64:67], v15 offset:30720
v_pk_add_f32 v[24:25], v[24:25], v[26:27]
s_waitcnt lgkmcnt(7)
v_smfmac_f32_16x16x64_bf16 v[92:95], v[124:127], v[40:47], v7
ds_read_b128 v[68:71], v15 offset:31744
v_pk_add_f32 v[28:29], v[28:29], v[30:31]
s_waitcnt lgkmcnt(6)
v_smfmac_f32_16x16x64_bf16 v[96:99], v[120:123], v[72:79], v7
v_cvt_pk_bf16_f32 v49, v24, v28
s_waitcnt lgkmcnt(4)
v_smfmac_f32_16x16x64_bf16 v[100:103], v[120:123], v[80:87], v7
v_cvt_pk_bf16_f32 v51, v25, v29
buffer_store_dwordx4 v[48:51], v12, s[24:27], s46 offen
s_waitcnt lgkmcnt(2)
v_smfmac_f32_16x16x64_bf16 v[96:99], v[124:127], v[56:63], v7
v_pk_add_f32 v[88:89], v[88:89], v[90:91]
s_waitcnt lgkmcnt(0)
v_smfmac_f32_16x16x64_bf16 v[100:103], v[124:127], v[64:71], v7
v_pk_add_f32 v[92:93], v[92:93], v[94:95]
v_cvt_pk_bf16_f32 v52, v88, v92
v_cvt_pk_bf16_f32 v54, v89, v93
v_bfi_b32 v52, 1, s70, v52
s_nop 3
v_pk_add_f32 v[96:97], v[96:97], v[98:99]
v_pk_add_f32 v[100:101], v[100:101], v[102:103]
v_cvt_pk_bf16_f32 v53, v96, v100
v_cvt_pk_bf16_f32 v55, v97, v101
buffer_store_dwordx4 v[52:55], v12, s[24:27], s42 offen
s_add_u32 s45, s45, 8192
s_and_b32 s45, s45, 0xffff7fff
s_xor_b32 s44, s45, 0x4000
s_add_u32 s48, s48, 65536
s_add_u32 s49, s49, 131072
s_add_u32 s30, s30, 1
s_cmp_lg_u32 s29, 0
s_cbranch_scc1 CH_next_8
s_mov_b32 s56, 0x00030003
s_mov_b32 s57, 0x00030003
s_lshl_b32 s42, s28, 13
s_add_u32 s42, s42, s46
s_add_u32 s43, s42, 4096
s_mov_b32 s52, 0
v_and_b32 v112, 16, v1
v_mov_b32 v113, 0x3f80
v_lshlrev_b32 v112, v112, v113
v_mov_b64 v[116:117], -1
v_cndmask_b32 v104, 0, v112, s[56:57]
s_lshl_b64 s[56:57], s[56:57], 2
v_cndmask_b32 v105, 0, v112, s[56:57]
s_lshl_b64 s[56:57], s[56:57], 2
v_cndmask_b32 v106, 0, v112, s[56:57]
s_lshl_b64 s[56:57], s[56:57], 2
v_cndmask_b32 v107, 0, v112, s[56:57]
v_mov_b64 v[56:57], 0
v_mov_b64 v[58:59], 0
v_mov_b64 v[60:61], 0
v_mov_b64 v[62:63], 0
v_mov_b64 v[64:65], 0
v_mov_b64 v[66:67], 0
v_mov_b64 v[68:69], 0
v_mov_b64 v[70:71], 0
v_mov_b64 v[48:49], 0
v_mov_b64 v[50:51], 0
v_mov_b64 v[52:53], 0
v_mov_b64 v[54:55], 0
s_sleep 2
s_mov_b64 vcc, -1
CH_red_4:
s_mov_b64 exec, vcc
buffer_load_dwordx4 v[72:75], v1, s[24:27], s42 offen offset:0 sc1
buffer_load_dwordx4 v[76:79], v1, s[24:27], s42 offen offset:1024 sc1
buffer_load_dwordx4 v[80:83], v1, s[24:27], s42 offen offset:2048 sc1
buffer_load_dwordx4 v[84:87], v1, s[24:27], s42 offen offset:3072 sc1
buffer_load_dwordx4 v[88:91], v1, s[24:27], s43 offen offset:0 sc1
buffer_load_dwordx4 v[92:95], v1, s[24:27], s43 offen offset:1024 sc1
buffer_load_dwordx4 v[96:99], v1, s[24:27], s43 offen offset:2048 sc1
buffer_load_dwordx4 v[100:103], v1, s[24:27], s43 offen offset:3072 sc1
s_mov_b64 exec, -1
s_add_u32 s52, s52, 1
s_waitcnt vmcnt(7)
v_mfma_f32_16x16x32_bf16 v[108:111], v[104:107], v[72:75], 0
s_waitcnt vmcnt(6)
v_mfma_f32_16x16x32_bf16 v[108:111], v[104:107], v[76:79], v[108:111]
v_bitop3_b32 v112, v72, v76, s70 bitop3:0x7e
s_waitcnt vmcnt(5)
v_mfma_f32_16x16x32_bf16 v[108:111], v[104:107], v[80:83], v[108:111]
s_waitcnt vmcnt(4)
v_mfma_f32_16x16x32_bf16 v[108:111], v[104:107], v[84:87], v[108:111]
v_bitop3_b32 v113, v80, v84, s70 bitop3:0x7e
s_waitcnt vmcnt(3)
v_mfma_f32_16x16x32_bf16 v[108:111], v[104:107], v[88:91], v[108:111]
s_waitcnt vmcnt(2)
v_mfma_f32_16x16x32_bf16 v[108:111], v[104:107], v[92:95], v[108:111]
v_bitop3_b32 v114, v88, v92, s70 bitop3:0x7e
s_waitcnt vmcnt(1)
v_mfma_f32_16x16x32_bf16 v[108:111], v[104:107], v[96:99], v[108:111]
s_waitcnt vmcnt(0)
v_mfma_f32_16x16x32_bf16 v[108:111], v[104:107], v[100:103], v[108:111]
v_bitop3_b32 v115, v96, v100, s70 bitop3:0x7e
v_or3_b32 v112, v112, v113, v114
v_or_b32 v112, v112, v115
v_and_b32 v112, 1, v112
v_cmp_ne_u32 vcc, 0, v112
s_cmp_gt_u32 s52, 300000
s_cbranch_scc1 CH_rok_7
s_cbranch_vccnz CH_red_4
CH_rok_7:
s_mov_b64 exec, 0xffffffff
v_cvt_pk_bf16_f32 v108, v108, v109
v_cvt_pk_bf16_f32 v109, v110, v111
v_min_u32 v108, s54, v108
v_min_u32 v109, s54, v109
buffer_store_dwordx2 v[108:109], v14, s[24:27], s45 offen
buffer_store_dwordx2 v[116:117], v14, s[24:27], s44 offen
s_mov_b64 exec, -1
s_sleep 3
s_branch CH_n2_12
CH_next_8:
s_nop 1
s_cmp_lg_u32 s29, 1
s_cbranch_scc1 KW_13
s_add_u32 s44, s30, 1
s_and_b32 s42, s44, 7
s_cmp_lg_u32 s42, 0
s_cbranch_scc1 KW_13
s_cmp_ge_u32 s44, 64
s_cbranch_scc1 KW_13
s_lshl_b32 s44, s44, 4
s_add_u32 s44, s44, 4196352
v_mov_b32 v72, s44
s_mov_b32 s43, 0
WF_14:
buffer_load_dword v73, v72, s[24:27], 0 offen sc1
s_add_u32 s43, s43, 1
s_waitcnt vmcnt(0)
v_readfirstlane_b32 s42, v73
s_cmp_ge_u32 s42, 64
s_cbranch_scc1 WFd_15
s_cmp_gt_u32 s43, 400000
s_cbranch_scc1 WFd_15
s_sleep 1
s_branch WF_14
WFd_15:
KW_13:
v_mov_b64 v[56:57], 0
v_mov_b64 v[58:59], 0
v_mov_b64 v[60:61], 0
v_mov_b64 v[62:63], 0
v_mov_b64 v[64:65], 0
v_mov_b64 v[66:67], 0
v_mov_b64 v[68:69], 0
v_mov_b64 v[70:71], 0
v_mov_b64 v[48:49], 0
v_mov_b64 v[50:51], 0
v_mov_b64 v[52:53], 0
v_mov_b64 v[54:55], 0
s_sleep 12
CH_n2_12:
s_xor_b32 s46, s46, 262144
s_bfe_i32 s70, s30, 0x10001
s_branch CH_step_2
CH_done_5:
s_waitcnt vmcnt(0)
s_barrier
s_add_u32 s30, s30, 1
s_cmp_lg_u32 s29, 1
s_cbranch_scc1 PG_16
s_cmp_eq_u32 s30, 0
s_cbranch_scc1 PG_16
s_sub_u32 s44, s30, 1
s_lshr_b32 s44, s44, 1
s_lshl_b32 s44, s44, 7
s_add_u32 s44, s44, 4199424
v_mov_b32 v72, 0
v_mov_b32 v73, 1
s_mov_b64 exec, 1
buffer_atomic_add v73, v72, s[24:27], s44 offen sc1
s_mov_b64 exec, -1
PG_16:
s_branch L_m_cend
L_m_slow:
s_mov_b32 s30, 0
s_mov_b32 s32, s53
s_mov_b32 s33, s53
s_mov_b32 s70, 0
s_mov_b32 s45, 2097152
s_mov_b32 s46, 3145728
s_lshl_b32 s42, s28, 14
s_lshl_b32 s43, s29, 11
s_add_u32 s42, s42, s43
s_add_u32 s47, s42, 33554432
s_lshl_b32 s42, s28, 11
s_add_u32 s48, s42, 5242880
s_lshl_b32 s42, s28, 12
s_lshl_b32 s43, s29, 10
s_add_u32 s42, s42, s43
s_add_u32 s49, s42, 9437184
s_lshl_b32 s42, s29, 11
s_add_u32 s68, s42, 131072
s_add_u32 s69, s42, 139264
v_mov_b32 v72, 4196352
s_mov_b32 s43, 0
WF_24:
buffer_load_dword v73, v72, s[24:27], 0 offen sc1
s_add_u32 s43, s43, 1
s_waitcnt vmcnt(0)
v_readfirstlane_b32 s42, v73
s_cmp_ge_u32 s42, 64
s_cbranch_scc1 WFd_25
s_cmp_gt_u32 s43, 400000
s_cbranch_scc1 WFd_25
s_sleep 1
s_branch WF_24
WFd_25:
s_mov_b32 m0, s68
s_nop 0
buffer_load_dwordx4 v1, s[24:27], s47 offen sc1 lds
buffer_load_dwordx4 v1, s[24:27], s47 offen offset:1024 sc1 lds
s_waitcnt vmcnt(0)
s_barrier
v_mov_b64 v[48:49], 0
v_mov_b64 v[50:51], 0
v_mov_b64 v[52:53], 0
v_mov_b64 v[54:55], 0
v_mov_b64 v[56:57], 0
v_mov_b64 v[58:59], 0
v_mov_b64 v[60:61], 0
v_mov_b64 v[62:63], 0
v_mov_b64 v[64:65], 0
v_mov_b64 v[66:67], 0
v_mov_b64 v[68:69], 0
v_mov_b64 v[70:71], 0
CH_step_17:
s_mov_b32 s71, 0
s_mov_b64 s[4:5], -1
s_mov_b64 s[6:7], -1
CH_poll_18:
s_mov_b64 exec, s[4:5]
buffer_load_dwordx4 v[16:19], v2, s[24:27], s45 offen sc1
s_mov_b64 exec, s[6:7]
buffer_load_dwordx4 v[20:23], v2, s[24:27], s45 offen offset:1024 sc1
s_mov_b64 exec, -1
s_add_u32 s71, s71, 1
s_waitcnt vmcnt(1)
v_max3_u32 v72, v16, v17, v18
v_max_u32 v72, v72, v19
v_cmp_eq_u32 s[4:5], -1, v72
s_waitcnt vmcnt(0)
v_max3_u32 v73, v20, v21, v22
v_max_u32 v73, v73, v23
v_cmp_eq_u32 s[6:7], -1, v73
s_cmp_gt_u32 s71, 300000
s_cbranch_scc1 CH_pok_21
s_or_b64 vcc, s[4:5], s[6:7]
s_cbranch_scc1 CH_poll_18
CH_pok_21:
ds_write_b128 v3, v[16:19]
ds_write_b128 v3, v[20:23] offset:1024
v_smfmac_f32_16x16x64_bf16 v[48:51], v[16:19], a[0:7], v7
s_add_u32 s42, s47, 8192
s_add_u32 s43, s47, 524288
s_mov_b32 m0, s69
v_smfmac_f32_16x16x64_bf16 v[52:55], v[16:19], a[64:71], v7
v_smfmac_f32_16x16x64_bf16 v[48:51], v[20:23], a[8:15], v7
v_smfmac_f32_16x16x64_bf16 v[52:55], v[20:23], a[72:79], v7
s_waitcnt lgkmcnt(0)
s_barrier
v_smfmac_f32_16x16x64_bf16 v[56:59], v[16:19], a[128:135], v7
ds_read_b128 v[24:27], v4 offset:0
v_smfmac_f32_16x16x64_bf16 v[60:63], v[16:19], a[192:199], v7
ds_read_b128 v[28:31], v4 offset:1024
v_smfmac_f32_16x16x64_bf16 v[56:59], v[20:23], a[136:143], v7
ds_read_b128 v[32:35], v5 offset:0
v_smfmac_f32_16x16x64_bf16 v[60:63], v[20:23], a[200:207], v7
ds_read_b128 v[36:39], v5 offset:1024
v_smfmac_f32_16x16x64_bf16 v[64:67], v[16:19], v[128:135], v7
ds_read_b128 v[40:43], v6 offset:0
v_smfmac_f32_16x16x64_bf16 v[68:71], v[16:19], v[192:199], v7
ds_read_b128 v[44:47], v6 offset:1024
v_smfmac_f32_16x16x64_bf16 v[64:67], v[20:23], v[136:143], v7
buffer_load_dwordx4 v[120:123], v1, s[24:27], s42 offen sc1
v_smfmac_f32_16x16x64_bf16 v[68:71], v[20:23], v[200:207], v7
buffer_load_dwordx4 v[124:127], v1, s[24:27], s42 offen offset:1024 sc1
s_waitcnt lgkmcnt(5)
v_smfmac_f32_16x16x64_bf16 v[48:51], v[24:27], a[16:23], v7
v_smfmac_f32_16x16x64_bf16 v[52:55], v[24:27], a[80:87], v7
s_waitcnt lgkmcnt(4)
v_smfmac_f32_16x16x64_bf16 v[48:51], v[28:31], a[24:31], v7
buffer_load_dwordx4 v1, s[24:27], s43 offen sc1 lds
v_smfmac_f32_16x16x64_bf16 v[52:55], v[28:31], a[88:95], v7
s_waitcnt lgkmcnt(3)
v_smfmac_f32_16x16x64_bf16 v[48:51], v[32:35], a[32:39], v7
v_smfmac_f32_16x16x64_bf16 v[52:55], v[32:35], a[96:103], v7
s_waitcnt lgkmcnt(2)
v_smfmac_f32_16x16x64_bf16 v[48:51], v[36:39], a[40:47], v7
buffer_load_dwordx4 v1, s[24:27], s43 offen offset:1024 sc1 lds
v_smfmac_f32_16x16x64_bf16 v[52:55], v[36:39], a[104:111], v7
s_waitcnt lgkmcnt(1)
v_smfmac_f32_16x16x64_bf16 v[48:51], v[40:43], a[48:55], v7
v_smfmac_f32_16x16x64_bf16 v[52:55], v[40:43], a[112:119], v7
s_waitcnt lgkmcnt(0)
v_smfmac_f32_16x16x64_bf16 v[48:51], v[44:47], a[56:63], v7
v_smfmac_f32_16x16x64_bf16 v[52:55], v[44:47], a[120:127], v7
s_cmp_lg_u32 s29, 1
s_cbranch_scc1 PG_26
s_cmp_eq_u32 s30, 0
s_cbranch_scc1 PG_26
s_sub_u32 s44, s30, 1
s_lshr_b32 s44, s44, 1
s_lshl_b32 s44, s44, 7
s_add_u32 s44, s44, 4199424
v_mov_b32 v72, 0
v_mov_b32 v73, 1
s_mov_b64 exec, 1
buffer_atomic_add v73, v72, s[24:27], s44 offen sc1
s_mov_b64 exec, -1
PG_26:
v_smfmac_f32_16x16x64_bf16 v[56:59], v[24:27], a[144:151], v7
ds_read_b128 v[88:91], v13 offset:0
v_smfmac_f32_16x16x64_bf16 v[60:63], v[24:27], a[208:215], v7
ds_read_b128 v[92:95], v13 offset:1024
v_pk_add_f32 v[48:49], v[48:49], v[50:51]
v_smfmac_f32_16x16x64_bf16 v[56:59], v[28:31], a[152:159], v7
ds_read_b128 v[96:99], v13 offset:2048
v_pk_add_f32 v[52:53], v[52:53], v[54:55]
v_smfmac_f32_16x16x64_bf16 v[60:63], v[28:31], a[216:223], v7
v_cvt_pk_bf16_f32 v48, v48, v52
ds_write_b32 v8, v48 offset:0
v_smfmac_f32_16x16x64_bf16 v[56:59], v[32:35], a[160:167], v7
v_cvt_pk_bf16_f32 v49, v49, v53
ds_write_b32 v8, v49 offset:272
v_smfmac_f32_16x16x64_bf16 v[60:63], v[32:35], a[224:231], v7
ds_read_b128 v[100:103], v13 offset:3072
v_smfmac_f32_16x16x64_bf16 v[56:59], v[36:39], a[168:175], v7
ds_read_b128 v[104:107], v15 offset:0
v_smfmac_f32_16x16x64_bf16 v[60:63], v[36:39], a[232:239], v7
ds_read_b128 v[108:111], v15 offset:1024
v_smfmac_f32_16x16x64_bf16 v[56:59], v[40:43], a[176:183], v7
ds_read_b128 v[112:115], v15 offset:4096
v_smfmac_f32_16x16x64_bf16 v[60:63], v[40:43], a[240:247], v7
ds_read_b128 v[116:119], v15 offset:5120
v_smfmac_f32_16x16x64_bf16 v[56:59], v[44:47], a[184:191], v7
ds_read_b128 v[16:19], v13 offset:4096
v_smfmac_f32_16x16x64_bf16 v[60:63], v[44:47], a[248:255], v7
ds_read_b128 v[20:23], v13 offset:5120
v_smfmac_f32_16x16x64_bf16 v[64:67], v[24:27], v[144:151], v7
v_smfmac_f32_16x16x64_bf16 v[68:71], v[24:27], v[208:215], v7
v_pk_add_f32 v[56:57], v[56:57], v[58:59]
v_smfmac_f32_16x16x64_bf16 v[64:67], v[28:31], v[152:159], v7
v_pk_add_f32 v[60:61], v[60:61], v[62:63]
v_smfmac_f32_16x16x64_bf16 v[68:71], v[28:31], v[216:223], v7
v_cvt_pk_bf16_f32 v56, v56, v60
ds_write_b32 v8, v56 offset:2176
v_smfmac_f32_16x16x64_bf16 v[64:67], v[32:35], v[160:167], v7
v_cvt_pk_bf16_f32 v57, v57, v61
ds_write_b32 v8, v57 offset:2448
v_smfmac_f32_16x16x64_bf16 v[68:71], v[32:35], v[224:231], v7
s_waitcnt lgkmcnt(0)
s_barrier
v_smfmac_f32_16x16x64_bf16 v[64:67], v[36:39], v[168:175], v7
ds_read_b128 v[72:75], v9 offset:0
v_smfmac_f32_16x16x64_bf16 v[68:71], v[36:39], v[232:239], v7
ds_read_b128 v[76:79], v9 offset:64
buffer_store_dword v56, v10, s[24:27], s48 offen sc1
v_smfmac_f32_16x16x64_bf16 v[64:67], v[40:43], v[176:183], v7
ds_read_b128 v[80:83], v9 offset:128
v_smfmac_f32_16x16x64_bf16 v[68:71], v[40:43], v[240:247], v7
ds_read_b128 v[84:87], v9 offset:192
buffer_store_dword v57, v10, s[24:27], s48 offen offset:64 sc1
v_smfmac_f32_16x16x64_bf16 v[64:67], v[44:47], v[184:191], v7
ds_read_b128 v[24:27], v13 offset:6144
v_smfmac_f32_16x16x64_bf16 v[68:71], v[44:47], v[248:255], v7
ds_read_b128 v[28:31], v13 offset:7168
s_waitcnt lgkmcnt(5)
v_mfma_f32_16x16x32_bf16 v[48:51], v[88:91], v[72:75], 0
ds_read_b128 v[88:91], v9 offset:2176
s_waitcnt lgkmcnt(5)
v_mfma_f32_16x16x32_bf16 v[48:51], v[92:95], v[76:79], v[48:51]
ds_read_b128 v[92:95], v9 offset:2240
s_waitcnt lgkmcnt(5)
v_mfma_f32_16x16x32_bf16 v[48:51], v[96:99], v[80:83], v[48:51]
ds_read_b128 v[96:99], v9 offset:2304
v_cvt_pk_bf16_f32 v64, v64, v65
v_cvt_pk_bf16_f32 v65, v66, v67
s_waitcnt lgkmcnt(5)
v_mfma_f32_16x16x32_bf16 v[48:51], v[100:103], v[84:87], v[48:51]
ds_read_b128 v[100:103], v9 offset:2368
v_cvt_pk_bf16_f32 v66, v68, v69
v_cvt_pk_bf16_f32 v67, v70, v71
v_mfma_f32_16x16x32_bf16 v[52:55], v[16:19], v[72:75], 0
ds_read_b128 v[32:35], v15 offset:2048
v_xor_b32 v13, 0x2000, v13
v_mfma_f32_16x16x32_bf16 v[52:55], v[20:23], v[76:79], v[52:55]
ds_read_b128 v[36:39], v15 offset:3072
s_waitcnt lgkmcnt(7)
v_mfma_f32_16x16x32_bf16 v[52:55], v[24:27], v[80:83], v[52:55]
ds_read_b128 v[40:43], v15 offset:6144
v_max3_f32 v68, v48, v49, v50
s_waitcnt lgkmcnt(7)
v_mfma_f32_16x16x32_bf16 v[52:55], v[28:31], v[84:87], v[52:55]
ds_read_b128 v[44:47], v15 offset:7168
buffer_store_dwordx4 v[64:67], v1, s[24:27], s49 offen sc1
s_cmp_eq_u32 s30, 63
s_cbranch_scc1 CH_done_20
s_waitcnt lgkmcnt(4)
v_mfma_f32_16x16x32_bf16 v[60:63], v[88:91], v[72:75], 0
v_mov_b64 v[16:17], 0
v_mov_b64 v[18:19], 0
v_mfma_f32_16x16x32_bf16 v[60:63], v[92:95], v[76:79], v[60:63]
v_mov_b64 v[20:21], 0
v_mov_b64 v[22:23], 0
v_mfma_f32_16x16x32_bf16 v[60:63], v[96:99], v[80:83], v[60:63]
v_max3_f32 v69, v51, v52, v53
v_max3_f32 v68, v68, v54, v55
v_mfma_f32_16x16x32_bf16 v[60:63], v[100:103], v[84:87], v[60:63]
v_max_f32 v68, v68, v69
v_mov_b64 v[24:25], 0
v_mov_b64 v[26:27], 0
v_mov_b64 v[28:29], 0
v_mov_b64 v[30:31], 0
v_mov_b64 v[88:89], 0
v_mov_b64 v[90:91], 0
v_mov_b64 v[92:93], 0
v_max3_f32 v68, v68, v60, v61
v_mov_b32 v69, v68
v_mov_b64 v[94:95], 0
v_mov_b64 v[96:97], 0
v_permlane16_swap_b32 v68, v69
v_max_f32 v68, v68, v69
v_mov_b32 v69, v68
v_mov_b64 v[98:99], 0
s_add_u32 s47, s47, 524288
v_permlane32_swap_b32 v68, v69
v_max_f32 v68, v68, v69
v_mul_f32 v68, s53, v68
v_pk_fma_f32 v[60:61], v[60:61], s[32:33], v[68:69] op_sel_hi:[1,1,0] neg_lo:[0,0,1] neg_hi:[0,0,1]
v_pk_fma_f32 v[48:49], v[48:49], s[32:33], v[68:69] op_sel_hi:[1,1,0] neg_lo:[0,0,1] neg_hi:[0,0,1]
v_pk_fma_f32 v[50:51], v[50:51], s[32:33], v[68:69] op_sel_hi:[1,1,0] neg_lo:[0,0,1] neg_hi:[0,0,1]
v_exp_f32 v60, v60
v_exp_f32 v61, v61
v_pk_fma_f32 v[52:53], v[52:53], s[32:33], v[68:69] op_sel_hi:[1,1,0] neg_lo:[0,0,1] neg_hi:[0,0,1]
v_pk_fma_f32 v[54:55], v[54:55], s[32:33], v[68:69] op_sel_hi:[1,1,0] neg_lo:[0,0,1] neg_hi:[0,0,1]
v_cvt_pk_bf16_f32 v56, v60, v61
v_cvt_pk_bf16_f32 v57, v60, v61
v_exp_f32 v48, v48
v_exp_f32 v49, v49
v_mfma_f32_16x16x16_bf16 v[100:103], v[64:65], v[56:57], 0
ds_read_b128 v[72:75], v15 offset:8192
v_exp_f32 v50, v50
v_exp_f32 v51, v51
v_pk_add_f32 v[70:71], v[60:61], v[48:49]
v_mfma_f32_16x16x16_bf16 v[60:63], v[66:67], v[56:57], 0
ds_read_b128 v[76:79], v15 offset:9216
v_exp_f32 v52, v52
v_exp_f32 v53, v53
v_exp_f32 v54, v54
v_exp_f32 v55, v55
v_pk_add_f32 v[68:69], v[50:51], v[52:53]
v_cvt_pk_bf16_f32 v48, v48, v49
v_cvt_pk_bf16_f32 v49, v50, v51
v_cvt_pk_bf16_f32 v50, v52, v53
v_cvt_pk_bf16_f32 v51, v54, v55
v_pk_add_f32 v[70:71], v[70:71], v[54:55]
s_waitcnt vmcnt(5)
v_mfma_f32_16x16x32_bf16 v[100:103], v[120:123], v[48:51], v[100:103]
ds_read_b128 v[80:83], v15 offset:12288
v_pk_add_f32 v[70:71], v[70:71], v[68:69]
v_mfma_f32_16x16x32_bf16 v[60:63], v[124:127], v[48:51], v[60:63]
ds_read_b128 v[84:87], v15 offset:13312
v_add_f32 v70, v70, v71
v_mov_b32 v71, v70
v_add_u32 v52, 160256, v1
s_xor_b32 s69, s69, 0x2000
v_permlane16_swap_b32 v70, v71
v_add_f32 v70, v70, v71
v_mov_b32 v71, v70
v_cndmask_b32 v56, v101, v100, s[50:51]
v_cndmask_b32 v58, v103, v102, s[50:51]
v_permlane32_swap_b32 v70, v71
v_add_f32 v70, v70, v71
v_rcp_f32 v70, v70
v_cndmask_b32 v57, v61, v60, s[50:51]
v_cndmask_b32 v59, v63, v62, s[50:51]
v_pk_mul_f32 v[56:57], v[56:57], v[70:71] op_sel_hi:[1,0]
v_pk_mul_f32 v[58:59], v[58:59], v[70:71] op_sel_hi:[1,0]
v_cvt_pk_bf16_f32 v48, v56, v57
v_cvt_pk_bf16_f32 v49, v58, v59
ds_write_b64 v11, v[48:49]
v_mov_b64 v[100:101], 0
v_mov_b64 v[102:103], 0
s_add_u32 s42, s46, 8192
s_waitcnt lgkmcnt(0)
s_barrier
ds_read_b128 v[120:123], v52
ds_read_b128 v[124:127], v52 offset:1024
ds_read_b128 v[56:59], v15 offset:10240
ds_read_b128 v[60:63], v15 offset:11264
ds_read_b128 v[64:67], v15 offset:14336
ds_read_b128 v[68:71], v15 offset:15360
s_waitcnt lgkmcnt(5)
v_smfmac_f32_16x16x64_bf16 v[16:19], v[120:123], v[104:111], v7
ds_read_b128 v[104:107], v15 offset:16384
ds_read_b128 v[108:111], v15 offset:17408
v_smfmac_f32_16x16x64_bf16 v[20:23], v[120:123], v[112:119], v7
ds_read_b128 v[112:115], v15 offset:20480
ds_read_b128 v[116:119], v15 offset:21504
s_waitcnt lgkmcnt(8)
v_smfmac_f32_16x16x64_bf16 v[16:19], v[124:127], v[32:39], v7
ds_read_b128 v[32:35], v15 offset:18432
ds_read_b128 v[36:39], v15 offset:19456
v_smfmac_f32_16x16x64_bf16 v[20:23], v[124:127], v[40:47], v7
ds_read_b128 v[40:43], v15 offset:22528
ds_read_b128 v[44:47], v15 offset:23552
v_smfmac_f32_16x16x64_bf16 v[24:27], v[120:123], v[72:79], v7
ds_read_b128 v[72:75], v15 offset:24576
v_smfmac_f32_16x16x64_bf16 v[28:31], v[120:123], v[80:87], v7
ds_read_b128 v[76:79], v15 offset:25600
v_pk_add_f32 v[16:17], v[16:17], v[18:19]
s_waitcnt lgkmcnt(12)
v_smfmac_f32_16x16x64_bf16 v[24:27], v[124:127], v[56:63], v7
ds_read_b128 v[80:83], v15 offset:28672
v_pk_add_f32 v[20:21], v[20:21], v[22:23]
s_waitcnt lgkmcnt(11)
v_smfmac_f32_16x16x64_bf16 v[28:31], v[124:127], v[64:71], v7
ds_read_b128 v[84:87], v15 offset:29696
v_cvt_pk_bf16_f32 v48, v16, v20
s_waitcnt lgkmcnt(10)
v_smfmac_f32_16x16x64_bf16 v[88:91], v[120:123], v[104:111], v7
ds_read_b128 v[56:59], v15 offset:26624
v_cvt_pk_bf16_f32 v50, v17, v21
s_waitcnt lgkmcnt(9)
v_smfmac_f32_16x16x64_bf16 v[92:95], v[120:123], v[112:119], v7
ds_read_b128 v[60:63], v15 offset:27648
v_bfi_b32 v48, 1, s70, v48
s_waitcnt lgkmcnt(8)
v_smfmac_f32_16x16x64_bf16 v[88:91], v[124:127], v[32:39], v7
ds_read_b128 v[64:67], v15 offset:30720
v_pk_add_f32 v[24:25], v[24:25], v[26:27]
s_waitcnt lgkmcnt(7)
v_smfmac_f32_16x16x64_bf16 v[92:95], v[124:127], v[40:47], v7
ds_read_b128 v[68:71], v15 offset:31744
v_pk_add_f32 v[28:29], v[28:29], v[30:31]
s_waitcnt lgkmcnt(6)
v_smfmac_f32_16x16x64_bf16 v[96:99], v[120:123], v[72:79], v7
v_cvt_pk_bf16_f32 v49, v24, v28
s_waitcnt lgkmcnt(4)
v_smfmac_f32_16x16x64_bf16 v[100:103], v[120:123], v[80:87], v7
v_cvt_pk_bf16_f32 v51, v25, v29
buffer_store_dwordx4 v[48:51], v12, s[24:27], s46 offen sc1
s_waitcnt lgkmcnt(2)
v_smfmac_f32_16x16x64_bf16 v[96:99], v[124:127], v[56:63], v7
v_pk_add_f32 v[88:89], v[88:89], v[90:91]
s_waitcnt lgkmcnt(0)
v_smfmac_f32_16x16x64_bf16 v[100:103], v[124:127], v[64:71], v7
v_pk_add_f32 v[92:93], v[92:93], v[94:95]
v_cvt_pk_bf16_f32 v52, v88, v92
v_cvt_pk_bf16_f32 v54, v89, v93
v_bfi_b32 v52, 1, s70, v52
s_nop 3
v_pk_add_f32 v[96:97], v[96:97], v[98:99]
v_pk_add_f32 v[100:101], v[100:101], v[102:103]
v_cvt_pk_bf16_f32 v53, v96, v100
v_cvt_pk_bf16_f32 v55, v97, v101
buffer_store_dwordx4 v[52:55], v12, s[24:27], s42 offen sc1
s_add_u32 s45, s45, 8192
s_and_b32 s45, s45, 0xffff7fff
s_xor_b32 s44, s45, 0x4000
s_add_u32 s48, s48, 65536
s_add_u32 s49, s49, 131072
s_add_u32 s30, s30, 1
s_cmp_lg_u32 s29, 0
s_cbranch_scc1 CH_next_23
s_mov_b32 s56, 0x00030003
s_mov_b32 s57, 0x00030003
s_lshl_b32 s42, s28, 13
s_add_u32 s42, s42, s46
s_add_u32 s43, s42, 4096
s_mov_b32 s52, 0
v_and_b32 v112, 16, v1
v_mov_b32 v113, 0x3f80
v_lshlrev_b32 v112, v112, v113
v_mov_b64 v[116:117], -1
v_cndmask_b32 v104, 0, v112, s[56:57]
s_lshl_b64 s[56:57], s[56:57], 2
v_cndmask_b32 v105, 0, v112, s[56:57]
s_lshl_b64 s[56:57], s[56:57], 2
v_cndmask_b32 v106, 0, v112, s[56:57]
s_lshl_b64 s[56:57], s[56:57], 2
v_cndmask_b32 v107, 0, v112, s[56:57]
v_mov_b64 v[56:57], 0
v_mov_b64 v[58:59], 0
v_mov_b64 v[60:61], 0
v_mov_b64 v[62:63], 0
v_mov_b64 v[64:65], 0
v_mov_b64 v[66:67], 0
v_mov_b64 v[68:69], 0
v_mov_b64 v[70:71], 0
v_mov_b64 v[48:49], 0
v_mov_b64 v[50:51], 0
v_mov_b64 v[52:53], 0
v_mov_b64 v[54:55], 0
s_sleep 2
s_mov_b64 vcc, -1
CH_red_19:
s_mov_b64 exec, vcc
buffer_load_dwordx4 v[72:75], v1, s[24:27], s42 offen offset:0 sc1
buffer_load_dwordx4 v[76:79], v1, s[24:27], s42 offen offset:1024 sc1
buffer_load_dwordx4 v[80:83], v1, s[24:27], s42 offen offset:2048 sc1
buffer_load_dwordx4 v[84:87], v1, s[24:27], s42 offen offset:3072 sc1
buffer_load_dwordx4 v[88:91], v1, s[24:27], s43 offen offset:0 sc1
buffer_load_dwordx4 v[92:95], v1, s[24:27], s43 offen offset:1024 sc1
buffer_load_dwordx4 v[96:99], v1, s[24:27], s43 offen offset:2048 sc1
buffer_load_dwordx4 v[100:103], v1, s[24:27], s43 offen offset:3072 sc1
s_mov_b64 exec, -1
s_add_u32 s52, s52, 1
s_waitcnt vmcnt(7)
v_mfma_f32_16x16x32_bf16 v[108:111], v[104:107], v[72:75], 0
s_waitcnt vmcnt(6)
v_mfma_f32_16x16x32_bf16 v[108:111], v[104:107], v[76:79], v[108:111]
v_bitop3_b32 v112, v72, v76, s70 bitop3:0x7e
s_waitcnt vmcnt(5)
v_mfma_f32_16x16x32_bf16 v[108:111], v[104:107], v[80:83], v[108:111]
s_waitcnt vmcnt(4)
v_mfma_f32_16x16x32_bf16 v[108:111], v[104:107], v[84:87], v[108:111]
v_bitop3_b32 v113, v80, v84, s70 bitop3:0x7e
s_waitcnt vmcnt(3)
v_mfma_f32_16x16x32_bf16 v[108:111], v[104:107], v[88:91], v[108:111]
s_waitcnt vmcnt(2)
v_mfma_f32_16x16x32_bf16 v[108:111], v[104:107], v[92:95], v[108:111]
v_bitop3_b32 v114, v88, v92, s70 bitop3:0x7e
s_waitcnt vmcnt(1)
v_mfma_f32_16x16x32_bf16 v[108:111], v[104:107], v[96:99], v[108:111]
s_waitcnt vmcnt(0)
v_mfma_f32_16x16x32_bf16 v[108:111], v[104:107], v[100:103], v[108:111]
v_bitop3_b32 v115, v96, v100, s70 bitop3:0x7e
v_or3_b32 v112, v112, v113, v114
v_or_b32 v112, v112, v115
v_and_b32 v112, 1, v112
v_cmp_ne_u32 vcc, 0, v112
s_cmp_gt_u32 s52, 300000
s_cbranch_scc1 CH_rok_22
s_cbranch_vccnz CH_red_19
CH_rok_22:
s_mov_b64 exec, 0xffffffff
v_cvt_pk_bf16_f32 v108, v108, v109
v_cvt_pk_bf16_f32 v109, v110, v111
v_min_u32 v108, s54, v108
v_min_u32 v109, s54, v109
buffer_store_dwordx2 v[108:109], v14, s[24:27], s45 offen sc1
buffer_store_dwordx2 v[116:117], v14, s[24:27], s44 offen sc1
s_mov_b64 exec, -1
s_sleep 3
s_branch CH_n2_27
CH_next_23:
s_nop 1
s_cmp_lg_u32 s29, 1
s_cbranch_scc1 KW_28
s_add_u32 s44, s30, 1
s_and_b32 s42, s44, 7
s_cmp_lg_u32 s42, 0
s_cbranch_scc1 KW_28
s_cmp_ge_u32 s44, 64
s_cbranch_scc1 KW_28
s_lshl_b32 s44, s44, 4
s_add_u32 s44, s44, 4196352
v_mov_b32 v72, s44
s_mov_b32 s43, 0
WF_29:
buffer_load_dword v73, v72, s[24:27], 0 offen sc1
s_add_u32 s43, s43, 1
s_waitcnt vmcnt(0)
v_readfirstlane_b32 s42, v73
s_cmp_ge_u32 s42, 64
s_cbranch_scc1 WFd_30
s_cmp_gt_u32 s43, 400000
s_cbranch_scc1 WFd_30
s_sleep 1
s_branch WF_29
WFd_30:
KW_28:
v_mov_b64 v[56:57], 0
v_mov_b64 v[58:59], 0
v_mov_b64 v[60:61], 0
v_mov_b64 v[62:63], 0
v_mov_b64 v[64:65], 0
v_mov_b64 v[66:67], 0
v_mov_b64 v[68:69], 0
v_mov_b64 v[70:71], 0
v_mov_b64 v[48:49], 0
v_mov_b64 v[50:51], 0
v_mov_b64 v[52:53], 0
v_mov_b64 v[54:55], 0
s_sleep 12
CH_n2_27:
s_xor_b32 s46, s46, 262144
s_bfe_i32 s70, s30, 0x10001
s_branch CH_step_17
CH_done_20:
s_waitcnt vmcnt(0)
s_barrier
s_add_u32 s30, s30, 1
s_cmp_lg_u32 s29, 1
s_cbranch_scc1 PG_31
s_cmp_eq_u32 s30, 0
s_cbranch_scc1 PG_31
s_sub_u32 s44, s30, 1
s_lshr_b32 s44, s44, 1
s_lshl_b32 s44, s44, 7
s_add_u32 s44, s44, 4199424
v_mov_b32 v72, 0
v_mov_b32 v73, 1
s_mov_b64 exec, 1
buffer_atomic_add v73, v72, s[24:27], s44 offen sc1
s_mov_b64 exec, -1
PG_31:
L_m_cend:
s_mov_b32 s89, 1
s_barrier
L_m_work:
v_lshrrev_b32 v34, 6, v0
s_nop 0
v_readfirstlane_b32 s29, v34
s_nop 3
s_mov_b32 s54, 0xc0135761
s_mov_b32 s55, 0xbdd2d3e8
s_cmp_eq_u32 s92, 1
s_mov_b32 s92, 0
s_cbranch_scc1 L_m_disp
L_m_next:
s_cmp_eq_u32 s89, 1
s_cbranch_scc1 L_m_tick
s_cmp_lg_u32 s29, 0
s_cbranch_scc1 AT_32
v_mov_b32 v2, 1024
v_mov_b32 v4, 0
s_mov_b32 s89, 4194304
s_mov_b64 exec, 1
buffer_load_dword v4, v2, s[84:87], s89 offen sc1
v_mov_b32 v3, 162304
s_waitcnt vmcnt(0)
ds_write_b32 v3, v4
s_mov_b64 exec, -1
s_waitcnt lgkmcnt(0)
AT_32:
s_barrier
v_mov_b32 v3, 162304
ds_read_b32 v4, v3
s_waitcnt lgkmcnt(0)
v_readfirstlane_b32 s89, v4
s_barrier
s_cmp_lg_u32 s89, 2
s_cbranch_scc1 L_m_tick
s_cmp_lg_u32 s29, 0
s_cbranch_scc1 AT_33
v_mov_b32 v2, 1408
v_mov_b32 v4, 1
s_mov_b32 s28, 4194304
s_mov_b64 exec, 1
buffer_atomic_add v4, v2, s[84:87], s28 offen sc0 sc1
v_mov_b32 v3, 162304
s_waitcnt vmcnt(0)
ds_write_b32 v3, v4
s_mov_b64 exec, -1
s_waitcnt lgkmcnt(0)
AT_33:
s_barrier
v_mov_b32 v3, 162304
ds_read_b32 v4, v3
s_waitcnt lgkmcnt(0)
v_readfirstlane_b32 s28, v4
s_barrier
s_mov_b32 s89, 1
s_mov_b32 s31, 1
s_cmp_lt_u32 s28, 32
s_cbranch_scc1 L_m_chain
L_m_tick:
s_cmp_lg_u32 s29, 0
s_cbranch_scc1 AT_34
v_mov_b32 v2, 1152
v_mov_b32 v4, 1
s_mov_b32 s88, 4194304
s_mov_b64 exec, 1
buffer_atomic_add v4, v2, s[84:87], s88 offen sc0 sc1
v_mov_b32 v3, 162304
s_waitcnt vmcnt(0)
ds_write_b32 v3, v4
s_mov_b64 exec, -1
s_waitcnt lgkmcnt(0)
AT_34:
s_barrier
v_mov_b32 v3, 162304
ds_read_b32 v4, v3
s_waitcnt lgkmcnt(0)
v_readfirstlane_b32 s88, v4
s_barrier
s_cmp_eq_u32 s89, 1
s_cbranch_scc1 L_m_disp
s_cmp_lt_u32 s88, 1000
s_cbranch_scc1 L_m_disp
s_mov_b32 s92, 0
L_m_res:
s_cmp_lg_u32 s29, 0
s_cbranch_scc1 AT_35
v_mov_b32 v2, 1024
v_mov_b32 v4, 0
s_mov_b32 s89, 4194304
s_mov_b64 exec, 1
buffer_load_dword v4, v2, s[84:87], s89 offen sc1
v_mov_b32 v3, 162304
s_waitcnt vmcnt(0)
ds_write_b32 v3, v4
s_mov_b64 exec, -1
s_waitcnt lgkmcnt(0)
AT_35:
s_barrier
v_mov_b32 v3, 162304
ds_read_b32 v4, v3
s_waitcnt lgkmcnt(0)
v_readfirstlane_b32 s89, v4
s_barrier
s_cmp_eq_u32 s89, 1
s_cbranch_scc1 L_m_res1
s_cmp_eq_u32 s89, 2
s_cbranch_scc1 L_m_res2
s_sleep 20
s_add_u32 s92, s92, 1
s_cmp_lt_u32 s92, 400
s_cbranch_scc1 L_m_res
s_cmp_lg_u32 s29, 0
s_cbranch_scc1 AT_36
v_mov_b32 v2, 1024
v_mov_b32 v4, 2
v_mov_b32 v5, 0
s_mov_b32 s89, 4194304
s_mov_b64 exec, 1
buffer_atomic_cmpswap v[4:5], v2, s[84:87], s89 offen sc0 sc1
v_mov_b32 v3, 162304
s_waitcnt vmcnt(0)
ds_write_b32 v3, v4
s_mov_b64 exec, -1
s_waitcnt lgkmcnt(0)
AT_36:
s_barrier
v_mov_b32 v3, 162304
ds_read_b32 v4, v3
s_waitcnt lgkmcnt(0)
v_readfirstlane_b32 s89, v4
s_barrier
s_branch L_m_res
L_m_res1:
s_mov_b32 s92, 0
s_branch L_m_disp
L_m_res2:
s_cmp_lg_u32 s29, 0
s_cbranch_scc1 AT_37
v_mov_b32 v2, 1408
v_mov_b32 v4, 1
s_mov_b32 s28, 4194304
s_mov_b64 exec, 1
buffer_atomic_add v4, v2, s[84:87], s28 offen sc0 sc1
v_mov_b32 v3, 162304
s_waitcnt vmcnt(0)
ds_write_b32 v3, v4
s_mov_b64 exec, -1
s_waitcnt lgkmcnt(0)
AT_37:
s_barrier
v_mov_b32 v3, 162304
ds_read_b32 v4, v3
s_waitcnt lgkmcnt(0)
v_readfirstlane_b32 s28, v4
s_barrier
s_mov_b32 s89, 1
s_mov_b32 s31, 1
s_mov_b32 s92, 1
s_cmp_lt_u32 s28, 32
s_cbranch_scc1 L_m_chain
s_mov_b32 s92, 0
L_m_disp:
s_mov_b32 s8, s80
s_and_b32 s9, s81, 0xffff
s_mov_b32 s10, 0x10000000
s_mov_b32 s11, 0x00020000
s_cmp_lt_u32 s88, 128
s_cbranch_scc1 L_m_d2
s_cmp_eq_u32 s93, 1
s_cbranch_scc1 L_m_d2
s_mov_b32 s93, 2
L_m_gw:
s_cmp_lg_u32 s29, 0
s_cbranch_scc1 AT_38
v_mov_b32 v2, 1536
v_mov_b32 v4, 0
s_mov_b32 s3, 4194304
s_mov_b64 exec, 1
buffer_load_dword v4, v2, s[84:87], s3 offen sc1
v_mov_b32 v3, 162304
s_waitcnt vmcnt(0)
ds_write_b32 v3, v4
s_mov_b64 exec, -1
s_waitcnt lgkmcnt(0)
AT_38:
s_barrier
v_mov_b32 v3, 162304
ds_read_b32 v4, v3
s_waitcnt lgkmcnt(0)
v_readfirstlane_b32 s3, v4
s_barrier
s_cmp_ge_u32 s3, 32
s_cbranch_scc1 L_m_gd
s_add_u32 s93, s93, 1
s_cmp_gt_u32 s93, 24
s_cbranch_scc1 L_m_gd
s_sleep 24
s_branch L_m_gw
L_m_gd:
s_mov_b32 s93, 1
L_m_d2:
s_cmp_ge_u32 s88, 64
s_cbranch_scc1 RG_39
s_sub_u32 s3, s88, 0
s_add_u32 s3, s3, 0
s_getpc_b64 s[90:91]
LJ_40:
s_add_u32 s90, s90, L_w_KV-LJ_40
s_addc_u32 s91, s91, 0
s_setpc_b64 s[90:91]
RG_39:
s_cmp_ge_u32 s88, 128
s_cbranch_scc1 RG_41
s_sub_u32 s3, s88, 64
s_getpc_b64 s[90:91]
LJ_42:
s_add_u32 s90, s90, L_w_Z2-LJ_42
s_addc_u32 s91, s91, 0
s_setpc_b64 s[90:91]
RG_41:
s_cmp_ge_u32 s88, 184
s_cbranch_scc1 RG_43
s_sub_u32 s3, s88, 128
s_getpc_b64 s[90:91]
LJ_44:
s_add_u32 s90, s90, L_w_Z1-LJ_44
s_addc_u32 s91, s91, 0
s_setpc_b64 s[90:91]
RG_43:
s_cmp_ge_u32 s88, 248
s_cbranch_scc1 RG_45
s_sub_u32 s3, s88, 184
s_add_u32 s3, s3, 64
s_getpc_b64 s[90:91]
LJ_46:
s_add_u32 s90, s90, L_w_KV-LJ_46
s_addc_u32 s91, s91, 0
s_setpc_b64 s[90:91]
RG_45:
s_cmp_ge_u32 s88, 376
s_cbranch_scc1 RG_47
s_sub_u32 s3, s88, 248
s_add_u32 s3, s3, 128
s_getpc_b64 s[90:91]
LJ_48:
s_add_u32 s90, s90, L_w_KV-LJ_48
s_addc_u32 s91, s91, 0
s_setpc_b64 s[90:91]
RG_47:
s_cmp_ge_u32 s88, 488
s_cbranch_scc1 RG_49
s_sub_u32 s3, s88, 376
s_getpc_b64 s[90:91]
LJ_50:
s_add_u32 s90, s90, L_w_SP-LJ_50
s_addc_u32 s91, s91, 0
s_setpc_b64 s[90:91]
RG_49:
s_cmp_ge_u32 s88, 552
s_cbranch_scc1 RG_51
s_sub_u32 s3, s88, 488
s_getpc_b64 s[90:91]
LJ_52:
s_add_u32 s90, s90, L_w_Q-LJ_52
s_addc_u32 s91, s91, 0
s_setpc_b64 s[90:91]
RG_51:
s_cmp_ge_u32 s88, 808
s_cbranch_scc1 RG_53
s_sub_u32 s3, s88, 552
s_add_u32 s3, s3, 256
s_getpc_b64 s[90:91]
LJ_54:
s_add_u32 s90, s90, L_w_KV-LJ_54
s_addc_u32 s91, s91, 0
s_setpc_b64 s[90:91]
RG_53:
s_cmp_ge_u32 s88, 1000
s_cbranch_scc1 RG_55
s_sub_u32 s3, s88, 808
s_add_u32 s3, s3, 64
s_getpc_b64 s[90:91]
LJ_56:
s_add_u32 s90, s90, L_w_Q-LJ_56
s_addc_u32 s91, s91, 0
s_setpc_b64 s[90:91]
RG_55:
s_cmp_ge_u32 s88, 1192
s_cbranch_scc1 RG_57
s_sub_u32 s3, s88, 1000
s_getpc_b64 s[90:91]
LJ_58:
s_add_u32 s90, s90, L_w_AT-LJ_58
s_addc_u32 s91, s91, 0
s_setpc_b64 s[90:91]
RG_57:
s_cmp_ge_u32 s88, 1448
s_cbranch_scc1 RG_59
s_sub_u32 s3, s88, 1192
s_getpc_b64 s[90:91]
LJ_60:
s_add_u32 s90, s90, L_w_FU-LJ_60
s_addc_u32 s91, s91, 0
s_setpc_b64 s[90:91]
RG_59:
s_cmp_ge_u32 s88, 2408
s_cbranch_scc1 RG_61
s_sub_u32 s3, s88, 1448
s_getpc_b64 s[90:91]
LJ_62:
s_add_u32 s90, s90, L_w_PO-LJ_62
s_addc_u32 s91, s91, 0
s_setpc_b64 s[90:91]
RG_61:
s_cmp_ge_u32 s88, 2792
s_cbranch_scc1 RG_63
s_sub_u32 s3, s88, 2408
s_add_u32 s3, s3, 640
s_getpc_b64 s[90:91]
LJ_64:
s_add_u32 s90, s90, L_w_FS-LJ_64
s_addc_u32 s91, s91, 0
s_setpc_b64 s[90:91]
RG_63:
s_waitcnt vmcnt(0)
s_endpgm
L_w_KV:
s_load_dwordx4 s[16:19], s[0:1], 24
v_and_b32 v34, 63, v0
v_lshlrev_b32 v1, 4, v34
s_mul_i32 s42, s29, 256
s_add_u32 s42, s42, 0
v_add_u32 v35, s42, v34
v_lshrrev_b32 v36, 4, v35
v_and_b32 v37, 15, v35
v_lshrrev_b32 v38, 2, v36
v_lshrrev_b32 v39, 3, v36
v_xor_b32 v38, v38, v39
v_and_b32 v38, 1, v38
v_and_b32 v39, 3, v36
v_lshl_or_b32 v38, v38, 2, v39
v_lshlrev_b32 v38, 1, v38
v_xor_b32 v37, v37, v38
s_mov_b32 s42, 8192
v_mul_lo_u32 v36, v36, s42
v_lshl_add_u32 v2, v37, 4, v36
s_mul_i32 s42, s29, 256
s_add_u32 s42, s42, 64
v_add_u32 v35, s42, v34
v_lshrrev_b32 v36, 4, v35
v_and_b32 v37, 15, v35
v_lshrrev_b32 v38, 2, v36
v_lshrrev_b32 v39, 3, v36
v_xor_b32 v38, v38, v39
v_and_b32 v38, 1, v38
v_and_b32 v39, 3, v36
v_lshl_or_b32 v38, v38, 2, v39
v_lshlrev_b32 v38, 1, v38
v_xor_b32 v37, v37, v38
s_mov_b32 s42, 8192
v_mul_lo_u32 v36, v36, s42
v_lshl_add_u32 v3, v37, 4, v36
s_mul_i32 s42, s29, 256
s_add_u32 s42, s42, 128
v_add_u32 v35, s42, v34
v_lshrrev_b32 v36, 4, v35
v_and_b32 v37, 15, v35
v_lshrrev_b32 v38, 2, v36
v_lshrrev_b32 v39, 3, v36
v_xor_b32 v38, v38, v39
v_and_b32 v38, 1, v38
v_and_b32 v39, 3, v36
v_lshl_or_b32 v38, v38, 2, v39
v_lshlrev_b32 v38, 1, v38
v_xor_b32 v37, v37, v38
s_mov_b32 s42, 8192
v_mul_lo_u32 v36, v36, s42
v_lshl_add_u32 v4, v37, 4, v36
s_mul_i32 s42, s29, 256
s_add_u32 s42, s42, 192
v_add_u32 v35, s42, v34
v_lshrrev_b32 v36, 4, v35
v_and_b32 v37, 15, v35
v_lshrrev_b32 v38, 2, v36
v_lshrrev_b32 v39, 3, v36
v_xor_b32 v38, v38, v39
v_and_b32 v38, 1, v38
v_and_b32 v39, 3, v36
v_lshl_or_b32 v38, v38, 2, v39
v_lshlrev_b32 v38, 1, v38
v_xor_b32 v37, v37, v38
s_mov_b32 s42, 8192
v_mul_lo_u32 v36, v36, s42
v_lshl_add_u32 v5, v37, 4, v36
v_bfe_u32 v35, v34, 2, 2
v_lshrrev_b32 v36, 4, v34
v_lshl_add_u32 v37, v36, 3, v35
v_lshrrev_b32 v38, 2, v37
v_lshrrev_b32 v39, 3, v37
v_xor_b32 v38, v38, v39
v_and_b32 v38, 1, v38
v_and_b32 v39, 3, v37
v_lshl_or_b32 v38, v38, 2, v39
v_mul_u32_u24 v37, 256, v37
v_and_b32 v39, 3, v34
v_lshl_add_u32 v37, v39, 3, v37
v_xor_b32 v39, 0, v38
v_lshl_add_u32 v18, v39, 5, v37
v_xor_b32 v39, 1, v38
v_lshl_add_u32 v19, v39, 5, v37
v_xor_b32 v39, 2, v38
v_lshl_add_u32 v20, v39, 5, v37
v_xor_b32 v39, 3, v38
v_lshl_add_u32 v21, v39, 5, v37
v_xor_b32 v39, 4, v38
v_lshl_add_u32 v22, v39, 5, v37
v_xor_b32 v39, 5, v38
v_lshl_add_u32 v23, v39, 5, v37
v_xor_b32 v39, 6, v38
v_lshl_add_u32 v24, v39, 5, v37
v_xor_b32 v39, 7, v38
v_lshl_add_u32 v25, v39, 5, v37
v_lshl_add_u32 v37, v36, 3, v35
v_add_u32 v37, 4, v37
v_lshrrev_b32 v38, 2, v37
v_lshrrev_b32 v39, 3, v37
v_xor_b32 v38, v38, v39
v_and_b32 v38, 1, v38
v_and_b32 v39, 3, v37
v_lshl_or_b32 v38, v38, 2, v39
v_mul_u32_u24 v37, 256, v37
v_and_b32 v39, 3, v34
v_lshl_add_u32 v37, v39, 3, v37
v_xor_b32 v39, 0, v38
v_lshl_add_u32 v26, v39, 5, v37
v_xor_b32 v39, 1, v38
v_lshl_add_u32 v27, v39, 5, v37
v_xor_b32 v39, 2, v38
v_lshl_add_u32 v28, v39, 5, v37
v_xor_b32 v39, 3, v38
v_lshl_add_u32 v29, v39, 5, v37
v_xor_b32 v39, 4, v38
v_lshl_add_u32 v30, v39, 5, v37
v_xor_b32 v39, 5, v38
v_lshl_add_u32 v31, v39, 5, v37
v_xor_b32 v39, 6, v38
v_lshl_add_u32 v32, v39, 5, v37
v_xor_b32 v39, 7, v38
v_lshl_add_u32 v33, v39, 5, v37
v_and_b32 v34, 1, v0
v_lshlrev_b32 v40, 10, v34
v_bfe_u32 v34, v0, 4, 2
v_lshl_add_u32 v40, v34, 8, v40
v_bfe_u32 v34, v0, 1, 3
v_lshl_add_u32 v40, v34, 4, v40
s_and_b32 s53, s3, 31
s_lshr_b32 s52, s3, 6
s_bitcmp1_b32 s3, 5
s_waitcnt lgkmcnt(0)
s_cbranch_scc1 L_w_V
s_mov_b32 s12, s16
s_and_b32 s13, s17, 0xffff
s_mov_b32 s14, 0x400000
s_mov_b32 s15, 0x00020000
s_lshl_b32 s48, s52, 2
s_add_u32 s48, s48, s29
s_lshl_b32 s48, s48, 16
s_add_u32 s48, s48, 0
s_lshl_b32 s49, s53, 8
s_mul_i32 s51, s29, 4096
s_add_u32 s42, s49, 0
s_add_u32 m0, s51, 0
s_nop 0
buffer_load_dwordx4 v2, s[12:15], s42 offen lds
s_add_u32 m0, s51, 1024
s_nop 0
buffer_load_dwordx4 v3, s[12:15], s42 offen lds
s_add_u32 m0, s51, 2048
s_nop 0
buffer_load_dwordx4 v4, s[12:15], s42 offen lds
s_add_u32 m0, s51, 3072
s_nop 0
buffer_load_dwordx4 v5, s[12:15], s42 offen lds
s_add_u32 s42, s49, 524288
s_add_u32 m0, s51, 16384
s_nop 0
buffer_load_dwordx4 v2, s[12:15], s42 offen lds
s_add_u32 m0, s51, 17408
s_nop 0
buffer_load_dwordx4 v3, s[12:15], s42 offen lds
s_add_u32 m0, s51, 18432
s_nop 0
buffer_load_dwordx4 v4, s[12:15], s42 offen lds
s_add_u32 m0, s51, 19456
s_nop 0
buffer_load_dwordx4 v5, s[12:15], s42 offen lds
buffer_load_dwordx4 v[48:51], v1, s[8:11], s48 offen offset:0
s_add_u32 s43, s48, 16384
buffer_load_dwordx4 v[52:55], v1, s[8:11], s43 offen offset:0
s_add_u32 s43, s48, 32768
buffer_load_dwordx4 v[56:59], v1, s[8:11], s43 offen offset:0
s_add_u32 s43, s48, 49152
buffer_load_dwordx4 v[60:63], v1, s[8:11], s43 offen offset:0
buffer_load_dwordx4 v[64:67], v1, s[8:11], s48 offen offset:1024
s_add_u32 s43, s48, 16384
buffer_load_dwordx4 v[68:71], v1, s[8:11], s43 offen offset:1024
s_add_u32 s43, s48, 32768
buffer_load_dwordx4 v[72:75], v1, s[8:11], s43 offen offset:1024
s_add_u32 s43, s48, 49152
buffer_load_dwordx4 v[76:79], v1, s[8:11], s43 offen offset:1024
buffer_load_dwordx4 v[80:83], v1, s[8:11], s48 offen offset:2048
s_add_u32 s43, s48, 16384
buffer_load_dwordx4 v[84:87], v1, s[8:11], s43 offen offset:2048
s_add_u32 s43, s48, 32768
buffer_load_dwordx4 v[88:91], v1, s[8:11], s43 offen offset:2048
s_add_u32 s43, s48, 49152
buffer_load_dwordx4 v[92:95], v1, s[8:11], s43 offen offset:2048
s_waitcnt vmcnt(16)
s_barrier
s_add_u32 s42, s49, 1048576
s_add_u32 m0, s51, 32768
s_nop 0
buffer_load_dwordx4 v2, s[12:15], s42 offen lds
s_add_u32 m0, s51, 33792
s_nop 0
buffer_load_dwordx4 v3, s[12:15], s42 offen lds
s_add_u32 m0, s51, 34816
s_nop 0
buffer_load_dwordx4 v4, s[12:15], s42 offen lds
s_add_u32 m0, s51, 35840
s_nop 0
buffer_load_dwordx4 v5, s[12:15], s42 offen lds
ds_read_b64_tr_b16 v[96:97], v18 offset:0
ds_read_b64_tr_b16 v[98:99], v26 offset:0
ds_read_b64_tr_b16 v[100:101], v19 offset:0
ds_read_b64_tr_b16 v[102:103], v27 offset:0
ds_read_b64_tr_b16 v[104:105], v20 offset:0
ds_read_b64_tr_b16 v[106:107], v28 offset:0
ds_read_b64_tr_b16 v[108:109], v21 offset:0
ds_read_b64_tr_b16 v[110:111], v29 offset:0
s_waitcnt vmcnt(12)
s_waitcnt lgkmcnt(6)
v_mfma_f32_16x16x32_bf16 a[0:3], v[96:99], v[48:51], 0
v_mfma_f32_16x16x32_bf16 a[32:35], v[96:99], v[52:55], 0
v_mfma_f32_16x16x32_bf16 a[64:67], v[96:99], v[56:59], 0
v_mfma_f32_16x16x32_bf16 a[96:99], v[96:99], v[60:63], 0
ds_read_b64_tr_b16 v[96:97], v22 offset:0
ds_read_b64_tr_b16 v[98:99], v30 offset:0
s_waitcnt lgkmcnt(6)
v_mfma_f32_16x16x32_bf16 a[4:7], v[100:103], v[48:51], 0
v_mfma_f32_16x16x32_bf16 a[36:39], v[100:103], v[52:55], 0
v_mfma_f32_16x16x32_bf16 a[68:71], v[100:103], v[56:59], 0
v_mfma_f32_16x16x32_bf16 a[100:103], v[100:103], v[60:63], 0
ds_read_b64_tr_b16 v[100:101], v23 offset:0
ds_read_b64_tr_b16 v[102:103], v31 offset:0
s_waitcnt lgkmcnt(6)
v_mfma_f32_16x16x32_bf16 a[8:11], v[104:107], v[48:51], 0
v_mfma_f32_16x16x32_bf16 a[40:43], v[104:107], v[52:55], 0
v_mfma_f32_16x16x32_bf16 a[72:75], v[104:107], v[56:59], 0
v_mfma_f32_16x16x32_bf16 a[104:107], v[104:107], v[60:63], 0
ds_read_b64_tr_b16 v[104:105], v24 offset:0
ds_read_b64_tr_b16 v[106:107], v32 offset:0
s_waitcnt lgkmcnt(6)
v_mfma_f32_16x16x32_bf16 a[12:15], v[108:111], v[48:51], 0
v_mfma_f32_16x16x32_bf16 a[44:47], v[108:111], v[52:55], 0
v_mfma_f32_16x16x32_bf16 a[76:79], v[108:111], v[56:59], 0
v_mfma_f32_16x16x32_bf16 a[108:111], v[108:111], v[60:63], 0
ds_read_b64_tr_b16 v[108:109], v25 offset:0
ds_read_b64_tr_b16 v[110:111], v33 offset:0
s_waitcnt lgkmcnt(6)
v_mfma_f32_16x16x32_bf16 a[16:19], v[96:99], v[48:51], 0
v_mfma_f32_16x16x32_bf16 a[48:51], v[96:99], v[52:55], 0
v_mfma_f32_16x16x32_bf16 a[80:83], v[96:99], v[56:59], 0
v_mfma_f32_16x16x32_bf16 a[112:115], v[96:99], v[60:63], 0
ds_read_b64_tr_b16 v[96:97], v18 offset:8192
ds_read_b64_tr_b16 v[98:99], v26 offset:8192
s_waitcnt lgkmcnt(6)
v_mfma_f32_16x16x32_bf16 a[20:23], v[100:103], v[48:51], 0
v_mfma_f32_16x16x32_bf16 a[52:55], v[100:103], v[52:55], 0
v_mfma_f32_16x16x32_bf16 a[84:87], v[100:103], v[56:59], 0
v_mfma_f32_16x16x32_bf16 a[116:119], v[100:103], v[60:63], 0
ds_read_b64_tr_b16 v[100:101], v19 offset:8192
ds_read_b64_tr_b16 v[102:103], v27 offset:8192
s_waitcnt lgkmcnt(6)
v_mfma_f32_16x16x32_bf16 a[24:27], v[104:107], v[48:51], 0
v_mfma_f32_16x16x32_bf16 a[56:59], v[104:107], v[52:55], 0
v_mfma_f32_16x16x32_bf16 a[88:91], v[104:107], v[56:59], 0
v_mfma_f32_16x16x32_bf16 a[120:123], v[104:107], v[60:63], 0
ds_read_b64_tr_b16 v[104:105], v20 offset:8192
ds_read_b64_tr_b16 v[106:107], v28 offset:8192
s_waitcnt lgkmcnt(6)
v_mfma_f32_16x16x32_bf16 a[28:31], v[108:111], v[48:51], 0
v_mfma_f32_16x16x32_bf16 a[60:63], v[108:111], v[52:55], 0
v_mfma_f32_16x16x32_bf16 a[92:95], v[108:111], v[56:59], 0
v_mfma_f32_16x16x32_bf16 a[124:127], v[108:111], v[60:63], 0
buffer_load_dwordx4 v[48:51], v1, s[8:11], s48 offen offset:3072
s_add_u32 s43, s48, 16384
buffer_load_dwordx4 v[52:55], v1, s[8:11], s43 offen offset:3072
s_add_u32 s43, s48, 32768
buffer_load_dwordx4 v[56:59], v1, s[8:11], s43 offen offset:3072
s_add_u32 s43, s48, 49152
buffer_load_dwordx4 v[60:63], v1, s[8:11], s43 offen offset:3072
ds_read_b64_tr_b16 v[108:109], v21 offset:8192
ds_read_b64_tr_b16 v[110:111], v29 offset:8192
s_waitcnt vmcnt(12)
s_waitcnt lgkmcnt(6)
v_mfma_f32_16x16x32_bf16 a[0:3], v[96:99], v[64:67], a[0:3]
v_mfma_f32_16x16x32_bf16 a[32:35], v[96:99], v[68:71], a[32:35]
v_mfma_f32_16x16x32_bf16 a[64:67], v[96:99], v[72:75], a[64:67]
v_mfma_f32_16x16x32_bf16 a[96:99], v[96:99], v[76:79], a[96:99]
ds_read_b64_tr_b16 v[96:97], v22 offset:8192
ds_read_b64_tr_b16 v[98:99], v30 offset:8192
s_waitcnt lgkmcnt(6)
v_mfma_f32_16x16x32_bf16 a[4:7], v[100:103], v[64:67], a[4:7]
v_mfma_f32_16x16x32_bf16 a[36:39], v[100:103], v[68:71], a[36:39]
v_mfma_f32_16x16x32_bf16 a[68:71], v[100:103], v[72:75], a[68:71]
v_mfma_f32_16x16x32_bf16 a[100:103], v[100:103], v[76:79], a[100:103]
ds_read_b64_tr_b16 v[100:101], v23 offset:8192
ds_read_b64_tr_b16 v[102:103], v31 offset:8192
s_waitcnt lgkmcnt(6)
v_mfma_f32_16x16x32_bf16 a[8:11], v[104:107], v[64:67], a[8:11]
v_mfma_f32_16x16x32_bf16 a[40:43], v[104:107], v[68:71], a[40:43]
v_mfma_f32_16x16x32_bf16 a[72:75], v[104:107], v[72:75], a[72:75]
v_mfma_f32_16x16x32_bf16 a[104:107], v[104:107], v[76:79], a[104:107]
ds_read_b64_tr_b16 v[104:105], v24 offset:8192
ds_read_b64_tr_b16 v[106:107], v32 offset:8192
s_waitcnt lgkmcnt(6)
v_mfma_f32_16x16x32_bf16 a[12:15], v[108:111], v[64:67], a[12:15]
v_mfma_f32_16x16x32_bf16 a[44:47], v[108:111], v[68:71], a[44:47]
v_mfma_f32_16x16x32_bf16 a[76:79], v[108:111], v[72:75], a[76:79]
v_mfma_f32_16x16x32_bf16 a[108:111], v[108:111], v[76:79], a[108:111]
ds_read_b64_tr_b16 v[108:109], v25 offset:8192
ds_read_b64_tr_b16 v[110:111], v33 offset:8192
s_waitcnt lgkmcnt(6)
v_mfma_f32_16x16x32_bf16 a[16:19], v[96:99], v[64:67], a[16:19]
v_mfma_f32_16x16x32_bf16 a[48:51], v[96:99], v[68:71], a[48:51]
v_mfma_f32_16x16x32_bf16 a[80:83], v[96:99], v[72:75], a[80:83]
v_mfma_f32_16x16x32_bf16 a[112:115], v[96:99], v[76:79], a[112:115]
s_barrier
s_add_u32 s42, s49, 1572864
s_add_u32 m0, s51, 49152
s_nop 0
buffer_load_dwordx4 v2, s[12:15], s42 offen lds
s_add_u32 m0, s51, 50176
s_nop 0
buffer_load_dwordx4 v3, s[12:15], s42 offen lds
s_add_u32 m0, s51, 51200
s_nop 0
buffer_load_dwordx4 v4, s[12:15], s42 offen lds
s_add_u32 m0, s51, 52224
s_nop 0
buffer_load_dwordx4 v5, s[12:15], s42 offen lds
ds_read_b64_tr_b16 v[96:97], v18 offset:16384
ds_read_b64_tr_b16 v[98:99], v26 offset:16384
s_waitcnt lgkmcnt(6)
v_mfma_f32_16x16x32_bf16 a[20:23], v[100:103], v[64:67], a[20:23]
v_mfma_f32_16x16x32_bf16 a[52:55], v[100:103], v[68:71], a[52:55]
v_mfma_f32_16x16x32_bf16 a[84:87], v[100:103], v[72:75], a[84:87]
v_mfma_f32_16x16x32_bf16 a[116:119], v[100:103], v[76:79], a[116:119]
ds_read_b64_tr_b16 v[100:101], v19 offset:16384
ds_read_b64_tr_b16 v[102:103], v27 offset:16384
s_waitcnt lgkmcnt(6)
v_mfma_f32_16x16x32_bf16 a[24:27], v[104:107], v[64:67], a[24:27]
v_mfma_f32_16x16x32_bf16 a[56:59], v[104:107], v[68:71], a[56:59]
v_mfma_f32_16x16x32_bf16 a[88:91], v[104:107], v[72:75], a[88:91]
v_mfma_f32_16x16x32_bf16 a[120:123], v[104:107], v[76:79], a[120:123]
ds_read_b64_tr_b16 v[104:105], v20 offset:16384
ds_read_b64_tr_b16 v[106:107], v28 offset:16384
s_waitcnt lgkmcnt(6)
v_mfma_f32_16x16x32_bf16 a[28:31], v[108:111], v[64:67], a[28:31]
v_mfma_f32_16x16x32_bf16 a[60:63], v[108:111], v[68:71], a[60:63]
v_mfma_f32_16x16x32_bf16 a[92:95], v[108:111], v[72:75], a[92:95]
v_mfma_f32_16x16x32_bf16 a[124:127], v[108:111], v[76:79], a[124:127]
s_add_u32 s43, s48, 4096
buffer_load_dwordx4 v[64:67], v1, s[8:11], s43 offen offset:0
s_add_u32 s43, s48, 20480
buffer_load_dwordx4 v[68:71], v1, s[8:11], s43 offen offset:0
s_add_u32 s43, s48, 36864
buffer_load_dwordx4 v[72:75], v1, s[8:11], s43 offen offset:0
s_add_u32 s43, s48, 53248
buffer_load_dwordx4 v[76:79], v1, s[8:11], s43 offen offset:0
ds_read_b64_tr_b16 v[108:109], v21 offset:16384
ds_read_b64_tr_b16 v[110:111], v29 offset:16384
s_waitcnt vmcnt(16)
s_waitcnt lgkmcnt(6)
v_mfma_f32_16x16x32_bf16 a[0:3], v[96:99], v[80:83], a[0:3]
v_mfma_f32_16x16x32_bf16 a[32:35], v[96:99], v[84:87], a[32:35]
v_mfma_f32_16x16x32_bf16 a[64:67], v[96:99], v[88:91], a[64:67]
v_mfma_f32_16x16x32_bf16 a[96:99], v[96:99], v[92:95], a[96:99]
ds_read_b64_tr_b16 v[96:97], v22 offset:16384
ds_read_b64_tr_b16 v[98:99], v30 offset:16384
s_waitcnt lgkmcnt(6)
v_mfma_f32_16x16x32_bf16 a[4:7], v[100:103], v[80:83], a[4:7]
v_mfma_f32_16x16x32_bf16 a[36:39], v[100:103], v[84:87], a[36:39]
v_mfma_f32_16x16x32_bf16 a[68:71], v[100:103], v[88:91], a[68:71]
v_mfma_f32_16x16x32_bf16 a[100:103], v[100:103], v[92:95], a[100:103]
ds_read_b64_tr_b16 v[100:101], v23 offset:16384
ds_read_b64_tr_b16 v[102:103], v31 offset:16384
s_waitcnt lgkmcnt(6)
v_mfma_f32_16x16x32_bf16 a[8:11], v[104:107], v[80:83], a[8:11]
v_mfma_f32_16x16x32_bf16 a[40:43], v[104:107], v[84:87], a[40:43]
v_mfma_f32_16x16x32_bf16 a[72:75], v[104:107], v[88:91], a[72:75]
v_mfma_f32_16x16x32_bf16 a[104:107], v[104:107], v[92:95], a[104:107]
ds_read_b64_tr_b16 v[104:105], v24 offset:16384
ds_read_b64_tr_b16 v[106:107], v32 offset:16384
s_waitcnt lgkmcnt(6)
v_mfma_f32_16x16x32_bf16 a[12:15], v[108:111], v[80:83], a[12:15]
v_mfma_f32_16x16x32_bf16 a[44:47], v[108:111], v[84:87], a[44:47]
v_mfma_f32_16x16x32_bf16 a[76:79], v[108:111], v[88:91], a[76:79]
v_mfma_f32_16x16x32_bf16 a[108:111], v[108:111], v[92:95], a[108:111]
ds_read_b64_tr_b16 v[108:109], v25 offset:16384
ds_read_b64_tr_b16 v[110:111], v33 offset:16384
s_waitcnt lgkmcnt(6)
v_mfma_f32_16x16x32_bf16 a[16:19], v[96:99], v[80:83], a[16:19]
v_mfma_f32_16x16x32_bf16 a[48:51], v[96:99], v[84:87], a[48:51]
v_mfma_f32_16x16x32_bf16 a[80:83], v[96:99], v[88:91], a[80:83]
v_mfma_f32_16x16x32_bf16 a[112:115], v[96:99], v[92:95], a[112:115]
ds_read_b64_tr_b16 v[96:97], v18 offset:24576
ds_read_b64_tr_b16 v[98:99], v26 offset:24576
s_waitcnt lgkmcnt(6)
v_mfma_f32_16x16x32_bf16 a[20:23], v[100:103], v[80:83], a[20:23]
v_mfma_f32_16x16x32_bf16 a[52:55], v[100:103], v[84:87], a[52:55]
v_mfma_f32_16x16x32_bf16 a[84:87], v[100:103], v[88:91], a[84:87]
v_mfma_f32_16x16x32_bf16 a[116:119], v[100:103], v[92:95], a[116:119]
ds_read_b64_tr_b16 v[100:101], v19 offset:24576
ds_read_b64_tr_b16 v[102:103], v27 offset:24576
s_waitcnt lgkmcnt(6)
v_mfma_f32_16x16x32_bf16 a[24:27], v[104:107], v[80:83], a[24:27]
v_mfma_f32_16x16x32_bf16 a[56:59], v[104:107], v[84:87], a[56:59]
v_mfma_f32_16x16x32_bf16 a[88:91], v[104:107], v[88:91], a[88:91]
v_mfma_f32_16x16x32_bf16 a[120:123], v[104:107], v[92:95], a[120:123]
ds_read_b64_tr_b16 v[104:105], v20 offset:24576
ds_read_b64_tr_b16 v[106:107], v28 offset:24576
s_waitcnt lgkmcnt(6)
v_mfma_f32_16x16x32_bf16 a[28:31], v[108:111], v[80:83], a[28:31]
v_mfma_f32_16x16x32_bf16 a[60:63], v[108:111], v[84:87], a[60:63]
v_mfma_f32_16x16x32_bf16 a[92:95], v[108:111], v[88:91], a[92:95]
v_mfma_f32_16x16x32_bf16 a[124:127], v[108:111], v[92:95], a[124:127]
s_add_u32 s43, s48, 4096
buffer_load_dwordx4 v[80:83], v1, s[8:11], s43 offen offset:1024
s_add_u32 s43, s48, 20480
buffer_load_dwordx4 v[84:87], v1, s[8:11], s43 offen offset:1024
s_add_u32 s43, s48, 36864
buffer_load_dwordx4 v[88:91], v1, s[8:11], s43 offen offset:1024
s_add_u32 s43, s48, 53248
buffer_load_dwordx4 v[92:95], v1, s[8:11], s43 offen offset:1024
ds_read_b64_tr_b16 v[108:109], v21 offset:24576
ds_read_b64_tr_b16 v[110:111], v29 offset:24576
s_waitcnt vmcnt(12)
s_waitcnt lgkmcnt(6)
v_mfma_f32_16x16x32_bf16 a[0:3], v[96:99], v[48:51], a[0:3]
v_mfma_f32_16x16x32_bf16 a[32:35], v[96:99], v[52:55], a[32:35]
v_mfma_f32_16x16x32_bf16 a[64:67], v[96:99], v[56:59], a[64:67]
v_mfma_f32_16x16x32_bf16 a[96:99], v[96:99], v[60:63], a[96:99]
ds_read_b64_tr_b16 v[96:97], v22 offset:24576
ds_read_b64_tr_b16 v[98:99], v30 offset:24576
s_waitcnt lgkmcnt(6)
v_mfma_f32_16x16x32_bf16 a[4:7], v[100:103], v[48:51], a[4:7]
v_mfma_f32_16x16x32_bf16 a[36:39], v[100:103], v[52:55], a[36:39]
v_mfma_f32_16x16x32_bf16 a[68:71], v[100:103], v[56:59], a[68:71]
v_mfma_f32_16x16x32_bf16 a[100:103], v[100:103], v[60:63], a[100:103]
ds_read_b64_tr_b16 v[100:101], v23 offset:24576
ds_read_b64_tr_b16 v[102:103], v31 offset:24576
s_waitcnt lgkmcnt(6)
v_mfma_f32_16x16x32_bf16 a[8:11], v[104:107], v[48:51], a[8:11]
v_mfma_f32_16x16x32_bf16 a[40:43], v[104:107], v[52:55], a[40:43]
v_mfma_f32_16x16x32_bf16 a[72:75], v[104:107], v[56:59], a[72:75]
v_mfma_f32_16x16x32_bf16 a[104:107], v[104:107], v[60:63], a[104:107]
ds_read_b64_tr_b16 v[104:105], v24 offset:24576
ds_read_b64_tr_b16 v[106:107], v32 offset:24576
s_waitcnt lgkmcnt(6)
v_mfma_f32_16x16x32_bf16 a[12:15], v[108:111], v[48:51], a[12:15]
v_mfma_f32_16x16x32_bf16 a[44:47], v[108:111], v[52:55], a[44:47]
v_mfma_f32_16x16x32_bf16 a[76:79], v[108:111], v[56:59], a[76:79]
v_mfma_f32_16x16x32_bf16 a[108:111], v[108:111], v[60:63], a[108:111]
ds_read_b64_tr_b16 v[108:109], v25 offset:24576
ds_read_b64_tr_b16 v[110:111], v33 offset:24576
s_waitcnt lgkmcnt(6)
v_mfma_f32_16x16x32_bf16 a[16:19], v[96:99], v[48:51], a[16:19]
v_mfma_f32_16x16x32_bf16 a[48:51], v[96:99], v[52:55], a[48:51]
v_mfma_f32_16x16x32_bf16 a[80:83], v[96:99], v[56:59], a[80:83]
v_mfma_f32_16x16x32_bf16 a[112:115], v[96:99], v[60:63], a[112:115]
s_barrier
s_add_u32 s42, s49, 2097152
s_add_u32 m0, s51, 0
s_nop 0
buffer_load_dwordx4 v2, s[12:15], s42 offen lds
s_add_u32 m0, s51, 1024
s_nop 0
buffer_load_dwordx4 v3, s[12:15], s42 offen lds
s_add_u32 m0, s51, 2048
s_nop 0
buffer_load_dwordx4 v4, s[12:15], s42 offen lds
s_add_u32 m0, s51, 3072
s_nop 0
buffer_load_dwordx4 v5, s[12:15], s42 offen lds
ds_read_b64_tr_b16 v[96:97], v18 offset:32768
ds_read_b64_tr_b16 v[98:99], v26 offset:32768
s_waitcnt lgkmcnt(6)
v_mfma_f32_16x16x32_bf16 a[20:23], v[100:103], v[48:51], a[20:23]
v_mfma_f32_16x16x32_bf16 a[52:55], v[100:103], v[52:55], a[52:55]
v_mfma_f32_16x16x32_bf16 a[84:87], v[100:103], v[56:59], a[84:87]
v_mfma_f32_16x16x32_bf16 a[116:119], v[100:103], v[60:63], a[116:119]
ds_read_b64_tr_b16 v[100:101], v19 offset:32768
ds_read_b64_tr_b16 v[102:103], v27 offset:32768
s_waitcnt lgkmcnt(6)
v_mfma_f32_16x16x32_bf16 a[24:27], v[104:107], v[48:51], a[24:27]
v_mfma_f32_16x16x32_bf16 a[56:59], v[104:107], v[52:55], a[56:59]
v_mfma_f32_16x16x32_bf16 a[88:91], v[104:107], v[56:59], a[88:91]
v_mfma_f32_16x16x32_bf16 a[120:123], v[104:107], v[60:63], a[120:123]
ds_read_b64_tr_b16 v[104:105], v20 offset:32768
ds_read_b64_tr_b16 v[106:107], v28 offset:32768
s_waitcnt lgkmcnt(6)
v_mfma_f32_16x16x32_bf16 a[28:31], v[108:111], v[48:51], a[28:31]
v_mfma_f32_16x16x32_bf16 a[60:63], v[108:111], v[52:55], a[60:63]
v_mfma_f32_16x16x32_bf16 a[92:95], v[108:111], v[56:59], a[92:95]
v_mfma_f32_16x16x32_bf16 a[124:127], v[108:111], v[60:63], a[124:127]
s_add_u32 s43, s48, 4096
buffer_load_dwordx4 v[48:51], v1, s[8:11], s43 offen offset:2048
s_add_u32 s43, s48, 20480
buffer_load_dwordx4 v[52:55], v1, s[8:11], s43 offen offset:2048
s_add_u32 s43, s48, 36864
buffer_load_dwordx4 v[56:59], v1, s[8:11], s43 offen offset:2048
s_add_u32 s43, s48, 53248
buffer_load_dwordx4 v[60:63], v1, s[8:11], s43 offen offset:2048
ds_read_b64_tr_b16 v[108:109], v21 offset:32768
ds_read_b64_tr_b16 v[110:111], v29 offset:32768
s_waitcnt vmcnt(12)
s_waitcnt lgkmcnt(6)
v_mfma_f32_16x16x32_bf16 a[0:3], v[96:99], v[64:67], a[0:3]
v_mfma_f32_16x16x32_bf16 a[32:35], v[96:99], v[68:71], a[32:35]
v_mfma_f32_16x16x32_bf16 a[64:67], v[96:99], v[72:75], a[64:67]
v_mfma_f32_16x16x32_bf16 a[96:99], v[96:99], v[76:79], a[96:99]
ds_read_b64_tr_b16 v[96:97], v22 offset:32768
ds_read_b64_tr_b16 v[98:99], v30 offset:32768
s_waitcnt lgkmcnt(6)
v_mfma_f32_16x16x32_bf16 a[4:7], v[100:103], v[64:67], a[4:7]
v_mfma_f32_16x16x32_bf16 a[36:39], v[100:103], v[68:71], a[36:39]
v_mfma_f32_16x16x32_bf16 a[68:71], v[100:103], v[72:75], a[68:71]
v_mfma_f32_16x16x32_bf16 a[100:103], v[100:103], v[76:79], a[100:103]
ds_read_b64_tr_b16 v[100:101], v23 offset:32768
ds_read_b64_tr_b16 v[102:103], v31 offset:32768
s_waitcnt lgkmcnt(6)
v_mfma_f32_16x16x32_bf16 a[8:11], v[104:107], v[64:67], a[8:11]
v_mfma_f32_16x16x32_bf16 a[40:43], v[104:107], v[68:71], a[40:43]
v_mfma_f32_16x16x32_bf16 a[72:75], v[104:107], v[72:75], a[72:75]
v_mfma_f32_16x16x32_bf16 a[104:107], v[104:107], v[76:79], a[104:107]
ds_read_b64_tr_b16 v[104:105], v24 offset:32768
ds_read_b64_tr_b16 v[106:107], v32 offset:32768
s_waitcnt lgkmcnt(6)
v_mfma_f32_16x16x32_bf16 a[12:15], v[108:111], v[64:67], a[12:15]
v_mfma_f32_16x16x32_bf16 a[44:47], v[108:111], v[68:71], a[44:47]
v_mfma_f32_16x16x32_bf16 a[76:79], v[108:111], v[72:75], a[76:79]
v_mfma_f32_16x16x32_bf16 a[108:111], v[108:111], v[76:79], a[108:111]
ds_read_b64_tr_b16 v[108:109], v25 offset:32768
ds_read_b64_tr_b16 v[110:111], v33 offset:32768
s_waitcnt lgkmcnt(6)
v_mfma_f32_16x16x32_bf16 a[16:19], v[96:99], v[64:67], a[16:19]
v_mfma_f32_16x16x32_bf16 a[48:51], v[96:99], v[68:71], a[48:51]
v_mfma_f32_16x16x32_bf16 a[80:83], v[96:99], v[72:75], a[80:83]
v_mfma_f32_16x16x32_bf16 a[112:115], v[96:99], v[76:79], a[112:115]
ds_read_b64_tr_b16 v[96:97], v18 offset:40960
ds_read_b64_tr_b16 v[98:99], v26 offset:40960
s_waitcnt lgkmcnt(6)
v_mfma_f32_16x16x32_bf16 a[20:23], v[100:103], v[64:67], a[20:23]
v_mfma_f32_16x16x32_bf16 a[52:55], v[100:103], v[68:71], a[52:55]
v_mfma_f32_16x16x32_bf16 a[84:87], v[100:103], v[72:75], a[84:87]
v_mfma_f32_16x16x32_bf16 a[116:119], v[100:103], v[76:79], a[116:119]
ds_read_b64_tr_b16 v[100:101], v19 offset:40960
ds_read_b64_tr_b16 v[102:103], v27 offset:40960
s_waitcnt lgkmcnt(6)
v_mfma_f32_16x16x32_bf16 a[24:27], v[104:107], v[64:67], a[24:27]
v_mfma_f32_16x16x32_bf16 a[56:59], v[104:107], v[68:71], a[56:59]
v_mfma_f32_16x16x32_bf16 a[88:91], v[104:107], v[72:75], a[88:91]
v_mfma_f32_16x16x32_bf16 a[120:123], v[104:107], v[76:79], a[120:123]
ds_read_b64_tr_b16 v[104:105], v20 offset:40960
ds_read_b64_tr_b16 v[106:107], v28 offset:40960
s_waitcnt lgkmcnt(6)
v_mfma_f32_16x16x32_bf16 a[28:31], v[108:111], v[64:67], a[28:31]
v_mfma_f32_16x16x32_bf16 a[60:63], v[108:111], v[68:71], a[60:63]
v_mfma_f32_16x16x32_bf16 a[92:95], v[108:111], v[72:75], a[92:95]
v_mfma_f32_16x16x32_bf16 a[124:127], v[108:111], v[76:79], a[124:127]
s_add_u32 s43, s48, 4096
buffer_load_dwordx4 v[64:67], v1, s[8:11], s43 offen offset:3072
s_add_u32 s43, s48, 20480
buffer_load_dwordx4 v[68:71], v1, s[8:11], s43 offen offset:3072
s_add_u32 s43, s48, 36864
buffer_load_dwordx4 v[72:75], v1, s[8:11], s43 offen offset:3072
s_add_u32 s43, s48, 53248
buffer_load_dwordx4 v[76:79], v1, s[8:11], s43 offen offset:3072
ds_read_b64_tr_b16 v[108:109], v21 offset:40960
ds_read_b64_tr_b16 v[110:111], v29 offset:40960
s_waitcnt vmcnt(12)
s_waitcnt lgkmcnt(6)
v_mfma_f32_16x16x32_bf16 a[0:3], v[96:99], v[80:83], a[0:3]
v_mfma_f32_16x16x32_bf16 a[32:35], v[96:99], v[84:87], a[32:35]
v_mfma_f32_16x16x32_bf16 a[64:67], v[96:99], v[88:91], a[64:67]
v_mfma_f32_16x16x32_bf16 a[96:99], v[96:99], v[92:95], a[96:99]
ds_read_b64_tr_b16 v[96:97], v22 offset:40960
ds_read_b64_tr_b16 v[98:99], v30 offset:40960
s_waitcnt lgkmcnt(6)
v_mfma_f32_16x16x32_bf16 a[4:7], v[100:103], v[80:83], a[4:7]
v_mfma_f32_16x16x32_bf16 a[36:39], v[100:103], v[84:87], a[36:39]
v_mfma_f32_16x16x32_bf16 a[68:71], v[100:103], v[88:91], a[68:71]
v_mfma_f32_16x16x32_bf16 a[100:103], v[100:103], v[92:95], a[100:103]
ds_read_b64_tr_b16 v[100:101], v23 offset:40960
ds_read_b64_tr_b16 v[102:103], v31 offset:40960
s_waitcnt lgkmcnt(6)
v_mfma_f32_16x16x32_bf16 a[8:11], v[104:107], v[80:83], a[8:11]
v_mfma_f32_16x16x32_bf16 a[40:43], v[104:107], v[84:87], a[40:43]
v_mfma_f32_16x16x32_bf16 a[72:75], v[104:107], v[88:91], a[72:75]
v_mfma_f32_16x16x32_bf16 a[104:107], v[104:107], v[92:95], a[104:107]
ds_read_b64_tr_b16 v[104:105], v24 offset:40960
ds_read_b64_tr_b16 v[106:107], v32 offset:40960
s_waitcnt lgkmcnt(6)
v_mfma_f32_16x16x32_bf16 a[12:15], v[108:111], v[80:83], a[12:15]
v_mfma_f32_16x16x32_bf16 a[44:47], v[108:111], v[84:87], a[44:47]
v_mfma_f32_16x16x32_bf16 a[76:79], v[108:111], v[88:91], a[76:79]
v_mfma_f32_16x16x32_bf16 a[108:111], v[108:111], v[92:95], a[108:111]
ds_read_b64_tr_b16 v[108:109], v25 offset:40960
ds_read_b64_tr_b16 v[110:111], v33 offset:40960
s_waitcnt lgkmcnt(6)
v_mfma_f32_16x16x32_bf16 a[16:19], v[96:99], v[80:83], a[16:19]
v_mfma_f32_16x16x32_bf16 a[48:51], v[96:99], v[84:87], a[48:51]
v_mfma_f32_16x16x32_bf16 a[80:83], v[96:99], v[88:91], a[80:83]
v_mfma_f32_16x16x32_bf16 a[112:115], v[96:99], v[92:95], a[112:115]
s_barrier
s_add_u32 s42, s49, 2621440
s_add_u32 m0, s51, 16384
s_nop 0
buffer_load_dwordx4 v2, s[12:15], s42 offen lds
s_add_u32 m0, s51, 17408
s_nop 0
buffer_load_dwordx4 v3, s[12:15], s42 offen lds
s_add_u32 m0, s51, 18432
s_nop 0
buffer_load_dwordx4 v4, s[12:15], s42 offen lds
s_add_u32 m0, s51, 19456
s_nop 0
buffer_load_dwordx4 v5, s[12:15], s42 offen lds
ds_read_b64_tr_b16 v[96:97], v18 offset:49152
ds_read_b64_tr_b16 v[98:99], v26 offset:49152
s_waitcnt lgkmcnt(6)
v_mfma_f32_16x16x32_bf16 a[20:23], v[100:103], v[80:83], a[20:23]
v_mfma_f32_16x16x32_bf16 a[52:55], v[100:103], v[84:87], a[52:55]
v_mfma_f32_16x16x32_bf16 a[84:87], v[100:103], v[88:91], a[84:87]
v_mfma_f32_16x16x32_bf16 a[116:119], v[100:103], v[92:95], a[116:119]
ds_read_b64_tr_b16 v[100:101], v19 offset:49152
ds_read_b64_tr_b16 v[102:103], v27 offset:49152
s_waitcnt lgkmcnt(6)
v_mfma_f32_16x16x32_bf16 a[24:27], v[104:107], v[80:83], a[24:27]
v_mfma_f32_16x16x32_bf16 a[56:59], v[104:107], v[84:87], a[56:59]
v_mfma_f32_16x16x32_bf16 a[88:91], v[104:107], v[88:91], a[88:91]
v_mfma_f32_16x16x32_bf16 a[120:123], v[104:107], v[92:95], a[120:123]
ds_read_b64_tr_b16 v[104:105], v20 offset:49152
ds_read_b64_tr_b16 v[106:107], v28 offset:49152
s_waitcnt lgkmcnt(6)
v_mfma_f32_16x16x32_bf16 a[28:31], v[108:111], v[80:83], a[28:31]
v_mfma_f32_16x16x32_bf16 a[60:63], v[108:111], v[84:87], a[60:63]
v_mfma_f32_16x16x32_bf16 a[92:95], v[108:111], v[88:91], a[92:95]
v_mfma_f32_16x16x32_bf16 a[124:127], v[108:111], v[92:95], a[124:127]
s_add_u32 s43, s48, 8192
buffer_load_dwordx4 v[80:83], v1, s[8:11], s43 offen offset:0
s_add_u32 s43, s48, 24576
buffer_load_dwordx4 v[84:87], v1, s[8:11], s43 offen offset:0
s_add_u32 s43, s48, 40960
buffer_load_dwordx4 v[88:91], v1, s[8:11], s43 offen offset:0
s_add_u32 s43, s48, 57344
buffer_load_dwordx4 v[92:95], v1, s[8:11], s43 offen offset:0
ds_read_b64_tr_b16 v[108:109], v21 offset:49152
ds_read_b64_tr_b16 v[110:111], v29 offset:49152
s_waitcnt vmcnt(12)
s_waitcnt lgkmcnt(6)
v_mfma_f32_16x16x32_bf16 a[0:3], v[96:99], v[48:51], a[0:3]
v_mfma_f32_16x16x32_bf16 a[32:35], v[96:99], v[52:55], a[32:35]
v_mfma_f32_16x16x32_bf16 a[64:67], v[96:99], v[56:59], a[64:67]
v_mfma_f32_16x16x32_bf16 a[96:99], v[96:99], v[60:63], a[96:99]
ds_read_b64_tr_b16 v[96:97], v22 offset:49152
ds_read_b64_tr_b16 v[98:99], v30 offset:49152
s_waitcnt lgkmcnt(6)
v_mfma_f32_16x16x32_bf16 a[4:7], v[100:103], v[48:51], a[4:7]
v_mfma_f32_16x16x32_bf16 a[36:39], v[100:103], v[52:55], a[36:39]
v_mfma_f32_16x16x32_bf16 a[68:71], v[100:103], v[56:59], a[68:71]
v_mfma_f32_16x16x32_bf16 a[100:103], v[100:103], v[60:63], a[100:103]
ds_read_b64_tr_b16 v[100:101], v23 offset:49152
ds_read_b64_tr_b16 v[102:103], v31 offset:49152
s_waitcnt lgkmcnt(6)
v_mfma_f32_16x16x32_bf16 a[8:11], v[104:107], v[48:51], a[8:11]
v_mfma_f32_16x16x32_bf16 a[40:43], v[104:107], v[52:55], a[40:43]
v_mfma_f32_16x16x32_bf16 a[72:75], v[104:107], v[56:59], a[72:75]
v_mfma_f32_16x16x32_bf16 a[104:107], v[104:107], v[60:63], a[104:107]
ds_read_b64_tr_b16 v[104:105], v24 offset:49152
ds_read_b64_tr_b16 v[106:107], v32 offset:49152
s_waitcnt lgkmcnt(6)
v_mfma_f32_16x16x32_bf16 a[12:15], v[108:111], v[48:51], a[12:15]
v_mfma_f32_16x16x32_bf16 a[44:47], v[108:111], v[52:55], a[44:47]
v_mfma_f32_16x16x32_bf16 a[76:79], v[108:111], v[56:59], a[76:79]
v_mfma_f32_16x16x32_bf16 a[108:111], v[108:111], v[60:63], a[108:111]
ds_read_b64_tr_b16 v[108:109], v25 offset:49152
ds_read_b64_tr_b16 v[110:111], v33 offset:49152
s_waitcnt lgkmcnt(6)
v_mfma_f32_16x16x32_bf16 a[16:19], v[96:99], v[48:51], a[16:19]
v_mfma_f32_16x16x32_bf16 a[48:51], v[96:99], v[52:55], a[48:51]
v_mfma_f32_16x16x32_bf16 a[80:83], v[96:99], v[56:59], a[80:83]
v_mfma_f32_16x16x32_bf16 a[112:115], v[96:99], v[60:63], a[112:115]
ds_read_b64_tr_b16 v[96:97], v18 offset:57344
ds_read_b64_tr_b16 v[98:99], v26 offset:57344
s_waitcnt lgkmcnt(6)
v_mfma_f32_16x16x32_bf16 a[20:23], v[100:103], v[48:51], a[20:23]
v_mfma_f32_16x16x32_bf16 a[52:55], v[100:103], v[52:55], a[52:55]
v_mfma_f32_16x16x32_bf16 a[84:87], v[100:103], v[56:59], a[84:87]
v_mfma_f32_16x16x32_bf16 a[116:119], v[100:103], v[60:63], a[116:119]
ds_read_b64_tr_b16 v[100:101], v19 offset:57344
ds_read_b64_tr_b16 v[102:103], v27 offset:57344
s_waitcnt lgkmcnt(6)
v_mfma_f32_16x16x32_bf16 a[24:27], v[104:107], v[48:51], a[24:27]
v_mfma_f32_16x16x32_bf16 a[56:59], v[104:107], v[52:55], a[56:59]
v_mfma_f32_16x16x32_bf16 a[88:91], v[104:107], v[56:59], a[88:91]
v_mfma_f32_16x16x32_bf16 a[120:123], v[104:107], v[60:63], a[120:123]
ds_read_b64_tr_b16 v[104:105], v20 offset:57344
ds_read_b64_tr_b16 v[106:107], v28 offset:57344
s_waitcnt lgkmcnt(6)
v_mfma_f32_16x16x32_bf16 a[28:31], v[108:111], v[48:51], a[28:31]
v_mfma_f32_16x16x32_bf16 a[60:63], v[108:111], v[52:55], a[60:63]
v_mfma_f32_16x16x32_bf16 a[92:95], v[108:111], v[56:59], a[92:95]
v_mfma_f32_16x16x32_bf16 a[124:127], v[108:111], v[60:63], a[124:127]
s_add_u32 s43, s48, 8192
buffer_load_dwordx4 v[48:51], v1, s[8:11], s43 offen offset:1024
s_add_u32 s43, s48, 24576
buffer_load_dwordx4 v[52:55], v1, s[8:11], s43 offen offset:1024
s_add_u32 s43, s48, 40960
buffer_load_dwordx4 v[56:59], v1, s[8:11], s43 offen offset:1024
s_add_u32 s43, s48, 57344
buffer_load_dwordx4 v[60:63], v1, s[8:11], s43 offen offset:1024
ds_read_b64_tr_b16 v[108:109], v21 offset:57344
ds_read_b64_tr_b16 v[110:111], v29 offset:57344
s_waitcnt vmcnt(12)
s_waitcnt lgkmcnt(6)
v_mfma_f32_16x16x32_bf16 a[0:3], v[96:99], v[64:67], a[0:3]
v_mfma_f32_16x16x32_bf16 a[32:35], v[96:99], v[68:71], a[32:35]
v_mfma_f32_16x16x32_bf16 a[64:67], v[96:99], v[72:75], a[64:67]
v_mfma_f32_16x16x32_bf16 a[96:99], v[96:99], v[76:79], a[96:99]
ds_read_b64_tr_b16 v[96:97], v22 offset:57344
ds_read_b64_tr_b16 v[98:99], v30 offset:57344
s_waitcnt lgkmcnt(6)
v_mfma_f32_16x16x32_bf16 a[4:7], v[100:103], v[64:67], a[4:7]
v_mfma_f32_16x16x32_bf16 a[36:39], v[100:103], v[68:71], a[36:39]
v_mfma_f32_16x16x32_bf16 a[68:71], v[100:103], v[72:75], a[68:71]
v_mfma_f32_16x16x32_bf16 a[100:103], v[100:103], v[76:79], a[100:103]
ds_read_b64_tr_b16 v[100:101], v23 offset:57344
ds_read_b64_tr_b16 v[102:103], v31 offset:57344
s_waitcnt lgkmcnt(6)
v_mfma_f32_16x16x32_bf16 a[8:11], v[104:107], v[64:67], a[8:11]
v_mfma_f32_16x16x32_bf16 a[40:43], v[104:107], v[68:71], a[40:43]
v_mfma_f32_16x16x32_bf16 a[72:75], v[104:107], v[72:75], a[72:75]
v_mfma_f32_16x16x32_bf16 a[104:107], v[104:107], v[76:79], a[104:107]
ds_read_b64_tr_b16 v[104:105], v24 offset:57344
ds_read_b64_tr_b16 v[106:107], v32 offset:57344
s_waitcnt lgkmcnt(6)
v_mfma_f32_16x16x32_bf16 a[12:15], v[108:111], v[64:67], a[12:15]
v_mfma_f32_16x16x32_bf16 a[44:47], v[108:111], v[68:71], a[44:47]
v_mfma_f32_16x16x32_bf16 a[76:79], v[108:111], v[72:75], a[76:79]
v_mfma_f32_16x16x32_bf16 a[108:111], v[108:111], v[76:79], a[108:111]
ds_read_b64_tr_b16 v[108:109], v25 offset:57344
ds_read_b64_tr_b16 v[110:111], v33 offset:57344
s_waitcnt lgkmcnt(6)
v_mfma_f32_16x16x32_bf16 a[16:19], v[96:99], v[64:67], a[16:19]
v_mfma_f32_16x16x32_bf16 a[48:51], v[96:99], v[68:71], a[48:51]
v_mfma_f32_16x16x32_bf16 a[80:83], v[96:99], v[72:75], a[80:83]
v_mfma_f32_16x16x32_bf16 a[112:115], v[96:99], v[76:79], a[112:115]
s_barrier
s_add_u32 s42, s49, 3145728
s_add_u32 m0, s51, 32768
s_nop 0
buffer_load_dwordx4 v2, s[12:15], s42 offen lds
s_add_u32 m0, s51, 33792
s_nop 0
buffer_load_dwordx4 v3, s[12:15], s42 offen lds
s_add_u32 m0, s51, 34816
s_nop 0
buffer_load_dwordx4 v4, s[12:15], s42 offen lds
s_add_u32 m0, s51, 35840
s_nop 0
buffer_load_dwordx4 v5, s[12:15], s42 offen lds
ds_read_b64_tr_b16 v[96:97], v18 offset:0
ds_read_b64_tr_b16 v[98:99], v26 offset:0
s_waitcnt lgkmcnt(6)
v_mfma_f32_16x16x32_bf16 a[20:23], v[100:103], v[64:67], a[20:23]
v_mfma_f32_16x16x32_bf16 a[52:55], v[100:103], v[68:71], a[52:55]
v_mfma_f32_16x16x32_bf16 a[84:87], v[100:103], v[72:75], a[84:87]
v_mfma_f32_16x16x32_bf16 a[116:119], v[100:103], v[76:79], a[116:119]
ds_read_b64_tr_b16 v[100:101], v19 offset:0
ds_read_b64_tr_b16 v[102:103], v27 offset:0
s_waitcnt lgkmcnt(6)
v_mfma_f32_16x16x32_bf16 a[24:27], v[104:107], v[64:67], a[24:27]
v_mfma_f32_16x16x32_bf16 a[56:59], v[104:107], v[68:71], a[56:59]
v_mfma_f32_16x16x32_bf16 a[88:91], v[104:107], v[72:75], a[88:91]
v_mfma_f32_16x16x32_bf16 a[120:123], v[104:107], v[76:79], a[120:123]
ds_read_b64_tr_b16 v[104:105], v20 offset:0
ds_read_b64_tr_b16 v[106:107], v28 offset:0
s_waitcnt lgkmcnt(6)
v_mfma_f32_16x16x32_bf16 a[28:31], v[108:111], v[64:67], a[28:31]
v_mfma_f32_16x16x32_bf16 a[60:63], v[108:111], v[68:71], a[60:63]
v_mfma_f32_16x16x32_bf16 a[92:95], v[108:111], v[72:75], a[92:95]
v_mfma_f32_16x16x32_bf16 a[124:127], v[108:111], v[76:79], a[124:127]
s_add_u32 s43, s48, 8192
buffer_load_dwordx4 v[64:67], v1, s[8:11], s43 offen offset:2048
s_add_u32 s43, s48, 24576
buffer_load_dwordx4 v[68:71], v1, s[8:11], s43 offen offset:2048
s_add_u32 s43, s48, 40960
buffer_load_dwordx4 v[72:75], v1, s[8:11], s43 offen offset:2048
s_add_u32 s43, s48, 57344
buffer_load_dwordx4 v[76:79], v1, s[8:11], s43 offen offset:2048
ds_read_b64_tr_b16 v[108:109], v21 offset:0
ds_read_b64_tr_b16 v[110:111], v29 offset:0
s_waitcnt vmcnt(12)
s_waitcnt lgkmcnt(6)
v_mfma_f32_16x16x32_bf16 a[0:3], v[96:99], v[80:83], a[0:3]
v_mfma_f32_16x16x32_bf16 a[32:35], v[96:99], v[84:87], a[32:35]
v_mfma_f32_16x16x32_bf16 a[64:67], v[96:99], v[88:91], a[64:67]
v_mfma_f32_16x16x32_bf16 a[96:99], v[96:99], v[92:95], a[96:99]
ds_read_b64_tr_b16 v[96:97], v22 offset:0
ds_read_b64_tr_b16 v[98:99], v30 offset:0
s_waitcnt lgkmcnt(6)
v_mfma_f32_16x16x32_bf16 a[4:7], v[100:103], v[80:83], a[4:7]
v_mfma_f32_16x16x32_bf16 a[36:39], v[100:103], v[84:87], a[36:39]
v_mfma_f32_16x16x32_bf16 a[68:71], v[100:103], v[88:91], a[68:71]
v_mfma_f32_16x16x32_bf16 a[100:103], v[100:103], v[92:95], a[100:103]
ds_read_b64_tr_b16 v[100:101], v23 offset:0
ds_read_b64_tr_b16 v[102:103], v31 offset:0
s_waitcnt lgkmcnt(6)
v_mfma_f32_16x16x32_bf16 a[8:11], v[104:107], v[80:83], a[8:11]
v_mfma_f32_16x16x32_bf16 a[40:43], v[104:107], v[84:87], a[40:43]
v_mfma_f32_16x16x32_bf16 a[72:75], v[104:107], v[88:91], a[72:75]
v_mfma_f32_16x16x32_bf16 a[104:107], v[104:107], v[92:95], a[104:107]
ds_read_b64_tr_b16 v[104:105], v24 offset:0
ds_read_b64_tr_b16 v[106:107], v32 offset:0
s_waitcnt lgkmcnt(6)
v_mfma_f32_16x16x32_bf16 a[12:15], v[108:111], v[80:83], a[12:15]
v_mfma_f32_16x16x32_bf16 a[44:47], v[108:111], v[84:87], a[44:47]
v_mfma_f32_16x16x32_bf16 a[76:79], v[108:111], v[88:91], a[76:79]
v_mfma_f32_16x16x32_bf16 a[108:111], v[108:111], v[92:95], a[108:111]
ds_read_b64_tr_b16 v[108:109], v25 offset:0
ds_read_b64_tr_b16 v[110:111], v33 offset:0
s_waitcnt lgkmcnt(6)
v_mfma_f32_16x16x32_bf16 a[16:19], v[96:99], v[80:83], a[16:19]
v_mfma_f32_16x16x32_bf16 a[48:51], v[96:99], v[84:87], a[48:51]
v_mfma_f32_16x16x32_bf16 a[80:83], v[96:99], v[88:91], a[80:83]
v_mfma_f32_16x16x32_bf16 a[112:115], v[96:99], v[92:95], a[112:115]
ds_read_b64_tr_b16 v[96:97], v18 offset:8192
ds_read_b64_tr_b16 v[98:99], v26 offset:8192
s_waitcnt lgkmcnt(6)
v_mfma_f32_16x16x32_bf16 a[20:23], v[100:103], v[80:83], a[20:23]
v_mfma_f32_16x16x32_bf16 a[52:55], v[100:103], v[84:87], a[52:55]
v_mfma_f32_16x16x32_bf16 a[84:87], v[100:103], v[88:91], a[84:87]
v_mfma_f32_16x16x32_bf16 a[116:119], v[100:103], v[92:95], a[116:119]
ds_read_b64_tr_b16 v[100:101], v19 offset:8192
ds_read_b64_tr_b16 v[102:103], v27 offset:8192
s_waitcnt lgkmcnt(6)
v_mfma_f32_16x16x32_bf16 a[24:27], v[104:107], v[80:83], a[24:27]
v_mfma_f32_16x16x32_bf16 a[56:59], v[104:107], v[84:87], a[56:59]
v_mfma_f32_16x16x32_bf16 a[88:91], v[104:107], v[88:91], a[88:91]
v_mfma_f32_16x16x32_bf16 a[120:123], v[104:107], v[92:95], a[120:123]
ds_read_b64_tr_b16 v[104:105], v20 offset:8192
ds_read_b64_tr_b16 v[106:107], v28 offset:8192
s_waitcnt lgkmcnt(6)
v_mfma_f32_16x16x32_bf16 a[28:31], v[108:111], v[80:83], a[28:31]
v_mfma_f32_16x16x32_bf16 a[60:63], v[108:111], v[84:87], a[60:63]
v_mfma_f32_16x16x32_bf16 a[92:95], v[108:111], v[88:91], a[92:95]
v_mfma_f32_16x16x32_bf16 a[124:127], v[108:111], v[92:95], a[124:127]
s_add_u32 s43, s48, 8192
buffer_load_dwordx4 v[80:83], v1, s[8:11], s43 offen offset:3072
s_add_u32 s43, s48, 24576
buffer_load_dwordx4 v[84:87], v1, s[8:11], s43 offen offset:3072
s_add_u32 s43, s48, 40960
buffer_load_dwordx4 v[88:91], v1, s[8:11], s43 offen offset:3072
s_add_u32 s43, s48, 57344
buffer_load_dwordx4 v[92:95], v1, s[8:11], s43 offen offset:3072
ds_read_b64_tr_b16 v[108:109], v21 offset:8192
ds_read_b64_tr_b16 v[110:111], v29 offset:8192
s_waitcnt vmcnt(12)
s_waitcnt lgkmcnt(6)
v_mfma_f32_16x16x32_bf16 a[0:3], v[96:99], v[48:51], a[0:3]
v_mfma_f32_16x16x32_bf16 a[32:35], v[96:99], v[52:55], a[32:35]
v_mfma_f32_16x16x32_bf16 a[64:67], v[96:99], v[56:59], a[64:67]
v_mfma_f32_16x16x32_bf16 a[96:99], v[96:99], v[60:63], a[96:99]
ds_read_b64_tr_b16 v[96:97], v22 offset:8192
ds_read_b64_tr_b16 v[98:99], v30 offset:8192
s_waitcnt lgkmcnt(6)
v_mfma_f32_16x16x32_bf16 a[4:7], v[100:103], v[48:51], a[4:7]
v_mfma_f32_16x16x32_bf16 a[36:39], v[100:103], v[52:55], a[36:39]
v_mfma_f32_16x16x32_bf16 a[68:71], v[100:103], v[56:59], a[68:71]
v_mfma_f32_16x16x32_bf16 a[100:103], v[100:103], v[60:63], a[100:103]
ds_read_b64_tr_b16 v[100:101], v23 offset:8192
ds_read_b64_tr_b16 v[102:103], v31 offset:8192
s_waitcnt lgkmcnt(6)
v_mfma_f32_16x16x32_bf16 a[8:11], v[104:107], v[48:51], a[8:11]
v_mfma_f32_16x16x32_bf16 a[40:43], v[104:107], v[52:55], a[40:43]
v_mfma_f32_16x16x32_bf16 a[72:75], v[104:107], v[56:59], a[72:75]
v_mfma_f32_16x16x32_bf16 a[104:107], v[104:107], v[60:63], a[104:107]
ds_read_b64_tr_b16 v[104:105], v24 offset:8192
ds_read_b64_tr_b16 v[106:107], v32 offset:8192
s_waitcnt lgkmcnt(6)
v_mfma_f32_16x16x32_bf16 a[12:15], v[108:111], v[48:51], a[12:15]
v_mfma_f32_16x16x32_bf16 a[44:47], v[108:111], v[52:55], a[44:47]
v_mfma_f32_16x16x32_bf16 a[76:79], v[108:111], v[56:59], a[76:79]
v_mfma_f32_16x16x32_bf16 a[108:111], v[108:111], v[60:63], a[108:111]
ds_read_b64_tr_b16 v[108:109], v25 offset:8192
ds_read_b64_tr_b16 v[110:111], v33 offset:8192
s_waitcnt lgkmcnt(6)
v_mfma_f32_16x16x32_bf16 a[16:19], v[96:99], v[48:51], a[16:19]
v_mfma_f32_16x16x32_bf16 a[48:51], v[96:99], v[52:55], a[48:51]
v_mfma_f32_16x16x32_bf16 a[80:83], v[96:99], v[56:59], a[80:83]
v_mfma_f32_16x16x32_bf16 a[112:115], v[96:99], v[60:63], a[112:115]
s_barrier
s_add_u32 s42, s49, 3670016
s_add_u32 m0, s51, 49152
s_nop 0
buffer_load_dwordx4 v2, s[12:15], s42 offen lds
s_add_u32 m0, s51, 50176
s_nop 0
buffer_load_dwordx4 v3, s[12:15], s42 offen lds
s_add_u32 m0, s51, 51200
s_nop 0
buffer_load_dwordx4 v4, s[12:15], s42 offen lds
s_add_u32 m0, s51, 52224
s_nop 0
buffer_load_dwordx4 v5, s[12:15], s42 offen lds
ds_read_b64_tr_b16 v[96:97], v18 offset:16384
ds_read_b64_tr_b16 v[98:99], v26 offset:16384
s_waitcnt lgkmcnt(6)
v_mfma_f32_16x16x32_bf16 a[20:23], v[100:103], v[48:51], a[20:23]
v_mfma_f32_16x16x32_bf16 a[52:55], v[100:103], v[52:55], a[52:55]
v_mfma_f32_16x16x32_bf16 a[84:87], v[100:103], v[56:59], a[84:87]
v_mfma_f32_16x16x32_bf16 a[116:119], v[100:103], v[60:63], a[116:119]
ds_read_b64_tr_b16 v[100:101], v19 offset:16384
ds_read_b64_tr_b16 v[102:103], v27 offset:16384
s_waitcnt lgkmcnt(6)
v_mfma_f32_16x16x32_bf16 a[24:27], v[104:107], v[48:51], a[24:27]
v_mfma_f32_16x16x32_bf16 a[56:59], v[104:107], v[52:55], a[56:59]
v_mfma_f32_16x16x32_bf16 a[88:91], v[104:107], v[56:59], a[88:91]
v_mfma_f32_16x16x32_bf16 a[120:123], v[104:107], v[60:63], a[120:123]
ds_read_b64_tr_b16 v[104:105], v20 offset:16384
ds_read_b64_tr_b16 v[106:107], v28 offset:16384
s_waitcnt lgkmcnt(6)
v_mfma_f32_16x16x32_bf16 a[28:31], v[108:111], v[48:51], a[28:31]
v_mfma_f32_16x16x32_bf16 a[60:63], v[108:111], v[52:55], a[60:63]
v_mfma_f32_16x16x32_bf16 a[92:95], v[108:111], v[56:59], a[92:95]
v_mfma_f32_16x16x32_bf16 a[124:127], v[108:111], v[60:63], a[124:127]
s_add_u32 s43, s48, 12288
buffer_load_dwordx4 v[48:51], v1, s[8:11], s43 offen offset:0
s_add_u32 s43, s48, 28672
buffer_load_dwordx4 v[52:55], v1, s[8:11], s43 offen offset:0
s_add_u32 s43, s48, 45056
buffer_load_dwordx4 v[56:59], v1, s[8:11], s43 offen offset:0
s_add_u32 s43, s48, 61440
buffer_load_dwordx4 v[60:63], v1, s[8:11], s43 offen offset:0
ds_read_b64_tr_b16 v[108:109], v21 offset:16384
ds_read_b64_tr_b16 v[110:111], v29 offset:16384
s_waitcnt vmcnt(12)
s_waitcnt lgkmcnt(6)
v_mfma_f32_16x16x32_bf16 a[0:3], v[96:99], v[64:67], a[0:3]
v_mfma_f32_16x16x32_bf16 a[32:35], v[96:99], v[68:71], a[32:35]
v_mfma_f32_16x16x32_bf16 a[64:67], v[96:99], v[72:75], a[64:67]
v_mfma_f32_16x16x32_bf16 a[96:99], v[96:99], v[76:79], a[96:99]
ds_read_b64_tr_b16 v[96:97], v22 offset:16384
ds_read_b64_tr_b16 v[98:99], v30 offset:16384
s_waitcnt lgkmcnt(6)
v_mfma_f32_16x16x32_bf16 a[4:7], v[100:103], v[64:67], a[4:7]
v_mfma_f32_16x16x32_bf16 a[36:39], v[100:103], v[68:71], a[36:39]
v_mfma_f32_16x16x32_bf16 a[68:71], v[100:103], v[72:75], a[68:71]
v_mfma_f32_16x16x32_bf16 a[100:103], v[100:103], v[76:79], a[100:103]
ds_read_b64_tr_b16 v[100:101], v23 offset:16384
ds_read_b64_tr_b16 v[102:103], v31 offset:16384
s_waitcnt lgkmcnt(6)
v_mfma_f32_16x16x32_bf16 a[8:11], v[104:107], v[64:67], a[8:11]
v_mfma_f32_16x16x32_bf16 a[40:43], v[104:107], v[68:71], a[40:43]
v_mfma_f32_16x16x32_bf16 a[72:75], v[104:107], v[72:75], a[72:75]
v_mfma_f32_16x16x32_bf16 a[104:107], v[104:107], v[76:79], a[104:107]
ds_read_b64_tr_b16 v[104:105], v24 offset:16384
ds_read_b64_tr_b16 v[106:107], v32 offset:16384
s_waitcnt lgkmcnt(6)
v_mfma_f32_16x16x32_bf16 a[12:15], v[108:111], v[64:67], a[12:15]
v_mfma_f32_16x16x32_bf16 a[44:47], v[108:111], v[68:71], a[44:47]
v_mfma_f32_16x16x32_bf16 a[76:79], v[108:111], v[72:75], a[76:79]
v_mfma_f32_16x16x32_bf16 a[108:111], v[108:111], v[76:79], a[108:111]
ds_read_b64_tr_b16 v[108:109], v25 offset:16384
ds_read_b64_tr_b16 v[110:111], v33 offset:16384
s_waitcnt lgkmcnt(6)
v_mfma_f32_16x16x32_bf16 a[16:19], v[96:99], v[64:67], a[16:19]
v_mfma_f32_16x16x32_bf16 a[48:51], v[96:99], v[68:71], a[48:51]
v_mfma_f32_16x16x32_bf16 a[80:83], v[96:99], v[72:75], a[80:83]
v_mfma_f32_16x16x32_bf16 a[112:115], v[96:99], v[76:79], a[112:115]
ds_read_b64_tr_b16 v[96:97], v18 offset:24576
ds_read_b64_tr_b16 v[98:99], v26 offset:24576
s_waitcnt lgkmcnt(6)
v_mfma_f32_16x16x32_bf16 a[20:23], v[100:103], v[64:67], a[20:23]
v_mfma_f32_16x16x32_bf16 a[52:55], v[100:103], v[68:71], a[52:55]
v_mfma_f32_16x16x32_bf16 a[84:87], v[100:103], v[72:75], a[84:87]
v_mfma_f32_16x16x32_bf16 a[116:119], v[100:103], v[76:79], a[116:119]
ds_read_b64_tr_b16 v[100:101], v19 offset:24576
ds_read_b64_tr_b16 v[102:103], v27 offset:24576
s_waitcnt lgkmcnt(6)
v_mfma_f32_16x16x32_bf16 a[24:27], v[104:107], v[64:67], a[24:27]
v_mfma_f32_16x16x32_bf16 a[56:59], v[104:107], v[68:71], a[56:59]
v_mfma_f32_16x16x32_bf16 a[88:91], v[104:107], v[72:75], a[88:91]
v_mfma_f32_16x16x32_bf16 a[120:123], v[104:107], v[76:79], a[120:123]
ds_read_b64_tr_b16 v[104:105], v20 offset:24576
ds_read_b64_tr_b16 v[106:107], v28 offset:24576
s_waitcnt lgkmcnt(6)
v_mfma_f32_16x16x32_bf16 a[28:31], v[108:111], v[64:67], a[28:31]
v_mfma_f32_16x16x32_bf16 a[60:63], v[108:111], v[68:71], a[60:63]
v_mfma_f32_16x16x32_bf16 a[92:95], v[108:111], v[72:75], a[92:95]
v_mfma_f32_16x16x32_bf16 a[124:127], v[108:111], v[76:79], a[124:127]
s_add_u32 s43, s48, 12288
buffer_load_dwordx4 v[64:67], v1, s[8:11], s43 offen offset:1024
s_add_u32 s43, s48, 28672
buffer_load_dwordx4 v[68:71], v1, s[8:11], s43 offen offset:1024
s_add_u32 s43, s48, 45056
buffer_load_dwordx4 v[72:75], v1, s[8:11], s43 offen offset:1024
s_add_u32 s43, s48, 61440
buffer_load_dwordx4 v[76:79], v1, s[8:11], s43 offen offset:1024
ds_read_b64_tr_b16 v[108:109], v21 offset:24576
ds_read_b64_tr_b16 v[110:111], v29 offset:24576
s_waitcnt vmcnt(12)
s_waitcnt lgkmcnt(6)
v_mfma_f32_16x16x32_bf16 a[0:3], v[96:99], v[80:83], a[0:3]
v_mfma_f32_16x16x32_bf16 a[32:35], v[96:99], v[84:87], a[32:35]
v_mfma_f32_16x16x32_bf16 a[64:67], v[96:99], v[88:91], a[64:67]
v_mfma_f32_16x16x32_bf16 a[96:99], v[96:99], v[92:95], a[96:99]
ds_read_b64_tr_b16 v[96:97], v22 offset:24576
ds_read_b64_tr_b16 v[98:99], v30 offset:24576
s_waitcnt lgkmcnt(6)
v_mfma_f32_16x16x32_bf16 a[4:7], v[100:103], v[80:83], a[4:7]
v_mfma_f32_16x16x32_bf16 a[36:39], v[100:103], v[84:87], a[36:39]
v_mfma_f32_16x16x32_bf16 a[68:71], v[100:103], v[88:91], a[68:71]
v_mfma_f32_16x16x32_bf16 a[100:103], v[100:103], v[92:95], a[100:103]
ds_read_b64_tr_b16 v[100:101], v23 offset:24576
ds_read_b64_tr_b16 v[102:103], v31 offset:24576
s_waitcnt lgkmcnt(6)
v_mfma_f32_16x16x32_bf16 a[8:11], v[104:107], v[80:83], a[8:11]
v_mfma_f32_16x16x32_bf16 a[40:43], v[104:107], v[84:87], a[40:43]
v_mfma_f32_16x16x32_bf16 a[72:75], v[104:107], v[88:91], a[72:75]
v_mfma_f32_16x16x32_bf16 a[104:107], v[104:107], v[92:95], a[104:107]
ds_read_b64_tr_b16 v[104:105], v24 offset:24576
ds_read_b64_tr_b16 v[106:107], v32 offset:24576
s_waitcnt lgkmcnt(6)
v_mfma_f32_16x16x32_bf16 a[12:15], v[108:111], v[80:83], a[12:15]
v_mfma_f32_16x16x32_bf16 a[44:47], v[108:111], v[84:87], a[44:47]
v_mfma_f32_16x16x32_bf16 a[76:79], v[108:111], v[88:91], a[76:79]
v_mfma_f32_16x16x32_bf16 a[108:111], v[108:111], v[92:95], a[108:111]
ds_read_b64_tr_b16 v[108:109], v25 offset:24576
ds_read_b64_tr_b16 v[110:111], v33 offset:24576
s_waitcnt lgkmcnt(6)
v_mfma_f32_16x16x32_bf16 a[16:19], v[96:99], v[80:83], a[16:19]
v_mfma_f32_16x16x32_bf16 a[48:51], v[96:99], v[84:87], a[48:51]
v_mfma_f32_16x16x32_bf16 a[80:83], v[96:99], v[88:91], a[80:83]
v_mfma_f32_16x16x32_bf16 a[112:115], v[96:99], v[92:95], a[112:115]
s_barrier
ds_read_b64_tr_b16 v[96:97], v18 offset:32768
ds_read_b64_tr_b16 v[98:99], v26 offset:32768
s_waitcnt lgkmcnt(6)
v_mfma_f32_16x16x32_bf16 a[20:23], v[100:103], v[80:83], a[20:23]
v_mfma_f32_16x16x32_bf16 a[52:55], v[100:103], v[84:87], a[52:55]
v_mfma_f32_16x16x32_bf16 a[84:87], v[100:103], v[88:91], a[84:87]
v_mfma_f32_16x16x32_bf16 a[116:119], v[100:103], v[92:95], a[116:119]
ds_read_b64_tr_b16 v[100:101], v19 offset:32768
ds_read_b64_tr_b16 v[102:103], v27 offset:32768
s_waitcnt lgkmcnt(6)
v_mfma_f32_16x16x32_bf16 a[24:27], v[104:107], v[80:83], a[24:27]
v_mfma_f32_16x16x32_bf16 a[56:59], v[104:107], v[84:87], a[56:59]
v_mfma_f32_16x16x32_bf16 a[88:91], v[104:107], v[88:91], a[88:91]
v_mfma_f32_16x16x32_bf16 a[120:123], v[104:107], v[92:95], a[120:123]
ds_read_b64_tr_b16 v[104:105], v20 offset:32768
ds_read_b64_tr_b16 v[106:107], v28 offset:32768
s_waitcnt lgkmcnt(6)
v_mfma_f32_16x16x32_bf16 a[28:31], v[108:111], v[80:83], a[28:31]
v_mfma_f32_16x16x32_bf16 a[60:63], v[108:111], v[84:87], a[60:63]
v_mfma_f32_16x16x32_bf16 a[92:95], v[108:111], v[88:91], a[92:95]
v_mfma_f32_16x16x32_bf16 a[124:127], v[108:111], v[92:95], a[124:127]
s_add_u32 s43, s48, 12288
buffer_load_dwordx4 v[80:83], v1, s[8:11], s43 offen offset:2048
s_add_u32 s43, s48, 28672
buffer_load_dwordx4 v[84:87], v1, s[8:11], s43 offen offset:2048
s_add_u32 s43, s48, 45056
buffer_load_dwordx4 v[88:91], v1, s[8:11], s43 offen offset:2048
s_add_u32 s43, s48, 61440
buffer_load_dwordx4 v[92:95], v1, s[8:11], s43 offen offset:2048
ds_read_b64_tr_b16 v[108:109], v21 offset:32768
ds_read_b64_tr_b16 v[110:111], v29 offset:32768
s_waitcnt vmcnt(8)
s_waitcnt lgkmcnt(6)
v_mfma_f32_16x16x32_bf16 a[0:3], v[96:99], v[48:51], a[0:3]
v_mfma_f32_16x16x32_bf16 a[32:35], v[96:99], v[52:55], a[32:35]
v_mfma_f32_16x16x32_bf16 a[64:67], v[96:99], v[56:59], a[64:67]
v_mfma_f32_16x16x32_bf16 a[96:99], v[96:99], v[60:63], a[96:99]
ds_read_b64_tr_b16 v[96:97], v22 offset:32768
ds_read_b64_tr_b16 v[98:99], v30 offset:32768
s_waitcnt lgkmcnt(6)
v_mfma_f32_16x16x32_bf16 a[4:7], v[100:103], v[48:51], a[4:7]
v_mfma_f32_16x16x32_bf16 a[36:39], v[100:103], v[52:55], a[36:39]
v_mfma_f32_16x16x32_bf16 a[68:71], v[100:103], v[56:59], a[68:71]
v_mfma_f32_16x16x32_bf16 a[100:103], v[100:103], v[60:63], a[100:103]
ds_read_b64_tr_b16 v[100:101], v23 offset:32768
ds_read_b64_tr_b16 v[102:103], v31 offset:32768
s_waitcnt lgkmcnt(6)
v_mfma_f32_16x16x32_bf16 a[8:11], v[104:107], v[48:51], a[8:11]
v_mfma_f32_16x16x32_bf16 a[40:43], v[104:107], v[52:55], a[40:43]
v_mfma_f32_16x16x32_bf16 a[72:75], v[104:107], v[56:59], a[72:75]
v_mfma_f32_16x16x32_bf16 a[104:107], v[104:107], v[60:63], a[104:107]
ds_read_b64_tr_b16 v[104:105], v24 offset:32768
ds_read_b64_tr_b16 v[106:107], v32 offset:32768
s_waitcnt lgkmcnt(6)
v_mfma_f32_16x16x32_bf16 a[12:15], v[108:111], v[48:51], a[12:15]
v_mfma_f32_16x16x32_bf16 a[44:47], v[108:111], v[52:55], a[44:47]
v_mfma_f32_16x16x32_bf16 a[76:79], v[108:111], v[56:59], a[76:79]
v_mfma_f32_16x16x32_bf16 a[108:111], v[108:111], v[60:63], a[108:111]
ds_read_b64_tr_b16 v[108:109], v25 offset:32768
ds_read_b64_tr_b16 v[110:111], v33 offset:32768
s_waitcnt lgkmcnt(6)
v_mfma_f32_16x16x32_bf16 a[16:19], v[96:99], v[48:51], a[16:19]
v_mfma_f32_16x16x32_bf16 a[48:51], v[96:99], v[52:55], a[48:51]
v_mfma_f32_16x16x32_bf16 a[80:83], v[96:99], v[56:59], a[80:83]
v_mfma_f32_16x16x32_bf16 a[112:115], v[96:99], v[60:63], a[112:115]
ds_read_b64_tr_b16 v[96:97], v18 offset:40960
ds_read_b64_tr_b16 v[98:99], v26 offset:40960
s_waitcnt lgkmcnt(6)
v_mfma_f32_16x16x32_bf16 a[20:23], v[100:103], v[48:51], a[20:23]
v_mfma_f32_16x16x32_bf16 a[52:55], v[100:103], v[52:55], a[52:55]
v_mfma_f32_16x16x32_bf16 a[84:87], v[100:103], v[56:59], a[84:87]
v_mfma_f32_16x16x32_bf16 a[116:119], v[100:103], v[60:63], a[116:119]
ds_read_b64_tr_b16 v[100:101], v19 offset:40960
ds_read_b64_tr_b16 v[102:103], v27 offset:40960
s_waitcnt lgkmcnt(6)
v_mfma_f32_16x16x32_bf16 a[24:27], v[104:107], v[48:51], a[24:27]
v_mfma_f32_16x16x32_bf16 a[56:59], v[104:107], v[52:55], a[56:59]
v_mfma_f32_16x16x32_bf16 a[88:91], v[104:107], v[56:59], a[88:91]
v_mfma_f32_16x16x32_bf16 a[120:123], v[104:107], v[60:63], a[120:123]
ds_read_b64_tr_b16 v[104:105], v20 offset:40960
ds_read_b64_tr_b16 v[106:107], v28 offset:40960
s_waitcnt lgkmcnt(6)
v_mfma_f32_16x16x32_bf16 a[28:31], v[108:111], v[48:51], a[28:31]
v_mfma_f32_16x16x32_bf16 a[60:63], v[108:111], v[52:55], a[60:63]
v_mfma_f32_16x16x32_bf16 a[92:95], v[108:111], v[56:59], a[92:95]
v_mfma_f32_16x16x32_bf16 a[124:127], v[108:111], v[60:63], a[124:127]
s_add_u32 s43, s48, 12288
buffer_load_dwordx4 v[48:51], v1, s[8:11], s43 offen offset:3072
s_add_u32 s43, s48, 28672
buffer_load_dwordx4 v[52:55], v1, s[8:11], s43 offen offset:3072
s_add_u32 s43, s48, 45056
buffer_load_dwordx4 v[56:59], v1, s[8:11], s43 offen offset:3072
s_add_u32 s43, s48, 61440
buffer_load_dwordx4 v[60:63], v1, s[8:11], s43 offen offset:3072
ds_read_b64_tr_b16 v[108:109], v21 offset:40960
ds_read_b64_tr_b16 v[110:111], v29 offset:40960
s_waitcnt vmcnt(8)
s_waitcnt lgkmcnt(6)
v_mfma_f32_16x16x32_bf16 a[0:3], v[96:99], v[64:67], a[0:3]
v_mfma_f32_16x16x32_bf16 a[32:35], v[96:99], v[68:71], a[32:35]
v_mfma_f32_16x16x32_bf16 a[64:67], v[96:99], v[72:75], a[64:67]
v_mfma_f32_16x16x32_bf16 a[96:99], v[96:99], v[76:79], a[96:99]
ds_read_b64_tr_b16 v[96:97], v22 offset:40960
ds_read_b64_tr_b16 v[98:99], v30 offset:40960
s_waitcnt lgkmcnt(6)
v_mfma_f32_16x16x32_bf16 a[4:7], v[100:103], v[64:67], a[4:7]
v_mfma_f32_16x16x32_bf16 a[36:39], v[100:103], v[68:71], a[36:39]
v_mfma_f32_16x16x32_bf16 a[68:71], v[100:103], v[72:75], a[68:71]
v_mfma_f32_16x16x32_bf16 a[100:103], v[100:103], v[76:79], a[100:103]
ds_read_b64_tr_b16 v[100:101], v23 offset:40960
ds_read_b64_tr_b16 v[102:103], v31 offset:40960
s_waitcnt lgkmcnt(6)
v_mfma_f32_16x16x32_bf16 a[8:11], v[104:107], v[64:67], a[8:11]
v_mfma_f32_16x16x32_bf16 a[40:43], v[104:107], v[68:71], a[40:43]
v_mfma_f32_16x16x32_bf16 a[72:75], v[104:107], v[72:75], a[72:75]
v_mfma_f32_16x16x32_bf16 a[104:107], v[104:107], v[76:79], a[104:107]
ds_read_b64_tr_b16 v[104:105], v24 offset:40960
ds_read_b64_tr_b16 v[106:107], v32 offset:40960
s_waitcnt lgkmcnt(6)
v_mfma_f32_16x16x32_bf16 a[12:15], v[108:111], v[64:67], a[12:15]
v_mfma_f32_16x16x32_bf16 a[44:47], v[108:111], v[68:71], a[44:47]
v_mfma_f32_16x16x32_bf16 a[76:79], v[108:111], v[72:75], a[76:79]
v_mfma_f32_16x16x32_bf16 a[108:111], v[108:111], v[76:79], a[108:111]
ds_read_b64_tr_b16 v[108:109], v25 offset:40960
ds_read_b64_tr_b16 v[110:111], v33 offset:40960
s_waitcnt lgkmcnt(6)
v_mfma_f32_16x16x32_bf16 a[16:19], v[96:99], v[64:67], a[16:19]
v_mfma_f32_16x16x32_bf16 a[48:51], v[96:99], v[68:71], a[48:51]
v_mfma_f32_16x16x32_bf16 a[80:83], v[96:99], v[72:75], a[80:83]
v_mfma_f32_16x16x32_bf16 a[112:115], v[96:99], v[76:79], a[112:115]
s_barrier
ds_read_b64_tr_b16 v[96:97], v18 offset:49152
ds_read_b64_tr_b16 v[98:99], v26 offset:49152
s_waitcnt lgkmcnt(6)
v_mfma_f32_16x16x32_bf16 a[20:23], v[100:103], v[64:67], a[20:23]
v_mfma_f32_16x16x32_bf16 a[52:55], v[100:103], v[68:71], a[52:55]
v_mfma_f32_16x16x32_bf16 a[84:87], v[100:103], v[72:75], a[84:87]
v_mfma_f32_16x16x32_bf16 a[116:119], v[100:103], v[76:79], a[116:119]
ds_read_b64_tr_b16 v[100:101], v19 offset:49152
ds_read_b64_tr_b16 v[102:103], v27 offset:49152
s_waitcnt lgkmcnt(6)
v_mfma_f32_16x16x32_bf16 a[24:27], v[104:107], v[64:67], a[24:27]
v_mfma_f32_16x16x32_bf16 a[56:59], v[104:107], v[68:71], a[56:59]
v_mfma_f32_16x16x32_bf16 a[88:91], v[104:107], v[72:75], a[88:91]
v_mfma_f32_16x16x32_bf16 a[120:123], v[104:107], v[76:79], a[120:123]
ds_read_b64_tr_b16 v[104:105], v20 offset:49152
ds_read_b64_tr_b16 v[106:107], v28 offset:49152
s_waitcnt lgkmcnt(6)
v_mfma_f32_16x16x32_bf16 a[28:31], v[108:111], v[64:67], a[28:31]
v_mfma_f32_16x16x32_bf16 a[60:63], v[108:111], v[68:71], a[60:63]
v_mfma_f32_16x16x32_bf16 a[92:95], v[108:111], v[72:75], a[92:95]
v_mfma_f32_16x16x32_bf16 a[124:127], v[108:111], v[76:79], a[124:127]
ds_read_b64_tr_b16 v[108:109], v21 offset:49152
ds_read_b64_tr_b16 v[110:111], v29 offset:49152
s_waitcnt vmcnt(4)
s_waitcnt lgkmcnt(6)
v_mfma_f32_16x16x32_bf16 a[0:3], v[96:99], v[80:83], a[0:3]
v_mfma_f32_16x16x32_bf16 a[32:35], v[96:99], v[84:87], a[32:35]
v_mfma_f32_16x16x32_bf16 a[64:67], v[96:99], v[88:91], a[64:67]
v_mfma_f32_16x16x32_bf16 a[96:99], v[96:99], v[92:95], a[96:99]
ds_read_b64_tr_b16 v[96:97], v22 offset:49152
ds_read_b64_tr_b16 v[98:99], v30 offset:49152
s_waitcnt lgkmcnt(6)
v_mfma_f32_16x16x32_bf16 a[4:7], v[100:103], v[80:83], a[4:7]
v_mfma_f32_16x16x32_bf16 a[36:39], v[100:103], v[84:87], a[36:39]
v_mfma_f32_16x16x32_bf16 a[68:71], v[100:103], v[88:91], a[68:71]
v_mfma_f32_16x16x32_bf16 a[100:103], v[100:103], v[92:95], a[100:103]
ds_read_b64_tr_b16 v[100:101], v23 offset:49152
ds_read_b64_tr_b16 v[102:103], v31 offset:49152
s_waitcnt lgkmcnt(6)
v_mfma_f32_16x16x32_bf16 a[8:11], v[104:107], v[80:83], a[8:11]
v_mfma_f32_16x16x32_bf16 a[40:43], v[104:107], v[84:87], a[40:43]
v_mfma_f32_16x16x32_bf16 a[72:75], v[104:107], v[88:91], a[72:75]
v_mfma_f32_16x16x32_bf16 a[104:107], v[104:107], v[92:95], a[104:107]
ds_read_b64_tr_b16 v[104:105], v24 offset:49152
ds_read_b64_tr_b16 v[106:107], v32 offset:49152
s_waitcnt lgkmcnt(6)
v_mfma_f32_16x16x32_bf16 a[12:15], v[108:111], v[80:83], a[12:15]
v_mfma_f32_16x16x32_bf16 a[44:47], v[108:111], v[84:87], a[44:47]
v_mfma_f32_16x16x32_bf16 a[76:79], v[108:111], v[88:91], a[76:79]
v_mfma_f32_16x16x32_bf16 a[108:111], v[108:111], v[92:95], a[108:111]
ds_read_b64_tr_b16 v[108:109], v25 offset:49152
ds_read_b64_tr_b16 v[110:111], v33 offset:49152
s_waitcnt lgkmcnt(6)
v_mfma_f32_16x16x32_bf16 a[16:19], v[96:99], v[80:83], a[16:19]
v_mfma_f32_16x16x32_bf16 a[48:51], v[96:99], v[84:87], a[48:51]
v_mfma_f32_16x16x32_bf16 a[80:83], v[96:99], v[88:91], a[80:83]
v_mfma_f32_16x16x32_bf16 a[112:115], v[96:99], v[92:95], a[112:115]
ds_read_b64_tr_b16 v[96:97], v18 offset:57344
ds_read_b64_tr_b16 v[98:99], v26 offset:57344
s_waitcnt lgkmcnt(6)
v_mfma_f32_16x16x32_bf16 a[20:23], v[100:103], v[80:83], a[20:23]
v_mfma_f32_16x16x32_bf16 a[52:55], v[100:103], v[84:87], a[52:55]
v_mfma_f32_16x16x32_bf16 a[84:87], v[100:103], v[88:91], a[84:87]
v_mfma_f32_16x16x32_bf16 a[116:119], v[100:103], v[92:95], a[116:119]
ds_read_b64_tr_b16 v[100:101], v19 offset:57344
ds_read_b64_tr_b16 v[102:103], v27 offset:57344
s_waitcnt lgkmcnt(6)
v_mfma_f32_16x16x32_bf16 a[24:27], v[104:107], v[80:83], a[24:27]
v_mfma_f32_16x16x32_bf16 a[56:59], v[104:107], v[84:87], a[56:59]
v_mfma_f32_16x16x32_bf16 a[88:91], v[104:107], v[88:91], a[88:91]
v_mfma_f32_16x16x32_bf16 a[120:123], v[104:107], v[92:95], a[120:123]
ds_read_b64_tr_b16 v[104:105], v20 offset:57344
ds_read_b64_tr_b16 v[106:107], v28 offset:57344
s_waitcnt lgkmcnt(6)
v_mfma_f32_16x16x32_bf16 a[28:31], v[108:111], v[80:83], a[28:31]
v_mfma_f32_16x16x32_bf16 a[60:63], v[108:111], v[84:87], a[60:63]
v_mfma_f32_16x16x32_bf16 a[92:95], v[108:111], v[88:91], a[92:95]
v_mfma_f32_16x16x32_bf16 a[124:127], v[108:111], v[92:95], a[124:127]
ds_read_b64_tr_b16 v[108:109], v21 offset:57344
ds_read_b64_tr_b16 v[110:111], v29 offset:57344
s_waitcnt vmcnt(0)
s_waitcnt lgkmcnt(6)
v_mfma_f32_16x16x32_bf16 a[0:3], v[96:99], v[48:51], a[0:3]
v_mfma_f32_16x16x32_bf16 a[32:35], v[96:99], v[52:55], a[32:35]
v_mfma_f32_16x16x32_bf16 a[64:67], v[96:99], v[56:59], a[64:67]
v_mfma_f32_16x16x32_bf16 a[96:99], v[96:99], v[60:63], a[96:99]
ds_read_b64_tr_b16 v[96:97], v22 offset:57344
ds_read_b64_tr_b16 v[98:99], v30 offset:57344
s_waitcnt lgkmcnt(6)
v_mfma_f32_16x16x32_bf16 a[4:7], v[100:103], v[48:51], a[4:7]
v_mfma_f32_16x16x32_bf16 a[36:39], v[100:103], v[52:55], a[36:39]
v_mfma_f32_16x16x32_bf16 a[68:71], v[100:103], v[56:59], a[68:71]
v_mfma_f32_16x16x32_bf16 a[100:103], v[100:103], v[60:63], a[100:103]
ds_read_b64_tr_b16 v[100:101], v23 offset:57344
ds_read_b64_tr_b16 v[102:103], v31 offset:57344
s_waitcnt lgkmcnt(6)
v_mfma_f32_16x16x32_bf16 a[8:11], v[104:107], v[48:51], a[8:11]
v_mfma_f32_16x16x32_bf16 a[40:43], v[104:107], v[52:55], a[40:43]
v_mfma_f32_16x16x32_bf16 a[72:75], v[104:107], v[56:59], a[72:75]
v_mfma_f32_16x16x32_bf16 a[104:107], v[104:107], v[60:63], a[104:107]
ds_read_b64_tr_b16 v[104:105], v24 offset:57344
ds_read_b64_tr_b16 v[106:107], v32 offset:57344
s_waitcnt lgkmcnt(6)
v_mfma_f32_16x16x32_bf16 a[12:15], v[108:111], v[48:51], a[12:15]
v_mfma_f32_16x16x32_bf16 a[44:47], v[108:111], v[52:55], a[44:47]
v_mfma_f32_16x16x32_bf16 a[76:79], v[108:111], v[56:59], a[76:79]
v_mfma_f32_16x16x32_bf16 a[108:111], v[108:111], v[60:63], a[108:111]
ds_read_b64_tr_b16 v[108:109], v25 offset:57344
ds_read_b64_tr_b16 v[110:111], v33 offset:57344
s_waitcnt lgkmcnt(6)
v_mfma_f32_16x16x32_bf16 a[16:19], v[96:99], v[48:51], a[16:19]
v_mfma_f32_16x16x32_bf16 a[48:51], v[96:99], v[52:55], a[48:51]
v_mfma_f32_16x16x32_bf16 a[80:83], v[96:99], v[56:59], a[80:83]
v_mfma_f32_16x16x32_bf16 a[112:115], v[96:99], v[60:63], a[112:115]
s_waitcnt lgkmcnt(4)
v_mfma_f32_16x16x32_bf16 a[20:23], v[100:103], v[48:51], a[20:23]
v_mfma_f32_16x16x32_bf16 a[52:55], v[100:103], v[52:55], a[52:55]
v_mfma_f32_16x16x32_bf16 a[84:87], v[100:103], v[56:59], a[84:87]
v_mfma_f32_16x16x32_bf16 a[116:119], v[100:103], v[60:63], a[116:119]
s_waitcnt lgkmcnt(2)
v_mfma_f32_16x16x32_bf16 a[24:27], v[104:107], v[48:51], a[24:27]
v_mfma_f32_16x16x32_bf16 a[56:59], v[104:107], v[52:55], a[56:59]
v_mfma_f32_16x16x32_bf16 a[88:91], v[104:107], v[56:59], a[88:91]
v_mfma_f32_16x16x32_bf16 a[120:123], v[104:107], v[60:63], a[120:123]
s_waitcnt lgkmcnt(0)
v_mfma_f32_16x16x32_bf16 a[28:31], v[108:111], v[48:51], a[28:31]
v_mfma_f32_16x16x32_bf16 a[60:63], v[108:111], v[52:55], a[60:63]
v_mfma_f32_16x16x32_bf16 a[92:95], v[108:111], v[56:59], a[92:95]
v_mfma_f32_16x16x32_bf16 a[124:127], v[108:111], v[60:63], a[124:127]
s_lshl_b32 s42, s52, 2
s_add_u32 s42, s42, s29
s_lshl_b32 s42, s42, 6
s_add_u32 s42, s42, s53
s_lshl_b32 s42, s42, 14
s_add_u32 s42, s42, 33554432
s_nop 7
v_accvgpr_read_b32 v52, a0
v_accvgpr_read_b32 v56, a4
v_accvgpr_read_b32 v53, a1
v_accvgpr_read_b32 v57, a5
v_accvgpr_read_b32 v54, a2
v_accvgpr_read_b32 v58, a6
v_accvgpr_read_b32 v55, a3
v_accvgpr_read_b32 v59, a7
v_cvt_pk_bf16_f32 v48, v52, v53
v_cvt_pk_bf16_f32 v49, v54, v55
v_cvt_pk_bf16_f32 v50, v56, v57
v_cvt_pk_bf16_f32 v51, v58, v59
s_add_u32 s43, s42, 0
buffer_store_dwordx4 v[48:51], v1, s[8:11], s43 offen offset:0 sc1
v_accvgpr_read_b32 v64, a8
v_accvgpr_read_b32 v68, a12
v_accvgpr_read_b32 v65, a9
v_accvgpr_read_b32 v69, a13
v_accvgpr_read_b32 v66, a10
v_accvgpr_read_b32 v70, a14
v_accvgpr_read_b32 v67, a11
v_accvgpr_read_b32 v71, a15
v_cvt_pk_bf16_f32 v60, v64, v65
v_cvt_pk_bf16_f32 v61, v66, v67
v_cvt_pk_bf16_f32 v62, v68, v69
v_cvt_pk_bf16_f32 v63, v70, v71
s_add_u32 s43, s42, 0
buffer_store_dwordx4 v[60:63], v1, s[8:11], s43 offen offset:1024 sc1
v_accvgpr_read_b32 v76, a16
v_accvgpr_read_b32 v80, a20
v_accvgpr_read_b32 v77, a17
v_accvgpr_read_b32 v81, a21
v_accvgpr_read_b32 v78, a18
v_accvgpr_read_b32 v82, a22
v_accvgpr_read_b32 v79, a19
v_accvgpr_read_b32 v83, a23
v_cvt_pk_bf16_f32 v72, v76, v77
v_cvt_pk_bf16_f32 v73, v78, v79
v_cvt_pk_bf16_f32 v74, v80, v81
v_cvt_pk_bf16_f32 v75, v82, v83
s_add_u32 s43, s42, 0
buffer_store_dwordx4 v[72:75], v1, s[8:11], s43 offen offset:2048 sc1
v_accvgpr_read_b32 v88, a24
v_accvgpr_read_b32 v92, a28
v_accvgpr_read_b32 v89, a25
v_accvgpr_read_b32 v93, a29
v_accvgpr_read_b32 v90, a26
v_accvgpr_read_b32 v94, a30
v_accvgpr_read_b32 v91, a27
v_accvgpr_read_b32 v95, a31
v_cvt_pk_bf16_f32 v84, v88, v89
v_cvt_pk_bf16_f32 v85, v90, v91
v_cvt_pk_bf16_f32 v86, v92, v93
v_cvt_pk_bf16_f32 v87, v94, v95
s_add_u32 s43, s42, 0
buffer_store_dwordx4 v[84:87], v1, s[8:11], s43 offen offset:3072 sc1
v_accvgpr_read_b32 v52, a32
v_accvgpr_read_b32 v56, a36
v_accvgpr_read_b32 v53, a33
v_accvgpr_read_b32 v57, a37
v_accvgpr_read_b32 v54, a34
v_accvgpr_read_b32 v58, a38
v_accvgpr_read_b32 v55, a35
v_accvgpr_read_b32 v59, a39
v_cvt_pk_bf16_f32 v48, v52, v53
v_cvt_pk_bf16_f32 v49, v54, v55
v_cvt_pk_bf16_f32 v50, v56, v57
v_cvt_pk_bf16_f32 v51, v58, v59
s_add_u32 s43, s42, 4096
buffer_store_dwordx4 v[48:51], v1, s[8:11], s43 offen offset:0 sc1
v_accvgpr_read_b32 v64, a40
v_accvgpr_read_b32 v68, a44
v_accvgpr_read_b32 v65, a41
v_accvgpr_read_b32 v69, a45
v_accvgpr_read_b32 v66, a42
v_accvgpr_read_b32 v70, a46
v_accvgpr_read_b32 v67, a43
v_accvgpr_read_b32 v71, a47
v_cvt_pk_bf16_f32 v60, v64, v65
v_cvt_pk_bf16_f32 v61, v66, v67
v_cvt_pk_bf16_f32 v62, v68, v69
v_cvt_pk_bf16_f32 v63, v70, v71
s_add_u32 s43, s42, 4096
buffer_store_dwordx4 v[60:63], v1, s[8:11], s43 offen offset:1024 sc1
v_accvgpr_read_b32 v76, a48
v_accvgpr_read_b32 v80, a52
v_accvgpr_read_b32 v77, a49
v_accvgpr_read_b32 v81, a53
v_accvgpr_read_b32 v78, a50
v_accvgpr_read_b32 v82, a54
v_accvgpr_read_b32 v79, a51
v_accvgpr_read_b32 v83, a55
v_cvt_pk_bf16_f32 v72, v76, v77
v_cvt_pk_bf16_f32 v73, v78, v79
v_cvt_pk_bf16_f32 v74, v80, v81
v_cvt_pk_bf16_f32 v75, v82, v83
s_add_u32 s43, s42, 4096
buffer_store_dwordx4 v[72:75], v1, s[8:11], s43 offen offset:2048 sc1
v_accvgpr_read_b32 v88, a56
v_accvgpr_read_b32 v92, a60
v_accvgpr_read_b32 v89, a57
v_accvgpr_read_b32 v93, a61
v_accvgpr_read_b32 v90, a58
v_accvgpr_read_b32 v94, a62
v_accvgpr_read_b32 v91, a59
v_accvgpr_read_b32 v95, a63
v_cvt_pk_bf16_f32 v84, v88, v89
v_cvt_pk_bf16_f32 v85, v90, v91
v_cvt_pk_bf16_f32 v86, v92, v93
v_cvt_pk_bf16_f32 v87, v94, v95
s_add_u32 s43, s42, 4096
buffer_store_dwordx4 v[84:87], v1, s[8:11], s43 offen offset:3072 sc1
v_accvgpr_read_b32 v52, a64
v_accvgpr_read_b32 v56, a68
v_accvgpr_read_b32 v53, a65
v_accvgpr_read_b32 v57, a69
v_accvgpr_read_b32 v54, a66
v_accvgpr_read_b32 v58, a70
v_accvgpr_read_b32 v55, a67
v_accvgpr_read_b32 v59, a71
v_cvt_pk_bf16_f32 v48, v52, v53
v_cvt_pk_bf16_f32 v49, v54, v55
v_cvt_pk_bf16_f32 v50, v56, v57
v_cvt_pk_bf16_f32 v51, v58, v59
s_add_u32 s43, s42, 524288
buffer_store_dwordx4 v[48:51], v1, s[8:11], s43 offen offset:0 sc1
v_accvgpr_read_b32 v64, a72
v_accvgpr_read_b32 v68, a76
v_accvgpr_read_b32 v65, a73
v_accvgpr_read_b32 v69, a77
v_accvgpr_read_b32 v66, a74
v_accvgpr_read_b32 v70, a78
v_accvgpr_read_b32 v67, a75
v_accvgpr_read_b32 v71, a79
v_cvt_pk_bf16_f32 v60, v64, v65
v_cvt_pk_bf16_f32 v61, v66, v67
v_cvt_pk_bf16_f32 v62, v68, v69
v_cvt_pk_bf16_f32 v63, v70, v71
s_add_u32 s43, s42, 524288
buffer_store_dwordx4 v[60:63], v1, s[8:11], s43 offen offset:1024 sc1
v_accvgpr_read_b32 v76, a80
v_accvgpr_read_b32 v80, a84
v_accvgpr_read_b32 v77, a81
v_accvgpr_read_b32 v81, a85
v_accvgpr_read_b32 v78, a82
v_accvgpr_read_b32 v82, a86
v_accvgpr_read_b32 v79, a83
v_accvgpr_read_b32 v83, a87
v_cvt_pk_bf16_f32 v72, v76, v77
v_cvt_pk_bf16_f32 v73, v78, v79
v_cvt_pk_bf16_f32 v74, v80, v81
v_cvt_pk_bf16_f32 v75, v82, v83
s_add_u32 s43, s42, 524288
buffer_store_dwordx4 v[72:75], v1, s[8:11], s43 offen offset:2048 sc1
v_accvgpr_read_b32 v88, a88
v_accvgpr_read_b32 v92, a92
v_accvgpr_read_b32 v89, a89
v_accvgpr_read_b32 v93, a93
v_accvgpr_read_b32 v90, a90
v_accvgpr_read_b32 v94, a94
v_accvgpr_read_b32 v91, a91
v_accvgpr_read_b32 v95, a95
v_cvt_pk_bf16_f32 v84, v88, v89
v_cvt_pk_bf16_f32 v85, v90, v91
v_cvt_pk_bf16_f32 v86, v92, v93
v_cvt_pk_bf16_f32 v87, v94, v95
s_add_u32 s43, s42, 524288
buffer_store_dwordx4 v[84:87], v1, s[8:11], s43 offen offset:3072 sc1
v_accvgpr_read_b32 v52, a96
v_accvgpr_read_b32 v56, a100
v_accvgpr_read_b32 v53, a97
v_accvgpr_read_b32 v57, a101
v_accvgpr_read_b32 v54, a98
v_accvgpr_read_b32 v58, a102
v_accvgpr_read_b32 v55, a99
v_accvgpr_read_b32 v59, a103
v_cvt_pk_bf16_f32 v48, v52, v53
v_cvt_pk_bf16_f32 v49, v54, v55
v_cvt_pk_bf16_f32 v50, v56, v57
v_cvt_pk_bf16_f32 v51, v58, v59
s_add_u32 s43, s42, 528384
buffer_store_dwordx4 v[48:51], v1, s[8:11], s43 offen offset:0 sc1
v_accvgpr_read_b32 v64, a104
v_accvgpr_read_b32 v68, a108
v_accvgpr_read_b32 v65, a105
v_accvgpr_read_b32 v69, a109
v_accvgpr_read_b32 v66, a106
v_accvgpr_read_b32 v70, a110
v_accvgpr_read_b32 v67, a107
v_accvgpr_read_b32 v71, a111
v_cvt_pk_bf16_f32 v60, v64, v65
v_cvt_pk_bf16_f32 v61, v66, v67
v_cvt_pk_bf16_f32 v62, v68, v69
v_cvt_pk_bf16_f32 v63, v70, v71
s_add_u32 s43, s42, 528384
buffer_store_dwordx4 v[60:63], v1, s[8:11], s43 offen offset:1024 sc1
v_accvgpr_read_b32 v76, a112
v_accvgpr_read_b32 v80, a116
v_accvgpr_read_b32 v77, a113
v_accvgpr_read_b32 v81, a117
v_accvgpr_read_b32 v78, a114
v_accvgpr_read_b32 v82, a118
v_accvgpr_read_b32 v79, a115
v_accvgpr_read_b32 v83, a119
v_cvt_pk_bf16_f32 v72, v76, v77
v_cvt_pk_bf16_f32 v73, v78, v79
v_cvt_pk_bf16_f32 v74, v80, v81
v_cvt_pk_bf16_f32 v75, v82, v83
s_add_u32 s43, s42, 528384
buffer_store_dwordx4 v[72:75], v1, s[8:11], s43 offen offset:2048 sc1
v_accvgpr_read_b32 v88, a120
v_accvgpr_read_b32 v92, a124
v_accvgpr_read_b32 v89, a121
v_accvgpr_read_b32 v93, a125
v_accvgpr_read_b32 v90, a122
v_accvgpr_read_b32 v94, a126
v_accvgpr_read_b32 v91, a123
v_accvgpr_read_b32 v95, a127
v_cvt_pk_bf16_f32 v84, v88, v89
v_cvt_pk_bf16_f32 v85, v90, v91
v_cvt_pk_bf16_f32 v86, v92, v93
v_cvt_pk_bf16_f32 v87, v94, v95
s_add_u32 s43, s42, 528384
buffer_store_dwordx4 v[84:87], v1, s[8:11], s43 offen offset:3072 sc1
s_branch L_w_KVd
L_w_V:
s_mov_b32 s12, s18
s_and_b32 s13, s19, 0xffff
s_mov_b32 s14, 0x400000
s_mov_b32 s15, 0x00020000
s_lshl_b32 s48, s52, 2
s_add_u32 s48, s48, s29
s_lshl_b32 s48, s48, 16
s_add_u32 s48, s48, 0
s_lshl_b32 s49, s53, 8
s_mul_i32 s51, s29, 4096
s_add_u32 s42, s49, 0
s_add_u32 m0, s51, 0
s_nop 0
buffer_load_dwordx4 v2, s[12:15], s42 offen lds
s_add_u32 m0, s51, 1024
s_nop 0
buffer_load_dwordx4 v3, s[12:15], s42 offen lds
s_add_u32 m0, s51, 2048
s_nop 0
buffer_load_dwordx4 v4, s[12:15], s42 offen lds
s_add_u32 m0, s51, 3072
s_nop 0
buffer_load_dwordx4 v5, s[12:15], s42 offen lds
s_add_u32 s42, s49, 524288
s_add_u32 m0, s51, 16384
s_nop 0
buffer_load_dwordx4 v2, s[12:15], s42 offen lds
s_add_u32 m0, s51, 17408
s_nop 0
buffer_load_dwordx4 v3, s[12:15], s42 offen lds
s_add_u32 m0, s51, 18432
s_nop 0
buffer_load_dwordx4 v4, s[12:15], s42 offen lds
s_add_u32 m0, s51, 19456
s_nop 0
buffer_load_dwordx4 v5, s[12:15], s42 offen lds
buffer_load_dwordx4 v[48:51], v1, s[8:11], s48 offen offset:0
s_add_u32 s43, s48, 16384
buffer_load_dwordx4 v[52:55], v1, s[8:11], s43 offen offset:0
s_add_u32 s43, s48, 32768
buffer_load_dwordx4 v[56:59], v1, s[8:11], s43 offen offset:0
s_add_u32 s43, s48, 49152
buffer_load_dwordx4 v[60:63], v1, s[8:11], s43 offen offset:0
buffer_load_dwordx4 v[64:67], v1, s[8:11], s48 offen offset:1024
s_add_u32 s43, s48, 16384
buffer_load_dwordx4 v[68:71], v1, s[8:11], s43 offen offset:1024
s_add_u32 s43, s48, 32768
buffer_load_dwordx4 v[72:75], v1, s[8:11], s43 offen offset:1024
s_add_u32 s43, s48, 49152
buffer_load_dwordx4 v[76:79], v1, s[8:11], s43 offen offset:1024
buffer_load_dwordx4 v[80:83], v1, s[8:11], s48 offen offset:2048
s_add_u32 s43, s48, 16384
buffer_load_dwordx4 v[84:87], v1, s[8:11], s43 offen offset:2048
s_add_u32 s43, s48, 32768
buffer_load_dwordx4 v[88:91], v1, s[8:11], s43 offen offset:2048
s_add_u32 s43, s48, 49152
buffer_load_dwordx4 v[92:95], v1, s[8:11], s43 offen offset:2048
s_waitcnt vmcnt(16)
s_barrier
s_add_u32 s42, s49, 1048576
s_add_u32 m0, s51, 32768
s_nop 0
buffer_load_dwordx4 v2, s[12:15], s42 offen lds
s_add_u32 m0, s51, 33792
s_nop 0
buffer_load_dwordx4 v3, s[12:15], s42 offen lds
s_add_u32 m0, s51, 34816
s_nop 0
buffer_load_dwordx4 v4, s[12:15], s42 offen lds
s_add_u32 m0, s51, 35840
s_nop 0
buffer_load_dwordx4 v5, s[12:15], s42 offen lds
ds_read_b64_tr_b16 v[96:97], v18 offset:0
ds_read_b64_tr_b16 v[98:99], v26 offset:0
ds_read_b64_tr_b16 v[100:101], v19 offset:0
ds_read_b64_tr_b16 v[102:103], v27 offset:0
ds_read_b64_tr_b16 v[104:105], v20 offset:0
ds_read_b64_tr_b16 v[106:107], v28 offset:0
ds_read_b64_tr_b16 v[108:109], v21 offset:0
ds_read_b64_tr_b16 v[110:111], v29 offset:0
s_waitcnt vmcnt(12)
s_waitcnt lgkmcnt(6)
v_mfma_f32_16x16x32_bf16 a[0:3], v[48:51], v[96:99], 0
v_mfma_f32_16x16x32_bf16 a[32:35], v[52:55], v[96:99], 0
v_mfma_f32_16x16x32_bf16 a[64:67], v[56:59], v[96:99], 0
v_mfma_f32_16x16x32_bf16 a[96:99], v[60:63], v[96:99], 0
ds_read_b64_tr_b16 v[96:97], v22 offset:0
ds_read_b64_tr_b16 v[98:99], v30 offset:0
s_waitcnt lgkmcnt(6)
v_mfma_f32_16x16x32_bf16 a[4:7], v[48:51], v[100:103], 0
v_mfma_f32_16x16x32_bf16 a[36:39], v[52:55], v[100:103], 0
v_mfma_f32_16x16x32_bf16 a[68:71], v[56:59], v[100:103], 0
v_mfma_f32_16x16x32_bf16 a[100:103], v[60:63], v[100:103], 0
ds_read_b64_tr_b16 v[100:101], v23 offset:0
ds_read_b64_tr_b16 v[102:103], v31 offset:0
s_waitcnt lgkmcnt(6)
v_mfma_f32_16x16x32_bf16 a[8:11], v[48:51], v[104:107], 0
v_mfma_f32_16x16x32_bf16 a[40:43], v[52:55], v[104:107], 0
v_mfma_f32_16x16x32_bf16 a[72:75], v[56:59], v[104:107], 0
v_mfma_f32_16x16x32_bf16 a[104:107], v[60:63], v[104:107], 0
ds_read_b64_tr_b16 v[104:105], v24 offset:0
ds_read_b64_tr_b16 v[106:107], v32 offset:0
s_waitcnt lgkmcnt(6)
v_mfma_f32_16x16x32_bf16 a[12:15], v[48:51], v[108:111], 0
v_mfma_f32_16x16x32_bf16 a[44:47], v[52:55], v[108:111], 0
v_mfma_f32_16x16x32_bf16 a[76:79], v[56:59], v[108:111], 0
v_mfma_f32_16x16x32_bf16 a[108:111], v[60:63], v[108:111], 0
ds_read_b64_tr_b16 v[108:109], v25 offset:0
ds_read_b64_tr_b16 v[110:111], v33 offset:0
s_waitcnt lgkmcnt(6)
v_mfma_f32_16x16x32_bf16 a[16:19], v[48:51], v[96:99], 0
v_mfma_f32_16x16x32_bf16 a[48:51], v[52:55], v[96:99], 0
v_mfma_f32_16x16x32_bf16 a[80:83], v[56:59], v[96:99], 0
v_mfma_f32_16x16x32_bf16 a[112:115], v[60:63], v[96:99], 0
ds_read_b64_tr_b16 v[96:97], v18 offset:8192
ds_read_b64_tr_b16 v[98:99], v26 offset:8192
s_waitcnt lgkmcnt(6)
v_mfma_f32_16x16x32_bf16 a[20:23], v[48:51], v[100:103], 0
v_mfma_f32_16x16x32_bf16 a[52:55], v[52:55], v[100:103], 0
v_mfma_f32_16x16x32_bf16 a[84:87], v[56:59], v[100:103], 0
v_mfma_f32_16x16x32_bf16 a[116:119], v[60:63], v[100:103], 0
ds_read_b64_tr_b16 v[100:101], v19 offset:8192
ds_read_b64_tr_b16 v[102:103], v27 offset:8192
s_waitcnt lgkmcnt(6)
v_mfma_f32_16x16x32_bf16 a[24:27], v[48:51], v[104:107], 0
v_mfma_f32_16x16x32_bf16 a[56:59], v[52:55], v[104:107], 0
v_mfma_f32_16x16x32_bf16 a[88:91], v[56:59], v[104:107], 0
v_mfma_f32_16x16x32_bf16 a[120:123], v[60:63], v[104:107], 0
ds_read_b64_tr_b16 v[104:105], v20 offset:8192
ds_read_b64_tr_b16 v[106:107], v28 offset:8192
s_waitcnt lgkmcnt(6)
v_mfma_f32_16x16x32_bf16 a[28:31], v[48:51], v[108:111], 0
v_mfma_f32_16x16x32_bf16 a[60:63], v[52:55], v[108:111], 0
v_mfma_f32_16x16x32_bf16 a[92:95], v[56:59], v[108:111], 0
v_mfma_f32_16x16x32_bf16 a[124:127], v[60:63], v[108:111], 0
buffer_load_dwordx4 v[48:51], v1, s[8:11], s48 offen offset:3072
s_add_u32 s43, s48, 16384
buffer_load_dwordx4 v[52:55], v1, s[8:11], s43 offen offset:3072
s_add_u32 s43, s48, 32768
buffer_load_dwordx4 v[56:59], v1, s[8:11], s43 offen offset:3072
s_add_u32 s43, s48, 49152
buffer_load_dwordx4 v[60:63], v1, s[8:11], s43 offen offset:3072
ds_read_b64_tr_b16 v[108:109], v21 offset:8192
ds_read_b64_tr_b16 v[110:111], v29 offset:8192
s_waitcnt vmcnt(12)
s_waitcnt lgkmcnt(6)
v_mfma_f32_16x16x32_bf16 a[0:3], v[64:67], v[96:99], a[0:3]
v_mfma_f32_16x16x32_bf16 a[32:35], v[68:71], v[96:99], a[32:35]
v_mfma_f32_16x16x32_bf16 a[64:67], v[72:75], v[96:99], a[64:67]
v_mfma_f32_16x16x32_bf16 a[96:99], v[76:79], v[96:99], a[96:99]
ds_read_b64_tr_b16 v[96:97], v22 offset:8192
ds_read_b64_tr_b16 v[98:99], v30 offset:8192
s_waitcnt lgkmcnt(6)
v_mfma_f32_16x16x32_bf16 a[4:7], v[64:67], v[100:103], a[4:7]
v_mfma_f32_16x16x32_bf16 a[36:39], v[68:71], v[100:103], a[36:39]
v_mfma_f32_16x16x32_bf16 a[68:71], v[72:75], v[100:103], a[68:71]
v_mfma_f32_16x16x32_bf16 a[100:103], v[76:79], v[100:103], a[100:103]
ds_read_b64_tr_b16 v[100:101], v23 offset:8192
ds_read_b64_tr_b16 v[102:103], v31 offset:8192
s_waitcnt lgkmcnt(6)
v_mfma_f32_16x16x32_bf16 a[8:11], v[64:67], v[104:107], a[8:11]
v_mfma_f32_16x16x32_bf16 a[40:43], v[68:71], v[104:107], a[40:43]
v_mfma_f32_16x16x32_bf16 a[72:75], v[72:75], v[104:107], a[72:75]
v_mfma_f32_16x16x32_bf16 a[104:107], v[76:79], v[104:107], a[104:107]
ds_read_b64_tr_b16 v[104:105], v24 offset:8192
ds_read_b64_tr_b16 v[106:107], v32 offset:8192
s_waitcnt lgkmcnt(6)
v_mfma_f32_16x16x32_bf16 a[12:15], v[64:67], v[108:111], a[12:15]
v_mfma_f32_16x16x32_bf16 a[44:47], v[68:71], v[108:111], a[44:47]
v_mfma_f32_16x16x32_bf16 a[76:79], v[72:75], v[108:111], a[76:79]
v_mfma_f32_16x16x32_bf16 a[108:111], v[76:79], v[108:111], a[108:111]
ds_read_b64_tr_b16 v[108:109], v25 offset:8192
ds_read_b64_tr_b16 v[110:111], v33 offset:8192
s_waitcnt lgkmcnt(6)
v_mfma_f32_16x16x32_bf16 a[16:19], v[64:67], v[96:99], a[16:19]
v_mfma_f32_16x16x32_bf16 a[48:51], v[68:71], v[96:99], a[48:51]
v_mfma_f32_16x16x32_bf16 a[80:83], v[72:75], v[96:99], a[80:83]
v_mfma_f32_16x16x32_bf16 a[112:115], v[76:79], v[96:99], a[112:115]
s_barrier
s_add_u32 s42, s49, 1572864
s_add_u32 m0, s51, 49152
s_nop 0
buffer_load_dwordx4 v2, s[12:15], s42 offen lds
s_add_u32 m0, s51, 50176
s_nop 0
buffer_load_dwordx4 v3, s[12:15], s42 offen lds
s_add_u32 m0, s51, 51200
s_nop 0
buffer_load_dwordx4 v4, s[12:15], s42 offen lds
s_add_u32 m0, s51, 52224
s_nop 0
buffer_load_dwordx4 v5, s[12:15], s42 offen lds
ds_read_b64_tr_b16 v[96:97], v18 offset:16384
ds_read_b64_tr_b16 v[98:99], v26 offset:16384
s_waitcnt lgkmcnt(6)
v_mfma_f32_16x16x32_bf16 a[20:23], v[64:67], v[100:103], a[20:23]
v_mfma_f32_16x16x32_bf16 a[52:55], v[68:71], v[100:103], a[52:55]
v_mfma_f32_16x16x32_bf16 a[84:87], v[72:75], v[100:103], a[84:87]
v_mfma_f32_16x16x32_bf16 a[116:119], v[76:79], v[100:103], a[116:119]
ds_read_b64_tr_b16 v[100:101], v19 offset:16384
ds_read_b64_tr_b16 v[102:103], v27 offset:16384
s_waitcnt lgkmcnt(6)
v_mfma_f32_16x16x32_bf16 a[24:27], v[64:67], v[104:107], a[24:27]
v_mfma_f32_16x16x32_bf16 a[56:59], v[68:71], v[104:107], a[56:59]
v_mfma_f32_16x16x32_bf16 a[88:91], v[72:75], v[104:107], a[88:91]
v_mfma_f32_16x16x32_bf16 a[120:123], v[76:79], v[104:107], a[120:123]
ds_read_b64_tr_b16 v[104:105], v20 offset:16384
ds_read_b64_tr_b16 v[106:107], v28 offset:16384
s_waitcnt lgkmcnt(6)
v_mfma_f32_16x16x32_bf16 a[28:31], v[64:67], v[108:111], a[28:31]
v_mfma_f32_16x16x32_bf16 a[60:63], v[68:71], v[108:111], a[60:63]
v_mfma_f32_16x16x32_bf16 a[92:95], v[72:75], v[108:111], a[92:95]
v_mfma_f32_16x16x32_bf16 a[124:127], v[76:79], v[108:111], a[124:127]
s_add_u32 s43, s48, 4096
buffer_load_dwordx4 v[64:67], v1, s[8:11], s43 offen offset:0
s_add_u32 s43, s48, 20480
buffer_load_dwordx4 v[68:71], v1, s[8:11], s43 offen offset:0
s_add_u32 s43, s48, 36864
buffer_load_dwordx4 v[72:75], v1, s[8:11], s43 offen offset:0
s_add_u32 s43, s48, 53248
buffer_load_dwordx4 v[76:79], v1, s[8:11], s43 offen offset:0
ds_read_b64_tr_b16 v[108:109], v21 offset:16384
ds_read_b64_tr_b16 v[110:111], v29 offset:16384
s_waitcnt vmcnt(16)
s_waitcnt lgkmcnt(6)
v_mfma_f32_16x16x32_bf16 a[0:3], v[80:83], v[96:99], a[0:3]
v_mfma_f32_16x16x32_bf16 a[32:35], v[84:87], v[96:99], a[32:35]
v_mfma_f32_16x16x32_bf16 a[64:67], v[88:91], v[96:99], a[64:67]
v_mfma_f32_16x16x32_bf16 a[96:99], v[92:95], v[96:99], a[96:99]
ds_read_b64_tr_b16 v[96:97], v22 offset:16384
ds_read_b64_tr_b16 v[98:99], v30 offset:16384
s_waitcnt lgkmcnt(6)
v_mfma_f32_16x16x32_bf16 a[4:7], v[80:83], v[100:103], a[4:7]
v_mfma_f32_16x16x32_bf16 a[36:39], v[84:87], v[100:103], a[36:39]
v_mfma_f32_16x16x32_bf16 a[68:71], v[88:91], v[100:103], a[68:71]
v_mfma_f32_16x16x32_bf16 a[100:103], v[92:95], v[100:103], a[100:103]
ds_read_b64_tr_b16 v[100:101], v23 offset:16384
ds_read_b64_tr_b16 v[102:103], v31 offset:16384
s_waitcnt lgkmcnt(6)
v_mfma_f32_16x16x32_bf16 a[8:11], v[80:83], v[104:107], a[8:11]
v_mfma_f32_16x16x32_bf16 a[40:43], v[84:87], v[104:107], a[40:43]
v_mfma_f32_16x16x32_bf16 a[72:75], v[88:91], v[104:107], a[72:75]
v_mfma_f32_16x16x32_bf16 a[104:107], v[92:95], v[104:107], a[104:107]
ds_read_b64_tr_b16 v[104:105], v24 offset:16384
ds_read_b64_tr_b16 v[106:107], v32 offset:16384
s_waitcnt lgkmcnt(6)
v_mfma_f32_16x16x32_bf16 a[12:15], v[80:83], v[108:111], a[12:15]
v_mfma_f32_16x16x32_bf16 a[44:47], v[84:87], v[108:111], a[44:47]
v_mfma_f32_16x16x32_bf16 a[76:79], v[88:91], v[108:111], a[76:79]
v_mfma_f32_16x16x32_bf16 a[108:111], v[92:95], v[108:111], a[108:111]
ds_read_b64_tr_b16 v[108:109], v25 offset:16384
ds_read_b64_tr_b16 v[110:111], v33 offset:16384
s_waitcnt lgkmcnt(6)
v_mfma_f32_16x16x32_bf16 a[16:19], v[80:83], v[96:99], a[16:19]
v_mfma_f32_16x16x32_bf16 a[48:51], v[84:87], v[96:99], a[48:51]
v_mfma_f32_16x16x32_bf16 a[80:83], v[88:91], v[96:99], a[80:83]
v_mfma_f32_16x16x32_bf16 a[112:115], v[92:95], v[96:99], a[112:115]
ds_read_b64_tr_b16 v[96:97], v18 offset:24576
ds_read_b64_tr_b16 v[98:99], v26 offset:24576
s_waitcnt lgkmcnt(6)
v_mfma_f32_16x16x32_bf16 a[20:23], v[80:83], v[100:103], a[20:23]
v_mfma_f32_16x16x32_bf16 a[52:55], v[84:87], v[100:103], a[52:55]
v_mfma_f32_16x16x32_bf16 a[84:87], v[88:91], v[100:103], a[84:87]
v_mfma_f32_16x16x32_bf16 a[116:119], v[92:95], v[100:103], a[116:119]
ds_read_b64_tr_b16 v[100:101], v19 offset:24576
ds_read_b64_tr_b16 v[102:103], v27 offset:24576
s_waitcnt lgkmcnt(6)
v_mfma_f32_16x16x32_bf16 a[24:27], v[80:83], v[104:107], a[24:27]
v_mfma_f32_16x16x32_bf16 a[56:59], v[84:87], v[104:107], a[56:59]
v_mfma_f32_16x16x32_bf16 a[88:91], v[88:91], v[104:107], a[88:91]
v_mfma_f32_16x16x32_bf16 a[120:123], v[92:95], v[104:107], a[120:123]
ds_read_b64_tr_b16 v[104:105], v20 offset:24576
ds_read_b64_tr_b16 v[106:107], v28 offset:24576
s_waitcnt lgkmcnt(6)
v_mfma_f32_16x16x32_bf16 a[28:31], v[80:83], v[108:111], a[28:31]
v_mfma_f32_16x16x32_bf16 a[60:63], v[84:87], v[108:111], a[60:63]
v_mfma_f32_16x16x32_bf16 a[92:95], v[88:91], v[108:111], a[92:95]
v_mfma_f32_16x16x32_bf16 a[124:127], v[92:95], v[108:111], a[124:127]
s_add_u32 s43, s48, 4096
buffer_load_dwordx4 v[80:83], v1, s[8:11], s43 offen offset:1024
s_add_u32 s43, s48, 20480
buffer_load_dwordx4 v[84:87], v1, s[8:11], s43 offen offset:1024
s_add_u32 s43, s48, 36864
buffer_load_dwordx4 v[88:91], v1, s[8:11], s43 offen offset:1024
s_add_u32 s43, s48, 53248
buffer_load_dwordx4 v[92:95], v1, s[8:11], s43 offen offset:1024
ds_read_b64_tr_b16 v[108:109], v21 offset:24576
ds_read_b64_tr_b16 v[110:111], v29 offset:24576
s_waitcnt vmcnt(12)
s_waitcnt lgkmcnt(6)
v_mfma_f32_16x16x32_bf16 a[0:3], v[48:51], v[96:99], a[0:3]
v_mfma_f32_16x16x32_bf16 a[32:35], v[52:55], v[96:99], a[32:35]
v_mfma_f32_16x16x32_bf16 a[64:67], v[56:59], v[96:99], a[64:67]
v_mfma_f32_16x16x32_bf16 a[96:99], v[60:63], v[96:99], a[96:99]
ds_read_b64_tr_b16 v[96:97], v22 offset:24576
ds_read_b64_tr_b16 v[98:99], v30 offset:24576
s_waitcnt lgkmcnt(6)
v_mfma_f32_16x16x32_bf16 a[4:7], v[48:51], v[100:103], a[4:7]
v_mfma_f32_16x16x32_bf16 a[36:39], v[52:55], v[100:103], a[36:39]
v_mfma_f32_16x16x32_bf16 a[68:71], v[56:59], v[100:103], a[68:71]
v_mfma_f32_16x16x32_bf16 a[100:103], v[60:63], v[100:103], a[100:103]
ds_read_b64_tr_b16 v[100:101], v23 offset:24576
ds_read_b64_tr_b16 v[102:103], v31 offset:24576
s_waitcnt lgkmcnt(6)
v_mfma_f32_16x16x32_bf16 a[8:11], v[48:51], v[104:107], a[8:11]
v_mfma_f32_16x16x32_bf16 a[40:43], v[52:55], v[104:107], a[40:43]
v_mfma_f32_16x16x32_bf16 a[72:75], v[56:59], v[104:107], a[72:75]
v_mfma_f32_16x16x32_bf16 a[104:107], v[60:63], v[104:107], a[104:107]
ds_read_b64_tr_b16 v[104:105], v24 offset:24576
ds_read_b64_tr_b16 v[106:107], v32 offset:24576
s_waitcnt lgkmcnt(6)
v_mfma_f32_16x16x32_bf16 a[12:15], v[48:51], v[108:111], a[12:15]
v_mfma_f32_16x16x32_bf16 a[44:47], v[52:55], v[108:111], a[44:47]
v_mfma_f32_16x16x32_bf16 a[76:79], v[56:59], v[108:111], a[76:79]
v_mfma_f32_16x16x32_bf16 a[108:111], v[60:63], v[108:111], a[108:111]
ds_read_b64_tr_b16 v[108:109], v25 offset:24576
ds_read_b64_tr_b16 v[110:111], v33 offset:24576
s_waitcnt lgkmcnt(6)
v_mfma_f32_16x16x32_bf16 a[16:19], v[48:51], v[96:99], a[16:19]
v_mfma_f32_16x16x32_bf16 a[48:51], v[52:55], v[96:99], a[48:51]
v_mfma_f32_16x16x32_bf16 a[80:83], v[56:59], v[96:99], a[80:83]
v_mfma_f32_16x16x32_bf16 a[112:115], v[60:63], v[96:99], a[112:115]
s_barrier
s_add_u32 s42, s49, 2097152
s_add_u32 m0, s51, 0
s_nop 0
buffer_load_dwordx4 v2, s[12:15], s42 offen lds
s_add_u32 m0, s51, 1024
s_nop 0
buffer_load_dwordx4 v3, s[12:15], s42 offen lds
s_add_u32 m0, s51, 2048
s_nop 0
buffer_load_dwordx4 v4, s[12:15], s42 offen lds
s_add_u32 m0, s51, 3072
s_nop 0
buffer_load_dwordx4 v5, s[12:15], s42 offen lds
ds_read_b64_tr_b16 v[96:97], v18 offset:32768
ds_read_b64_tr_b16 v[98:99], v26 offset:32768
s_waitcnt lgkmcnt(6)
v_mfma_f32_16x16x32_bf16 a[20:23], v[48:51], v[100:103], a[20:23]
v_mfma_f32_16x16x32_bf16 a[52:55], v[52:55], v[100:103], a[52:55]
v_mfma_f32_16x16x32_bf16 a[84:87], v[56:59], v[100:103], a[84:87]
v_mfma_f32_16x16x32_bf16 a[116:119], v[60:63], v[100:103], a[116:119]
ds_read_b64_tr_b16 v[100:101], v19 offset:32768
ds_read_b64_tr_b16 v[102:103], v27 offset:32768
s_waitcnt lgkmcnt(6)
v_mfma_f32_16x16x32_bf16 a[24:27], v[48:51], v[104:107], a[24:27]
v_mfma_f32_16x16x32_bf16 a[56:59], v[52:55], v[104:107], a[56:59]
v_mfma_f32_16x16x32_bf16 a[88:91], v[56:59], v[104:107], a[88:91]
v_mfma_f32_16x16x32_bf16 a[120:123], v[60:63], v[104:107], a[120:123]
ds_read_b64_tr_b16 v[104:105], v20 offset:32768
ds_read_b64_tr_b16 v[106:107], v28 offset:32768
s_waitcnt lgkmcnt(6)
v_mfma_f32_16x16x32_bf16 a[28:31], v[48:51], v[108:111], a[28:31]
v_mfma_f32_16x16x32_bf16 a[60:63], v[52:55], v[108:111], a[60:63]
v_mfma_f32_16x16x32_bf16 a[92:95], v[56:59], v[108:111], a[92:95]
v_mfma_f32_16x16x32_bf16 a[124:127], v[60:63], v[108:111], a[124:127]
s_add_u32 s43, s48, 4096
buffer_load_dwordx4 v[48:51], v1, s[8:11], s43 offen offset:2048
s_add_u32 s43, s48, 20480
buffer_load_dwordx4 v[52:55], v1, s[8:11], s43 offen offset:2048
s_add_u32 s43, s48, 36864
buffer_load_dwordx4 v[56:59], v1, s[8:11], s43 offen offset:2048
s_add_u32 s43, s48, 53248
buffer_load_dwordx4 v[60:63], v1, s[8:11], s43 offen offset:2048
ds_read_b64_tr_b16 v[108:109], v21 offset:32768
ds_read_b64_tr_b16 v[110:111], v29 offset:32768
s_waitcnt vmcnt(12)
s_waitcnt lgkmcnt(6)
v_mfma_f32_16x16x32_bf16 a[0:3], v[64:67], v[96:99], a[0:3]
v_mfma_f32_16x16x32_bf16 a[32:35], v[68:71], v[96:99], a[32:35]
v_mfma_f32_16x16x32_bf16 a[64:67], v[72:75], v[96:99], a[64:67]
v_mfma_f32_16x16x32_bf16 a[96:99], v[76:79], v[96:99], a[96:99]
ds_read_b64_tr_b16 v[96:97], v22 offset:32768
ds_read_b64_tr_b16 v[98:99], v30 offset:32768
s_waitcnt lgkmcnt(6)
v_mfma_f32_16x16x32_bf16 a[4:7], v[64:67], v[100:103], a[4:7]
v_mfma_f32_16x16x32_bf16 a[36:39], v[68:71], v[100:103], a[36:39]
v_mfma_f32_16x16x32_bf16 a[68:71], v[72:75], v[100:103], a[68:71]
v_mfma_f32_16x16x32_bf16 a[100:103], v[76:79], v[100:103], a[100:103]
ds_read_b64_tr_b16 v[100:101], v23 offset:32768
ds_read_b64_tr_b16 v[102:103], v31 offset:32768
s_waitcnt lgkmcnt(6)
v_mfma_f32_16x16x32_bf16 a[8:11], v[64:67], v[104:107], a[8:11]
v_mfma_f32_16x16x32_bf16 a[40:43], v[68:71], v[104:107], a[40:43]
v_mfma_f32_16x16x32_bf16 a[72:75], v[72:75], v[104:107], a[72:75]
v_mfma_f32_16x16x32_bf16 a[104:107], v[76:79], v[104:107], a[104:107]
ds_read_b64_tr_b16 v[104:105], v24 offset:32768
ds_read_b64_tr_b16 v[106:107], v32 offset:32768
s_waitcnt lgkmcnt(6)
v_mfma_f32_16x16x32_bf16 a[12:15], v[64:67], v[108:111], a[12:15]
v_mfma_f32_16x16x32_bf16 a[44:47], v[68:71], v[108:111], a[44:47]
v_mfma_f32_16x16x32_bf16 a[76:79], v[72:75], v[108:111], a[76:79]
v_mfma_f32_16x16x32_bf16 a[108:111], v[76:79], v[108:111], a[108:111]
ds_read_b64_tr_b16 v[108:109], v25 offset:32768
ds_read_b64_tr_b16 v[110:111], v33 offset:32768
s_waitcnt lgkmcnt(6)
v_mfma_f32_16x16x32_bf16 a[16:19], v[64:67], v[96:99], a[16:19]
v_mfma_f32_16x16x32_bf16 a[48:51], v[68:71], v[96:99], a[48:51]
v_mfma_f32_16x16x32_bf16 a[80:83], v[72:75], v[96:99], a[80:83]
v_mfma_f32_16x16x32_bf16 a[112:115], v[76:79], v[96:99], a[112:115]
ds_read_b64_tr_b16 v[96:97], v18 offset:40960
ds_read_b64_tr_b16 v[98:99], v26 offset:40960
s_waitcnt lgkmcnt(6)
v_mfma_f32_16x16x32_bf16 a[20:23], v[64:67], v[100:103], a[20:23]
v_mfma_f32_16x16x32_bf16 a[52:55], v[68:71], v[100:103], a[52:55]
v_mfma_f32_16x16x32_bf16 a[84:87], v[72:75], v[100:103], a[84:87]
v_mfma_f32_16x16x32_bf16 a[116:119], v[76:79], v[100:103], a[116:119]
ds_read_b64_tr_b16 v[100:101], v19 offset:40960
ds_read_b64_tr_b16 v[102:103], v27 offset:40960
s_waitcnt lgkmcnt(6)
v_mfma_f32_16x16x32_bf16 a[24:27], v[64:67], v[104:107], a[24:27]
v_mfma_f32_16x16x32_bf16 a[56:59], v[68:71], v[104:107], a[56:59]
v_mfma_f32_16x16x32_bf16 a[88:91], v[72:75], v[104:107], a[88:91]
v_mfma_f32_16x16x32_bf16 a[120:123], v[76:79], v[104:107], a[120:123]
ds_read_b64_tr_b16 v[104:105], v20 offset:40960
ds_read_b64_tr_b16 v[106:107], v28 offset:40960
s_waitcnt lgkmcnt(6)
v_mfma_f32_16x16x32_bf16 a[28:31], v[64:67], v[108:111], a[28:31]
v_mfma_f32_16x16x32_bf16 a[60:63], v[68:71], v[108:111], a[60:63]
v_mfma_f32_16x16x32_bf16 a[92:95], v[72:75], v[108:111], a[92:95]
v_mfma_f32_16x16x32_bf16 a[124:127], v[76:79], v[108:111], a[124:127]
s_add_u32 s43, s48, 4096
buffer_load_dwordx4 v[64:67], v1, s[8:11], s43 offen offset:3072
s_add_u32 s43, s48, 20480
buffer_load_dwordx4 v[68:71], v1, s[8:11], s43 offen offset:3072
s_add_u32 s43, s48, 36864
buffer_load_dwordx4 v[72:75], v1, s[8:11], s43 offen offset:3072
s_add_u32 s43, s48, 53248
buffer_load_dwordx4 v[76:79], v1, s[8:11], s43 offen offset:3072
ds_read_b64_tr_b16 v[108:109], v21 offset:40960
ds_read_b64_tr_b16 v[110:111], v29 offset:40960
s_waitcnt vmcnt(12)
s_waitcnt lgkmcnt(6)
v_mfma_f32_16x16x32_bf16 a[0:3], v[80:83], v[96:99], a[0:3]
v_mfma_f32_16x16x32_bf16 a[32:35], v[84:87], v[96:99], a[32:35]
v_mfma_f32_16x16x32_bf16 a[64:67], v[88:91], v[96:99], a[64:67]
v_mfma_f32_16x16x32_bf16 a[96:99], v[92:95], v[96:99], a[96:99]
ds_read_b64_tr_b16 v[96:97], v22 offset:40960
ds_read_b64_tr_b16 v[98:99], v30 offset:40960
s_waitcnt lgkmcnt(6)
v_mfma_f32_16x16x32_bf16 a[4:7], v[80:83], v[100:103], a[4:7]
v_mfma_f32_16x16x32_bf16 a[36:39], v[84:87], v[100:103], a[36:39]
v_mfma_f32_16x16x32_bf16 a[68:71], v[88:91], v[100:103], a[68:71]
v_mfma_f32_16x16x32_bf16 a[100:103], v[92:95], v[100:103], a[100:103]
ds_read_b64_tr_b16 v[100:101], v23 offset:40960
ds_read_b64_tr_b16 v[102:103], v31 offset:40960
s_waitcnt lgkmcnt(6)
v_mfma_f32_16x16x32_bf16 a[8:11], v[80:83], v[104:107], a[8:11]
v_mfma_f32_16x16x32_bf16 a[40:43], v[84:87], v[104:107], a[40:43]
v_mfma_f32_16x16x32_bf16 a[72:75], v[88:91], v[104:107], a[72:75]
v_mfma_f32_16x16x32_bf16 a[104:107], v[92:95], v[104:107], a[104:107]
ds_read_b64_tr_b16 v[104:105], v24 offset:40960
ds_read_b64_tr_b16 v[106:107], v32 offset:40960
s_waitcnt lgkmcnt(6)
v_mfma_f32_16x16x32_bf16 a[12:15], v[80:83], v[108:111], a[12:15]
v_mfma_f32_16x16x32_bf16 a[44:47], v[84:87], v[108:111], a[44:47]
v_mfma_f32_16x16x32_bf16 a[76:79], v[88:91], v[108:111], a[76:79]
v_mfma_f32_16x16x32_bf16 a[108:111], v[92:95], v[108:111], a[108:111]
ds_read_b64_tr_b16 v[108:109], v25 offset:40960
ds_read_b64_tr_b16 v[110:111], v33 offset:40960
s_waitcnt lgkmcnt(6)
v_mfma_f32_16x16x32_bf16 a[16:19], v[80:83], v[96:99], a[16:19]
v_mfma_f32_16x16x32_bf16 a[48:51], v[84:87], v[96:99], a[48:51]
v_mfma_f32_16x16x32_bf16 a[80:83], v[88:91], v[96:99], a[80:83]
v_mfma_f32_16x16x32_bf16 a[112:115], v[92:95], v[96:99], a[112:115]
s_barrier
s_add_u32 s42, s49, 2621440
s_add_u32 m0, s51, 16384
s_nop 0
buffer_load_dwordx4 v2, s[12:15], s42 offen lds
s_add_u32 m0, s51, 17408
s_nop 0
buffer_load_dwordx4 v3, s[12:15], s42 offen lds
s_add_u32 m0, s51, 18432
s_nop 0
buffer_load_dwordx4 v4, s[12:15], s42 offen lds
s_add_u32 m0, s51, 19456
s_nop 0
buffer_load_dwordx4 v5, s[12:15], s42 offen lds
ds_read_b64_tr_b16 v[96:97], v18 offset:49152
ds_read_b64_tr_b16 v[98:99], v26 offset:49152
s_waitcnt lgkmcnt(6)
v_mfma_f32_16x16x32_bf16 a[20:23], v[80:83], v[100:103], a[20:23]
v_mfma_f32_16x16x32_bf16 a[52:55], v[84:87], v[100:103], a[52:55]
v_mfma_f32_16x16x32_bf16 a[84:87], v[88:91], v[100:103], a[84:87]
v_mfma_f32_16x16x32_bf16 a[116:119], v[92:95], v[100:103], a[116:119]
ds_read_b64_tr_b16 v[100:101], v19 offset:49152
ds_read_b64_tr_b16 v[102:103], v27 offset:49152
s_waitcnt lgkmcnt(6)
v_mfma_f32_16x16x32_bf16 a[24:27], v[80:83], v[104:107], a[24:27]
v_mfma_f32_16x16x32_bf16 a[56:59], v[84:87], v[104:107], a[56:59]
v_mfma_f32_16x16x32_bf16 a[88:91], v[88:91], v[104:107], a[88:91]
v_mfma_f32_16x16x32_bf16 a[120:123], v[92:95], v[104:107], a[120:123]
ds_read_b64_tr_b16 v[104:105], v20 offset:49152
ds_read_b64_tr_b16 v[106:107], v28 offset:49152
s_waitcnt lgkmcnt(6)
v_mfma_f32_16x16x32_bf16 a[28:31], v[80:83], v[108:111], a[28:31]
v_mfma_f32_16x16x32_bf16 a[60:63], v[84:87], v[108:111], a[60:63]
v_mfma_f32_16x16x32_bf16 a[92:95], v[88:91], v[108:111], a[92:95]
v_mfma_f32_16x16x32_bf16 a[124:127], v[92:95], v[108:111], a[124:127]
s_add_u32 s43, s48, 8192
buffer_load_dwordx4 v[80:83], v1, s[8:11], s43 offen offset:0
s_add_u32 s43, s48, 24576
buffer_load_dwordx4 v[84:87], v1, s[8:11], s43 offen offset:0
s_add_u32 s43, s48, 40960
buffer_load_dwordx4 v[88:91], v1, s[8:11], s43 offen offset:0
s_add_u32 s43, s48, 57344
buffer_load_dwordx4 v[92:95], v1, s[8:11], s43 offen offset:0
ds_read_b64_tr_b16 v[108:109], v21 offset:49152
ds_read_b64_tr_b16 v[110:111], v29 offset:49152
s_waitcnt vmcnt(12)
s_waitcnt lgkmcnt(6)
v_mfma_f32_16x16x32_bf16 a[0:3], v[48:51], v[96:99], a[0:3]
v_mfma_f32_16x16x32_bf16 a[32:35], v[52:55], v[96:99], a[32:35]
v_mfma_f32_16x16x32_bf16 a[64:67], v[56:59], v[96:99], a[64:67]
v_mfma_f32_16x16x32_bf16 a[96:99], v[60:63], v[96:99], a[96:99]
ds_read_b64_tr_b16 v[96:97], v22 offset:49152
ds_read_b64_tr_b16 v[98:99], v30 offset:49152
s_waitcnt lgkmcnt(6)
v_mfma_f32_16x16x32_bf16 a[4:7], v[48:51], v[100:103], a[4:7]
v_mfma_f32_16x16x32_bf16 a[36:39], v[52:55], v[100:103], a[36:39]
v_mfma_f32_16x16x32_bf16 a[68:71], v[56:59], v[100:103], a[68:71]
v_mfma_f32_16x16x32_bf16 a[100:103], v[60:63], v[100:103], a[100:103]
ds_read_b64_tr_b16 v[100:101], v23 offset:49152
ds_read_b64_tr_b16 v[102:103], v31 offset:49152
s_waitcnt lgkmcnt(6)
v_mfma_f32_16x16x32_bf16 a[8:11], v[48:51], v[104:107], a[8:11]
v_mfma_f32_16x16x32_bf16 a[40:43], v[52:55], v[104:107], a[40:43]
v_mfma_f32_16x16x32_bf16 a[72:75], v[56:59], v[104:107], a[72:75]
v_mfma_f32_16x16x32_bf16 a[104:107], v[60:63], v[104:107], a[104:107]
ds_read_b64_tr_b16 v[104:105], v24 offset:49152
ds_read_b64_tr_b16 v[106:107], v32 offset:49152
s_waitcnt lgkmcnt(6)
v_mfma_f32_16x16x32_bf16 a[12:15], v[48:51], v[108:111], a[12:15]
v_mfma_f32_16x16x32_bf16 a[44:47], v[52:55], v[108:111], a[44:47]
v_mfma_f32_16x16x32_bf16 a[76:79], v[56:59], v[108:111], a[76:79]
v_mfma_f32_16x16x32_bf16 a[108:111], v[60:63], v[108:111], a[108:111]
ds_read_b64_tr_b16 v[108:109], v25 offset:49152
ds_read_b64_tr_b16 v[110:111], v33 offset:49152
s_waitcnt lgkmcnt(6)
v_mfma_f32_16x16x32_bf16 a[16:19], v[48:51], v[96:99], a[16:19]
v_mfma_f32_16x16x32_bf16 a[48:51], v[52:55], v[96:99], a[48:51]
v_mfma_f32_16x16x32_bf16 a[80:83], v[56:59], v[96:99], a[80:83]
v_mfma_f32_16x16x32_bf16 a[112:115], v[60:63], v[96:99], a[112:115]
ds_read_b64_tr_b16 v[96:97], v18 offset:57344
ds_read_b64_tr_b16 v[98:99], v26 offset:57344
s_waitcnt lgkmcnt(6)
v_mfma_f32_16x16x32_bf16 a[20:23], v[48:51], v[100:103], a[20:23]
v_mfma_f32_16x16x32_bf16 a[52:55], v[52:55], v[100:103], a[52:55]
v_mfma_f32_16x16x32_bf16 a[84:87], v[56:59], v[100:103], a[84:87]
v_mfma_f32_16x16x32_bf16 a[116:119], v[60:63], v[100:103], a[116:119]
ds_read_b64_tr_b16 v[100:101], v19 offset:57344
ds_read_b64_tr_b16 v[102:103], v27 offset:57344
s_waitcnt lgkmcnt(6)
v_mfma_f32_16x16x32_bf16 a[24:27], v[48:51], v[104:107], a[24:27]
v_mfma_f32_16x16x32_bf16 a[56:59], v[52:55], v[104:107], a[56:59]
v_mfma_f32_16x16x32_bf16 a[88:91], v[56:59], v[104:107], a[88:91]
v_mfma_f32_16x16x32_bf16 a[120:123], v[60:63], v[104:107], a[120:123]
ds_read_b64_tr_b16 v[104:105], v20 offset:57344
ds_read_b64_tr_b16 v[106:107], v28 offset:57344
s_waitcnt lgkmcnt(6)
v_mfma_f32_16x16x32_bf16 a[28:31], v[48:51], v[108:111], a[28:31]
v_mfma_f32_16x16x32_bf16 a[60:63], v[52:55], v[108:111], a[60:63]
v_mfma_f32_16x16x32_bf16 a[92:95], v[56:59], v[108:111], a[92:95]
v_mfma_f32_16x16x32_bf16 a[124:127], v[60:63], v[108:111], a[124:127]
s_add_u32 s43, s48, 8192
buffer_load_dwordx4 v[48:51], v1, s[8:11], s43 offen offset:1024
s_add_u32 s43, s48, 24576
buffer_load_dwordx4 v[52:55], v1, s[8:11], s43 offen offset:1024
s_add_u32 s43, s48, 40960
buffer_load_dwordx4 v[56:59], v1, s[8:11], s43 offen offset:1024
s_add_u32 s43, s48, 57344
buffer_load_dwordx4 v[60:63], v1, s[8:11], s43 offen offset:1024
ds_read_b64_tr_b16 v[108:109], v21 offset:57344
ds_read_b64_tr_b16 v[110:111], v29 offset:57344
s_waitcnt vmcnt(12)
s_waitcnt lgkmcnt(6)
v_mfma_f32_16x16x32_bf16 a[0:3], v[64:67], v[96:99], a[0:3]
v_mfma_f32_16x16x32_bf16 a[32:35], v[68:71], v[96:99], a[32:35]
v_mfma_f32_16x16x32_bf16 a[64:67], v[72:75], v[96:99], a[64:67]
v_mfma_f32_16x16x32_bf16 a[96:99], v[76:79], v[96:99], a[96:99]
ds_read_b64_tr_b16 v[96:97], v22 offset:57344
ds_read_b64_tr_b16 v[98:99], v30 offset:57344
s_waitcnt lgkmcnt(6)
v_mfma_f32_16x16x32_bf16 a[4:7], v[64:67], v[100:103], a[4:7]
v_mfma_f32_16x16x32_bf16 a[36:39], v[68:71], v[100:103], a[36:39]
v_mfma_f32_16x16x32_bf16 a[68:71], v[72:75], v[100:103], a[68:71]
v_mfma_f32_16x16x32_bf16 a[100:103], v[76:79], v[100:103], a[100:103]
ds_read_b64_tr_b16 v[100:101], v23 offset:57344
ds_read_b64_tr_b16 v[102:103], v31 offset:57344
s_waitcnt lgkmcnt(6)
v_mfma_f32_16x16x32_bf16 a[8:11], v[64:67], v[104:107], a[8:11]
v_mfma_f32_16x16x32_bf16 a[40:43], v[68:71], v[104:107], a[40:43]
v_mfma_f32_16x16x32_bf16 a[72:75], v[72:75], v[104:107], a[72:75]
v_mfma_f32_16x16x32_bf16 a[104:107], v[76:79], v[104:107], a[104:107]
ds_read_b64_tr_b16 v[104:105], v24 offset:57344
ds_read_b64_tr_b16 v[106:107], v32 offset:57344
s_waitcnt lgkmcnt(6)
v_mfma_f32_16x16x32_bf16 a[12:15], v[64:67], v[108:111], a[12:15]
v_mfma_f32_16x16x32_bf16 a[44:47], v[68:71], v[108:111], a[44:47]
v_mfma_f32_16x16x32_bf16 a[76:79], v[72:75], v[108:111], a[76:79]
v_mfma_f32_16x16x32_bf16 a[108:111], v[76:79], v[108:111], a[108:111]
ds_read_b64_tr_b16 v[108:109], v25 offset:57344
ds_read_b64_tr_b16 v[110:111], v33 offset:57344
s_waitcnt lgkmcnt(6)
v_mfma_f32_16x16x32_bf16 a[16:19], v[64:67], v[96:99], a[16:19]
v_mfma_f32_16x16x32_bf16 a[48:51], v[68:71], v[96:99], a[48:51]
v_mfma_f32_16x16x32_bf16 a[80:83], v[72:75], v[96:99], a[80:83]
v_mfma_f32_16x16x32_bf16 a[112:115], v[76:79], v[96:99], a[112:115]
s_barrier
s_add_u32 s42, s49, 3145728
s_add_u32 m0, s51, 32768
s_nop 0
buffer_load_dwordx4 v2, s[12:15], s42 offen lds
s_add_u32 m0, s51, 33792
s_nop 0
buffer_load_dwordx4 v3, s[12:15], s42 offen lds
s_add_u32 m0, s51, 34816
s_nop 0
buffer_load_dwordx4 v4, s[12:15], s42 offen lds
s_add_u32 m0, s51, 35840
s_nop 0
buffer_load_dwordx4 v5, s[12:15], s42 offen lds
ds_read_b64_tr_b16 v[96:97], v18 offset:0
ds_read_b64_tr_b16 v[98:99], v26 offset:0
s_waitcnt lgkmcnt(6)
v_mfma_f32_16x16x32_bf16 a[20:23], v[64:67], v[100:103], a[20:23]
v_mfma_f32_16x16x32_bf16 a[52:55], v[68:71], v[100:103], a[52:55]
v_mfma_f32_16x16x32_bf16 a[84:87], v[72:75], v[100:103], a[84:87]
v_mfma_f32_16x16x32_bf16 a[116:119], v[76:79], v[100:103], a[116:119]
ds_read_b64_tr_b16 v[100:101], v19 offset:0
ds_read_b64_tr_b16 v[102:103], v27 offset:0
s_waitcnt lgkmcnt(6)
v_mfma_f32_16x16x32_bf16 a[24:27], v[64:67], v[104:107], a[24:27]
v_mfma_f32_16x16x32_bf16 a[56:59], v[68:71], v[104:107], a[56:59]
v_mfma_f32_16x16x32_bf16 a[88:91], v[72:75], v[104:107], a[88:91]
v_mfma_f32_16x16x32_bf16 a[120:123], v[76:79], v[104:107], a[120:123]
ds_read_b64_tr_b16 v[104:105], v20 offset:0
ds_read_b64_tr_b16 v[106:107], v28 offset:0
s_waitcnt lgkmcnt(6)
v_mfma_f32_16x16x32_bf16 a[28:31], v[64:67], v[108:111], a[28:31]
v_mfma_f32_16x16x32_bf16 a[60:63], v[68:71], v[108:111], a[60:63]
v_mfma_f32_16x16x32_bf16 a[92:95], v[72:75], v[108:111], a[92:95]
v_mfma_f32_16x16x32_bf16 a[124:127], v[76:79], v[108:111], a[124:127]
s_add_u32 s43, s48, 8192
buffer_load_dwordx4 v[64:67], v1, s[8:11], s43 offen offset:2048
s_add_u32 s43, s48, 24576
buffer_load_dwordx4 v[68:71], v1, s[8:11], s43 offen offset:2048
s_add_u32 s43, s48, 40960
buffer_load_dwordx4 v[72:75], v1, s[8:11], s43 offen offset:2048
s_add_u32 s43, s48, 57344
buffer_load_dwordx4 v[76:79], v1, s[8:11], s43 offen offset:2048
ds_read_b64_tr_b16 v[108:109], v21 offset:0
ds_read_b64_tr_b16 v[110:111], v29 offset:0
s_waitcnt vmcnt(12)
s_waitcnt lgkmcnt(6)
v_mfma_f32_16x16x32_bf16 a[0:3], v[80:83], v[96:99], a[0:3]
v_mfma_f32_16x16x32_bf16 a[32:35], v[84:87], v[96:99], a[32:35]
v_mfma_f32_16x16x32_bf16 a[64:67], v[88:91], v[96:99], a[64:67]
v_mfma_f32_16x16x32_bf16 a[96:99], v[92:95], v[96:99], a[96:99]
ds_read_b64_tr_b16 v[96:97], v22 offset:0
ds_read_b64_tr_b16 v[98:99], v30 offset:0
s_waitcnt lgkmcnt(6)
v_mfma_f32_16x16x32_bf16 a[4:7], v[80:83], v[100:103], a[4:7]
v_mfma_f32_16x16x32_bf16 a[36:39], v[84:87], v[100:103], a[36:39]
v_mfma_f32_16x16x32_bf16 a[68:71], v[88:91], v[100:103], a[68:71]
v_mfma_f32_16x16x32_bf16 a[100:103], v[92:95], v[100:103], a[100:103]
ds_read_b64_tr_b16 v[100:101], v23 offset:0
ds_read_b64_tr_b16 v[102:103], v31 offset:0
s_waitcnt lgkmcnt(6)
v_mfma_f32_16x16x32_bf16 a[8:11], v[80:83], v[104:107], a[8:11]
v_mfma_f32_16x16x32_bf16 a[40:43], v[84:87], v[104:107], a[40:43]
v_mfma_f32_16x16x32_bf16 a[72:75], v[88:91], v[104:107], a[72:75]
v_mfma_f32_16x16x32_bf16 a[104:107], v[92:95], v[104:107], a[104:107]
ds_read_b64_tr_b16 v[104:105], v24 offset:0
ds_read_b64_tr_b16 v[106:107], v32 offset:0
s_waitcnt lgkmcnt(6)
v_mfma_f32_16x16x32_bf16 a[12:15], v[80:83], v[108:111], a[12:15]
v_mfma_f32_16x16x32_bf16 a[44:47], v[84:87], v[108:111], a[44:47]
v_mfma_f32_16x16x32_bf16 a[76:79], v[88:91], v[108:111], a[76:79]
v_mfma_f32_16x16x32_bf16 a[108:111], v[92:95], v[108:111], a[108:111]
ds_read_b64_tr_b16 v[108:109], v25 offset:0
ds_read_b64_tr_b16 v[110:111], v33 offset:0
s_waitcnt lgkmcnt(6)
v_mfma_f32_16x16x32_bf16 a[16:19], v[80:83], v[96:99], a[16:19]
v_mfma_f32_16x16x32_bf16 a[48:51], v[84:87], v[96:99], a[48:51]
v_mfma_f32_16x16x32_bf16 a[80:83], v[88:91], v[96:99], a[80:83]
v_mfma_f32_16x16x32_bf16 a[112:115], v[92:95], v[96:99], a[112:115]
ds_read_b64_tr_b16 v[96:97], v18 offset:8192
ds_read_b64_tr_b16 v[98:99], v26 offset:8192
s_waitcnt lgkmcnt(6)
v_mfma_f32_16x16x32_bf16 a[20:23], v[80:83], v[100:103], a[20:23]
v_mfma_f32_16x16x32_bf16 a[52:55], v[84:87], v[100:103], a[52:55]
v_mfma_f32_16x16x32_bf16 a[84:87], v[88:91], v[100:103], a[84:87]
v_mfma_f32_16x16x32_bf16 a[116:119], v[92:95], v[100:103], a[116:119]
ds_read_b64_tr_b16 v[100:101], v19 offset:8192
ds_read_b64_tr_b16 v[102:103], v27 offset:8192
s_waitcnt lgkmcnt(6)
v_mfma_f32_16x16x32_bf16 a[24:27], v[80:83], v[104:107], a[24:27]
v_mfma_f32_16x16x32_bf16 a[56:59], v[84:87], v[104:107], a[56:59]
v_mfma_f32_16x16x32_bf16 a[88:91], v[88:91], v[104:107], a[88:91]
v_mfma_f32_16x16x32_bf16 a[120:123], v[92:95], v[104:107], a[120:123]
ds_read_b64_tr_b16 v[104:105], v20 offset:8192
ds_read_b64_tr_b16 v[106:107], v28 offset:8192
s_waitcnt lgkmcnt(6)
v_mfma_f32_16x16x32_bf16 a[28:31], v[80:83], v[108:111], a[28:31]
v_mfma_f32_16x16x32_bf16 a[60:63], v[84:87], v[108:111], a[60:63]
v_mfma_f32_16x16x32_bf16 a[92:95], v[88:91], v[108:111], a[92:95]
v_mfma_f32_16x16x32_bf16 a[124:127], v[92:95], v[108:111], a[124:127]
s_add_u32 s43, s48, 8192
buffer_load_dwordx4 v[80:83], v1, s[8:11], s43 offen offset:3072
s_add_u32 s43, s48, 24576
buffer_load_dwordx4 v[84:87], v1, s[8:11], s43 offen offset:3072
s_add_u32 s43, s48, 40960
buffer_load_dwordx4 v[88:91], v1, s[8:11], s43 offen offset:3072
s_add_u32 s43, s48, 57344
buffer_load_dwordx4 v[92:95], v1, s[8:11], s43 offen offset:3072
ds_read_b64_tr_b16 v[108:109], v21 offset:8192
ds_read_b64_tr_b16 v[110:111], v29 offset:8192
s_waitcnt vmcnt(12)
s_waitcnt lgkmcnt(6)
v_mfma_f32_16x16x32_bf16 a[0:3], v[48:51], v[96:99], a[0:3]
v_mfma_f32_16x16x32_bf16 a[32:35], v[52:55], v[96:99], a[32:35]
v_mfma_f32_16x16x32_bf16 a[64:67], v[56:59], v[96:99], a[64:67]
v_mfma_f32_16x16x32_bf16 a[96:99], v[60:63], v[96:99], a[96:99]
ds_read_b64_tr_b16 v[96:97], v22 offset:8192
ds_read_b64_tr_b16 v[98:99], v30 offset:8192
s_waitcnt lgkmcnt(6)
v_mfma_f32_16x16x32_bf16 a[4:7], v[48:51], v[100:103], a[4:7]
v_mfma_f32_16x16x32_bf16 a[36:39], v[52:55], v[100:103], a[36:39]
v_mfma_f32_16x16x32_bf16 a[68:71], v[56:59], v[100:103], a[68:71]
v_mfma_f32_16x16x32_bf16 a[100:103], v[60:63], v[100:103], a[100:103]
ds_read_b64_tr_b16 v[100:101], v23 offset:8192
ds_read_b64_tr_b16 v[102:103], v31 offset:8192
s_waitcnt lgkmcnt(6)
v_mfma_f32_16x16x32_bf16 a[8:11], v[48:51], v[104:107], a[8:11]
v_mfma_f32_16x16x32_bf16 a[40:43], v[52:55], v[104:107], a[40:43]
v_mfma_f32_16x16x32_bf16 a[72:75], v[56:59], v[104:107], a[72:75]
v_mfma_f32_16x16x32_bf16 a[104:107], v[60:63], v[104:107], a[104:107]
ds_read_b64_tr_b16 v[104:105], v24 offset:8192
ds_read_b64_tr_b16 v[106:107], v32 offset:8192
s_waitcnt lgkmcnt(6)
v_mfma_f32_16x16x32_bf16 a[12:15], v[48:51], v[108:111], a[12:15]
v_mfma_f32_16x16x32_bf16 a[44:47], v[52:55], v[108:111], a[44:47]
v_mfma_f32_16x16x32_bf16 a[76:79], v[56:59], v[108:111], a[76:79]
v_mfma_f32_16x16x32_bf16 a[108:111], v[60:63], v[108:111], a[108:111]
ds_read_b64_tr_b16 v[108:109], v25 offset:8192
ds_read_b64_tr_b16 v[110:111], v33 offset:8192
s_waitcnt lgkmcnt(6)
v_mfma_f32_16x16x32_bf16 a[16:19], v[48:51], v[96:99], a[16:19]
v_mfma_f32_16x16x32_bf16 a[48:51], v[52:55], v[96:99], a[48:51]
v_mfma_f32_16x16x32_bf16 a[80:83], v[56:59], v[96:99], a[80:83]
v_mfma_f32_16x16x32_bf16 a[112:115], v[60:63], v[96:99], a[112:115]
s_barrier
s_add_u32 s42, s49, 3670016
s_add_u32 m0, s51, 49152
s_nop 0
buffer_load_dwordx4 v2, s[12:15], s42 offen lds
s_add_u32 m0, s51, 50176
s_nop 0
buffer_load_dwordx4 v3, s[12:15], s42 offen lds
s_add_u32 m0, s51, 51200
s_nop 0
buffer_load_dwordx4 v4, s[12:15], s42 offen lds
s_add_u32 m0, s51, 52224
s_nop 0
buffer_load_dwordx4 v5, s[12:15], s42 offen lds
ds_read_b64_tr_b16 v[96:97], v18 offset:16384
ds_read_b64_tr_b16 v[98:99], v26 offset:16384
s_waitcnt lgkmcnt(6)
v_mfma_f32_16x16x32_bf16 a[20:23], v[48:51], v[100:103], a[20:23]
v_mfma_f32_16x16x32_bf16 a[52:55], v[52:55], v[100:103], a[52:55]
v_mfma_f32_16x16x32_bf16 a[84:87], v[56:59], v[100:103], a[84:87]
v_mfma_f32_16x16x32_bf16 a[116:119], v[60:63], v[100:103], a[116:119]
ds_read_b64_tr_b16 v[100:101], v19 offset:16384
ds_read_b64_tr_b16 v[102:103], v27 offset:16384
s_waitcnt lgkmcnt(6)
v_mfma_f32_16x16x32_bf16 a[24:27], v[48:51], v[104:107], a[24:27]
v_mfma_f32_16x16x32_bf16 a[56:59], v[52:55], v[104:107], a[56:59]
v_mfma_f32_16x16x32_bf16 a[88:91], v[56:59], v[104:107], a[88:91]
v_mfma_f32_16x16x32_bf16 a[120:123], v[60:63], v[104:107], a[120:123]
ds_read_b64_tr_b16 v[104:105], v20 offset:16384
ds_read_b64_tr_b16 v[106:107], v28 offset:16384
s_waitcnt lgkmcnt(6)
v_mfma_f32_16x16x32_bf16 a[28:31], v[48:51], v[108:111], a[28:31]
v_mfma_f32_16x16x32_bf16 a[60:63], v[52:55], v[108:111], a[60:63]
v_mfma_f32_16x16x32_bf16 a[92:95], v[56:59], v[108:111], a[92:95]
v_mfma_f32_16x16x32_bf16 a[124:127], v[60:63], v[108:111], a[124:127]
s_add_u32 s43, s48, 12288
buffer_load_dwordx4 v[48:51], v1, s[8:11], s43 offen offset:0
s_add_u32 s43, s48, 28672
buffer_load_dwordx4 v[52:55], v1, s[8:11], s43 offen offset:0
s_add_u32 s43, s48, 45056
buffer_load_dwordx4 v[56:59], v1, s[8:11], s43 offen offset:0
s_add_u32 s43, s48, 61440
buffer_load_dwordx4 v[60:63], v1, s[8:11], s43 offen offset:0
ds_read_b64_tr_b16 v[108:109], v21 offset:16384
ds_read_b64_tr_b16 v[110:111], v29 offset:16384
s_waitcnt vmcnt(12)
s_waitcnt lgkmcnt(6)
v_mfma_f32_16x16x32_bf16 a[0:3], v[64:67], v[96:99], a[0:3]
v_mfma_f32_16x16x32_bf16 a[32:35], v[68:71], v[96:99], a[32:35]
v_mfma_f32_16x16x32_bf16 a[64:67], v[72:75], v[96:99], a[64:67]
v_mfma_f32_16x16x32_bf16 a[96:99], v[76:79], v[96:99], a[96:99]
ds_read_b64_tr_b16 v[96:97], v22 offset:16384
ds_read_b64_tr_b16 v[98:99], v30 offset:16384
s_waitcnt lgkmcnt(6)
v_mfma_f32_16x16x32_bf16 a[4:7], v[64:67], v[100:103], a[4:7]
v_mfma_f32_16x16x32_bf16 a[36:39], v[68:71], v[100:103], a[36:39]
v_mfma_f32_16x16x32_bf16 a[68:71], v[72:75], v[100:103], a[68:71]
v_mfma_f32_16x16x32_bf16 a[100:103], v[76:79], v[100:103], a[100:103]
ds_read_b64_tr_b16 v[100:101], v23 offset:16384
ds_read_b64_tr_b16 v[102:103], v31 offset:16384
s_waitcnt lgkmcnt(6)
v_mfma_f32_16x16x32_bf16 a[8:11], v[64:67], v[104:107], a[8:11]
v_mfma_f32_16x16x32_bf16 a[40:43], v[68:71], v[104:107], a[40:43]
v_mfma_f32_16x16x32_bf16 a[72:75], v[72:75], v[104:107], a[72:75]
v_mfma_f32_16x16x32_bf16 a[104:107], v[76:79], v[104:107], a[104:107]
ds_read_b64_tr_b16 v[104:105], v24 offset:16384
ds_read_b64_tr_b16 v[106:107], v32 offset:16384
s_waitcnt lgkmcnt(6)
v_mfma_f32_16x16x32_bf16 a[12:15], v[64:67], v[108:111], a[12:15]
v_mfma_f32_16x16x32_bf16 a[44:47], v[68:71], v[108:111], a[44:47]
v_mfma_f32_16x16x32_bf16 a[76:79], v[72:75], v[108:111], a[76:79]
v_mfma_f32_16x16x32_bf16 a[108:111], v[76:79], v[108:111], a[108:111]
ds_read_b64_tr_b16 v[108:109], v25 offset:16384
ds_read_b64_tr_b16 v[110:111], v33 offset:16384
s_waitcnt lgkmcnt(6)
v_mfma_f32_16x16x32_bf16 a[16:19], v[64:67], v[96:99], a[16:19]
v_mfma_f32_16x16x32_bf16 a[48:51], v[68:71], v[96:99], a[48:51]
v_mfma_f32_16x16x32_bf16 a[80:83], v[72:75], v[96:99], a[80:83]
v_mfma_f32_16x16x32_bf16 a[112:115], v[76:79], v[96:99], a[112:115]
ds_read_b64_tr_b16 v[96:97], v18 offset:24576
ds_read_b64_tr_b16 v[98:99], v26 offset:24576
s_waitcnt lgkmcnt(6)
v_mfma_f32_16x16x32_bf16 a[20:23], v[64:67], v[100:103], a[20:23]
v_mfma_f32_16x16x32_bf16 a[52:55], v[68:71], v[100:103], a[52:55]
v_mfma_f32_16x16x32_bf16 a[84:87], v[72:75], v[100:103], a[84:87]
v_mfma_f32_16x16x32_bf16 a[116:119], v[76:79], v[100:103], a[116:119]
ds_read_b64_tr_b16 v[100:101], v19 offset:24576
ds_read_b64_tr_b16 v[102:103], v27 offset:24576
s_waitcnt lgkmcnt(6)
v_mfma_f32_16x16x32_bf16 a[24:27], v[64:67], v[104:107], a[24:27]
v_mfma_f32_16x16x32_bf16 a[56:59], v[68:71], v[104:107], a[56:59]
v_mfma_f32_16x16x32_bf16 a[88:91], v[72:75], v[104:107], a[88:91]
v_mfma_f32_16x16x32_bf16 a[120:123], v[76:79], v[104:107], a[120:123]
ds_read_b64_tr_b16 v[104:105], v20 offset:24576
ds_read_b64_tr_b16 v[106:107], v28 offset:24576
s_waitcnt lgkmcnt(6)
v_mfma_f32_16x16x32_bf16 a[28:31], v[64:67], v[108:111], a[28:31]
v_mfma_f32_16x16x32_bf16 a[60:63], v[68:71], v[108:111], a[60:63]
v_mfma_f32_16x16x32_bf16 a[92:95], v[72:75], v[108:111], a[92:95]
v_mfma_f32_16x16x32_bf16 a[124:127], v[76:79], v[108:111], a[124:127]
s_add_u32 s43, s48, 12288
buffer_load_dwordx4 v[64:67], v1, s[8:11], s43 offen offset:1024
s_add_u32 s43, s48, 28672
buffer_load_dwordx4 v[68:71], v1, s[8:11], s43 offen offset:1024
s_add_u32 s43, s48, 45056
buffer_load_dwordx4 v[72:75], v1, s[8:11], s43 offen offset:1024
s_add_u32 s43, s48, 61440
buffer_load_dwordx4 v[76:79], v1, s[8:11], s43 offen offset:1024
ds_read_b64_tr_b16 v[108:109], v21 offset:24576
ds_read_b64_tr_b16 v[110:111], v29 offset:24576
s_waitcnt vmcnt(12)
s_waitcnt lgkmcnt(6)
v_mfma_f32_16x16x32_bf16 a[0:3], v[80:83], v[96:99], a[0:3]
v_mfma_f32_16x16x32_bf16 a[32:35], v[84:87], v[96:99], a[32:35]
v_mfma_f32_16x16x32_bf16 a[64:67], v[88:91], v[96:99], a[64:67]
v_mfma_f32_16x16x32_bf16 a[96:99], v[92:95], v[96:99], a[96:99]
ds_read_b64_tr_b16 v[96:97], v22 offset:24576
ds_read_b64_tr_b16 v[98:99], v30 offset:24576
s_waitcnt lgkmcnt(6)
v_mfma_f32_16x16x32_bf16 a[4:7], v[80:83], v[100:103], a[4:7]
v_mfma_f32_16x16x32_bf16 a[36:39], v[84:87], v[100:103], a[36:39]
v_mfma_f32_16x16x32_bf16 a[68:71], v[88:91], v[100:103], a[68:71]
v_mfma_f32_16x16x32_bf16 a[100:103], v[92:95], v[100:103], a[100:103]
ds_read_b64_tr_b16 v[100:101], v23 offset:24576
ds_read_b64_tr_b16 v[102:103], v31 offset:24576
s_waitcnt lgkmcnt(6)
v_mfma_f32_16x16x32_bf16 a[8:11], v[80:83], v[104:107], a[8:11]
v_mfma_f32_16x16x32_bf16 a[40:43], v[84:87], v[104:107], a[40:43]
v_mfma_f32_16x16x32_bf16 a[72:75], v[88:91], v[104:107], a[72:75]
v_mfma_f32_16x16x32_bf16 a[104:107], v[92:95], v[104:107], a[104:107]
ds_read_b64_tr_b16 v[104:105], v24 offset:24576
ds_read_b64_tr_b16 v[106:107], v32 offset:24576
s_waitcnt lgkmcnt(6)
v_mfma_f32_16x16x32_bf16 a[12:15], v[80:83], v[108:111], a[12:15]
v_mfma_f32_16x16x32_bf16 a[44:47], v[84:87], v[108:111], a[44:47]
v_mfma_f32_16x16x32_bf16 a[76:79], v[88:91], v[108:111], a[76:79]
v_mfma_f32_16x16x32_bf16 a[108:111], v[92:95], v[108:111], a[108:111]
ds_read_b64_tr_b16 v[108:109], v25 offset:24576
ds_read_b64_tr_b16 v[110:111], v33 offset:24576
s_waitcnt lgkmcnt(6)
v_mfma_f32_16x16x32_bf16 a[16:19], v[80:83], v[96:99], a[16:19]
v_mfma_f32_16x16x32_bf16 a[48:51], v[84:87], v[96:99], a[48:51]
v_mfma_f32_16x16x32_bf16 a[80:83], v[88:91], v[96:99], a[80:83]
v_mfma_f32_16x16x32_bf16 a[112:115], v[92:95], v[96:99], a[112:115]
s_barrier
ds_read_b64_tr_b16 v[96:97], v18 offset:32768
ds_read_b64_tr_b16 v[98:99], v26 offset:32768
s_waitcnt lgkmcnt(6)
v_mfma_f32_16x16x32_bf16 a[20:23], v[80:83], v[100:103], a[20:23]
v_mfma_f32_16x16x32_bf16 a[52:55], v[84:87], v[100:103], a[52:55]
v_mfma_f32_16x16x32_bf16 a[84:87], v[88:91], v[100:103], a[84:87]
v_mfma_f32_16x16x32_bf16 a[116:119], v[92:95], v[100:103], a[116:119]
ds_read_b64_tr_b16 v[100:101], v19 offset:32768
ds_read_b64_tr_b16 v[102:103], v27 offset:32768
s_waitcnt lgkmcnt(6)
v_mfma_f32_16x16x32_bf16 a[24:27], v[80:83], v[104:107], a[24:27]
v_mfma_f32_16x16x32_bf16 a[56:59], v[84:87], v[104:107], a[56:59]
v_mfma_f32_16x16x32_bf16 a[88:91], v[88:91], v[104:107], a[88:91]
v_mfma_f32_16x16x32_bf16 a[120:123], v[92:95], v[104:107], a[120:123]
ds_read_b64_tr_b16 v[104:105], v20 offset:32768
ds_read_b64_tr_b16 v[106:107], v28 offset:32768
s_waitcnt lgkmcnt(6)
v_mfma_f32_16x16x32_bf16 a[28:31], v[80:83], v[108:111], a[28:31]
v_mfma_f32_16x16x32_bf16 a[60:63], v[84:87], v[108:111], a[60:63]
v_mfma_f32_16x16x32_bf16 a[92:95], v[88:91], v[108:111], a[92:95]
v_mfma_f32_16x16x32_bf16 a[124:127], v[92:95], v[108:111], a[124:127]
s_add_u32 s43, s48, 12288
buffer_load_dwordx4 v[80:83], v1, s[8:11], s43 offen offset:2048
s_add_u32 s43, s48, 28672
buffer_load_dwordx4 v[84:87], v1, s[8:11], s43 offen offset:2048
s_add_u32 s43, s48, 45056
buffer_load_dwordx4 v[88:91], v1, s[8:11], s43 offen offset:2048
s_add_u32 s43, s48, 61440
buffer_load_dwordx4 v[92:95], v1, s[8:11], s43 offen offset:2048
ds_read_b64_tr_b16 v[108:109], v21 offset:32768
ds_read_b64_tr_b16 v[110:111], v29 offset:32768
s_waitcnt vmcnt(8)
s_waitcnt lgkmcnt(6)
v_mfma_f32_16x16x32_bf16 a[0:3], v[48:51], v[96:99], a[0:3]
v_mfma_f32_16x16x32_bf16 a[32:35], v[52:55], v[96:99], a[32:35]
v_mfma_f32_16x16x32_bf16 a[64:67], v[56:59], v[96:99], a[64:67]
v_mfma_f32_16x16x32_bf16 a[96:99], v[60:63], v[96:99], a[96:99]
ds_read_b64_tr_b16 v[96:97], v22 offset:32768
ds_read_b64_tr_b16 v[98:99], v30 offset:32768
s_waitcnt lgkmcnt(6)
v_mfma_f32_16x16x32_bf16 a[4:7], v[48:51], v[100:103], a[4:7]
v_mfma_f32_16x16x32_bf16 a[36:39], v[52:55], v[100:103], a[36:39]
v_mfma_f32_16x16x32_bf16 a[68:71], v[56:59], v[100:103], a[68:71]
v_mfma_f32_16x16x32_bf16 a[100:103], v[60:63], v[100:103], a[100:103]
ds_read_b64_tr_b16 v[100:101], v23 offset:32768
ds_read_b64_tr_b16 v[102:103], v31 offset:32768
s_waitcnt lgkmcnt(6)
v_mfma_f32_16x16x32_bf16 a[8:11], v[48:51], v[104:107], a[8:11]
v_mfma_f32_16x16x32_bf16 a[40:43], v[52:55], v[104:107], a[40:43]
v_mfma_f32_16x16x32_bf16 a[72:75], v[56:59], v[104:107], a[72:75]
v_mfma_f32_16x16x32_bf16 a[104:107], v[60:63], v[104:107], a[104:107]
ds_read_b64_tr_b16 v[104:105], v24 offset:32768
ds_read_b64_tr_b16 v[106:107], v32 offset:32768
s_waitcnt lgkmcnt(6)
v_mfma_f32_16x16x32_bf16 a[12:15], v[48:51], v[108:111], a[12:15]
v_mfma_f32_16x16x32_bf16 a[44:47], v[52:55], v[108:111], a[44:47]
v_mfma_f32_16x16x32_bf16 a[76:79], v[56:59], v[108:111], a[76:79]
v_mfma_f32_16x16x32_bf16 a[108:111], v[60:63], v[108:111], a[108:111]
ds_read_b64_tr_b16 v[108:109], v25 offset:32768
ds_read_b64_tr_b16 v[110:111], v33 offset:32768
s_waitcnt lgkmcnt(6)
v_mfma_f32_16x16x32_bf16 a[16:19], v[48:51], v[96:99], a[16:19]
v_mfma_f32_16x16x32_bf16 a[48:51], v[52:55], v[96:99], a[48:51]
v_mfma_f32_16x16x32_bf16 a[80:83], v[56:59], v[96:99], a[80:83]
v_mfma_f32_16x16x32_bf16 a[112:115], v[60:63], v[96:99], a[112:115]
ds_read_b64_tr_b16 v[96:97], v18 offset:40960
ds_read_b64_tr_b16 v[98:99], v26 offset:40960
s_waitcnt lgkmcnt(6)
v_mfma_f32_16x16x32_bf16 a[20:23], v[48:51], v[100:103], a[20:23]
v_mfma_f32_16x16x32_bf16 a[52:55], v[52:55], v[100:103], a[52:55]
v_mfma_f32_16x16x32_bf16 a[84:87], v[56:59], v[100:103], a[84:87]
v_mfma_f32_16x16x32_bf16 a[116:119], v[60:63], v[100:103], a[116:119]
ds_read_b64_tr_b16 v[100:101], v19 offset:40960
ds_read_b64_tr_b16 v[102:103], v27 offset:40960
s_waitcnt lgkmcnt(6)
v_mfma_f32_16x16x32_bf16 a[24:27], v[48:51], v[104:107], a[24:27]
v_mfma_f32_16x16x32_bf16 a[56:59], v[52:55], v[104:107], a[56:59]
v_mfma_f32_16x16x32_bf16 a[88:91], v[56:59], v[104:107], a[88:91]
v_mfma_f32_16x16x32_bf16 a[120:123], v[60:63], v[104:107], a[120:123]
ds_read_b64_tr_b16 v[104:105], v20 offset:40960
ds_read_b64_tr_b16 v[106:107], v28 offset:40960
s_waitcnt lgkmcnt(6)
v_mfma_f32_16x16x32_bf16 a[28:31], v[48:51], v[108:111], a[28:31]
v_mfma_f32_16x16x32_bf16 a[60:63], v[52:55], v[108:111], a[60:63]
v_mfma_f32_16x16x32_bf16 a[92:95], v[56:59], v[108:111], a[92:95]
v_mfma_f32_16x16x32_bf16 a[124:127], v[60:63], v[108:111], a[124:127]
s_add_u32 s43, s48, 12288
buffer_load_dwordx4 v[48:51], v1, s[8:11], s43 offen offset:3072
s_add_u32 s43, s48, 28672
buffer_load_dwordx4 v[52:55], v1, s[8:11], s43 offen offset:3072
s_add_u32 s43, s48, 45056
buffer_load_dwordx4 v[56:59], v1, s[8:11], s43 offen offset:3072
s_add_u32 s43, s48, 61440
buffer_load_dwordx4 v[60:63], v1, s[8:11], s43 offen offset:3072
ds_read_b64_tr_b16 v[108:109], v21 offset:40960
ds_read_b64_tr_b16 v[110:111], v29 offset:40960
s_waitcnt vmcnt(8)
s_waitcnt lgkmcnt(6)
v_mfma_f32_16x16x32_bf16 a[0:3], v[64:67], v[96:99], a[0:3]
v_mfma_f32_16x16x32_bf16 a[32:35], v[68:71], v[96:99], a[32:35]
v_mfma_f32_16x16x32_bf16 a[64:67], v[72:75], v[96:99], a[64:67]
v_mfma_f32_16x16x32_bf16 a[96:99], v[76:79], v[96:99], a[96:99]
ds_read_b64_tr_b16 v[96:97], v22 offset:40960
ds_read_b64_tr_b16 v[98:99], v30 offset:40960
s_waitcnt lgkmcnt(6)
v_mfma_f32_16x16x32_bf16 a[4:7], v[64:67], v[100:103], a[4:7]
v_mfma_f32_16x16x32_bf16 a[36:39], v[68:71], v[100:103], a[36:39]
v_mfma_f32_16x16x32_bf16 a[68:71], v[72:75], v[100:103], a[68:71]
v_mfma_f32_16x16x32_bf16 a[100:103], v[76:79], v[100:103], a[100:103]
ds_read_b64_tr_b16 v[100:101], v23 offset:40960
ds_read_b64_tr_b16 v[102:103], v31 offset:40960
s_waitcnt lgkmcnt(6)
v_mfma_f32_16x16x32_bf16 a[8:11], v[64:67], v[104:107], a[8:11]
v_mfma_f32_16x16x32_bf16 a[40:43], v[68:71], v[104:107], a[40:43]
v_mfma_f32_16x16x32_bf16 a[72:75], v[72:75], v[104:107], a[72:75]
v_mfma_f32_16x16x32_bf16 a[104:107], v[76:79], v[104:107], a[104:107]
ds_read_b64_tr_b16 v[104:105], v24 offset:40960
ds_read_b64_tr_b16 v[106:107], v32 offset:40960
s_waitcnt lgkmcnt(6)
v_mfma_f32_16x16x32_bf16 a[12:15], v[64:67], v[108:111], a[12:15]
v_mfma_f32_16x16x32_bf16 a[44:47], v[68:71], v[108:111], a[44:47]
v_mfma_f32_16x16x32_bf16 a[76:79], v[72:75], v[108:111], a[76:79]
v_mfma_f32_16x16x32_bf16 a[108:111], v[76:79], v[108:111], a[108:111]
ds_read_b64_tr_b16 v[108:109], v25 offset:40960
ds_read_b64_tr_b16 v[110:111], v33 offset:40960
s_waitcnt lgkmcnt(6)
v_mfma_f32_16x16x32_bf16 a[16:19], v[64:67], v[96:99], a[16:19]
v_mfma_f32_16x16x32_bf16 a[48:51], v[68:71], v[96:99], a[48:51]
v_mfma_f32_16x16x32_bf16 a[80:83], v[72:75], v[96:99], a[80:83]
v_mfma_f32_16x16x32_bf16 a[112:115], v[76:79], v[96:99], a[112:115]
s_barrier
ds_read_b64_tr_b16 v[96:97], v18 offset:49152
ds_read_b64_tr_b16 v[98:99], v26 offset:49152
s_waitcnt lgkmcnt(6)
v_mfma_f32_16x16x32_bf16 a[20:23], v[64:67], v[100:103], a[20:23]
v_mfma_f32_16x16x32_bf16 a[52:55], v[68:71], v[100:103], a[52:55]
v_mfma_f32_16x16x32_bf16 a[84:87], v[72:75], v[100:103], a[84:87]
v_mfma_f32_16x16x32_bf16 a[116:119], v[76:79], v[100:103], a[116:119]
ds_read_b64_tr_b16 v[100:101], v19 offset:49152
ds_read_b64_tr_b16 v[102:103], v27 offset:49152
s_waitcnt lgkmcnt(6)
v_mfma_f32_16x16x32_bf16 a[24:27], v[64:67], v[104:107], a[24:27]
v_mfma_f32_16x16x32_bf16 a[56:59], v[68:71], v[104:107], a[56:59]
v_mfma_f32_16x16x32_bf16 a[88:91], v[72:75], v[104:107], a[88:91]
v_mfma_f32_16x16x32_bf16 a[120:123], v[76:79], v[104:107], a[120:123]
ds_read_b64_tr_b16 v[104:105], v20 offset:49152
ds_read_b64_tr_b16 v[106:107], v28 offset:49152
s_waitcnt lgkmcnt(6)
v_mfma_f32_16x16x32_bf16 a[28:31], v[64:67], v[108:111], a[28:31]
v_mfma_f32_16x16x32_bf16 a[60:63], v[68:71], v[108:111], a[60:63]
v_mfma_f32_16x16x32_bf16 a[92:95], v[72:75], v[108:111], a[92:95]
v_mfma_f32_16x16x32_bf16 a[124:127], v[76:79], v[108:111], a[124:127]
ds_read_b64_tr_b16 v[108:109], v21 offset:49152
ds_read_b64_tr_b16 v[110:111], v29 offset:49152
s_waitcnt vmcnt(4)
s_waitcnt lgkmcnt(6)
v_mfma_f32_16x16x32_bf16 a[0:3], v[80:83], v[96:99], a[0:3]
v_mfma_f32_16x16x32_bf16 a[32:35], v[84:87], v[96:99], a[32:35]
v_mfma_f32_16x16x32_bf16 a[64:67], v[88:91], v[96:99], a[64:67]
v_mfma_f32_16x16x32_bf16 a[96:99], v[92:95], v[96:99], a[96:99]
ds_read_b64_tr_b16 v[96:97], v22 offset:49152
ds_read_b64_tr_b16 v[98:99], v30 offset:49152
s_waitcnt lgkmcnt(6)
v_mfma_f32_16x16x32_bf16 a[4:7], v[80:83], v[100:103], a[4:7]
v_mfma_f32_16x16x32_bf16 a[36:39], v[84:87], v[100:103], a[36:39]
v_mfma_f32_16x16x32_bf16 a[68:71], v[88:91], v[100:103], a[68:71]
v_mfma_f32_16x16x32_bf16 a[100:103], v[92:95], v[100:103], a[100:103]
ds_read_b64_tr_b16 v[100:101], v23 offset:49152
ds_read_b64_tr_b16 v[102:103], v31 offset:49152
s_waitcnt lgkmcnt(6)
v_mfma_f32_16x16x32_bf16 a[8:11], v[80:83], v[104:107], a[8:11]
v_mfma_f32_16x16x32_bf16 a[40:43], v[84:87], v[104:107], a[40:43]
v_mfma_f32_16x16x32_bf16 a[72:75], v[88:91], v[104:107], a[72:75]
v_mfma_f32_16x16x32_bf16 a[104:107], v[92:95], v[104:107], a[104:107]
ds_read_b64_tr_b16 v[104:105], v24 offset:49152
ds_read_b64_tr_b16 v[106:107], v32 offset:49152
s_waitcnt lgkmcnt(6)
v_mfma_f32_16x16x32_bf16 a[12:15], v[80:83], v[108:111], a[12:15]
v_mfma_f32_16x16x32_bf16 a[44:47], v[84:87], v[108:111], a[44:47]
v_mfma_f32_16x16x32_bf16 a[76:79], v[88:91], v[108:111], a[76:79]
v_mfma_f32_16x16x32_bf16 a[108:111], v[92:95], v[108:111], a[108:111]
ds_read_b64_tr_b16 v[108:109], v25 offset:49152
ds_read_b64_tr_b16 v[110:111], v33 offset:49152
s_waitcnt lgkmcnt(6)
v_mfma_f32_16x16x32_bf16 a[16:19], v[80:83], v[96:99], a[16:19]
v_mfma_f32_16x16x32_bf16 a[48:51], v[84:87], v[96:99], a[48:51]
v_mfma_f32_16x16x32_bf16 a[80:83], v[88:91], v[96:99], a[80:83]
v_mfma_f32_16x16x32_bf16 a[112:115], v[92:95], v[96:99], a[112:115]
ds_read_b64_tr_b16 v[96:97], v18 offset:57344
ds_read_b64_tr_b16 v[98:99], v26 offset:57344
s_waitcnt lgkmcnt(6)
v_mfma_f32_16x16x32_bf16 a[20:23], v[80:83], v[100:103], a[20:23]
v_mfma_f32_16x16x32_bf16 a[52:55], v[84:87], v[100:103], a[52:55]
v_mfma_f32_16x16x32_bf16 a[84:87], v[88:91], v[100:103], a[84:87]
v_mfma_f32_16x16x32_bf16 a[116:119], v[92:95], v[100:103], a[116:119]
ds_read_b64_tr_b16 v[100:101], v19 offset:57344
ds_read_b64_tr_b16 v[102:103], v27 offset:57344
s_waitcnt lgkmcnt(6)
v_mfma_f32_16x16x32_bf16 a[24:27], v[80:83], v[104:107], a[24:27]
v_mfma_f32_16x16x32_bf16 a[56:59], v[84:87], v[104:107], a[56:59]
v_mfma_f32_16x16x32_bf16 a[88:91], v[88:91], v[104:107], a[88:91]
v_mfma_f32_16x16x32_bf16 a[120:123], v[92:95], v[104:107], a[120:123]
ds_read_b64_tr_b16 v[104:105], v20 offset:57344
ds_read_b64_tr_b16 v[106:107], v28 offset:57344
s_waitcnt lgkmcnt(6)
v_mfma_f32_16x16x32_bf16 a[28:31], v[80:83], v[108:111], a[28:31]
v_mfma_f32_16x16x32_bf16 a[60:63], v[84:87], v[108:111], a[60:63]
v_mfma_f32_16x16x32_bf16 a[92:95], v[88:91], v[108:111], a[92:95]
v_mfma_f32_16x16x32_bf16 a[124:127], v[92:95], v[108:111], a[124:127]
ds_read_b64_tr_b16 v[108:109], v21 offset:57344
ds_read_b64_tr_b16 v[110:111], v29 offset:57344
s_waitcnt vmcnt(0)
s_waitcnt lgkmcnt(6)
v_mfma_f32_16x16x32_bf16 a[0:3], v[48:51], v[96:99], a[0:3]
v_mfma_f32_16x16x32_bf16 a[32:35], v[52:55], v[96:99], a[32:35]
v_mfma_f32_16x16x32_bf16 a[64:67], v[56:59], v[96:99], a[64:67]
v_mfma_f32_16x16x32_bf16 a[96:99], v[60:63], v[96:99], a[96:99]
ds_read_b64_tr_b16 v[96:97], v22 offset:57344
ds_read_b64_tr_b16 v[98:99], v30 offset:57344
s_waitcnt lgkmcnt(6)
v_mfma_f32_16x16x32_bf16 a[4:7], v[48:51], v[100:103], a[4:7]
v_mfma_f32_16x16x32_bf16 a[36:39], v[52:55], v[100:103], a[36:39]
v_mfma_f32_16x16x32_bf16 a[68:71], v[56:59], v[100:103], a[68:71]
v_mfma_f32_16x16x32_bf16 a[100:103], v[60:63], v[100:103], a[100:103]
ds_read_b64_tr_b16 v[100:101], v23 offset:57344
ds_read_b64_tr_b16 v[102:103], v31 offset:57344
s_waitcnt lgkmcnt(6)
v_mfma_f32_16x16x32_bf16 a[8:11], v[48:51], v[104:107], a[8:11]
v_mfma_f32_16x16x32_bf16 a[40:43], v[52:55], v[104:107], a[40:43]
v_mfma_f32_16x16x32_bf16 a[72:75], v[56:59], v[104:107], a[72:75]
v_mfma_f32_16x16x32_bf16 a[104:107], v[60:63], v[104:107], a[104:107]
ds_read_b64_tr_b16 v[104:105], v24 offset:57344
ds_read_b64_tr_b16 v[106:107], v32 offset:57344
s_waitcnt lgkmcnt(6)
v_mfma_f32_16x16x32_bf16 a[12:15], v[48:51], v[108:111], a[12:15]
v_mfma_f32_16x16x32_bf16 a[44:47], v[52:55], v[108:111], a[44:47]
v_mfma_f32_16x16x32_bf16 a[76:79], v[56:59], v[108:111], a[76:79]
v_mfma_f32_16x16x32_bf16 a[108:111], v[60:63], v[108:111], a[108:111]
ds_read_b64_tr_b16 v[108:109], v25 offset:57344
ds_read_b64_tr_b16 v[110:111], v33 offset:57344
s_waitcnt lgkmcnt(6)
v_mfma_f32_16x16x32_bf16 a[16:19], v[48:51], v[96:99], a[16:19]
v_mfma_f32_16x16x32_bf16 a[48:51], v[52:55], v[96:99], a[48:51]
v_mfma_f32_16x16x32_bf16 a[80:83], v[56:59], v[96:99], a[80:83]
v_mfma_f32_16x16x32_bf16 a[112:115], v[60:63], v[96:99], a[112:115]
s_waitcnt lgkmcnt(4)
v_mfma_f32_16x16x32_bf16 a[20:23], v[48:51], v[100:103], a[20:23]
v_mfma_f32_16x16x32_bf16 a[52:55], v[52:55], v[100:103], a[52:55]
v_mfma_f32_16x16x32_bf16 a[84:87], v[56:59], v[100:103], a[84:87]
v_mfma_f32_16x16x32_bf16 a[116:119], v[60:63], v[100:103], a[116:119]
s_waitcnt lgkmcnt(2)
v_mfma_f32_16x16x32_bf16 a[24:27], v[48:51], v[104:107], a[24:27]
v_mfma_f32_16x16x32_bf16 a[56:59], v[52:55], v[104:107], a[56:59]
v_mfma_f32_16x16x32_bf16 a[88:91], v[56:59], v[104:107], a[88:91]
v_mfma_f32_16x16x32_bf16 a[120:123], v[60:63], v[104:107], a[120:123]
s_waitcnt lgkmcnt(0)
v_mfma_f32_16x16x32_bf16 a[28:31], v[48:51], v[108:111], a[28:31]
v_mfma_f32_16x16x32_bf16 a[60:63], v[52:55], v[108:111], a[60:63]
v_mfma_f32_16x16x32_bf16 a[92:95], v[56:59], v[108:111], a[92:95]
v_mfma_f32_16x16x32_bf16 a[124:127], v[60:63], v[108:111], a[124:127]
s_lshl_b32 s42, s52, 2
s_add_u32 s42, s42, s29
s_lshl_b32 s42, s42, 6
s_add_u32 s42, s42, s53
s_lshl_b32 s42, s42, 14
s_add_u32 s42, s42, 33562624
s_nop 7
v_accvgpr_read_b32 v52, a0
v_accvgpr_read_b32 v56, a32
v_accvgpr_read_b32 v53, a1
v_accvgpr_read_b32 v57, a33
v_accvgpr_read_b32 v54, a2
v_accvgpr_read_b32 v58, a34
v_accvgpr_read_b32 v55, a3
v_accvgpr_read_b32 v59, a35
v_cvt_pk_bf16_f32 v48, v52, v53
v_cvt_pk_bf16_f32 v49, v54, v55
v_cvt_pk_bf16_f32 v50, v56, v57
v_cvt_pk_bf16_f32 v51, v58, v59
s_add_u32 s43, s42, 0
buffer_store_dwordx4 v[48:51], v40, s[8:11], s43 offen offset:0 sc1
v_accvgpr_read_b32 v64, a4
v_accvgpr_read_b32 v68, a36
v_accvgpr_read_b32 v65, a5
v_accvgpr_read_b32 v69, a37
v_accvgpr_read_b32 v66, a6
v_accvgpr_read_b32 v70, a38
v_accvgpr_read_b32 v67, a7
v_accvgpr_read_b32 v71, a39
v_cvt_pk_bf16_f32 v60, v64, v65
v_cvt_pk_bf16_f32 v61, v66, v67
v_cvt_pk_bf16_f32 v62, v68, v69
v_cvt_pk_bf16_f32 v63, v70, v71
s_add_u32 s43, s42, 0
buffer_store_dwordx4 v[60:63], v40, s[8:11], s43 offen offset:128 sc1
v_accvgpr_read_b32 v76, a8
v_accvgpr_read_b32 v80, a40
v_accvgpr_read_b32 v77, a9
v_accvgpr_read_b32 v81, a41
v_accvgpr_read_b32 v78, a10
v_accvgpr_read_b32 v82, a42
v_accvgpr_read_b32 v79, a11
v_accvgpr_read_b32 v83, a43
v_cvt_pk_bf16_f32 v72, v76, v77
v_cvt_pk_bf16_f32 v73, v78, v79
v_cvt_pk_bf16_f32 v74, v80, v81
v_cvt_pk_bf16_f32 v75, v82, v83
s_add_u32 s43, s42, 0
buffer_store_dwordx4 v[72:75], v40, s[8:11], s43 offen offset:2048 sc1
v_accvgpr_read_b32 v88, a12
v_accvgpr_read_b32 v92, a44
v_accvgpr_read_b32 v89, a13
v_accvgpr_read_b32 v93, a45
v_accvgpr_read_b32 v90, a14
v_accvgpr_read_b32 v94, a46
v_accvgpr_read_b32 v91, a15
v_accvgpr_read_b32 v95, a47
v_cvt_pk_bf16_f32 v84, v88, v89
v_cvt_pk_bf16_f32 v85, v90, v91
v_cvt_pk_bf16_f32 v86, v92, v93
v_cvt_pk_bf16_f32 v87, v94, v95
s_add_u32 s43, s42, 0
buffer_store_dwordx4 v[84:87], v40, s[8:11], s43 offen offset:2176 sc1
v_accvgpr_read_b32 v52, a16
v_accvgpr_read_b32 v56, a48
v_accvgpr_read_b32 v53, a17
v_accvgpr_read_b32 v57, a49
v_accvgpr_read_b32 v54, a18
v_accvgpr_read_b32 v58, a50
v_accvgpr_read_b32 v55, a19
v_accvgpr_read_b32 v59, a51
v_cvt_pk_bf16_f32 v48, v52, v53
v_cvt_pk_bf16_f32 v49, v54, v55
v_cvt_pk_bf16_f32 v50, v56, v57
v_cvt_pk_bf16_f32 v51, v58, v59
s_add_u32 s43, s42, 4096
buffer_store_dwordx4 v[48:51], v40, s[8:11], s43 offen offset:0 sc1
v_accvgpr_read_b32 v64, a20
v_accvgpr_read_b32 v68, a52
v_accvgpr_read_b32 v65, a21
v_accvgpr_read_b32 v69, a53
v_accvgpr_read_b32 v66, a22
v_accvgpr_read_b32 v70, a54
v_accvgpr_read_b32 v67, a23
v_accvgpr_read_b32 v71, a55
v_cvt_pk_bf16_f32 v60, v64, v65
v_cvt_pk_bf16_f32 v61, v66, v67
v_cvt_pk_bf16_f32 v62, v68, v69
v_cvt_pk_bf16_f32 v63, v70, v71
s_add_u32 s43, s42, 4096
buffer_store_dwordx4 v[60:63], v40, s[8:11], s43 offen offset:128 sc1
v_accvgpr_read_b32 v76, a24
v_accvgpr_read_b32 v80, a56
v_accvgpr_read_b32 v77, a25
v_accvgpr_read_b32 v81, a57
v_accvgpr_read_b32 v78, a26
v_accvgpr_read_b32 v82, a58
v_accvgpr_read_b32 v79, a27
v_accvgpr_read_b32 v83, a59
v_cvt_pk_bf16_f32 v72, v76, v77
v_cvt_pk_bf16_f32 v73, v78, v79
v_cvt_pk_bf16_f32 v74, v80, v81
v_cvt_pk_bf16_f32 v75, v82, v83
s_add_u32 s43, s42, 4096
buffer_store_dwordx4 v[72:75], v40, s[8:11], s43 offen offset:2048 sc1
v_accvgpr_read_b32 v88, a28
v_accvgpr_read_b32 v92, a60
v_accvgpr_read_b32 v89, a29
v_accvgpr_read_b32 v93, a61
v_accvgpr_read_b32 v90, a30
v_accvgpr_read_b32 v94, a62
v_accvgpr_read_b32 v91, a31
v_accvgpr_read_b32 v95, a63
v_cvt_pk_bf16_f32 v84, v88, v89
v_cvt_pk_bf16_f32 v85, v90, v91
v_cvt_pk_bf16_f32 v86, v92, v93
v_cvt_pk_bf16_f32 v87, v94, v95
s_add_u32 s43, s42, 4096
buffer_store_dwordx4 v[84:87], v40, s[8:11], s43 offen offset:2176 sc1
v_accvgpr_read_b32 v52, a64
v_accvgpr_read_b32 v56, a96
v_accvgpr_read_b32 v53, a65
v_accvgpr_read_b32 v57, a97
v_accvgpr_read_b32 v54, a66
v_accvgpr_read_b32 v58, a98
v_accvgpr_read_b32 v55, a67
v_accvgpr_read_b32 v59, a99
v_cvt_pk_bf16_f32 v48, v52, v53
v_cvt_pk_bf16_f32 v49, v54, v55
v_cvt_pk_bf16_f32 v50, v56, v57
v_cvt_pk_bf16_f32 v51, v58, v59
s_add_u32 s43, s42, 524288
buffer_store_dwordx4 v[48:51], v40, s[8:11], s43 offen offset:0 sc1
v_accvgpr_read_b32 v64, a68
v_accvgpr_read_b32 v68, a100
v_accvgpr_read_b32 v65, a69
v_accvgpr_read_b32 v69, a101
v_accvgpr_read_b32 v66, a70
v_accvgpr_read_b32 v70, a102
v_accvgpr_read_b32 v67, a71
v_accvgpr_read_b32 v71, a103
v_cvt_pk_bf16_f32 v60, v64, v65
v_cvt_pk_bf16_f32 v61, v66, v67
v_cvt_pk_bf16_f32 v62, v68, v69
v_cvt_pk_bf16_f32 v63, v70, v71
s_add_u32 s43, s42, 524288
buffer_store_dwordx4 v[60:63], v40, s[8:11], s43 offen offset:128 sc1
v_accvgpr_read_b32 v76, a72
v_accvgpr_read_b32 v80, a104
v_accvgpr_read_b32 v77, a73
v_accvgpr_read_b32 v81, a105
v_accvgpr_read_b32 v78, a74
v_accvgpr_read_b32 v82, a106
v_accvgpr_read_b32 v79, a75
v_accvgpr_read_b32 v83, a107
v_cvt_pk_bf16_f32 v72, v76, v77
v_cvt_pk_bf16_f32 v73, v78, v79
v_cvt_pk_bf16_f32 v74, v80, v81
v_cvt_pk_bf16_f32 v75, v82, v83
s_add_u32 s43, s42, 524288
buffer_store_dwordx4 v[72:75], v40, s[8:11], s43 offen offset:2048 sc1
v_accvgpr_read_b32 v88, a76
v_accvgpr_read_b32 v92, a108
v_accvgpr_read_b32 v89, a77
v_accvgpr_read_b32 v93, a109
v_accvgpr_read_b32 v90, a78
v_accvgpr_read_b32 v94, a110
v_accvgpr_read_b32 v91, a79
v_accvgpr_read_b32 v95, a111
v_cvt_pk_bf16_f32 v84, v88, v89
v_cvt_pk_bf16_f32 v85, v90, v91
v_cvt_pk_bf16_f32 v86, v92, v93
v_cvt_pk_bf16_f32 v87, v94, v95
s_add_u32 s43, s42, 524288
buffer_store_dwordx4 v[84:87], v40, s[8:11], s43 offen offset:2176 sc1
v_accvgpr_read_b32 v52, a80
v_accvgpr_read_b32 v56, a112
v_accvgpr_read_b32 v53, a81
v_accvgpr_read_b32 v57, a113
v_accvgpr_read_b32 v54, a82
v_accvgpr_read_b32 v58, a114
v_accvgpr_read_b32 v55, a83
v_accvgpr_read_b32 v59, a115
v_cvt_pk_bf16_f32 v48, v52, v53
v_cvt_pk_bf16_f32 v49, v54, v55
v_cvt_pk_bf16_f32 v50, v56, v57
v_cvt_pk_bf16_f32 v51, v58, v59
s_add_u32 s43, s42, 528384
buffer_store_dwordx4 v[48:51], v40, s[8:11], s43 offen offset:0 sc1
v_accvgpr_read_b32 v64, a84
v_accvgpr_read_b32 v68, a116
v_accvgpr_read_b32 v65, a85
v_accvgpr_read_b32 v69, a117
v_accvgpr_read_b32 v66, a86
v_accvgpr_read_b32 v70, a118
v_accvgpr_read_b32 v67, a87
v_accvgpr_read_b32 v71, a119
v_cvt_pk_bf16_f32 v60, v64, v65
v_cvt_pk_bf16_f32 v61, v66, v67
v_cvt_pk_bf16_f32 v62, v68, v69
v_cvt_pk_bf16_f32 v63, v70, v71
s_add_u32 s43, s42, 528384
buffer_store_dwordx4 v[60:63], v40, s[8:11], s43 offen offset:128 sc1
v_accvgpr_read_b32 v76, a88
v_accvgpr_read_b32 v80, a120
v_accvgpr_read_b32 v77, a89
v_accvgpr_read_b32 v81, a121
v_accvgpr_read_b32 v78, a90
v_accvgpr_read_b32 v82, a122
v_accvgpr_read_b32 v79, a91
v_accvgpr_read_b32 v83, a123
v_cvt_pk_bf16_f32 v72, v76, v77
v_cvt_pk_bf16_f32 v73, v78, v79
v_cvt_pk_bf16_f32 v74, v80, v81
v_cvt_pk_bf16_f32 v75, v82, v83
s_add_u32 s43, s42, 528384
buffer_store_dwordx4 v[72:75], v40, s[8:11], s43 offen offset:2048 sc1
v_accvgpr_read_b32 v88, a92
v_accvgpr_read_b32 v92, a124
v_accvgpr_read_b32 v89, a93
v_accvgpr_read_b32 v93, a125
v_accvgpr_read_b32 v90, a94
v_accvgpr_read_b32 v94, a126
v_accvgpr_read_b32 v91, a95
v_accvgpr_read_b32 v95, a127
v_cvt_pk_bf16_f32 v84, v88, v89
v_cvt_pk_bf16_f32 v85, v90, v91
v_cvt_pk_bf16_f32 v86, v92, v93
v_cvt_pk_bf16_f32 v87, v94, v95
s_add_u32 s43, s42, 528384
buffer_store_dwordx4 v[84:87], v40, s[8:11], s43 offen offset:2176 sc1
L_w_KVd:
s_lshl_b32 s3, s52, 7
s_add_u32 s3, s3, 2048
s_waitcnt vmcnt(0)
s_barrier
s_cmp_lg_u32 s29, 0
s_cbranch_scc1 SG_65
v_mov_b32 v2, s3
v_mov_b32 v4, 1
s_mov_b32 s42, 4194304
s_mov_b64 exec, 1
buffer_atomic_add v4, v2, s[84:87], s42 offen sc1
s_mov_b64 exec, -1
SG_65:
s_getpc_b64 s[90:91]
LJ_66:
s_add_u32 s90, s90, L_m_next-LJ_66
s_addc_u32 s91, s91, -1
s_setpc_b64 s[90:91]
L_w_Q:
s_load_dwordx2 s[16:17], s[0:1], 16
v_and_b32 v34, 63, v0
v_lshlrev_b32 v1, 4, v34
s_mul_i32 s42, s29, 256
s_add_u32 s42, s42, 0
v_add_u32 v35, s42, v34
v_lshrrev_b32 v36, 4, v35
v_and_b32 v37, 15, v35
v_lshrrev_b32 v38, 2, v36
v_lshrrev_b32 v39, 3, v36
v_xor_b32 v38, v38, v39
v_and_b32 v38, 1, v38
v_and_b32 v39, 3, v36
v_lshl_or_b32 v38, v38, 2, v39
v_lshlrev_b32 v38, 1, v38
v_xor_b32 v37, v37, v38
s_mov_b32 s42, 8192
v_mul_lo_u32 v36, v36, s42
v_lshl_add_u32 v2, v37, 4, v36
s_mul_i32 s42, s29, 256
s_add_u32 s42, s42, 64
v_add_u32 v35, s42, v34
v_lshrrev_b32 v36, 4, v35
v_and_b32 v37, 15, v35
v_lshrrev_b32 v38, 2, v36
v_lshrrev_b32 v39, 3, v36
v_xor_b32 v38, v38, v39
v_and_b32 v38, 1, v38
v_and_b32 v39, 3, v36
v_lshl_or_b32 v38, v38, 2, v39
v_lshlrev_b32 v38, 1, v38
v_xor_b32 v37, v37, v38
s_mov_b32 s42, 8192
v_mul_lo_u32 v36, v36, s42
v_lshl_add_u32 v3, v37, 4, v36
s_mul_i32 s42, s29, 256
s_add_u32 s42, s42, 128
v_add_u32 v35, s42, v34
v_lshrrev_b32 v36, 4, v35
v_and_b32 v37, 15, v35
v_lshrrev_b32 v38, 2, v36
v_lshrrev_b32 v39, 3, v36
v_xor_b32 v38, v38, v39
v_and_b32 v38, 1, v38
v_and_b32 v39, 3, v36
v_lshl_or_b32 v38, v38, 2, v39
v_lshlrev_b32 v38, 1, v38
v_xor_b32 v37, v37, v38
s_mov_b32 s42, 8192
v_mul_lo_u32 v36, v36, s42
v_lshl_add_u32 v4, v37, 4, v36
s_mul_i32 s42, s29, 256
s_add_u32 s42, s42, 192
v_add_u32 v35, s42, v34
v_lshrrev_b32 v36, 4, v35
v_and_b32 v37, 15, v35
v_lshrrev_b32 v38, 2, v36
v_lshrrev_b32 v39, 3, v36
v_xor_b32 v38, v38, v39
v_and_b32 v38, 1, v38
v_and_b32 v39, 3, v36
v_lshl_or_b32 v38, v38, 2, v39
v_lshlrev_b32 v38, 1, v38
v_xor_b32 v37, v37, v38
s_mov_b32 s42, 8192
v_mul_lo_u32 v36, v36, s42
v_lshl_add_u32 v5, v37, 4, v36
v_bfe_u32 v35, v34, 2, 2
v_lshrrev_b32 v36, 4, v34
v_lshl_add_u32 v37, v36, 3, v35
v_lshrrev_b32 v38, 2, v37
v_lshrrev_b32 v39, 3, v37
v_xor_b32 v38, v38, v39
v_and_b32 v38, 1, v38
v_and_b32 v39, 3, v37
v_lshl_or_b32 v38, v38, 2, v39
v_mul_u32_u24 v37, 256, v37
v_and_b32 v39, 3, v34
v_lshl_add_u32 v37, v39, 3, v37
v_xor_b32 v39, 0, v38
v_lshl_add_u32 v18, v39, 5, v37
v_xor_b32 v39, 1, v38
v_lshl_add_u32 v19, v39, 5, v37
v_xor_b32 v39, 2, v38
v_lshl_add_u32 v20, v39, 5, v37
v_xor_b32 v39, 3, v38
v_lshl_add_u32 v21, v39, 5, v37
v_xor_b32 v39, 4, v38
v_lshl_add_u32 v22, v39, 5, v37
v_xor_b32 v39, 5, v38
v_lshl_add_u32 v23, v39, 5, v37
v_xor_b32 v39, 6, v38
v_lshl_add_u32 v24, v39, 5, v37
v_xor_b32 v39, 7, v38
v_lshl_add_u32 v25, v39, 5, v37
v_lshl_add_u32 v37, v36, 3, v35
v_add_u32 v37, 4, v37
v_lshrrev_b32 v38, 2, v37
v_lshrrev_b32 v39, 3, v37
v_xor_b32 v38, v38, v39
v_and_b32 v38, 1, v38
v_and_b32 v39, 3, v37
v_lshl_or_b32 v38, v38, 2, v39
v_mul_u32_u24 v37, 256, v37
v_and_b32 v39, 3, v34
v_lshl_add_u32 v37, v39, 3, v37
v_xor_b32 v39, 0, v38
v_lshl_add_u32 v26, v39, 5, v37
v_xor_b32 v39, 1, v38
v_lshl_add_u32 v27, v39, 5, v37
v_xor_b32 v39, 2, v38
v_lshl_add_u32 v28, v39, 5, v37
v_xor_b32 v39, 3, v38
v_lshl_add_u32 v29, v39, 5, v37
v_xor_b32 v39, 4, v38
v_lshl_add_u32 v30, v39, 5, v37
v_xor_b32 v39, 5, v38
v_lshl_add_u32 v31, v39, 5, v37
v_xor_b32 v39, 6, v38
v_lshl_add_u32 v32, v39, 5, v37
v_xor_b32 v39, 7, v38
v_lshl_add_u32 v33, v39, 5, v37
s_and_b32 s53, s3, 31
s_lshr_b32 s52, s3, 5
s_waitcnt lgkmcnt(0)
s_mov_b32 s12, s16
s_and_b32 s13, s17, 0xffff
s_mov_b32 s14, 0x400000
s_mov_b32 s15, 0x00020000
s_lshl_b32 s48, s52, 2
s_add_u32 s48, s48, s29
s_lshl_b32 s48, s48, 16
s_add_u32 s48, s48, 0
s_lshl_b32 s49, s53, 8
s_mul_i32 s51, s29, 4096
s_add_u32 s42, s49, 0
s_add_u32 m0, s51, 0
s_nop 0
buffer_load_dwordx4 v2, s[12:15], s42 offen lds
s_add_u32 m0, s51, 1024
s_nop 0
buffer_load_dwordx4 v3, s[12:15], s42 offen lds
s_add_u32 m0, s51, 2048
s_nop 0
buffer_load_dwordx4 v4, s[12:15], s42 offen lds
s_add_u32 m0, s51, 3072
s_nop 0
buffer_load_dwordx4 v5, s[12:15], s42 offen lds
s_add_u32 s42, s49, 524288
s_add_u32 m0, s51, 16384
s_nop 0
buffer_load_dwordx4 v2, s[12:15], s42 offen lds
s_add_u32 m0, s51, 17408
s_nop 0
buffer_load_dwordx4 v3, s[12:15], s42 offen lds
s_add_u32 m0, s51, 18432
s_nop 0
buffer_load_dwordx4 v4, s[12:15], s42 offen lds
s_add_u32 m0, s51, 19456
s_nop 0
buffer_load_dwordx4 v5, s[12:15], s42 offen lds
buffer_load_dwordx4 v[48:51], v1, s[8:11], s48 offen offset:0
s_add_u32 s43, s48, 16384
buffer_load_dwordx4 v[52:55], v1, s[8:11], s43 offen offset:0
s_add_u32 s43, s48, 32768
buffer_load_dwordx4 v[56:59], v1, s[8:11], s43 offen offset:0
s_add_u32 s43, s48, 49152
buffer_load_dwordx4 v[60:63], v1, s[8:11], s43 offen offset:0
buffer_load_dwordx4 v[64:67], v1, s[8:11], s48 offen offset:1024
s_add_u32 s43, s48, 16384
buffer_load_dwordx4 v[68:71], v1, s[8:11], s43 offen offset:1024
s_add_u32 s43, s48, 32768
buffer_load_dwordx4 v[72:75], v1, s[8:11], s43 offen offset:1024
s_add_u32 s43, s48, 49152
buffer_load_dwordx4 v[76:79], v1, s[8:11], s43 offen offset:1024
buffer_load_dwordx4 v[80:83], v1, s[8:11], s48 offen offset:2048
s_add_u32 s43, s48, 16384
buffer_load_dwordx4 v[84:87], v1, s[8:11], s43 offen offset:2048
s_add_u32 s43, s48, 32768
buffer_load_dwordx4 v[88:91], v1, s[8:11], s43 offen offset:2048
s_add_u32 s43, s48, 49152
buffer_load_dwordx4 v[92:95], v1, s[8:11], s43 offen offset:2048
s_waitcnt vmcnt(16)
s_barrier
s_add_u32 s42, s49, 1048576
s_add_u32 m0, s51, 32768
s_nop 0
buffer_load_dwordx4 v2, s[12:15], s42 offen lds
s_add_u32 m0, s51, 33792
s_nop 0
buffer_load_dwordx4 v3, s[12:15], s42 offen lds
s_add_u32 m0, s51, 34816
s_nop 0
buffer_load_dwordx4 v4, s[12:15], s42 offen lds
s_add_u32 m0, s51, 35840
s_nop 0
buffer_load_dwordx4 v5, s[12:15], s42 offen lds
ds_read_b64_tr_b16 v[96:97], v18 offset:0
ds_read_b64_tr_b16 v[98:99], v26 offset:0
ds_read_b64_tr_b16 v[100:101], v19 offset:0
ds_read_b64_tr_b16 v[102:103], v27 offset:0
ds_read_b64_tr_b16 v[104:105], v20 offset:0
ds_read_b64_tr_b16 v[106:107], v28 offset:0
ds_read_b64_tr_b16 v[108:109], v21 offset:0
ds_read_b64_tr_b16 v[110:111], v29 offset:0
s_waitcnt vmcnt(12)
s_waitcnt lgkmcnt(6)
v_mfma_f32_16x16x32_bf16 a[0:3], v[96:99], v[48:51], 0
v_mfma_f32_16x16x32_bf16 a[32:35], v[96:99], v[52:55], 0
v_mfma_f32_16x16x32_bf16 a[64:67], v[96:99], v[56:59], 0
v_mfma_f32_16x16x32_bf16 a[96:99], v[96:99], v[60:63], 0
ds_read_b64_tr_b16 v[96:97], v22 offset:0
ds_read_b64_tr_b16 v[98:99], v30 offset:0
s_waitcnt lgkmcnt(6)
v_mfma_f32_16x16x32_bf16 a[4:7], v[100:103], v[48:51], 0
v_mfma_f32_16x16x32_bf16 a[36:39], v[100:103], v[52:55], 0
v_mfma_f32_16x16x32_bf16 a[68:71], v[100:103], v[56:59], 0
v_mfma_f32_16x16x32_bf16 a[100:103], v[100:103], v[60:63], 0
ds_read_b64_tr_b16 v[100:101], v23 offset:0
ds_read_b64_tr_b16 v[102:103], v31 offset:0
s_waitcnt lgkmcnt(6)
v_mfma_f32_16x16x32_bf16 a[8:11], v[104:107], v[48:51], 0
v_mfma_f32_16x16x32_bf16 a[40:43], v[104:107], v[52:55], 0
v_mfma_f32_16x16x32_bf16 a[72:75], v[104:107], v[56:59], 0
v_mfma_f32_16x16x32_bf16 a[104:107], v[104:107], v[60:63], 0
ds_read_b64_tr_b16 v[104:105], v24 offset:0
ds_read_b64_tr_b16 v[106:107], v32 offset:0
s_waitcnt lgkmcnt(6)
v_mfma_f32_16x16x32_bf16 a[12:15], v[108:111], v[48:51], 0
v_mfma_f32_16x16x32_bf16 a[44:47], v[108:111], v[52:55], 0
v_mfma_f32_16x16x32_bf16 a[76:79], v[108:111], v[56:59], 0
v_mfma_f32_16x16x32_bf16 a[108:111], v[108:111], v[60:63], 0
ds_read_b64_tr_b16 v[108:109], v25 offset:0
ds_read_b64_tr_b16 v[110:111], v33 offset:0
s_waitcnt lgkmcnt(6)
v_mfma_f32_16x16x32_bf16 a[16:19], v[96:99], v[48:51], 0
v_mfma_f32_16x16x32_bf16 a[48:51], v[96:99], v[52:55], 0
v_mfma_f32_16x16x32_bf16 a[80:83], v[96:99], v[56:59], 0
v_mfma_f32_16x16x32_bf16 a[112:115], v[96:99], v[60:63], 0
ds_read_b64_tr_b16 v[96:97], v18 offset:8192
ds_read_b64_tr_b16 v[98:99], v26 offset:8192
s_waitcnt lgkmcnt(6)
v_mfma_f32_16x16x32_bf16 a[20:23], v[100:103], v[48:51], 0
v_mfma_f32_16x16x32_bf16 a[52:55], v[100:103], v[52:55], 0
v_mfma_f32_16x16x32_bf16 a[84:87], v[100:103], v[56:59], 0
v_mfma_f32_16x16x32_bf16 a[116:119], v[100:103], v[60:63], 0
ds_read_b64_tr_b16 v[100:101], v19 offset:8192
ds_read_b64_tr_b16 v[102:103], v27 offset:8192
s_waitcnt lgkmcnt(6)
v_mfma_f32_16x16x32_bf16 a[24:27], v[104:107], v[48:51], 0
v_mfma_f32_16x16x32_bf16 a[56:59], v[104:107], v[52:55], 0
v_mfma_f32_16x16x32_bf16 a[88:91], v[104:107], v[56:59], 0
v_mfma_f32_16x16x32_bf16 a[120:123], v[104:107], v[60:63], 0
ds_read_b64_tr_b16 v[104:105], v20 offset:8192
ds_read_b64_tr_b16 v[106:107], v28 offset:8192
s_waitcnt lgkmcnt(6)
v_mfma_f32_16x16x32_bf16 a[28:31], v[108:111], v[48:51], 0
v_mfma_f32_16x16x32_bf16 a[60:63], v[108:111], v[52:55], 0
v_mfma_f32_16x16x32_bf16 a[92:95], v[108:111], v[56:59], 0
v_mfma_f32_16x16x32_bf16 a[124:127], v[108:111], v[60:63], 0
buffer_load_dwordx4 v[48:51], v1, s[8:11], s48 offen offset:3072
s_add_u32 s43, s48, 16384
buffer_load_dwordx4 v[52:55], v1, s[8:11], s43 offen offset:3072
s_add_u32 s43, s48, 32768
buffer_load_dwordx4 v[56:59], v1, s[8:11], s43 offen offset:3072
s_add_u32 s43, s48, 49152
buffer_load_dwordx4 v[60:63], v1, s[8:11], s43 offen offset:3072
ds_read_b64_tr_b16 v[108:109], v21 offset:8192
ds_read_b64_tr_b16 v[110:111], v29 offset:8192
s_waitcnt vmcnt(12)
s_waitcnt lgkmcnt(6)
v_mfma_f32_16x16x32_bf16 a[0:3], v[96:99], v[64:67], a[0:3]
v_mfma_f32_16x16x32_bf16 a[32:35], v[96:99], v[68:71], a[32:35]
v_mfma_f32_16x16x32_bf16 a[64:67], v[96:99], v[72:75], a[64:67]
v_mfma_f32_16x16x32_bf16 a[96:99], v[96:99], v[76:79], a[96:99]
ds_read_b64_tr_b16 v[96:97], v22 offset:8192
ds_read_b64_tr_b16 v[98:99], v30 offset:8192
s_waitcnt lgkmcnt(6)
v_mfma_f32_16x16x32_bf16 a[4:7], v[100:103], v[64:67], a[4:7]
v_mfma_f32_16x16x32_bf16 a[36:39], v[100:103], v[68:71], a[36:39]
v_mfma_f32_16x16x32_bf16 a[68:71], v[100:103], v[72:75], a[68:71]
v_mfma_f32_16x16x32_bf16 a[100:103], v[100:103], v[76:79], a[100:103]
ds_read_b64_tr_b16 v[100:101], v23 offset:8192
ds_read_b64_tr_b16 v[102:103], v31 offset:8192
s_waitcnt lgkmcnt(6)
v_mfma_f32_16x16x32_bf16 a[8:11], v[104:107], v[64:67], a[8:11]
v_mfma_f32_16x16x32_bf16 a[40:43], v[104:107], v[68:71], a[40:43]
v_mfma_f32_16x16x32_bf16 a[72:75], v[104:107], v[72:75], a[72:75]
v_mfma_f32_16x16x32_bf16 a[104:107], v[104:107], v[76:79], a[104:107]
ds_read_b64_tr_b16 v[104:105], v24 offset:8192
ds_read_b64_tr_b16 v[106:107], v32 offset:8192
s_waitcnt lgkmcnt(6)
v_mfma_f32_16x16x32_bf16 a[12:15], v[108:111], v[64:67], a[12:15]
v_mfma_f32_16x16x32_bf16 a[44:47], v[108:111], v[68:71], a[44:47]
v_mfma_f32_16x16x32_bf16 a[76:79], v[108:111], v[72:75], a[76:79]
v_mfma_f32_16x16x32_bf16 a[108:111], v[108:111], v[76:79], a[108:111]
ds_read_b64_tr_b16 v[108:109], v25 offset:8192
ds_read_b64_tr_b16 v[110:111], v33 offset:8192
s_waitcnt lgkmcnt(6)
v_mfma_f32_16x16x32_bf16 a[16:19], v[96:99], v[64:67], a[16:19]
v_mfma_f32_16x16x32_bf16 a[48:51], v[96:99], v[68:71], a[48:51]
v_mfma_f32_16x16x32_bf16 a[80:83], v[96:99], v[72:75], a[80:83]
v_mfma_f32_16x16x32_bf16 a[112:115], v[96:99], v[76:79], a[112:115]
s_barrier
s_add_u32 s42, s49, 1572864
s_add_u32 m0, s51, 49152
s_nop 0
buffer_load_dwordx4 v2, s[12:15], s42 offen lds
s_add_u32 m0, s51, 50176
s_nop 0
buffer_load_dwordx4 v3, s[12:15], s42 offen lds
s_add_u32 m0, s51, 51200
s_nop 0
buffer_load_dwordx4 v4, s[12:15], s42 offen lds
s_add_u32 m0, s51, 52224
s_nop 0
buffer_load_dwordx4 v5, s[12:15], s42 offen lds
ds_read_b64_tr_b16 v[96:97], v18 offset:16384
ds_read_b64_tr_b16 v[98:99], v26 offset:16384
s_waitcnt lgkmcnt(6)
v_mfma_f32_16x16x32_bf16 a[20:23], v[100:103], v[64:67], a[20:23]
v_mfma_f32_16x16x32_bf16 a[52:55], v[100:103], v[68:71], a[52:55]
v_mfma_f32_16x16x32_bf16 a[84:87], v[100:103], v[72:75], a[84:87]
v_mfma_f32_16x16x32_bf16 a[116:119], v[100:103], v[76:79], a[116:119]
ds_read_b64_tr_b16 v[100:101], v19 offset:16384
ds_read_b64_tr_b16 v[102:103], v27 offset:16384
s_waitcnt lgkmcnt(6)
v_mfma_f32_16x16x32_bf16 a[24:27], v[104:107], v[64:67], a[24:27]
v_mfma_f32_16x16x32_bf16 a[56:59], v[104:107], v[68:71], a[56:59]
v_mfma_f32_16x16x32_bf16 a[88:91], v[104:107], v[72:75], a[88:91]
v_mfma_f32_16x16x32_bf16 a[120:123], v[104:107], v[76:79], a[120:123]
ds_read_b64_tr_b16 v[104:105], v20 offset:16384
ds_read_b64_tr_b16 v[106:107], v28 offset:16384
s_waitcnt lgkmcnt(6)
v_mfma_f32_16x16x32_bf16 a[28:31], v[108:111], v[64:67], a[28:31]
v_mfma_f32_16x16x32_bf16 a[60:63], v[108:111], v[68:71], a[60:63]
v_mfma_f32_16x16x32_bf16 a[92:95], v[108:111], v[72:75], a[92:95]
v_mfma_f32_16x16x32_bf16 a[124:127], v[108:111], v[76:79], a[124:127]
s_add_u32 s43, s48, 4096
buffer_load_dwordx4 v[64:67], v1, s[8:11], s43 offen offset:0
s_add_u32 s43, s48, 20480
buffer_load_dwordx4 v[68:71], v1, s[8:11], s43 offen offset:0
s_add_u32 s43, s48, 36864
buffer_load_dwordx4 v[72:75], v1, s[8:11], s43 offen offset:0
s_add_u32 s43, s48, 53248
buffer_load_dwordx4 v[76:79], v1, s[8:11], s43 offen offset:0
ds_read_b64_tr_b16 v[108:109], v21 offset:16384
ds_read_b64_tr_b16 v[110:111], v29 offset:16384
s_waitcnt vmcnt(16)
s_waitcnt lgkmcnt(6)
v_mfma_f32_16x16x32_bf16 a[0:3], v[96:99], v[80:83], a[0:3]
v_mfma_f32_16x16x32_bf16 a[32:35], v[96:99], v[84:87], a[32:35]
v_mfma_f32_16x16x32_bf16 a[64:67], v[96:99], v[88:91], a[64:67]
v_mfma_f32_16x16x32_bf16 a[96:99], v[96:99], v[92:95], a[96:99]
ds_read_b64_tr_b16 v[96:97], v22 offset:16384
ds_read_b64_tr_b16 v[98:99], v30 offset:16384
s_waitcnt lgkmcnt(6)
v_mfma_f32_16x16x32_bf16 a[4:7], v[100:103], v[80:83], a[4:7]
v_mfma_f32_16x16x32_bf16 a[36:39], v[100:103], v[84:87], a[36:39]
v_mfma_f32_16x16x32_bf16 a[68:71], v[100:103], v[88:91], a[68:71]
v_mfma_f32_16x16x32_bf16 a[100:103], v[100:103], v[92:95], a[100:103]
ds_read_b64_tr_b16 v[100:101], v23 offset:16384
ds_read_b64_tr_b16 v[102:103], v31 offset:16384
s_waitcnt lgkmcnt(6)
v_mfma_f32_16x16x32_bf16 a[8:11], v[104:107], v[80:83], a[8:11]
v_mfma_f32_16x16x32_bf16 a[40:43], v[104:107], v[84:87], a[40:43]
v_mfma_f32_16x16x32_bf16 a[72:75], v[104:107], v[88:91], a[72:75]
v_mfma_f32_16x16x32_bf16 a[104:107], v[104:107], v[92:95], a[104:107]
ds_read_b64_tr_b16 v[104:105], v24 offset:16384
ds_read_b64_tr_b16 v[106:107], v32 offset:16384
s_waitcnt lgkmcnt(6)
v_mfma_f32_16x16x32_bf16 a[12:15], v[108:111], v[80:83], a[12:15]
v_mfma_f32_16x16x32_bf16 a[44:47], v[108:111], v[84:87], a[44:47]
v_mfma_f32_16x16x32_bf16 a[76:79], v[108:111], v[88:91], a[76:79]
v_mfma_f32_16x16x32_bf16 a[108:111], v[108:111], v[92:95], a[108:111]
ds_read_b64_tr_b16 v[108:109], v25 offset:16384
ds_read_b64_tr_b16 v[110:111], v33 offset:16384
s_waitcnt lgkmcnt(6)
v_mfma_f32_16x16x32_bf16 a[16:19], v[96:99], v[80:83], a[16:19]
v_mfma_f32_16x16x32_bf16 a[48:51], v[96:99], v[84:87], a[48:51]
v_mfma_f32_16x16x32_bf16 a[80:83], v[96:99], v[88:91], a[80:83]
v_mfma_f32_16x16x32_bf16 a[112:115], v[96:99], v[92:95], a[112:115]
ds_read_b64_tr_b16 v[96:97], v18 offset:24576
ds_read_b64_tr_b16 v[98:99], v26 offset:24576
s_waitcnt lgkmcnt(6)
v_mfma_f32_16x16x32_bf16 a[20:23], v[100:103], v[80:83], a[20:23]
v_mfma_f32_16x16x32_bf16 a[52:55], v[100:103], v[84:87], a[52:55]
v_mfma_f32_16x16x32_bf16 a[84:87], v[100:103], v[88:91], a[84:87]
v_mfma_f32_16x16x32_bf16 a[116:119], v[100:103], v[92:95], a[116:119]
ds_read_b64_tr_b16 v[100:101], v19 offset:24576
ds_read_b64_tr_b16 v[102:103], v27 offset:24576
s_waitcnt lgkmcnt(6)
v_mfma_f32_16x16x32_bf16 a[24:27], v[104:107], v[80:83], a[24:27]
v_mfma_f32_16x16x32_bf16 a[56:59], v[104:107], v[84:87], a[56:59]
v_mfma_f32_16x16x32_bf16 a[88:91], v[104:107], v[88:91], a[88:91]
v_mfma_f32_16x16x32_bf16 a[120:123], v[104:107], v[92:95], a[120:123]
ds_read_b64_tr_b16 v[104:105], v20 offset:24576
ds_read_b64_tr_b16 v[106:107], v28 offset:24576
s_waitcnt lgkmcnt(6)
v_mfma_f32_16x16x32_bf16 a[28:31], v[108:111], v[80:83], a[28:31]
v_mfma_f32_16x16x32_bf16 a[60:63], v[108:111], v[84:87], a[60:63]
v_mfma_f32_16x16x32_bf16 a[92:95], v[108:111], v[88:91], a[92:95]
v_mfma_f32_16x16x32_bf16 a[124:127], v[108:111], v[92:95], a[124:127]
s_add_u32 s43, s48, 4096
buffer_load_dwordx4 v[80:83], v1, s[8:11], s43 offen offset:1024
s_add_u32 s43, s48, 20480
buffer_load_dwordx4 v[84:87], v1, s[8:11], s43 offen offset:1024
s_add_u32 s43, s48, 36864
buffer_load_dwordx4 v[88:91], v1, s[8:11], s43 offen offset:1024
s_add_u32 s43, s48, 53248
buffer_load_dwordx4 v[92:95], v1, s[8:11], s43 offen offset:1024
ds_read_b64_tr_b16 v[108:109], v21 offset:24576
ds_read_b64_tr_b16 v[110:111], v29 offset:24576
s_waitcnt vmcnt(12)
s_waitcnt lgkmcnt(6)
v_mfma_f32_16x16x32_bf16 a[0:3], v[96:99], v[48:51], a[0:3]
v_mfma_f32_16x16x32_bf16 a[32:35], v[96:99], v[52:55], a[32:35]
v_mfma_f32_16x16x32_bf16 a[64:67], v[96:99], v[56:59], a[64:67]
v_mfma_f32_16x16x32_bf16 a[96:99], v[96:99], v[60:63], a[96:99]
ds_read_b64_tr_b16 v[96:97], v22 offset:24576
ds_read_b64_tr_b16 v[98:99], v30 offset:24576
s_waitcnt lgkmcnt(6)
v_mfma_f32_16x16x32_bf16 a[4:7], v[100:103], v[48:51], a[4:7]
v_mfma_f32_16x16x32_bf16 a[36:39], v[100:103], v[52:55], a[36:39]
v_mfma_f32_16x16x32_bf16 a[68:71], v[100:103], v[56:59], a[68:71]
v_mfma_f32_16x16x32_bf16 a[100:103], v[100:103], v[60:63], a[100:103]
ds_read_b64_tr_b16 v[100:101], v23 offset:24576
ds_read_b64_tr_b16 v[102:103], v31 offset:24576
s_waitcnt lgkmcnt(6)
v_mfma_f32_16x16x32_bf16 a[8:11], v[104:107], v[48:51], a[8:11]
v_mfma_f32_16x16x32_bf16 a[40:43], v[104:107], v[52:55], a[40:43]
v_mfma_f32_16x16x32_bf16 a[72:75], v[104:107], v[56:59], a[72:75]
v_mfma_f32_16x16x32_bf16 a[104:107], v[104:107], v[60:63], a[104:107]
ds_read_b64_tr_b16 v[104:105], v24 offset:24576
ds_read_b64_tr_b16 v[106:107], v32 offset:24576
s_waitcnt lgkmcnt(6)
v_mfma_f32_16x16x32_bf16 a[12:15], v[108:111], v[48:51], a[12:15]
v_mfma_f32_16x16x32_bf16 a[44:47], v[108:111], v[52:55], a[44:47]
v_mfma_f32_16x16x32_bf16 a[76:79], v[108:111], v[56:59], a[76:79]
v_mfma_f32_16x16x32_bf16 a[108:111], v[108:111], v[60:63], a[108:111]
ds_read_b64_tr_b16 v[108:109], v25 offset:24576
ds_read_b64_tr_b16 v[110:111], v33 offset:24576
s_waitcnt lgkmcnt(6)
v_mfma_f32_16x16x32_bf16 a[16:19], v[96:99], v[48:51], a[16:19]
v_mfma_f32_16x16x32_bf16 a[48:51], v[96:99], v[52:55], a[48:51]
v_mfma_f32_16x16x32_bf16 a[80:83], v[96:99], v[56:59], a[80:83]
v_mfma_f32_16x16x32_bf16 a[112:115], v[96:99], v[60:63], a[112:115]
s_barrier
s_add_u32 s42, s49, 2097152
s_add_u32 m0, s51, 0
s_nop 0
buffer_load_dwordx4 v2, s[12:15], s42 offen lds
s_add_u32 m0, s51, 1024
s_nop 0
buffer_load_dwordx4 v3, s[12:15], s42 offen lds
s_add_u32 m0, s51, 2048
s_nop 0
buffer_load_dwordx4 v4, s[12:15], s42 offen lds
s_add_u32 m0, s51, 3072
s_nop 0
buffer_load_dwordx4 v5, s[12:15], s42 offen lds
ds_read_b64_tr_b16 v[96:97], v18 offset:32768
ds_read_b64_tr_b16 v[98:99], v26 offset:32768
s_waitcnt lgkmcnt(6)
v_mfma_f32_16x16x32_bf16 a[20:23], v[100:103], v[48:51], a[20:23]
v_mfma_f32_16x16x32_bf16 a[52:55], v[100:103], v[52:55], a[52:55]
v_mfma_f32_16x16x32_bf16 a[84:87], v[100:103], v[56:59], a[84:87]
v_mfma_f32_16x16x32_bf16 a[116:119], v[100:103], v[60:63], a[116:119]
ds_read_b64_tr_b16 v[100:101], v19 offset:32768
ds_read_b64_tr_b16 v[102:103], v27 offset:32768
s_waitcnt lgkmcnt(6)
v_mfma_f32_16x16x32_bf16 a[24:27], v[104:107], v[48:51], a[24:27]
v_mfma_f32_16x16x32_bf16 a[56:59], v[104:107], v[52:55], a[56:59]
v_mfma_f32_16x16x32_bf16 a[88:91], v[104:107], v[56:59], a[88:91]
v_mfma_f32_16x16x32_bf16 a[120:123], v[104:107], v[60:63], a[120:123]
ds_read_b64_tr_b16 v[104:105], v20 offset:32768
ds_read_b64_tr_b16 v[106:107], v28 offset:32768
s_waitcnt lgkmcnt(6)
v_mfma_f32_16x16x32_bf16 a[28:31], v[108:111], v[48:51], a[28:31]
v_mfma_f32_16x16x32_bf16 a[60:63], v[108:111], v[52:55], a[60:63]
v_mfma_f32_16x16x32_bf16 a[92:95], v[108:111], v[56:59], a[92:95]
v_mfma_f32_16x16x32_bf16 a[124:127], v[108:111], v[60:63], a[124:127]
s_add_u32 s43, s48, 4096
buffer_load_dwordx4 v[48:51], v1, s[8:11], s43 offen offset:2048
s_add_u32 s43, s48, 20480
buffer_load_dwordx4 v[52:55], v1, s[8:11], s43 offen offset:2048
s_add_u32 s43, s48, 36864
buffer_load_dwordx4 v[56:59], v1, s[8:11], s43 offen offset:2048
s_add_u32 s43, s48, 53248
buffer_load_dwordx4 v[60:63], v1, s[8:11], s43 offen offset:2048
ds_read_b64_tr_b16 v[108:109], v21 offset:32768
ds_read_b64_tr_b16 v[110:111], v29 offset:32768
s_waitcnt vmcnt(12)
s_waitcnt lgkmcnt(6)
v_mfma_f32_16x16x32_bf16 a[0:3], v[96:99], v[64:67], a[0:3]
v_mfma_f32_16x16x32_bf16 a[32:35], v[96:99], v[68:71], a[32:35]
v_mfma_f32_16x16x32_bf16 a[64:67], v[96:99], v[72:75], a[64:67]
v_mfma_f32_16x16x32_bf16 a[96:99], v[96:99], v[76:79], a[96:99]
ds_read_b64_tr_b16 v[96:97], v22 offset:32768
ds_read_b64_tr_b16 v[98:99], v30 offset:32768
s_waitcnt lgkmcnt(6)
v_mfma_f32_16x16x32_bf16 a[4:7], v[100:103], v[64:67], a[4:7]
v_mfma_f32_16x16x32_bf16 a[36:39], v[100:103], v[68:71], a[36:39]
v_mfma_f32_16x16x32_bf16 a[68:71], v[100:103], v[72:75], a[68:71]
v_mfma_f32_16x16x32_bf16 a[100:103], v[100:103], v[76:79], a[100:103]
ds_read_b64_tr_b16 v[100:101], v23 offset:32768
ds_read_b64_tr_b16 v[102:103], v31 offset:32768
s_waitcnt lgkmcnt(6)
v_mfma_f32_16x16x32_bf16 a[8:11], v[104:107], v[64:67], a[8:11]
v_mfma_f32_16x16x32_bf16 a[40:43], v[104:107], v[68:71], a[40:43]
v_mfma_f32_16x16x32_bf16 a[72:75], v[104:107], v[72:75], a[72:75]
v_mfma_f32_16x16x32_bf16 a[104:107], v[104:107], v[76:79], a[104:107]
ds_read_b64_tr_b16 v[104:105], v24 offset:32768
ds_read_b64_tr_b16 v[106:107], v32 offset:32768
s_waitcnt lgkmcnt(6)
v_mfma_f32_16x16x32_bf16 a[12:15], v[108:111], v[64:67], a[12:15]
v_mfma_f32_16x16x32_bf16 a[44:47], v[108:111], v[68:71], a[44:47]
v_mfma_f32_16x16x32_bf16 a[76:79], v[108:111], v[72:75], a[76:79]
v_mfma_f32_16x16x32_bf16 a[108:111], v[108:111], v[76:79], a[108:111]
ds_read_b64_tr_b16 v[108:109], v25 offset:32768
ds_read_b64_tr_b16 v[110:111], v33 offset:32768
s_waitcnt lgkmcnt(6)
v_mfma_f32_16x16x32_bf16 a[16:19], v[96:99], v[64:67], a[16:19]
v_mfma_f32_16x16x32_bf16 a[48:51], v[96:99], v[68:71], a[48:51]
v_mfma_f32_16x16x32_bf16 a[80:83], v[96:99], v[72:75], a[80:83]
v_mfma_f32_16x16x32_bf16 a[112:115], v[96:99], v[76:79], a[112:115]
ds_read_b64_tr_b16 v[96:97], v18 offset:40960
ds_read_b64_tr_b16 v[98:99], v26 offset:40960
s_waitcnt lgkmcnt(6)
v_mfma_f32_16x16x32_bf16 a[20:23], v[100:103], v[64:67], a[20:23]
v_mfma_f32_16x16x32_bf16 a[52:55], v[100:103], v[68:71], a[52:55]
v_mfma_f32_16x16x32_bf16 a[84:87], v[100:103], v[72:75], a[84:87]
v_mfma_f32_16x16x32_bf16 a[116:119], v[100:103], v[76:79], a[116:119]
ds_read_b64_tr_b16 v[100:101], v19 offset:40960
ds_read_b64_tr_b16 v[102:103], v27 offset:40960
s_waitcnt lgkmcnt(6)
v_mfma_f32_16x16x32_bf16 a[24:27], v[104:107], v[64:67], a[24:27]
v_mfma_f32_16x16x32_bf16 a[56:59], v[104:107], v[68:71], a[56:59]
v_mfma_f32_16x16x32_bf16 a[88:91], v[104:107], v[72:75], a[88:91]
v_mfma_f32_16x16x32_bf16 a[120:123], v[104:107], v[76:79], a[120:123]
ds_read_b64_tr_b16 v[104:105], v20 offset:40960
ds_read_b64_tr_b16 v[106:107], v28 offset:40960
s_waitcnt lgkmcnt(6)
v_mfma_f32_16x16x32_bf16 a[28:31], v[108:111], v[64:67], a[28:31]
v_mfma_f32_16x16x32_bf16 a[60:63], v[108:111], v[68:71], a[60:63]
v_mfma_f32_16x16x32_bf16 a[92:95], v[108:111], v[72:75], a[92:95]
v_mfma_f32_16x16x32_bf16 a[124:127], v[108:111], v[76:79], a[124:127]
s_add_u32 s43, s48, 4096
buffer_load_dwordx4 v[64:67], v1, s[8:11], s43 offen offset:3072
s_add_u32 s43, s48, 20480
buffer_load_dwordx4 v[68:71], v1, s[8:11], s43 offen offset:3072
s_add_u32 s43, s48, 36864
buffer_load_dwordx4 v[72:75], v1, s[8:11], s43 offen offset:3072
s_add_u32 s43, s48, 53248
buffer_load_dwordx4 v[76:79], v1, s[8:11], s43 offen offset:3072
ds_read_b64_tr_b16 v[108:109], v21 offset:40960
ds_read_b64_tr_b16 v[110:111], v29 offset:40960
s_waitcnt vmcnt(12)
s_waitcnt lgkmcnt(6)
v_mfma_f32_16x16x32_bf16 a[0:3], v[96:99], v[80:83], a[0:3]
v_mfma_f32_16x16x32_bf16 a[32:35], v[96:99], v[84:87], a[32:35]
v_mfma_f32_16x16x32_bf16 a[64:67], v[96:99], v[88:91], a[64:67]
v_mfma_f32_16x16x32_bf16 a[96:99], v[96:99], v[92:95], a[96:99]
ds_read_b64_tr_b16 v[96:97], v22 offset:40960
ds_read_b64_tr_b16 v[98:99], v30 offset:40960
s_waitcnt lgkmcnt(6)
v_mfma_f32_16x16x32_bf16 a[4:7], v[100:103], v[80:83], a[4:7]
v_mfma_f32_16x16x32_bf16 a[36:39], v[100:103], v[84:87], a[36:39]
v_mfma_f32_16x16x32_bf16 a[68:71], v[100:103], v[88:91], a[68:71]
v_mfma_f32_16x16x32_bf16 a[100:103], v[100:103], v[92:95], a[100:103]
ds_read_b64_tr_b16 v[100:101], v23 offset:40960
ds_read_b64_tr_b16 v[102:103], v31 offset:40960
s_waitcnt lgkmcnt(6)
v_mfma_f32_16x16x32_bf16 a[8:11], v[104:107], v[80:83], a[8:11]
v_mfma_f32_16x16x32_bf16 a[40:43], v[104:107], v[84:87], a[40:43]
v_mfma_f32_16x16x32_bf16 a[72:75], v[104:107], v[88:91], a[72:75]
v_mfma_f32_16x16x32_bf16 a[104:107], v[104:107], v[92:95], a[104:107]
ds_read_b64_tr_b16 v[104:105], v24 offset:40960
ds_read_b64_tr_b16 v[106:107], v32 offset:40960
s_waitcnt lgkmcnt(6)
v_mfma_f32_16x16x32_bf16 a[12:15], v[108:111], v[80:83], a[12:15]
v_mfma_f32_16x16x32_bf16 a[44:47], v[108:111], v[84:87], a[44:47]
v_mfma_f32_16x16x32_bf16 a[76:79], v[108:111], v[88:91], a[76:79]
v_mfma_f32_16x16x32_bf16 a[108:111], v[108:111], v[92:95], a[108:111]
ds_read_b64_tr_b16 v[108:109], v25 offset:40960
ds_read_b64_tr_b16 v[110:111], v33 offset:40960
s_waitcnt lgkmcnt(6)
v_mfma_f32_16x16x32_bf16 a[16:19], v[96:99], v[80:83], a[16:19]
v_mfma_f32_16x16x32_bf16 a[48:51], v[96:99], v[84:87], a[48:51]
v_mfma_f32_16x16x32_bf16 a[80:83], v[96:99], v[88:91], a[80:83]
v_mfma_f32_16x16x32_bf16 a[112:115], v[96:99], v[92:95], a[112:115]
s_barrier
s_add_u32 s42, s49, 2621440
s_add_u32 m0, s51, 16384
s_nop 0
buffer_load_dwordx4 v2, s[12:15], s42 offen lds
s_add_u32 m0, s51, 17408
s_nop 0
buffer_load_dwordx4 v3, s[12:15], s42 offen lds
s_add_u32 m0, s51, 18432
s_nop 0
buffer_load_dwordx4 v4, s[12:15], s42 offen lds
s_add_u32 m0, s51, 19456
s_nop 0
buffer_load_dwordx4 v5, s[12:15], s42 offen lds
ds_read_b64_tr_b16 v[96:97], v18 offset:49152
ds_read_b64_tr_b16 v[98:99], v26 offset:49152
s_waitcnt lgkmcnt(6)
v_mfma_f32_16x16x32_bf16 a[20:23], v[100:103], v[80:83], a[20:23]
v_mfma_f32_16x16x32_bf16 a[52:55], v[100:103], v[84:87], a[52:55]
v_mfma_f32_16x16x32_bf16 a[84:87], v[100:103], v[88:91], a[84:87]
v_mfma_f32_16x16x32_bf16 a[116:119], v[100:103], v[92:95], a[116:119]
ds_read_b64_tr_b16 v[100:101], v19 offset:49152
ds_read_b64_tr_b16 v[102:103], v27 offset:49152
s_waitcnt lgkmcnt(6)
v_mfma_f32_16x16x32_bf16 a[24:27], v[104:107], v[80:83], a[24:27]
v_mfma_f32_16x16x32_bf16 a[56:59], v[104:107], v[84:87], a[56:59]
v_mfma_f32_16x16x32_bf16 a[88:91], v[104:107], v[88:91], a[88:91]
v_mfma_f32_16x16x32_bf16 a[120:123], v[104:107], v[92:95], a[120:123]
ds_read_b64_tr_b16 v[104:105], v20 offset:49152
ds_read_b64_tr_b16 v[106:107], v28 offset:49152
s_waitcnt lgkmcnt(6)
v_mfma_f32_16x16x32_bf16 a[28:31], v[108:111], v[80:83], a[28:31]
v_mfma_f32_16x16x32_bf16 a[60:63], v[108:111], v[84:87], a[60:63]
v_mfma_f32_16x16x32_bf16 a[92:95], v[108:111], v[88:91], a[92:95]
v_mfma_f32_16x16x32_bf16 a[124:127], v[108:111], v[92:95], a[124:127]
s_add_u32 s43, s48, 8192
buffer_load_dwordx4 v[80:83], v1, s[8:11], s43 offen offset:0
s_add_u32 s43, s48, 24576
buffer_load_dwordx4 v[84:87], v1, s[8:11], s43 offen offset:0
s_add_u32 s43, s48, 40960
buffer_load_dwordx4 v[88:91], v1, s[8:11], s43 offen offset:0
s_add_u32 s43, s48, 57344
buffer_load_dwordx4 v[92:95], v1, s[8:11], s43 offen offset:0
ds_read_b64_tr_b16 v[108:109], v21 offset:49152
ds_read_b64_tr_b16 v[110:111], v29 offset:49152
s_waitcnt vmcnt(12)
s_waitcnt lgkmcnt(6)
v_mfma_f32_16x16x32_bf16 a[0:3], v[96:99], v[48:51], a[0:3]
v_mfma_f32_16x16x32_bf16 a[32:35], v[96:99], v[52:55], a[32:35]
v_mfma_f32_16x16x32_bf16 a[64:67], v[96:99], v[56:59], a[64:67]
v_mfma_f32_16x16x32_bf16 a[96:99], v[96:99], v[60:63], a[96:99]
ds_read_b64_tr_b16 v[96:97], v22 offset:49152
ds_read_b64_tr_b16 v[98:99], v30 offset:49152
s_waitcnt lgkmcnt(6)
v_mfma_f32_16x16x32_bf16 a[4:7], v[100:103], v[48:51], a[4:7]
v_mfma_f32_16x16x32_bf16 a[36:39], v[100:103], v[52:55], a[36:39]
v_mfma_f32_16x16x32_bf16 a[68:71], v[100:103], v[56:59], a[68:71]
v_mfma_f32_16x16x32_bf16 a[100:103], v[100:103], v[60:63], a[100:103]
ds_read_b64_tr_b16 v[100:101], v23 offset:49152
ds_read_b64_tr_b16 v[102:103], v31 offset:49152
s_waitcnt lgkmcnt(6)
v_mfma_f32_16x16x32_bf16 a[8:11], v[104:107], v[48:51], a[8:11]
v_mfma_f32_16x16x32_bf16 a[40:43], v[104:107], v[52:55], a[40:43]
v_mfma_f32_16x16x32_bf16 a[72:75], v[104:107], v[56:59], a[72:75]
v_mfma_f32_16x16x32_bf16 a[104:107], v[104:107], v[60:63], a[104:107]
ds_read_b64_tr_b16 v[104:105], v24 offset:49152
ds_read_b64_tr_b16 v[106:107], v32 offset:49152
s_waitcnt lgkmcnt(6)
v_mfma_f32_16x16x32_bf16 a[12:15], v[108:111], v[48:51], a[12:15]
v_mfma_f32_16x16x32_bf16 a[44:47], v[108:111], v[52:55], a[44:47]
v_mfma_f32_16x16x32_bf16 a[76:79], v[108:111], v[56:59], a[76:79]
v_mfma_f32_16x16x32_bf16 a[108:111], v[108:111], v[60:63], a[108:111]
ds_read_b64_tr_b16 v[108:109], v25 offset:49152
ds_read_b64_tr_b16 v[110:111], v33 offset:49152
s_waitcnt lgkmcnt(6)
v_mfma_f32_16x16x32_bf16 a[16:19], v[96:99], v[48:51], a[16:19]
v_mfma_f32_16x16x32_bf16 a[48:51], v[96:99], v[52:55], a[48:51]
v_mfma_f32_16x16x32_bf16 a[80:83], v[96:99], v[56:59], a[80:83]
v_mfma_f32_16x16x32_bf16 a[112:115], v[96:99], v[60:63], a[112:115]
ds_read_b64_tr_b16 v[96:97], v18 offset:57344
ds_read_b64_tr_b16 v[98:99], v26 offset:57344
s_waitcnt lgkmcnt(6)
v_mfma_f32_16x16x32_bf16 a[20:23], v[100:103], v[48:51], a[20:23]
v_mfma_f32_16x16x32_bf16 a[52:55], v[100:103], v[52:55], a[52:55]
v_mfma_f32_16x16x32_bf16 a[84:87], v[100:103], v[56:59], a[84:87]
v_mfma_f32_16x16x32_bf16 a[116:119], v[100:103], v[60:63], a[116:119]
ds_read_b64_tr_b16 v[100:101], v19 offset:57344
ds_read_b64_tr_b16 v[102:103], v27 offset:57344
s_waitcnt lgkmcnt(6)
v_mfma_f32_16x16x32_bf16 a[24:27], v[104:107], v[48:51], a[24:27]
v_mfma_f32_16x16x32_bf16 a[56:59], v[104:107], v[52:55], a[56:59]
v_mfma_f32_16x16x32_bf16 a[88:91], v[104:107], v[56:59], a[88:91]
v_mfma_f32_16x16x32_bf16 a[120:123], v[104:107], v[60:63], a[120:123]
ds_read_b64_tr_b16 v[104:105], v20 offset:57344
ds_read_b64_tr_b16 v[106:107], v28 offset:57344
s_waitcnt lgkmcnt(6)
v_mfma_f32_16x16x32_bf16 a[28:31], v[108:111], v[48:51], a[28:31]
v_mfma_f32_16x16x32_bf16 a[60:63], v[108:111], v[52:55], a[60:63]
v_mfma_f32_16x16x32_bf16 a[92:95], v[108:111], v[56:59], a[92:95]
v_mfma_f32_16x16x32_bf16 a[124:127], v[108:111], v[60:63], a[124:127]
s_add_u32 s43, s48, 8192
buffer_load_dwordx4 v[48:51], v1, s[8:11], s43 offen offset:1024
s_add_u32 s43, s48, 24576
buffer_load_dwordx4 v[52:55], v1, s[8:11], s43 offen offset:1024
s_add_u32 s43, s48, 40960
buffer_load_dwordx4 v[56:59], v1, s[8:11], s43 offen offset:1024
s_add_u32 s43, s48, 57344
buffer_load_dwordx4 v[60:63], v1, s[8:11], s43 offen offset:1024
ds_read_b64_tr_b16 v[108:109], v21 offset:57344
ds_read_b64_tr_b16 v[110:111], v29 offset:57344
s_waitcnt vmcnt(12)
s_waitcnt lgkmcnt(6)
v_mfma_f32_16x16x32_bf16 a[0:3], v[96:99], v[64:67], a[0:3]
v_mfma_f32_16x16x32_bf16 a[32:35], v[96:99], v[68:71], a[32:35]
v_mfma_f32_16x16x32_bf16 a[64:67], v[96:99], v[72:75], a[64:67]
v_mfma_f32_16x16x32_bf16 a[96:99], v[96:99], v[76:79], a[96:99]
ds_read_b64_tr_b16 v[96:97], v22 offset:57344
ds_read_b64_tr_b16 v[98:99], v30 offset:57344
s_waitcnt lgkmcnt(6)
v_mfma_f32_16x16x32_bf16 a[4:7], v[100:103], v[64:67], a[4:7]
v_mfma_f32_16x16x32_bf16 a[36:39], v[100:103], v[68:71], a[36:39]
v_mfma_f32_16x16x32_bf16 a[68:71], v[100:103], v[72:75], a[68:71]
v_mfma_f32_16x16x32_bf16 a[100:103], v[100:103], v[76:79], a[100:103]
ds_read_b64_tr_b16 v[100:101], v23 offset:57344
ds_read_b64_tr_b16 v[102:103], v31 offset:57344
s_waitcnt lgkmcnt(6)
v_mfma_f32_16x16x32_bf16 a[8:11], v[104:107], v[64:67], a[8:11]
v_mfma_f32_16x16x32_bf16 a[40:43], v[104:107], v[68:71], a[40:43]
v_mfma_f32_16x16x32_bf16 a[72:75], v[104:107], v[72:75], a[72:75]
v_mfma_f32_16x16x32_bf16 a[104:107], v[104:107], v[76:79], a[104:107]
ds_read_b64_tr_b16 v[104:105], v24 offset:57344
ds_read_b64_tr_b16 v[106:107], v32 offset:57344
s_waitcnt lgkmcnt(6)
v_mfma_f32_16x16x32_bf16 a[12:15], v[108:111], v[64:67], a[12:15]
v_mfma_f32_16x16x32_bf16 a[44:47], v[108:111], v[68:71], a[44:47]
v_mfma_f32_16x16x32_bf16 a[76:79], v[108:111], v[72:75], a[76:79]
v_mfma_f32_16x16x32_bf16 a[108:111], v[108:111], v[76:79], a[108:111]
ds_read_b64_tr_b16 v[108:109], v25 offset:57344
ds_read_b64_tr_b16 v[110:111], v33 offset:57344
s_waitcnt lgkmcnt(6)
v_mfma_f32_16x16x32_bf16 a[16:19], v[96:99], v[64:67], a[16:19]
v_mfma_f32_16x16x32_bf16 a[48:51], v[96:99], v[68:71], a[48:51]
v_mfma_f32_16x16x32_bf16 a[80:83], v[96:99], v[72:75], a[80:83]
v_mfma_f32_16x16x32_bf16 a[112:115], v[96:99], v[76:79], a[112:115]
s_barrier
s_add_u32 s42, s49, 3145728
s_add_u32 m0, s51, 32768
s_nop 0
buffer_load_dwordx4 v2, s[12:15], s42 offen lds
s_add_u32 m0, s51, 33792
s_nop 0
buffer_load_dwordx4 v3, s[12:15], s42 offen lds
s_add_u32 m0, s51, 34816
s_nop 0
buffer_load_dwordx4 v4, s[12:15], s42 offen lds
s_add_u32 m0, s51, 35840
s_nop 0
buffer_load_dwordx4 v5, s[12:15], s42 offen lds
ds_read_b64_tr_b16 v[96:97], v18 offset:0
ds_read_b64_tr_b16 v[98:99], v26 offset:0
s_waitcnt lgkmcnt(6)
v_mfma_f32_16x16x32_bf16 a[20:23], v[100:103], v[64:67], a[20:23]
v_mfma_f32_16x16x32_bf16 a[52:55], v[100:103], v[68:71], a[52:55]
v_mfma_f32_16x16x32_bf16 a[84:87], v[100:103], v[72:75], a[84:87]
v_mfma_f32_16x16x32_bf16 a[116:119], v[100:103], v[76:79], a[116:119]
ds_read_b64_tr_b16 v[100:101], v19 offset:0
ds_read_b64_tr_b16 v[102:103], v27 offset:0
s_waitcnt lgkmcnt(6)
v_mfma_f32_16x16x32_bf16 a[24:27], v[104:107], v[64:67], a[24:27]
v_mfma_f32_16x16x32_bf16 a[56:59], v[104:107], v[68:71], a[56:59]
v_mfma_f32_16x16x32_bf16 a[88:91], v[104:107], v[72:75], a[88:91]
v_mfma_f32_16x16x32_bf16 a[120:123], v[104:107], v[76:79], a[120:123]
ds_read_b64_tr_b16 v[104:105], v20 offset:0
ds_read_b64_tr_b16 v[106:107], v28 offset:0
s_waitcnt lgkmcnt(6)
v_mfma_f32_16x16x32_bf16 a[28:31], v[108:111], v[64:67], a[28:31]
v_mfma_f32_16x16x32_bf16 a[60:63], v[108:111], v[68:71], a[60:63]
v_mfma_f32_16x16x32_bf16 a[92:95], v[108:111], v[72:75], a[92:95]
v_mfma_f32_16x16x32_bf16 a[124:127], v[108:111], v[76:79], a[124:127]
s_add_u32 s43, s48, 8192
buffer_load_dwordx4 v[64:67], v1, s[8:11], s43 offen offset:2048
s_add_u32 s43, s48, 24576
buffer_load_dwordx4 v[68:71], v1, s[8:11], s43 offen offset:2048
s_add_u32 s43, s48, 40960
buffer_load_dwordx4 v[72:75], v1, s[8:11], s43 offen offset:2048
s_add_u32 s43, s48, 57344
buffer_load_dwordx4 v[76:79], v1, s[8:11], s43 offen offset:2048
ds_read_b64_tr_b16 v[108:109], v21 offset:0
ds_read_b64_tr_b16 v[110:111], v29 offset:0
s_waitcnt vmcnt(12)
s_waitcnt lgkmcnt(6)
v_mfma_f32_16x16x32_bf16 a[0:3], v[96:99], v[80:83], a[0:3]
v_mfma_f32_16x16x32_bf16 a[32:35], v[96:99], v[84:87], a[32:35]
v_mfma_f32_16x16x32_bf16 a[64:67], v[96:99], v[88:91], a[64:67]
v_mfma_f32_16x16x32_bf16 a[96:99], v[96:99], v[92:95], a[96:99]
ds_read_b64_tr_b16 v[96:97], v22 offset:0
ds_read_b64_tr_b16 v[98:99], v30 offset:0
s_waitcnt lgkmcnt(6)
v_mfma_f32_16x16x32_bf16 a[4:7], v[100:103], v[80:83], a[4:7]
v_mfma_f32_16x16x32_bf16 a[36:39], v[100:103], v[84:87], a[36:39]
v_mfma_f32_16x16x32_bf16 a[68:71], v[100:103], v[88:91], a[68:71]
v_mfma_f32_16x16x32_bf16 a[100:103], v[100:103], v[92:95], a[100:103]
ds_read_b64_tr_b16 v[100:101], v23 offset:0
ds_read_b64_tr_b16 v[102:103], v31 offset:0
s_waitcnt lgkmcnt(6)
v_mfma_f32_16x16x32_bf16 a[8:11], v[104:107], v[80:83], a[8:11]
v_mfma_f32_16x16x32_bf16 a[40:43], v[104:107], v[84:87], a[40:43]
v_mfma_f32_16x16x32_bf16 a[72:75], v[104:107], v[88:91], a[72:75]
v_mfma_f32_16x16x32_bf16 a[104:107], v[104:107], v[92:95], a[104:107]
ds_read_b64_tr_b16 v[104:105], v24 offset:0
ds_read_b64_tr_b16 v[106:107], v32 offset:0
s_waitcnt lgkmcnt(6)
v_mfma_f32_16x16x32_bf16 a[12:15], v[108:111], v[80:83], a[12:15]
v_mfma_f32_16x16x32_bf16 a[44:47], v[108:111], v[84:87], a[44:47]
v_mfma_f32_16x16x32_bf16 a[76:79], v[108:111], v[88:91], a[76:79]
v_mfma_f32_16x16x32_bf16 a[108:111], v[108:111], v[92:95], a[108:111]
ds_read_b64_tr_b16 v[108:109], v25 offset:0
ds_read_b64_tr_b16 v[110:111], v33 offset:0
s_waitcnt lgkmcnt(6)
v_mfma_f32_16x16x32_bf16 a[16:19], v[96:99], v[80:83], a[16:19]
v_mfma_f32_16x16x32_bf16 a[48:51], v[96:99], v[84:87], a[48:51]
v_mfma_f32_16x16x32_bf16 a[80:83], v[96:99], v[88:91], a[80:83]
v_mfma_f32_16x16x32_bf16 a[112:115], v[96:99], v[92:95], a[112:115]
ds_read_b64_tr_b16 v[96:97], v18 offset:8192
ds_read_b64_tr_b16 v[98:99], v26 offset:8192
s_waitcnt lgkmcnt(6)
v_mfma_f32_16x16x32_bf16 a[20:23], v[100:103], v[80:83], a[20:23]
v_mfma_f32_16x16x32_bf16 a[52:55], v[100:103], v[84:87], a[52:55]
v_mfma_f32_16x16x32_bf16 a[84:87], v[100:103], v[88:91], a[84:87]
v_mfma_f32_16x16x32_bf16 a[116:119], v[100:103], v[92:95], a[116:119]
ds_read_b64_tr_b16 v[100:101], v19 offset:8192
ds_read_b64_tr_b16 v[102:103], v27 offset:8192
s_waitcnt lgkmcnt(6)
v_mfma_f32_16x16x32_bf16 a[24:27], v[104:107], v[80:83], a[24:27]
v_mfma_f32_16x16x32_bf16 a[56:59], v[104:107], v[84:87], a[56:59]
v_mfma_f32_16x16x32_bf16 a[88:91], v[104:107], v[88:91], a[88:91]
v_mfma_f32_16x16x32_bf16 a[120:123], v[104:107], v[92:95], a[120:123]
ds_read_b64_tr_b16 v[104:105], v20 offset:8192
ds_read_b64_tr_b16 v[106:107], v28 offset:8192
s_waitcnt lgkmcnt(6)
v_mfma_f32_16x16x32_bf16 a[28:31], v[108:111], v[80:83], a[28:31]
v_mfma_f32_16x16x32_bf16 a[60:63], v[108:111], v[84:87], a[60:63]
v_mfma_f32_16x16x32_bf16 a[92:95], v[108:111], v[88:91], a[92:95]
v_mfma_f32_16x16x32_bf16 a[124:127], v[108:111], v[92:95], a[124:127]
s_add_u32 s43, s48, 8192
buffer_load_dwordx4 v[80:83], v1, s[8:11], s43 offen offset:3072
s_add_u32 s43, s48, 24576
buffer_load_dwordx4 v[84:87], v1, s[8:11], s43 offen offset:3072
s_add_u32 s43, s48, 40960
buffer_load_dwordx4 v[88:91], v1, s[8:11], s43 offen offset:3072
s_add_u32 s43, s48, 57344
buffer_load_dwordx4 v[92:95], v1, s[8:11], s43 offen offset:3072
ds_read_b64_tr_b16 v[108:109], v21 offset:8192
ds_read_b64_tr_b16 v[110:111], v29 offset:8192
s_waitcnt vmcnt(12)
s_waitcnt lgkmcnt(6)
v_mfma_f32_16x16x32_bf16 a[0:3], v[96:99], v[48:51], a[0:3]
v_mfma_f32_16x16x32_bf16 a[32:35], v[96:99], v[52:55], a[32:35]
v_mfma_f32_16x16x32_bf16 a[64:67], v[96:99], v[56:59], a[64:67]
v_mfma_f32_16x16x32_bf16 a[96:99], v[96:99], v[60:63], a[96:99]
ds_read_b64_tr_b16 v[96:97], v22 offset:8192
ds_read_b64_tr_b16 v[98:99], v30 offset:8192
s_waitcnt lgkmcnt(6)
v_mfma_f32_16x16x32_bf16 a[4:7], v[100:103], v[48:51], a[4:7]
v_mfma_f32_16x16x32_bf16 a[36:39], v[100:103], v[52:55], a[36:39]
v_mfma_f32_16x16x32_bf16 a[68:71], v[100:103], v[56:59], a[68:71]
v_mfma_f32_16x16x32_bf16 a[100:103], v[100:103], v[60:63], a[100:103]
ds_read_b64_tr_b16 v[100:101], v23 offset:8192
ds_read_b64_tr_b16 v[102:103], v31 offset:8192
s_waitcnt lgkmcnt(6)
v_mfma_f32_16x16x32_bf16 a[8:11], v[104:107], v[48:51], a[8:11]
v_mfma_f32_16x16x32_bf16 a[40:43], v[104:107], v[52:55], a[40:43]
v_mfma_f32_16x16x32_bf16 a[72:75], v[104:107], v[56:59], a[72:75]
v_mfma_f32_16x16x32_bf16 a[104:107], v[104:107], v[60:63], a[104:107]
ds_read_b64_tr_b16 v[104:105], v24 offset:8192
ds_read_b64_tr_b16 v[106:107], v32 offset:8192
s_waitcnt lgkmcnt(6)
v_mfma_f32_16x16x32_bf16 a[12:15], v[108:111], v[48:51], a[12:15]
v_mfma_f32_16x16x32_bf16 a[44:47], v[108:111], v[52:55], a[44:47]
v_mfma_f32_16x16x32_bf16 a[76:79], v[108:111], v[56:59], a[76:79]
v_mfma_f32_16x16x32_bf16 a[108:111], v[108:111], v[60:63], a[108:111]
ds_read_b64_tr_b16 v[108:109], v25 offset:8192
ds_read_b64_tr_b16 v[110:111], v33 offset:8192
s_waitcnt lgkmcnt(6)
v_mfma_f32_16x16x32_bf16 a[16:19], v[96:99], v[48:51], a[16:19]
v_mfma_f32_16x16x32_bf16 a[48:51], v[96:99], v[52:55], a[48:51]
v_mfma_f32_16x16x32_bf16 a[80:83], v[96:99], v[56:59], a[80:83]
v_mfma_f32_16x16x32_bf16 a[112:115], v[96:99], v[60:63], a[112:115]
s_barrier
s_add_u32 s42, s49, 3670016
s_add_u32 m0, s51, 49152
s_nop 0
buffer_load_dwordx4 v2, s[12:15], s42 offen lds
s_add_u32 m0, s51, 50176
s_nop 0
buffer_load_dwordx4 v3, s[12:15], s42 offen lds
s_add_u32 m0, s51, 51200
s_nop 0
buffer_load_dwordx4 v4, s[12:15], s42 offen lds
s_add_u32 m0, s51, 52224
s_nop 0
buffer_load_dwordx4 v5, s[12:15], s42 offen lds
ds_read_b64_tr_b16 v[96:97], v18 offset:16384
ds_read_b64_tr_b16 v[98:99], v26 offset:16384
s_waitcnt lgkmcnt(6)
v_mfma_f32_16x16x32_bf16 a[20:23], v[100:103], v[48:51], a[20:23]
v_mfma_f32_16x16x32_bf16 a[52:55], v[100:103], v[52:55], a[52:55]
v_mfma_f32_16x16x32_bf16 a[84:87], v[100:103], v[56:59], a[84:87]
v_mfma_f32_16x16x32_bf16 a[116:119], v[100:103], v[60:63], a[116:119]
ds_read_b64_tr_b16 v[100:101], v19 offset:16384
ds_read_b64_tr_b16 v[102:103], v27 offset:16384
s_waitcnt lgkmcnt(6)
v_mfma_f32_16x16x32_bf16 a[24:27], v[104:107], v[48:51], a[24:27]
v_mfma_f32_16x16x32_bf16 a[56:59], v[104:107], v[52:55], a[56:59]
v_mfma_f32_16x16x32_bf16 a[88:91], v[104:107], v[56:59], a[88:91]
v_mfma_f32_16x16x32_bf16 a[120:123], v[104:107], v[60:63], a[120:123]
ds_read_b64_tr_b16 v[104:105], v20 offset:16384
ds_read_b64_tr_b16 v[106:107], v28 offset:16384
s_waitcnt lgkmcnt(6)
v_mfma_f32_16x16x32_bf16 a[28:31], v[108:111], v[48:51], a[28:31]
v_mfma_f32_16x16x32_bf16 a[60:63], v[108:111], v[52:55], a[60:63]
v_mfma_f32_16x16x32_bf16 a[92:95], v[108:111], v[56:59], a[92:95]
v_mfma_f32_16x16x32_bf16 a[124:127], v[108:111], v[60:63], a[124:127]
s_add_u32 s43, s48, 12288
buffer_load_dwordx4 v[48:51], v1, s[8:11], s43 offen offset:0
s_add_u32 s43, s48, 28672
buffer_load_dwordx4 v[52:55], v1, s[8:11], s43 offen offset:0
s_add_u32 s43, s48, 45056
buffer_load_dwordx4 v[56:59], v1, s[8:11], s43 offen offset:0
s_add_u32 s43, s48, 61440
buffer_load_dwordx4 v[60:63], v1, s[8:11], s43 offen offset:0
ds_read_b64_tr_b16 v[108:109], v21 offset:16384
ds_read_b64_tr_b16 v[110:111], v29 offset:16384
s_waitcnt vmcnt(12)
s_waitcnt lgkmcnt(6)
v_mfma_f32_16x16x32_bf16 a[0:3], v[96:99], v[64:67], a[0:3]
v_mfma_f32_16x16x32_bf16 a[32:35], v[96:99], v[68:71], a[32:35]
v_mfma_f32_16x16x32_bf16 a[64:67], v[96:99], v[72:75], a[64:67]
v_mfma_f32_16x16x32_bf16 a[96:99], v[96:99], v[76:79], a[96:99]
ds_read_b64_tr_b16 v[96:97], v22 offset:16384
ds_read_b64_tr_b16 v[98:99], v30 offset:16384
s_waitcnt lgkmcnt(6)
v_mfma_f32_16x16x32_bf16 a[4:7], v[100:103], v[64:67], a[4:7]
v_mfma_f32_16x16x32_bf16 a[36:39], v[100:103], v[68:71], a[36:39]
v_mfma_f32_16x16x32_bf16 a[68:71], v[100:103], v[72:75], a[68:71]
v_mfma_f32_16x16x32_bf16 a[100:103], v[100:103], v[76:79], a[100:103]
ds_read_b64_tr_b16 v[100:101], v23 offset:16384
ds_read_b64_tr_b16 v[102:103], v31 offset:16384
s_waitcnt lgkmcnt(6)
v_mfma_f32_16x16x32_bf16 a[8:11], v[104:107], v[64:67], a[8:11]
v_mfma_f32_16x16x32_bf16 a[40:43], v[104:107], v[68:71], a[40:43]
v_mfma_f32_16x16x32_bf16 a[72:75], v[104:107], v[72:75], a[72:75]
v_mfma_f32_16x16x32_bf16 a[104:107], v[104:107], v[76:79], a[104:107]
ds_read_b64_tr_b16 v[104:105], v24 offset:16384
ds_read_b64_tr_b16 v[106:107], v32 offset:16384
s_waitcnt lgkmcnt(6)
v_mfma_f32_16x16x32_bf16 a[12:15], v[108:111], v[64:67], a[12:15]
v_mfma_f32_16x16x32_bf16 a[44:47], v[108:111], v[68:71], a[44:47]
v_mfma_f32_16x16x32_bf16 a[76:79], v[108:111], v[72:75], a[76:79]
v_mfma_f32_16x16x32_bf16 a[108:111], v[108:111], v[76:79], a[108:111]
ds_read_b64_tr_b16 v[108:109], v25 offset:16384
ds_read_b64_tr_b16 v[110:111], v33 offset:16384
s_waitcnt lgkmcnt(6)
v_mfma_f32_16x16x32_bf16 a[16:19], v[96:99], v[64:67], a[16:19]
v_mfma_f32_16x16x32_bf16 a[48:51], v[96:99], v[68:71], a[48:51]
v_mfma_f32_16x16x32_bf16 a[80:83], v[96:99], v[72:75], a[80:83]
v_mfma_f32_16x16x32_bf16 a[112:115], v[96:99], v[76:79], a[112:115]
ds_read_b64_tr_b16 v[96:97], v18 offset:24576
ds_read_b64_tr_b16 v[98:99], v26 offset:24576
s_waitcnt lgkmcnt(6)
v_mfma_f32_16x16x32_bf16 a[20:23], v[100:103], v[64:67], a[20:23]
v_mfma_f32_16x16x32_bf16 a[52:55], v[100:103], v[68:71], a[52:55]
v_mfma_f32_16x16x32_bf16 a[84:87], v[100:103], v[72:75], a[84:87]
v_mfma_f32_16x16x32_bf16 a[116:119], v[100:103], v[76:79], a[116:119]
ds_read_b64_tr_b16 v[100:101], v19 offset:24576
ds_read_b64_tr_b16 v[102:103], v27 offset:24576
s_waitcnt lgkmcnt(6)
v_mfma_f32_16x16x32_bf16 a[24:27], v[104:107], v[64:67], a[24:27]
v_mfma_f32_16x16x32_bf16 a[56:59], v[104:107], v[68:71], a[56:59]
v_mfma_f32_16x16x32_bf16 a[88:91], v[104:107], v[72:75], a[88:91]
v_mfma_f32_16x16x32_bf16 a[120:123], v[104:107], v[76:79], a[120:123]
ds_read_b64_tr_b16 v[104:105], v20 offset:24576
ds_read_b64_tr_b16 v[106:107], v28 offset:24576
s_waitcnt lgkmcnt(6)
v_mfma_f32_16x16x32_bf16 a[28:31], v[108:111], v[64:67], a[28:31]
v_mfma_f32_16x16x32_bf16 a[60:63], v[108:111], v[68:71], a[60:63]
v_mfma_f32_16x16x32_bf16 a[92:95], v[108:111], v[72:75], a[92:95]
v_mfma_f32_16x16x32_bf16 a[124:127], v[108:111], v[76:79], a[124:127]
s_add_u32 s43, s48, 12288
buffer_load_dwordx4 v[64:67], v1, s[8:11], s43 offen offset:1024
s_add_u32 s43, s48, 28672
buffer_load_dwordx4 v[68:71], v1, s[8:11], s43 offen offset:1024
s_add_u32 s43, s48, 45056
buffer_load_dwordx4 v[72:75], v1, s[8:11], s43 offen offset:1024
s_add_u32 s43, s48, 61440
buffer_load_dwordx4 v[76:79], v1, s[8:11], s43 offen offset:1024
ds_read_b64_tr_b16 v[108:109], v21 offset:24576
ds_read_b64_tr_b16 v[110:111], v29 offset:24576
s_waitcnt vmcnt(12)
s_waitcnt lgkmcnt(6)
v_mfma_f32_16x16x32_bf16 a[0:3], v[96:99], v[80:83], a[0:3]
v_mfma_f32_16x16x32_bf16 a[32:35], v[96:99], v[84:87], a[32:35]
v_mfma_f32_16x16x32_bf16 a[64:67], v[96:99], v[88:91], a[64:67]
v_mfma_f32_16x16x32_bf16 a[96:99], v[96:99], v[92:95], a[96:99]
ds_read_b64_tr_b16 v[96:97], v22 offset:24576
ds_read_b64_tr_b16 v[98:99], v30 offset:24576
s_waitcnt lgkmcnt(6)
v_mfma_f32_16x16x32_bf16 a[4:7], v[100:103], v[80:83], a[4:7]
v_mfma_f32_16x16x32_bf16 a[36:39], v[100:103], v[84:87], a[36:39]
v_mfma_f32_16x16x32_bf16 a[68:71], v[100:103], v[88:91], a[68:71]
v_mfma_f32_16x16x32_bf16 a[100:103], v[100:103], v[92:95], a[100:103]
ds_read_b64_tr_b16 v[100:101], v23 offset:24576
ds_read_b64_tr_b16 v[102:103], v31 offset:24576
s_waitcnt lgkmcnt(6)
v_mfma_f32_16x16x32_bf16 a[8:11], v[104:107], v[80:83], a[8:11]
v_mfma_f32_16x16x32_bf16 a[40:43], v[104:107], v[84:87], a[40:43]
v_mfma_f32_16x16x32_bf16 a[72:75], v[104:107], v[88:91], a[72:75]
v_mfma_f32_16x16x32_bf16 a[104:107], v[104:107], v[92:95], a[104:107]
ds_read_b64_tr_b16 v[104:105], v24 offset:24576
ds_read_b64_tr_b16 v[106:107], v32 offset:24576
s_waitcnt lgkmcnt(6)
v_mfma_f32_16x16x32_bf16 a[12:15], v[108:111], v[80:83], a[12:15]
v_mfma_f32_16x16x32_bf16 a[44:47], v[108:111], v[84:87], a[44:47]
v_mfma_f32_16x16x32_bf16 a[76:79], v[108:111], v[88:91], a[76:79]
v_mfma_f32_16x16x32_bf16 a[108:111], v[108:111], v[92:95], a[108:111]
ds_read_b64_tr_b16 v[108:109], v25 offset:24576
ds_read_b64_tr_b16 v[110:111], v33 offset:24576
s_waitcnt lgkmcnt(6)
v_mfma_f32_16x16x32_bf16 a[16:19], v[96:99], v[80:83], a[16:19]
v_mfma_f32_16x16x32_bf16 a[48:51], v[96:99], v[84:87], a[48:51]
v_mfma_f32_16x16x32_bf16 a[80:83], v[96:99], v[88:91], a[80:83]
v_mfma_f32_16x16x32_bf16 a[112:115], v[96:99], v[92:95], a[112:115]
s_barrier
ds_read_b64_tr_b16 v[96:97], v18 offset:32768
ds_read_b64_tr_b16 v[98:99], v26 offset:32768
s_waitcnt lgkmcnt(6)
v_mfma_f32_16x16x32_bf16 a[20:23], v[100:103], v[80:83], a[20:23]
v_mfma_f32_16x16x32_bf16 a[52:55], v[100:103], v[84:87], a[52:55]
v_mfma_f32_16x16x32_bf16 a[84:87], v[100:103], v[88:91], a[84:87]
v_mfma_f32_16x16x32_bf16 a[116:119], v[100:103], v[92:95], a[116:119]
ds_read_b64_tr_b16 v[100:101], v19 offset:32768
ds_read_b64_tr_b16 v[102:103], v27 offset:32768
s_waitcnt lgkmcnt(6)
v_mfma_f32_16x16x32_bf16 a[24:27], v[104:107], v[80:83], a[24:27]
v_mfma_f32_16x16x32_bf16 a[56:59], v[104:107], v[84:87], a[56:59]
v_mfma_f32_16x16x32_bf16 a[88:91], v[104:107], v[88:91], a[88:91]
v_mfma_f32_16x16x32_bf16 a[120:123], v[104:107], v[92:95], a[120:123]
ds_read_b64_tr_b16 v[104:105], v20 offset:32768
ds_read_b64_tr_b16 v[106:107], v28 offset:32768
s_waitcnt lgkmcnt(6)
v_mfma_f32_16x16x32_bf16 a[28:31], v[108:111], v[80:83], a[28:31]
v_mfma_f32_16x16x32_bf16 a[60:63], v[108:111], v[84:87], a[60:63]
v_mfma_f32_16x16x32_bf16 a[92:95], v[108:111], v[88:91], a[92:95]
v_mfma_f32_16x16x32_bf16 a[124:127], v[108:111], v[92:95], a[124:127]
s_add_u32 s43, s48, 12288
buffer_load_dwordx4 v[80:83], v1, s[8:11], s43 offen offset:2048
s_add_u32 s43, s48, 28672
buffer_load_dwordx4 v[84:87], v1, s[8:11], s43 offen offset:2048
s_add_u32 s43, s48, 45056
buffer_load_dwordx4 v[88:91], v1, s[8:11], s43 offen offset:2048
s_add_u32 s43, s48, 61440
buffer_load_dwordx4 v[92:95], v1, s[8:11], s43 offen offset:2048
ds_read_b64_tr_b16 v[108:109], v21 offset:32768
ds_read_b64_tr_b16 v[110:111], v29 offset:32768
s_waitcnt vmcnt(8)
s_waitcnt lgkmcnt(6)
v_mfma_f32_16x16x32_bf16 a[0:3], v[96:99], v[48:51], a[0:3]
v_mfma_f32_16x16x32_bf16 a[32:35], v[96:99], v[52:55], a[32:35]
v_mfma_f32_16x16x32_bf16 a[64:67], v[96:99], v[56:59], a[64:67]
v_mfma_f32_16x16x32_bf16 a[96:99], v[96:99], v[60:63], a[96:99]
ds_read_b64_tr_b16 v[96:97], v22 offset:32768
ds_read_b64_tr_b16 v[98:99], v30 offset:32768
s_waitcnt lgkmcnt(6)
v_mfma_f32_16x16x32_bf16 a[4:7], v[100:103], v[48:51], a[4:7]
v_mfma_f32_16x16x32_bf16 a[36:39], v[100:103], v[52:55], a[36:39]
v_mfma_f32_16x16x32_bf16 a[68:71], v[100:103], v[56:59], a[68:71]
v_mfma_f32_16x16x32_bf16 a[100:103], v[100:103], v[60:63], a[100:103]
ds_read_b64_tr_b16 v[100:101], v23 offset:32768
ds_read_b64_tr_b16 v[102:103], v31 offset:32768
s_waitcnt lgkmcnt(6)
v_mfma_f32_16x16x32_bf16 a[8:11], v[104:107], v[48:51], a[8:11]
v_mfma_f32_16x16x32_bf16 a[40:43], v[104:107], v[52:55], a[40:43]
v_mfma_f32_16x16x32_bf16 a[72:75], v[104:107], v[56:59], a[72:75]
v_mfma_f32_16x16x32_bf16 a[104:107], v[104:107], v[60:63], a[104:107]
ds_read_b64_tr_b16 v[104:105], v24 offset:32768
ds_read_b64_tr_b16 v[106:107], v32 offset:32768
s_waitcnt lgkmcnt(6)
v_mfma_f32_16x16x32_bf16 a[12:15], v[108:111], v[48:51], a[12:15]
v_mfma_f32_16x16x32_bf16 a[44:47], v[108:111], v[52:55], a[44:47]
v_mfma_f32_16x16x32_bf16 a[76:79], v[108:111], v[56:59], a[76:79]
v_mfma_f32_16x16x32_bf16 a[108:111], v[108:111], v[60:63], a[108:111]
ds_read_b64_tr_b16 v[108:109], v25 offset:32768
ds_read_b64_tr_b16 v[110:111], v33 offset:32768
s_waitcnt lgkmcnt(6)
v_mfma_f32_16x16x32_bf16 a[16:19], v[96:99], v[48:51], a[16:19]
v_mfma_f32_16x16x32_bf16 a[48:51], v[96:99], v[52:55], a[48:51]
v_mfma_f32_16x16x32_bf16 a[80:83], v[96:99], v[56:59], a[80:83]
v_mfma_f32_16x16x32_bf16 a[112:115], v[96:99], v[60:63], a[112:115]
ds_read_b64_tr_b16 v[96:97], v18 offset:40960
ds_read_b64_tr_b16 v[98:99], v26 offset:40960
s_waitcnt lgkmcnt(6)
v_mfma_f32_16x16x32_bf16 a[20:23], v[100:103], v[48:51], a[20:23]
v_mfma_f32_16x16x32_bf16 a[52:55], v[100:103], v[52:55], a[52:55]
v_mfma_f32_16x16x32_bf16 a[84:87], v[100:103], v[56:59], a[84:87]
v_mfma_f32_16x16x32_bf16 a[116:119], v[100:103], v[60:63], a[116:119]
ds_read_b64_tr_b16 v[100:101], v19 offset:40960
ds_read_b64_tr_b16 v[102:103], v27 offset:40960
s_waitcnt lgkmcnt(6)
v_mfma_f32_16x16x32_bf16 a[24:27], v[104:107], v[48:51], a[24:27]
v_mfma_f32_16x16x32_bf16 a[56:59], v[104:107], v[52:55], a[56:59]
v_mfma_f32_16x16x32_bf16 a[88:91], v[104:107], v[56:59], a[88:91]
v_mfma_f32_16x16x32_bf16 a[120:123], v[104:107], v[60:63], a[120:123]
ds_read_b64_tr_b16 v[104:105], v20 offset:40960
ds_read_b64_tr_b16 v[106:107], v28 offset:40960
s_waitcnt lgkmcnt(6)
v_mfma_f32_16x16x32_bf16 a[28:31], v[108:111], v[48:51], a[28:31]
v_mfma_f32_16x16x32_bf16 a[60:63], v[108:111], v[52:55], a[60:63]
v_mfma_f32_16x16x32_bf16 a[92:95], v[108:111], v[56:59], a[92:95]
v_mfma_f32_16x16x32_bf16 a[124:127], v[108:111], v[60:63], a[124:127]
s_add_u32 s43, s48, 12288
buffer_load_dwordx4 v[48:51], v1, s[8:11], s43 offen offset:3072
s_add_u32 s43, s48, 28672
buffer_load_dwordx4 v[52:55], v1, s[8:11], s43 offen offset:3072
s_add_u32 s43, s48, 45056
buffer_load_dwordx4 v[56:59], v1, s[8:11], s43 offen offset:3072
s_add_u32 s43, s48, 61440
buffer_load_dwordx4 v[60:63], v1, s[8:11], s43 offen offset:3072
ds_read_b64_tr_b16 v[108:109], v21 offset:40960
ds_read_b64_tr_b16 v[110:111], v29 offset:40960
s_waitcnt vmcnt(8)
s_waitcnt lgkmcnt(6)
v_mfma_f32_16x16x32_bf16 a[0:3], v[96:99], v[64:67], a[0:3]
v_mfma_f32_16x16x32_bf16 a[32:35], v[96:99], v[68:71], a[32:35]
v_mfma_f32_16x16x32_bf16 a[64:67], v[96:99], v[72:75], a[64:67]
v_mfma_f32_16x16x32_bf16 a[96:99], v[96:99], v[76:79], a[96:99]
ds_read_b64_tr_b16 v[96:97], v22 offset:40960
ds_read_b64_tr_b16 v[98:99], v30 offset:40960
s_waitcnt lgkmcnt(6)
v_mfma_f32_16x16x32_bf16 a[4:7], v[100:103], v[64:67], a[4:7]
v_mfma_f32_16x16x32_bf16 a[36:39], v[100:103], v[68:71], a[36:39]
v_mfma_f32_16x16x32_bf16 a[68:71], v[100:103], v[72:75], a[68:71]
v_mfma_f32_16x16x32_bf16 a[100:103], v[100:103], v[76:79], a[100:103]
ds_read_b64_tr_b16 v[100:101], v23 offset:40960
ds_read_b64_tr_b16 v[102:103], v31 offset:40960
s_waitcnt lgkmcnt(6)
v_mfma_f32_16x16x32_bf16 a[8:11], v[104:107], v[64:67], a[8:11]
v_mfma_f32_16x16x32_bf16 a[40:43], v[104:107], v[68:71], a[40:43]
v_mfma_f32_16x16x32_bf16 a[72:75], v[104:107], v[72:75], a[72:75]
v_mfma_f32_16x16x32_bf16 a[104:107], v[104:107], v[76:79], a[104:107]
ds_read_b64_tr_b16 v[104:105], v24 offset:40960
ds_read_b64_tr_b16 v[106:107], v32 offset:40960
s_waitcnt lgkmcnt(6)
v_mfma_f32_16x16x32_bf16 a[12:15], v[108:111], v[64:67], a[12:15]
v_mfma_f32_16x16x32_bf16 a[44:47], v[108:111], v[68:71], a[44:47]
v_mfma_f32_16x16x32_bf16 a[76:79], v[108:111], v[72:75], a[76:79]
v_mfma_f32_16x16x32_bf16 a[108:111], v[108:111], v[76:79], a[108:111]
ds_read_b64_tr_b16 v[108:109], v25 offset:40960
ds_read_b64_tr_b16 v[110:111], v33 offset:40960
s_waitcnt lgkmcnt(6)
v_mfma_f32_16x16x32_bf16 a[16:19], v[96:99], v[64:67], a[16:19]
v_mfma_f32_16x16x32_bf16 a[48:51], v[96:99], v[68:71], a[48:51]
v_mfma_f32_16x16x32_bf16 a[80:83], v[96:99], v[72:75], a[80:83]
v_mfma_f32_16x16x32_bf16 a[112:115], v[96:99], v[76:79], a[112:115]
s_barrier
ds_read_b64_tr_b16 v[96:97], v18 offset:49152
ds_read_b64_tr_b16 v[98:99], v26 offset:49152
s_waitcnt lgkmcnt(6)
v_mfma_f32_16x16x32_bf16 a[20:23], v[100:103], v[64:67], a[20:23]
v_mfma_f32_16x16x32_bf16 a[52:55], v[100:103], v[68:71], a[52:55]
v_mfma_f32_16x16x32_bf16 a[84:87], v[100:103], v[72:75], a[84:87]
v_mfma_f32_16x16x32_bf16 a[116:119], v[100:103], v[76:79], a[116:119]
ds_read_b64_tr_b16 v[100:101], v19 offset:49152
ds_read_b64_tr_b16 v[102:103], v27 offset:49152
s_waitcnt lgkmcnt(6)
v_mfma_f32_16x16x32_bf16 a[24:27], v[104:107], v[64:67], a[24:27]
v_mfma_f32_16x16x32_bf16 a[56:59], v[104:107], v[68:71], a[56:59]
v_mfma_f32_16x16x32_bf16 a[88:91], v[104:107], v[72:75], a[88:91]
v_mfma_f32_16x16x32_bf16 a[120:123], v[104:107], v[76:79], a[120:123]
ds_read_b64_tr_b16 v[104:105], v20 offset:49152
ds_read_b64_tr_b16 v[106:107], v28 offset:49152
s_waitcnt lgkmcnt(6)
v_mfma_f32_16x16x32_bf16 a[28:31], v[108:111], v[64:67], a[28:31]
v_mfma_f32_16x16x32_bf16 a[60:63], v[108:111], v[68:71], a[60:63]
v_mfma_f32_16x16x32_bf16 a[92:95], v[108:111], v[72:75], a[92:95]
v_mfma_f32_16x16x32_bf16 a[124:127], v[108:111], v[76:79], a[124:127]
ds_read_b64_tr_b16 v[108:109], v21 offset:49152
ds_read_b64_tr_b16 v[110:111], v29 offset:49152
s_waitcnt vmcnt(4)
s_waitcnt lgkmcnt(6)
v_mfma_f32_16x16x32_bf16 a[0:3], v[96:99], v[80:83], a[0:3]
v_mfma_f32_16x16x32_bf16 a[32:35], v[96:99], v[84:87], a[32:35]
v_mfma_f32_16x16x32_bf16 a[64:67], v[96:99], v[88:91], a[64:67]
v_mfma_f32_16x16x32_bf16 a[96:99], v[96:99], v[92:95], a[96:99]
ds_read_b64_tr_b16 v[96:97], v22 offset:49152
ds_read_b64_tr_b16 v[98:99], v30 offset:49152
s_waitcnt lgkmcnt(6)
v_mfma_f32_16x16x32_bf16 a[4:7], v[100:103], v[80:83], a[4:7]
v_mfma_f32_16x16x32_bf16 a[36:39], v[100:103], v[84:87], a[36:39]
v_mfma_f32_16x16x32_bf16 a[68:71], v[100:103], v[88:91], a[68:71]
v_mfma_f32_16x16x32_bf16 a[100:103], v[100:103], v[92:95], a[100:103]
ds_read_b64_tr_b16 v[100:101], v23 offset:49152
ds_read_b64_tr_b16 v[102:103], v31 offset:49152
s_waitcnt lgkmcnt(6)
v_mfma_f32_16x16x32_bf16 a[8:11], v[104:107], v[80:83], a[8:11]
v_mfma_f32_16x16x32_bf16 a[40:43], v[104:107], v[84:87], a[40:43]
v_mfma_f32_16x16x32_bf16 a[72:75], v[104:107], v[88:91], a[72:75]
v_mfma_f32_16x16x32_bf16 a[104:107], v[104:107], v[92:95], a[104:107]
ds_read_b64_tr_b16 v[104:105], v24 offset:49152
ds_read_b64_tr_b16 v[106:107], v32 offset:49152
s_waitcnt lgkmcnt(6)
v_mfma_f32_16x16x32_bf16 a[12:15], v[108:111], v[80:83], a[12:15]
v_mfma_f32_16x16x32_bf16 a[44:47], v[108:111], v[84:87], a[44:47]
v_mfma_f32_16x16x32_bf16 a[76:79], v[108:111], v[88:91], a[76:79]
v_mfma_f32_16x16x32_bf16 a[108:111], v[108:111], v[92:95], a[108:111]
ds_read_b64_tr_b16 v[108:109], v25 offset:49152
ds_read_b64_tr_b16 v[110:111], v33 offset:49152
s_waitcnt lgkmcnt(6)
v_mfma_f32_16x16x32_bf16 a[16:19], v[96:99], v[80:83], a[16:19]
v_mfma_f32_16x16x32_bf16 a[48:51], v[96:99], v[84:87], a[48:51]
v_mfma_f32_16x16x32_bf16 a[80:83], v[96:99], v[88:91], a[80:83]
v_mfma_f32_16x16x32_bf16 a[112:115], v[96:99], v[92:95], a[112:115]
ds_read_b64_tr_b16 v[96:97], v18 offset:57344
ds_read_b64_tr_b16 v[98:99], v26 offset:57344
s_waitcnt lgkmcnt(6)
v_mfma_f32_16x16x32_bf16 a[20:23], v[100:103], v[80:83], a[20:23]
v_mfma_f32_16x16x32_bf16 a[52:55], v[100:103], v[84:87], a[52:55]
v_mfma_f32_16x16x32_bf16 a[84:87], v[100:103], v[88:91], a[84:87]
v_mfma_f32_16x16x32_bf16 a[116:119], v[100:103], v[92:95], a[116:119]
ds_read_b64_tr_b16 v[100:101], v19 offset:57344
ds_read_b64_tr_b16 v[102:103], v27 offset:57344
s_waitcnt lgkmcnt(6)
v_mfma_f32_16x16x32_bf16 a[24:27], v[104:107], v[80:83], a[24:27]
v_mfma_f32_16x16x32_bf16 a[56:59], v[104:107], v[84:87], a[56:59]
v_mfma_f32_16x16x32_bf16 a[88:91], v[104:107], v[88:91], a[88:91]
v_mfma_f32_16x16x32_bf16 a[120:123], v[104:107], v[92:95], a[120:123]
ds_read_b64_tr_b16 v[104:105], v20 offset:57344
ds_read_b64_tr_b16 v[106:107], v28 offset:57344
s_waitcnt lgkmcnt(6)
v_mfma_f32_16x16x32_bf16 a[28:31], v[108:111], v[80:83], a[28:31]
v_mfma_f32_16x16x32_bf16 a[60:63], v[108:111], v[84:87], a[60:63]
v_mfma_f32_16x16x32_bf16 a[92:95], v[108:111], v[88:91], a[92:95]
v_mfma_f32_16x16x32_bf16 a[124:127], v[108:111], v[92:95], a[124:127]
ds_read_b64_tr_b16 v[108:109], v21 offset:57344
ds_read_b64_tr_b16 v[110:111], v29 offset:57344
s_waitcnt vmcnt(0)
s_waitcnt lgkmcnt(6)
v_mfma_f32_16x16x32_bf16 a[0:3], v[96:99], v[48:51], a[0:3]
v_mfma_f32_16x16x32_bf16 a[32:35], v[96:99], v[52:55], a[32:35]
v_mfma_f32_16x16x32_bf16 a[64:67], v[96:99], v[56:59], a[64:67]
v_mfma_f32_16x16x32_bf16 a[96:99], v[96:99], v[60:63], a[96:99]
ds_read_b64_tr_b16 v[96:97], v22 offset:57344
ds_read_b64_tr_b16 v[98:99], v30 offset:57344
s_waitcnt lgkmcnt(6)
v_mfma_f32_16x16x32_bf16 a[4:7], v[100:103], v[48:51], a[4:7]
v_mfma_f32_16x16x32_bf16 a[36:39], v[100:103], v[52:55], a[36:39]
v_mfma_f32_16x16x32_bf16 a[68:71], v[100:103], v[56:59], a[68:71]
v_mfma_f32_16x16x32_bf16 a[100:103], v[100:103], v[60:63], a[100:103]
ds_read_b64_tr_b16 v[100:101], v23 offset:57344
ds_read_b64_tr_b16 v[102:103], v31 offset:57344
s_waitcnt lgkmcnt(6)
v_mfma_f32_16x16x32_bf16 a[8:11], v[104:107], v[48:51], a[8:11]
v_mfma_f32_16x16x32_bf16 a[40:43], v[104:107], v[52:55], a[40:43]
v_mfma_f32_16x16x32_bf16 a[72:75], v[104:107], v[56:59], a[72:75]
v_mfma_f32_16x16x32_bf16 a[104:107], v[104:107], v[60:63], a[104:107]
ds_read_b64_tr_b16 v[104:105], v24 offset:57344
ds_read_b64_tr_b16 v[106:107], v32 offset:57344
s_waitcnt lgkmcnt(6)
v_mfma_f32_16x16x32_bf16 a[12:15], v[108:111], v[48:51], a[12:15]
v_mfma_f32_16x16x32_bf16 a[44:47], v[108:111], v[52:55], a[44:47]
v_mfma_f32_16x16x32_bf16 a[76:79], v[108:111], v[56:59], a[76:79]
v_mfma_f32_16x16x32_bf16 a[108:111], v[108:111], v[60:63], a[108:111]
ds_read_b64_tr_b16 v[108:109], v25 offset:57344
ds_read_b64_tr_b16 v[110:111], v33 offset:57344
s_waitcnt lgkmcnt(6)
v_mfma_f32_16x16x32_bf16 a[16:19], v[96:99], v[48:51], a[16:19]
v_mfma_f32_16x16x32_bf16 a[48:51], v[96:99], v[52:55], a[48:51]
v_mfma_f32_16x16x32_bf16 a[80:83], v[96:99], v[56:59], a[80:83]
v_mfma_f32_16x16x32_bf16 a[112:115], v[96:99], v[60:63], a[112:115]
s_waitcnt lgkmcnt(4)
v_mfma_f32_16x16x32_bf16 a[20:23], v[100:103], v[48:51], a[20:23]
v_mfma_f32_16x16x32_bf16 a[52:55], v[100:103], v[52:55], a[52:55]
v_mfma_f32_16x16x32_bf16 a[84:87], v[100:103], v[56:59], a[84:87]
v_mfma_f32_16x16x32_bf16 a[116:119], v[100:103], v[60:63], a[116:119]
s_waitcnt lgkmcnt(2)
v_mfma_f32_16x16x32_bf16 a[24:27], v[104:107], v[48:51], a[24:27]
v_mfma_f32_16x16x32_bf16 a[56:59], v[104:107], v[52:55], a[56:59]
v_mfma_f32_16x16x32_bf16 a[88:91], v[104:107], v[56:59], a[88:91]
v_mfma_f32_16x16x32_bf16 a[120:123], v[104:107], v[60:63], a[120:123]
s_waitcnt lgkmcnt(0)
v_mfma_f32_16x16x32_bf16 a[28:31], v[108:111], v[48:51], a[28:31]
v_mfma_f32_16x16x32_bf16 a[60:63], v[108:111], v[52:55], a[60:63]
v_mfma_f32_16x16x32_bf16 a[92:95], v[108:111], v[56:59], a[92:95]
v_mfma_f32_16x16x32_bf16 a[124:127], v[108:111], v[60:63], a[124:127]
s_lshl_b32 s42, s52, 2
s_add_u32 s42, s42, s29
s_lshl_b32 s42, s42, 6
s_add_u32 s42, s42, s53
s_lshl_b32 s42, s42, 13
s_add_u32 s42, s42, 67108864
s_nop 7
v_accvgpr_read_b32 v52, a0
v_accvgpr_read_b32 v56, a4
v_accvgpr_read_b32 v53, a1
v_accvgpr_read_b32 v57, a5
v_accvgpr_read_b32 v54, a2
v_accvgpr_read_b32 v58, a6
v_accvgpr_read_b32 v55, a3
v_accvgpr_read_b32 v59, a7
v_cvt_pk_bf16_f32 v48, v52, v53
v_cvt_pk_bf16_f32 v49, v54, v55
v_cvt_pk_bf16_f32 v50, v56, v57
v_cvt_pk_bf16_f32 v51, v58, v59
s_add_u32 s43, s42, 0
buffer_store_dwordx4 v[48:51], v1, s[8:11], s43 offen offset:0 sc1
v_accvgpr_read_b32 v64, a8
v_accvgpr_read_b32 v68, a12
v_accvgpr_read_b32 v65, a9
v_accvgpr_read_b32 v69, a13
v_accvgpr_read_b32 v66, a10
v_accvgpr_read_b32 v70, a14
v_accvgpr_read_b32 v67, a11
v_accvgpr_read_b32 v71, a15
v_cvt_pk_bf16_f32 v60, v64, v65
v_cvt_pk_bf16_f32 v61, v66, v67
v_cvt_pk_bf16_f32 v62, v68, v69
v_cvt_pk_bf16_f32 v63, v70, v71
s_add_u32 s43, s42, 0
buffer_store_dwordx4 v[60:63], v1, s[8:11], s43 offen offset:1024 sc1
v_accvgpr_read_b32 v76, a16
v_accvgpr_read_b32 v80, a20
v_accvgpr_read_b32 v77, a17
v_accvgpr_read_b32 v81, a21
v_accvgpr_read_b32 v78, a18
v_accvgpr_read_b32 v82, a22
v_accvgpr_read_b32 v79, a19
v_accvgpr_read_b32 v83, a23
v_cvt_pk_bf16_f32 v72, v76, v77
v_cvt_pk_bf16_f32 v73, v78, v79
v_cvt_pk_bf16_f32 v74, v80, v81
v_cvt_pk_bf16_f32 v75, v82, v83
s_add_u32 s43, s42, 0
buffer_store_dwordx4 v[72:75], v1, s[8:11], s43 offen offset:2048 sc1
v_accvgpr_read_b32 v88, a24
v_accvgpr_read_b32 v92, a28
v_accvgpr_read_b32 v89, a25
v_accvgpr_read_b32 v93, a29
v_accvgpr_read_b32 v90, a26
v_accvgpr_read_b32 v94, a30
v_accvgpr_read_b32 v91, a27
v_accvgpr_read_b32 v95, a31
v_cvt_pk_bf16_f32 v84, v88, v89
v_cvt_pk_bf16_f32 v85, v90, v91
v_cvt_pk_bf16_f32 v86, v92, v93
v_cvt_pk_bf16_f32 v87, v94, v95
s_add_u32 s43, s42, 0
buffer_store_dwordx4 v[84:87], v1, s[8:11], s43 offen offset:3072 sc1
v_accvgpr_read_b32 v52, a32
v_accvgpr_read_b32 v56, a36
v_accvgpr_read_b32 v53, a33
v_accvgpr_read_b32 v57, a37
v_accvgpr_read_b32 v54, a34
v_accvgpr_read_b32 v58, a38
v_accvgpr_read_b32 v55, a35
v_accvgpr_read_b32 v59, a39
v_cvt_pk_bf16_f32 v48, v52, v53
v_cvt_pk_bf16_f32 v49, v54, v55
v_cvt_pk_bf16_f32 v50, v56, v57
v_cvt_pk_bf16_f32 v51, v58, v59
s_add_u32 s43, s42, 4096
buffer_store_dwordx4 v[48:51], v1, s[8:11], s43 offen offset:0 sc1
v_accvgpr_read_b32 v64, a40
v_accvgpr_read_b32 v68, a44
v_accvgpr_read_b32 v65, a41
v_accvgpr_read_b32 v69, a45
v_accvgpr_read_b32 v66, a42
v_accvgpr_read_b32 v70, a46
v_accvgpr_read_b32 v67, a43
v_accvgpr_read_b32 v71, a47
v_cvt_pk_bf16_f32 v60, v64, v65
v_cvt_pk_bf16_f32 v61, v66, v67
v_cvt_pk_bf16_f32 v62, v68, v69
v_cvt_pk_bf16_f32 v63, v70, v71
s_add_u32 s43, s42, 4096
buffer_store_dwordx4 v[60:63], v1, s[8:11], s43 offen offset:1024 sc1
v_accvgpr_read_b32 v76, a48
v_accvgpr_read_b32 v80, a52
v_accvgpr_read_b32 v77, a49
v_accvgpr_read_b32 v81, a53
v_accvgpr_read_b32 v78, a50
v_accvgpr_read_b32 v82, a54
v_accvgpr_read_b32 v79, a51
v_accvgpr_read_b32 v83, a55
v_cvt_pk_bf16_f32 v72, v76, v77
v_cvt_pk_bf16_f32 v73, v78, v79
v_cvt_pk_bf16_f32 v74, v80, v81
v_cvt_pk_bf16_f32 v75, v82, v83
s_add_u32 s43, s42, 4096
buffer_store_dwordx4 v[72:75], v1, s[8:11], s43 offen offset:2048 sc1
v_accvgpr_read_b32 v88, a56
v_accvgpr_read_b32 v92, a60
v_accvgpr_read_b32 v89, a57
v_accvgpr_read_b32 v93, a61
v_accvgpr_read_b32 v90, a58
v_accvgpr_read_b32 v94, a62
v_accvgpr_read_b32 v91, a59
v_accvgpr_read_b32 v95, a63
v_cvt_pk_bf16_f32 v84, v88, v89
v_cvt_pk_bf16_f32 v85, v90, v91
v_cvt_pk_bf16_f32 v86, v92, v93
v_cvt_pk_bf16_f32 v87, v94, v95
s_add_u32 s43, s42, 4096
buffer_store_dwordx4 v[84:87], v1, s[8:11], s43 offen offset:3072 sc1
v_accvgpr_read_b32 v52, a64
v_accvgpr_read_b32 v56, a68
v_accvgpr_read_b32 v53, a65
v_accvgpr_read_b32 v57, a69
v_accvgpr_read_b32 v54, a66
v_accvgpr_read_b32 v58, a70
v_accvgpr_read_b32 v55, a67
v_accvgpr_read_b32 v59, a71
v_cvt_pk_bf16_f32 v48, v52, v53
v_cvt_pk_bf16_f32 v49, v54, v55
v_cvt_pk_bf16_f32 v50, v56, v57
v_cvt_pk_bf16_f32 v51, v58, v59
s_add_u32 s43, s42, 262144
buffer_store_dwordx4 v[48:51], v1, s[8:11], s43 offen offset:0 sc1
v_accvgpr_read_b32 v64, a72
v_accvgpr_read_b32 v68, a76
v_accvgpr_read_b32 v65, a73
v_accvgpr_read_b32 v69, a77
v_accvgpr_read_b32 v66, a74
v_accvgpr_read_b32 v70, a78
v_accvgpr_read_b32 v67, a75
v_accvgpr_read_b32 v71, a79
v_cvt_pk_bf16_f32 v60, v64, v65
v_cvt_pk_bf16_f32 v61, v66, v67
v_cvt_pk_bf16_f32 v62, v68, v69
v_cvt_pk_bf16_f32 v63, v70, v71
s_add_u32 s43, s42, 262144
buffer_store_dwordx4 v[60:63], v1, s[8:11], s43 offen offset:1024 sc1
v_accvgpr_read_b32 v76, a80
v_accvgpr_read_b32 v80, a84
v_accvgpr_read_b32 v77, a81
v_accvgpr_read_b32 v81, a85
v_accvgpr_read_b32 v78, a82
v_accvgpr_read_b32 v82, a86
v_accvgpr_read_b32 v79, a83
v_accvgpr_read_b32 v83, a87
v_cvt_pk_bf16_f32 v72, v76, v77
v_cvt_pk_bf16_f32 v73, v78, v79
v_cvt_pk_bf16_f32 v74, v80, v81
v_cvt_pk_bf16_f32 v75, v82, v83
s_add_u32 s43, s42, 262144
buffer_store_dwordx4 v[72:75], v1, s[8:11], s43 offen offset:2048 sc1
v_accvgpr_read_b32 v88, a88
v_accvgpr_read_b32 v92, a92
v_accvgpr_read_b32 v89, a89
v_accvgpr_read_b32 v93, a93
v_accvgpr_read_b32 v90, a90
v_accvgpr_read_b32 v94, a94
v_accvgpr_read_b32 v91, a91
v_accvgpr_read_b32 v95, a95
v_cvt_pk_bf16_f32 v84, v88, v89
v_cvt_pk_bf16_f32 v85, v90, v91
v_cvt_pk_bf16_f32 v86, v92, v93
v_cvt_pk_bf16_f32 v87, v94, v95
s_add_u32 s43, s42, 262144
buffer_store_dwordx4 v[84:87], v1, s[8:11], s43 offen offset:3072 sc1
v_accvgpr_read_b32 v52, a96
v_accvgpr_read_b32 v56, a100
v_accvgpr_read_b32 v53, a97
v_accvgpr_read_b32 v57, a101
v_accvgpr_read_b32 v54, a98
v_accvgpr_read_b32 v58, a102
v_accvgpr_read_b32 v55, a99
v_accvgpr_read_b32 v59, a103
v_cvt_pk_bf16_f32 v48, v52, v53
v_cvt_pk_bf16_f32 v49, v54, v55
v_cvt_pk_bf16_f32 v50, v56, v57
v_cvt_pk_bf16_f32 v51, v58, v59
s_add_u32 s43, s42, 266240
buffer_store_dwordx4 v[48:51], v1, s[8:11], s43 offen offset:0 sc1
v_accvgpr_read_b32 v64, a104
v_accvgpr_read_b32 v68, a108
v_accvgpr_read_b32 v65, a105
v_accvgpr_read_b32 v69, a109
v_accvgpr_read_b32 v66, a106
v_accvgpr_read_b32 v70, a110
v_accvgpr_read_b32 v67, a107
v_accvgpr_read_b32 v71, a111
v_cvt_pk_bf16_f32 v60, v64, v65
v_cvt_pk_bf16_f32 v61, v66, v67
v_cvt_pk_bf16_f32 v62, v68, v69
v_cvt_pk_bf16_f32 v63, v70, v71
s_add_u32 s43, s42, 266240
buffer_store_dwordx4 v[60:63], v1, s[8:11], s43 offen offset:1024 sc1
v_accvgpr_read_b32 v76, a112
v_accvgpr_read_b32 v80, a116
v_accvgpr_read_b32 v77, a113
v_accvgpr_read_b32 v81, a117
v_accvgpr_read_b32 v78, a114
v_accvgpr_read_b32 v82, a118
v_accvgpr_read_b32 v79, a115
v_accvgpr_read_b32 v83, a119
v_cvt_pk_bf16_f32 v72, v76, v77
v_cvt_pk_bf16_f32 v73, v78, v79
v_cvt_pk_bf16_f32 v74, v80, v81
v_cvt_pk_bf16_f32 v75, v82, v83
s_add_u32 s43, s42, 266240
buffer_store_dwordx4 v[72:75], v1, s[8:11], s43 offen offset:2048 sc1
v_accvgpr_read_b32 v88, a120
v_accvgpr_read_b32 v92, a124
v_accvgpr_read_b32 v89, a121
v_accvgpr_read_b32 v93, a125
v_accvgpr_read_b32 v90, a122
v_accvgpr_read_b32 v94, a126
v_accvgpr_read_b32 v91, a123
v_accvgpr_read_b32 v95, a127
v_cvt_pk_bf16_f32 v84, v88, v89
v_cvt_pk_bf16_f32 v85, v90, v91
v_cvt_pk_bf16_f32 v86, v92, v93
v_cvt_pk_bf16_f32 v87, v94, v95
s_add_u32 s43, s42, 266240
buffer_store_dwordx4 v[84:87], v1, s[8:11], s43 offen offset:3072 sc1
s_lshl_b32 s3, s52, 7
s_add_u32 s3, s3, 3072
s_waitcnt vmcnt(0)
s_barrier
s_cmp_lg_u32 s29, 0
s_cbranch_scc1 SG_67
v_mov_b32 v2, s3
v_mov_b32 v4, 1
s_mov_b32 s42, 4194304
s_mov_b64 exec, 1
buffer_atomic_add v4, v2, s[84:87], s42 offen sc1
s_mov_b64 exec, -1
SG_67:
s_getpc_b64 s[90:91]
LJ_68:
s_add_u32 s90, s90, L_m_next-LJ_68
s_addc_u32 s91, s91, -1
s_setpc_b64 s[90:91]
L_w_Z2:
s_load_dwordx2 s[16:17], s[0:1], 64
v_and_b32 v34, 63, v0
v_lshlrev_b32 v1, 4, v34
s_mul_i32 s42, s29, 896
s_add_u32 s42, s42, 0
v_add_u32 v35, s42, v34
v_mul_u32_u24 v36, 9363, v35
v_lshrrev_b32 v36, 20, v36
v_mul_u32_u24 v37, 112, v36
v_sub_u32 v37, v35, v37
v_lshrrev_b32 v38, 2, v36
v_lshrrev_b32 v39, 3, v36
v_xor_b32 v38, v38, v39
v_and_b32 v38, 1, v38
v_and_b32 v39, 3, v36
v_lshl_or_b32 v38, v38, 2, v39
v_lshlrev_b32 v38, 1, v38
v_xor_b32 v37, v37, v38
s_mov_b32 s42, 3584
v_mul_lo_u32 v36, v36, s42
v_lshl_add_u32 v2, v37, 4, v36
s_mul_i32 s42, s29, 896
s_add_u32 s42, s42, 64
v_add_u32 v35, s42, v34
v_mul_u32_u24 v36, 9363, v35
v_lshrrev_b32 v36, 20, v36
v_mul_u32_u24 v37, 112, v36
v_sub_u32 v37, v35, v37
v_lshrrev_b32 v38, 2, v36
v_lshrrev_b32 v39, 3, v36
v_xor_b32 v38, v38, v39
v_and_b32 v38, 1, v38
v_and_b32 v39, 3, v36
v_lshl_or_b32 v38, v38, 2, v39
v_lshlrev_b32 v38, 1, v38
v_xor_b32 v37, v37, v38
s_mov_b32 s42, 3584
v_mul_lo_u32 v36, v36, s42
v_lshl_add_u32 v3, v37, 4, v36
s_mul_i32 s42, s29, 896
s_add_u32 s42, s42, 128
v_add_u32 v35, s42, v34
v_mul_u32_u24 v36, 9363, v35
v_lshrrev_b32 v36, 20, v36
v_mul_u32_u24 v37, 112, v36
v_sub_u32 v37, v35, v37
v_lshrrev_b32 v38, 2, v36
v_lshrrev_b32 v39, 3, v36
v_xor_b32 v38, v38, v39
v_and_b32 v38, 1, v38
v_and_b32 v39, 3, v36
v_lshl_or_b32 v38, v38, 2, v39
v_lshlrev_b32 v38, 1, v38
v_xor_b32 v37, v37, v38
s_mov_b32 s42, 3584
v_mul_lo_u32 v36, v36, s42
v_lshl_add_u32 v4, v37, 4, v36
s_mul_i32 s42, s29, 896
s_add_u32 s42, s42, 192
v_add_u32 v35, s42, v34
v_mul_u32_u24 v36, 9363, v35
v_lshrrev_b32 v36, 20, v36
v_mul_u32_u24 v37, 112, v36
v_sub_u32 v37, v35, v37
v_lshrrev_b32 v38, 2, v36
v_lshrrev_b32 v39, 3, v36
v_xor_b32 v38, v38, v39
v_and_b32 v38, 1, v38
v_and_b32 v39, 3, v36
v_lshl_or_b32 v38, v38, 2, v39
v_lshlrev_b32 v38, 1, v38
v_xor_b32 v37, v37, v38
s_mov_b32 s42, 3584
v_mul_lo_u32 v36, v36, s42
v_lshl_add_u32 v5, v37, 4, v36
s_mul_i32 s42, s29, 896
s_add_u32 s42, s42, 256
v_add_u32 v35, s42, v34
v_mul_u32_u24 v36, 9363, v35
v_lshrrev_b32 v36, 20, v36
v_mul_u32_u24 v37, 112, v36
v_sub_u32 v37, v35, v37
v_lshrrev_b32 v38, 2, v36
v_lshrrev_b32 v39, 3, v36
v_xor_b32 v38, v38, v39
v_and_b32 v38, 1, v38
v_and_b32 v39, 3, v36
v_lshl_or_b32 v38, v38, 2, v39
v_lshlrev_b32 v38, 1, v38
v_xor_b32 v37, v37, v38
s_mov_b32 s42, 3584
v_mul_lo_u32 v36, v36, s42
v_lshl_add_u32 v6, v37, 4, v36
s_mul_i32 s42, s29, 896
s_add_u32 s42, s42, 320
v_add_u32 v35, s42, v34
v_mul_u32_u24 v36, 9363, v35
v_lshrrev_b32 v36, 20, v36
v_mul_u32_u24 v37, 112, v36
v_sub_u32 v37, v35, v37
v_lshrrev_b32 v38, 2, v36
v_lshrrev_b32 v39, 3, v36
v_xor_b32 v38, v38, v39
v_and_b32 v38, 1, v38
v_and_b32 v39, 3, v36
v_lshl_or_b32 v38, v38, 2, v39
v_lshlrev_b32 v38, 1, v38
v_xor_b32 v37, v37, v38
s_mov_b32 s42, 3584
v_mul_lo_u32 v36, v36, s42
v_lshl_add_u32 v7, v37, 4, v36
s_mul_i32 s42, s29, 896
s_add_u32 s42, s42, 384
v_add_u32 v35, s42, v34
v_mul_u32_u24 v36, 9363, v35
v_lshrrev_b32 v36, 20, v36
v_mul_u32_u24 v37, 112, v36
v_sub_u32 v37, v35, v37
v_lshrrev_b32 v38, 2, v36
v_lshrrev_b32 v39, 3, v36
v_xor_b32 v38, v38, v39
v_and_b32 v38, 1, v38
v_and_b32 v39, 3, v36
v_lshl_or_b32 v38, v38, 2, v39
v_lshlrev_b32 v38, 1, v38
v_xor_b32 v37, v37, v38
s_mov_b32 s42, 3584
v_mul_lo_u32 v36, v36, s42
v_lshl_add_u32 v8, v37, 4, v36
s_mul_i32 s42, s29, 896
s_add_u32 s42, s42, 448
v_add_u32 v35, s42, v34
v_mul_u32_u24 v36, 9363, v35
v_lshrrev_b32 v36, 20, v36
v_mul_u32_u24 v37, 112, v36
v_sub_u32 v37, v35, v37
v_lshrrev_b32 v38, 2, v36
v_lshrrev_b32 v39, 3, v36
v_xor_b32 v38, v38, v39
v_and_b32 v38, 1, v38
v_and_b32 v39, 3, v36
v_lshl_or_b32 v38, v38, 2, v39
v_lshlrev_b32 v38, 1, v38
v_xor_b32 v37, v37, v38
s_mov_b32 s42, 3584
v_mul_lo_u32 v36, v36, s42
v_lshl_add_u32 v9, v37, 4, v36
s_mul_i32 s42, s29, 896
s_add_u32 s42, s42, 512
v_add_u32 v35, s42, v34
v_mul_u32_u24 v36, 9363, v35
v_lshrrev_b32 v36, 20, v36
v_mul_u32_u24 v37, 112, v36
v_sub_u32 v37, v35, v37
v_lshrrev_b32 v38, 2, v36
v_lshrrev_b32 v39, 3, v36
v_xor_b32 v38, v38, v39
v_and_b32 v38, 1, v38
v_and_b32 v39, 3, v36
v_lshl_or_b32 v38, v38, 2, v39
v_lshlrev_b32 v38, 1, v38
v_xor_b32 v37, v37, v38
s_mov_b32 s42, 3584
v_mul_lo_u32 v36, v36, s42
v_lshl_add_u32 v10, v37, 4, v36
s_mul_i32 s42, s29, 896
s_add_u32 s42, s42, 576
v_add_u32 v35, s42, v34
v_mul_u32_u24 v36, 9363, v35
v_lshrrev_b32 v36, 20, v36
v_mul_u32_u24 v37, 112, v36
v_sub_u32 v37, v35, v37
v_lshrrev_b32 v38, 2, v36
v_lshrrev_b32 v39, 3, v36
v_xor_b32 v38, v38, v39
v_and_b32 v38, 1, v38
v_and_b32 v39, 3, v36
v_lshl_or_b32 v38, v38, 2, v39
v_lshlrev_b32 v38, 1, v38
v_xor_b32 v37, v37, v38
s_mov_b32 s42, 3584
v_mul_lo_u32 v36, v36, s42
v_lshl_add_u32 v11, v37, 4, v36
s_mul_i32 s42, s29, 896
s_add_u32 s42, s42, 640
v_add_u32 v35, s42, v34
v_mul_u32_u24 v36, 9363, v35
v_lshrrev_b32 v36, 20, v36
v_mul_u32_u24 v37, 112, v36
v_sub_u32 v37, v35, v37
v_lshrrev_b32 v38, 2, v36
v_lshrrev_b32 v39, 3, v36
v_xor_b32 v38, v38, v39
v_and_b32 v38, 1, v38
v_and_b32 v39, 3, v36
v_lshl_or_b32 v38, v38, 2, v39
v_lshlrev_b32 v38, 1, v38
v_xor_b32 v37, v37, v38
s_mov_b32 s42, 3584
v_mul_lo_u32 v36, v36, s42
v_lshl_add_u32 v12, v37, 4, v36
s_mul_i32 s42, s29, 896
s_add_u32 s42, s42, 704
v_add_u32 v35, s42, v34
v_mul_u32_u24 v36, 9363, v35
v_lshrrev_b32 v36, 20, v36
v_mul_u32_u24 v37, 112, v36
v_sub_u32 v37, v35, v37
v_lshrrev_b32 v38, 2, v36
v_lshrrev_b32 v39, 3, v36
v_xor_b32 v38, v38, v39
v_and_b32 v38, 1, v38
v_and_b32 v39, 3, v36
v_lshl_or_b32 v38, v38, 2, v39
v_lshlrev_b32 v38, 1, v38
v_xor_b32 v37, v37, v38
s_mov_b32 s42, 3584
v_mul_lo_u32 v36, v36, s42
v_lshl_add_u32 v13, v37, 4, v36
s_mul_i32 s42, s29, 896
s_add_u32 s42, s42, 768
v_add_u32 v35, s42, v34
v_mul_u32_u24 v36, 9363, v35
v_lshrrev_b32 v36, 20, v36
v_mul_u32_u24 v37, 112, v36
v_sub_u32 v37, v35, v37
v_lshrrev_b32 v38, 2, v36
v_lshrrev_b32 v39, 3, v36
v_xor_b32 v38, v38, v39
v_and_b32 v38, 1, v38
v_and_b32 v39, 3, v36
v_lshl_or_b32 v38, v38, 2, v39
v_lshlrev_b32 v38, 1, v38
v_xor_b32 v37, v37, v38
s_mov_b32 s42, 3584
v_mul_lo_u32 v36, v36, s42
v_lshl_add_u32 v14, v37, 4, v36
s_mul_i32 s42, s29, 896
s_add_u32 s42, s42, 832
v_add_u32 v35, s42, v34
v_mul_u32_u24 v36, 9363, v35
v_lshrrev_b32 v36, 20, v36
v_mul_u32_u24 v37, 112, v36
v_sub_u32 v37, v35, v37
v_lshrrev_b32 v38, 2, v36
v_lshrrev_b32 v39, 3, v36
v_xor_b32 v38, v38, v39
v_and_b32 v38, 1, v38
v_and_b32 v39, 3, v36
v_lshl_or_b32 v38, v38, 2, v39
v_lshlrev_b32 v38, 1, v38
v_xor_b32 v37, v37, v38
s_mov_b32 s42, 3584
v_mul_lo_u32 v36, v36, s42
v_lshl_add_u32 v15, v37, 4, v36
v_bfe_u32 v35, v34, 2, 2
v_lshrrev_b32 v36, 4, v34
v_lshl_add_u32 v37, v36, 3, v35
v_lshrrev_b32 v38, 2, v37
v_lshrrev_b32 v39, 3, v37
v_xor_b32 v38, v38, v39
v_and_b32 v38, 1, v38
v_and_b32 v39, 3, v37
v_lshl_or_b32 v38, v38, 2, v39
v_mul_u32_u24 v37, 1792, v37
v_and_b32 v39, 3, v34
v_lshl_add_u32 v37, v39, 3, v37
s_and_b32 s42, s29, 3
s_mul_i32 s42, s42, 14
s_add_u32 s42, s42, 0
s_and_b32 s43, s42, 7
s_lshr_b32 s42, s42, 3
s_lshl_b32 s42, s42, 8
s_add_u32 s42, s42, 0
v_xor_b32 v39, s43, v38
v_lshl_add_u32 v18, v39, 5, v37
v_add_u32 v18, s42, v18
s_and_b32 s42, s29, 3
s_mul_i32 s42, s42, 14
s_add_u32 s42, s42, 1
s_and_b32 s43, s42, 7
s_lshr_b32 s42, s42, 3
s_lshl_b32 s42, s42, 8
s_add_u32 s42, s42, 0
v_xor_b32 v39, s43, v38
v_lshl_add_u32 v19, v39, 5, v37
v_add_u32 v19, s42, v19
s_and_b32 s42, s29, 3
s_mul_i32 s42, s42, 14
s_add_u32 s42, s42, 2
s_and_b32 s43, s42, 7
s_lshr_b32 s42, s42, 3
s_lshl_b32 s42, s42, 8
s_add_u32 s42, s42, 0
v_xor_b32 v39, s43, v38
v_lshl_add_u32 v20, v39, 5, v37
v_add_u32 v20, s42, v20
s_and_b32 s42, s29, 3
s_mul_i32 s42, s42, 14
s_add_u32 s42, s42, 3
s_and_b32 s43, s42, 7
s_lshr_b32 s42, s42, 3
s_lshl_b32 s42, s42, 8
s_add_u32 s42, s42, 0
v_xor_b32 v39, s43, v38
v_lshl_add_u32 v21, v39, 5, v37
v_add_u32 v21, s42, v21
s_and_b32 s42, s29, 3
s_mul_i32 s42, s42, 14
s_add_u32 s42, s42, 4
s_and_b32 s43, s42, 7
s_lshr_b32 s42, s42, 3
s_lshl_b32 s42, s42, 8
s_add_u32 s42, s42, 0
v_xor_b32 v39, s43, v38
v_lshl_add_u32 v22, v39, 5, v37
v_add_u32 v22, s42, v22
s_and_b32 s42, s29, 3
s_mul_i32 s42, s42, 14
s_add_u32 s42, s42, 5
s_and_b32 s43, s42, 7
s_lshr_b32 s42, s42, 3
s_lshl_b32 s42, s42, 8
s_add_u32 s42, s42, 0
v_xor_b32 v39, s43, v38
v_lshl_add_u32 v23, v39, 5, v37
v_add_u32 v23, s42, v23
s_and_b32 s42, s29, 3
s_mul_i32 s42, s42, 14
s_add_u32 s42, s42, 6
s_and_b32 s43, s42, 7
s_lshr_b32 s42, s42, 3
s_lshl_b32 s42, s42, 8
s_add_u32 s42, s42, 0
v_xor_b32 v39, s43, v38
v_lshl_add_u32 v24, v39, 5, v37
v_add_u32 v24, s42, v24
s_and_b32 s42, s29, 3
s_mul_i32 s42, s42, 14
s_add_u32 s42, s42, 7
s_and_b32 s43, s42, 7
s_lshr_b32 s42, s42, 3
s_lshl_b32 s42, s42, 8
s_add_u32 s42, s42, 0
v_xor_b32 v39, s43, v38
v_lshl_add_u32 v25, v39, 5, v37
v_add_u32 v25, s42, v25
v_lshl_add_u32 v37, v36, 3, v35
v_add_u32 v37, 4, v37
v_lshrrev_b32 v38, 2, v37
v_lshrrev_b32 v39, 3, v37
v_xor_b32 v38, v38, v39
v_and_b32 v38, 1, v38
v_and_b32 v39, 3, v37
v_lshl_or_b32 v38, v38, 2, v39
v_mul_u32_u24 v37, 1792, v37
v_and_b32 v39, 3, v34
v_lshl_add_u32 v37, v39, 3, v37
s_and_b32 s42, s29, 3
s_mul_i32 s42, s42, 14
s_add_u32 s42, s42, 0
s_and_b32 s43, s42, 7
s_lshr_b32 s42, s42, 3
s_lshl_b32 s42, s42, 8
s_add_u32 s42, s42, 0
v_xor_b32 v39, s43, v38
v_lshl_add_u32 v26, v39, 5, v37
v_add_u32 v26, s42, v26
s_and_b32 s42, s29, 3
s_mul_i32 s42, s42, 14
s_add_u32 s42, s42, 1
s_and_b32 s43, s42, 7
s_lshr_b32 s42, s42, 3
s_lshl_b32 s42, s42, 8
s_add_u32 s42, s42, 0
v_xor_b32 v39, s43, v38
v_lshl_add_u32 v27, v39, 5, v37
v_add_u32 v27, s42, v27
s_and_b32 s42, s29, 3
s_mul_i32 s42, s42, 14
s_add_u32 s42, s42, 2
s_and_b32 s43, s42, 7
s_lshr_b32 s42, s42, 3
s_lshl_b32 s42, s42, 8
s_add_u32 s42, s42, 0
v_xor_b32 v39, s43, v38
v_lshl_add_u32 v28, v39, 5, v37
v_add_u32 v28, s42, v28
s_and_b32 s42, s29, 3
s_mul_i32 s42, s42, 14
s_add_u32 s42, s42, 3
s_and_b32 s43, s42, 7
s_lshr_b32 s42, s42, 3
s_lshl_b32 s42, s42, 8
s_add_u32 s42, s42, 0
v_xor_b32 v39, s43, v38
v_lshl_add_u32 v29, v39, 5, v37
v_add_u32 v29, s42, v29
s_and_b32 s42, s29, 3
s_mul_i32 s42, s42, 14
s_add_u32 s42, s42, 4
s_and_b32 s43, s42, 7
s_lshr_b32 s42, s42, 3
s_lshl_b32 s42, s42, 8
s_add_u32 s42, s42, 0
v_xor_b32 v39, s43, v38
v_lshl_add_u32 v30, v39, 5, v37
v_add_u32 v30, s42, v30
s_and_b32 s42, s29, 3
s_mul_i32 s42, s42, 14
s_add_u32 s42, s42, 5
s_and_b32 s43, s42, 7
s_lshr_b32 s42, s42, 3
s_lshl_b32 s42, s42, 8
s_add_u32 s42, s42, 0
v_xor_b32 v39, s43, v38
v_lshl_add_u32 v31, v39, 5, v37
v_add_u32 v31, s42, v31
s_and_b32 s42, s29, 3
s_mul_i32 s42, s42, 14
s_add_u32 s42, s42, 6
s_and_b32 s43, s42, 7
s_lshr_b32 s42, s42, 3
s_lshl_b32 s42, s42, 8
s_add_u32 s42, s42, 0
v_xor_b32 v39, s43, v38
v_lshl_add_u32 v32, v39, 5, v37
v_add_u32 v32, s42, v32
s_and_b32 s42, s29, 3
s_mul_i32 s42, s42, 14
s_add_u32 s42, s42, 7
s_and_b32 s43, s42, 7
s_lshr_b32 s42, s42, 3
s_lshl_b32 s42, s42, 8
s_add_u32 s42, s42, 0
v_xor_b32 v39, s43, v38
v_lshl_add_u32 v33, v39, 5, v37
v_add_u32 v33, s42, v33
s_mov_b32 s52, s3
s_waitcnt lgkmcnt(0)
s_mov_b32 s12, s16
s_and_b32 s13, s17, 0xffff
s_mov_b32 s14, 0x1c0000
s_mov_b32 s15, 0x00020000
s_mul_i32 s48, s52, 32768
s_add_u32 s48, s48, 0
s_mov_b32 s49, 1792
s_mul_i32 s51, s29, 14336
s_add_u32 s42, s49, 0
s_add_u32 m0, s51, 0
s_nop 0
buffer_load_dwordx4 v2, s[12:15], s42 offen lds
s_add_u32 m0, s51, 1024
s_nop 0
buffer_load_dwordx4 v3, s[12:15], s42 offen lds
s_add_u32 m0, s51, 2048
s_nop 0
buffer_load_dwordx4 v4, s[12:15], s42 offen lds
s_add_u32 m0, s51, 3072
s_nop 0
buffer_load_dwordx4 v5, s[12:15], s42 offen lds
s_add_u32 m0, s51, 4096
s_nop 0
buffer_load_dwordx4 v6, s[12:15], s42 offen lds
s_add_u32 m0, s51, 5120
s_nop 0
buffer_load_dwordx4 v7, s[12:15], s42 offen lds
s_add_u32 m0, s51, 6144
s_nop 0
buffer_load_dwordx4 v8, s[12:15], s42 offen lds
s_add_u32 m0, s51, 7168
s_nop 0
buffer_load_dwordx4 v9, s[12:15], s42 offen lds
s_add_u32 m0, s51, 8192
s_nop 0
buffer_load_dwordx4 v10, s[12:15], s42 offen lds
s_add_u32 m0, s51, 9216
s_nop 0
buffer_load_dwordx4 v11, s[12:15], s42 offen lds
s_add_u32 m0, s51, 10240
s_nop 0
buffer_load_dwordx4 v12, s[12:15], s42 offen lds
s_add_u32 m0, s51, 11264
s_nop 0
buffer_load_dwordx4 v13, s[12:15], s42 offen lds
s_add_u32 m0, s51, 12288
s_nop 0
buffer_load_dwordx4 v14, s[12:15], s42 offen lds
s_add_u32 m0, s51, 13312
s_nop 0
buffer_load_dwordx4 v15, s[12:15], s42 offen lds
buffer_load_dwordx4 v[48:51], v1, s[8:11], s48 offen offset:0
s_add_u32 s43, s48, 16384
buffer_load_dwordx4 v[52:55], v1, s[8:11], s43 offen offset:0
buffer_load_dwordx4 v[56:59], v1, s[8:11], s48 offen offset:1024
s_add_u32 s43, s48, 16384
buffer_load_dwordx4 v[60:63], v1, s[8:11], s43 offen offset:1024
buffer_load_dwordx4 v[64:67], v1, s[8:11], s48 offen offset:2048
s_add_u32 s43, s48, 16384
buffer_load_dwordx4 v[68:71], v1, s[8:11], s43 offen offset:2048
buffer_load_dwordx4 v[72:75], v1, s[8:11], s48 offen offset:3072
s_add_u32 s43, s48, 16384
buffer_load_dwordx4 v[76:79], v1, s[8:11], s43 offen offset:3072
s_waitcnt vmcnt(8)
s_barrier
s_add_u32 s42, s49, 114688
s_add_u32 m0, s51, 57344
s_nop 0
buffer_load_dwordx4 v2, s[12:15], s42 offen lds
s_add_u32 m0, s51, 58368
s_nop 0
buffer_load_dwordx4 v3, s[12:15], s42 offen lds
s_add_u32 m0, s51, 59392
s_nop 0
buffer_load_dwordx4 v4, s[12:15], s42 offen lds
s_add_u32 m0, s51, 60416
s_nop 0
buffer_load_dwordx4 v5, s[12:15], s42 offen lds
s_add_u32 m0, s51, 61440
s_nop 0
buffer_load_dwordx4 v6, s[12:15], s42 offen lds
s_add_u32 m0, s51, 62464
s_nop 0
buffer_load_dwordx4 v7, s[12:15], s42 offen lds
s_add_u32 m0, s51, 63488
s_nop 0
buffer_load_dwordx4 v8, s[12:15], s42 offen lds
s_add_u32 m0, s51, 64512
s_nop 0
buffer_load_dwordx4 v9, s[12:15], s42 offen lds
s_add_u32 m0, s51, 65536
s_nop 0
buffer_load_dwordx4 v10, s[12:15], s42 offen lds
s_add_u32 m0, s51, 66560
s_nop 0
buffer_load_dwordx4 v11, s[12:15], s42 offen lds
s_add_u32 m0, s51, 67584
s_nop 0
buffer_load_dwordx4 v12, s[12:15], s42 offen lds
s_add_u32 m0, s51, 68608
s_nop 0
buffer_load_dwordx4 v13, s[12:15], s42 offen lds
s_add_u32 m0, s51, 69632
s_nop 0
buffer_load_dwordx4 v14, s[12:15], s42 offen lds
s_add_u32 m0, s51, 70656
s_nop 0
buffer_load_dwordx4 v15, s[12:15], s42 offen lds
ds_read_b64_tr_b16 v[80:81], v18 offset:0
ds_read_b64_tr_b16 v[82:83], v26 offset:0
ds_read_b64_tr_b16 v[84:85], v19 offset:0
ds_read_b64_tr_b16 v[86:87], v27 offset:0
ds_read_b64_tr_b16 v[88:89], v20 offset:0
ds_read_b64_tr_b16 v[90:91], v28 offset:0
ds_read_b64_tr_b16 v[92:93], v21 offset:0
ds_read_b64_tr_b16 v[94:95], v29 offset:0
s_waitcnt vmcnt(20)
s_waitcnt lgkmcnt(6)
v_mfma_f32_16x16x32_bf16 a[0:3], v[48:51], v[80:83], 0
v_mfma_f32_16x16x32_bf16 a[56:59], v[52:55], v[80:83], 0
ds_read_b64_tr_b16 v[80:81], v22 offset:0
ds_read_b64_tr_b16 v[82:83], v30 offset:0
s_waitcnt lgkmcnt(6)
v_mfma_f32_16x16x32_bf16 a[4:7], v[48:51], v[84:87], 0
v_mfma_f32_16x16x32_bf16 a[60:63], v[52:55], v[84:87], 0
ds_read_b64_tr_b16 v[84:85], v23 offset:0
ds_read_b64_tr_b16 v[86:87], v31 offset:0
s_waitcnt lgkmcnt(6)
v_mfma_f32_16x16x32_bf16 a[8:11], v[48:51], v[88:91], 0
v_mfma_f32_16x16x32_bf16 a[64:67], v[52:55], v[88:91], 0
ds_read_b64_tr_b16 v[88:89], v24 offset:0
ds_read_b64_tr_b16 v[90:91], v32 offset:0
s_waitcnt lgkmcnt(6)
v_mfma_f32_16x16x32_bf16 a[12:15], v[48:51], v[92:95], 0
v_mfma_f32_16x16x32_bf16 a[68:71], v[52:55], v[92:95], 0
ds_read_b64_tr_b16 v[92:93], v25 offset:0
ds_read_b64_tr_b16 v[94:95], v33 offset:0
s_waitcnt lgkmcnt(6)
v_mfma_f32_16x16x32_bf16 a[16:19], v[48:51], v[80:83], 0
v_mfma_f32_16x16x32_bf16 a[72:75], v[52:55], v[80:83], 0
ds_read_b64_tr_b16 v[80:81], v18 offset:256
ds_read_b64_tr_b16 v[82:83], v26 offset:256
s_waitcnt lgkmcnt(6)
v_mfma_f32_16x16x32_bf16 a[20:23], v[48:51], v[84:87], 0
v_mfma_f32_16x16x32_bf16 a[76:79], v[52:55], v[84:87], 0
ds_read_b64_tr_b16 v[84:85], v19 offset:256
ds_read_b64_tr_b16 v[86:87], v27 offset:256
s_waitcnt lgkmcnt(6)
v_mfma_f32_16x16x32_bf16 a[24:27], v[48:51], v[88:91], 0
v_mfma_f32_16x16x32_bf16 a[80:83], v[52:55], v[88:91], 0
ds_read_b64_tr_b16 v[88:89], v20 offset:256
ds_read_b64_tr_b16 v[90:91], v28 offset:256
s_waitcnt lgkmcnt(6)
v_mfma_f32_16x16x32_bf16 a[28:31], v[48:51], v[92:95], 0
v_mfma_f32_16x16x32_bf16 a[84:87], v[52:55], v[92:95], 0
ds_read_b64_tr_b16 v[92:93], v21 offset:256
ds_read_b64_tr_b16 v[94:95], v29 offset:256
s_waitcnt lgkmcnt(6)
v_mfma_f32_16x16x32_bf16 a[32:35], v[48:51], v[80:83], 0
v_mfma_f32_16x16x32_bf16 a[88:91], v[52:55], v[80:83], 0
ds_read_b64_tr_b16 v[80:81], v22 offset:256
ds_read_b64_tr_b16 v[82:83], v30 offset:256
s_waitcnt lgkmcnt(6)
v_mfma_f32_16x16x32_bf16 a[36:39], v[48:51], v[84:87], 0
v_mfma_f32_16x16x32_bf16 a[92:95], v[52:55], v[84:87], 0
ds_read_b64_tr_b16 v[84:85], v23 offset:256
ds_read_b64_tr_b16 v[86:87], v31 offset:256
s_waitcnt lgkmcnt(6)
v_mfma_f32_16x16x32_bf16 a[40:43], v[48:51], v[88:91], 0
v_mfma_f32_16x16x32_bf16 a[96:99], v[52:55], v[88:91], 0
s_waitcnt lgkmcnt(4)
v_mfma_f32_16x16x32_bf16 a[44:47], v[48:51], v[92:95], 0
v_mfma_f32_16x16x32_bf16 a[100:103], v[52:55], v[92:95], 0
s_waitcnt lgkmcnt(2)
v_mfma_f32_16x16x32_bf16 a[48:51], v[48:51], v[80:83], 0
v_mfma_f32_16x16x32_bf16 a[104:107], v[52:55], v[80:83], 0
s_waitcnt lgkmcnt(0)
v_mfma_f32_16x16x32_bf16 a[52:55], v[48:51], v[84:87], 0
v_mfma_f32_16x16x32_bf16 a[108:111], v[52:55], v[84:87], 0
s_add_u32 s43, s48, 4096
buffer_load_dwordx4 v[48:51], v1, s[8:11], s43 offen offset:0
s_add_u32 s43, s48, 20480
buffer_load_dwordx4 v[52:55], v1, s[8:11], s43 offen offset:0
s_waitcnt vmcnt(2)
s_barrier
s_add_u32 s42, s49, 229376
s_add_u32 m0, s51, 0
s_nop 0
buffer_load_dwordx4 v2, s[12:15], s42 offen lds
s_add_u32 m0, s51, 1024
s_nop 0
buffer_load_dwordx4 v3, s[12:15], s42 offen lds
s_add_u32 m0, s51, 2048
s_nop 0
buffer_load_dwordx4 v4, s[12:15], s42 offen lds
s_add_u32 m0, s51, 3072
s_nop 0
buffer_load_dwordx4 v5, s[12:15], s42 offen lds
s_add_u32 m0, s51, 4096
s_nop 0
buffer_load_dwordx4 v6, s[12:15], s42 offen lds
s_add_u32 m0, s51, 5120
s_nop 0
buffer_load_dwordx4 v7, s[12:15], s42 offen lds
s_add_u32 m0, s51, 6144
s_nop 0
buffer_load_dwordx4 v8, s[12:15], s42 offen lds
s_add_u32 m0, s51, 7168
s_nop 0
buffer_load_dwordx4 v9, s[12:15], s42 offen lds
s_add_u32 m0, s51, 8192
s_nop 0
buffer_load_dwordx4 v10, s[12:15], s42 offen lds
s_add_u32 m0, s51, 9216
s_nop 0
buffer_load_dwordx4 v11, s[12:15], s42 offen lds
s_add_u32 m0, s51, 10240
s_nop 0
buffer_load_dwordx4 v12, s[12:15], s42 offen lds
s_add_u32 m0, s51, 11264
s_nop 0
buffer_load_dwordx4 v13, s[12:15], s42 offen lds
s_add_u32 m0, s51, 12288
s_nop 0
buffer_load_dwordx4 v14, s[12:15], s42 offen lds
s_add_u32 m0, s51, 13312
s_nop 0
buffer_load_dwordx4 v15, s[12:15], s42 offen lds
ds_read_b64_tr_b16 v[88:89], v18 offset:57344
ds_read_b64_tr_b16 v[90:91], v26 offset:57344
ds_read_b64_tr_b16 v[92:93], v19 offset:57344
ds_read_b64_tr_b16 v[94:95], v27 offset:57344
ds_read_b64_tr_b16 v[80:81], v20 offset:57344
ds_read_b64_tr_b16 v[82:83], v28 offset:57344
ds_read_b64_tr_b16 v[84:85], v21 offset:57344
ds_read_b64_tr_b16 v[86:87], v29 offset:57344
s_waitcnt lgkmcnt(6)
v_mfma_f32_16x16x32_bf16 a[0:3], v[56:59], v[88:91], a[0:3]
v_mfma_f32_16x16x32_bf16 a[56:59], v[60:63], v[88:91], a[56:59]
ds_read_b64_tr_b16 v[88:89], v22 offset:57344
ds_read_b64_tr_b16 v[90:91], v30 offset:57344
s_waitcnt lgkmcnt(6)
v_mfma_f32_16x16x32_bf16 a[4:7], v[56:59], v[92:95], a[4:7]
v_mfma_f32_16x16x32_bf16 a[60:63], v[60:63], v[92:95], a[60:63]
ds_read_b64_tr_b16 v[92:93], v23 offset:57344
ds_read_b64_tr_b16 v[94:95], v31 offset:57344
s_waitcnt lgkmcnt(6)
v_mfma_f32_16x16x32_bf16 a[8:11], v[56:59], v[80:83], a[8:11]
v_mfma_f32_16x16x32_bf16 a[64:67], v[60:63], v[80:83], a[64:67]
ds_read_b64_tr_b16 v[80:81], v24 offset:57344
ds_read_b64_tr_b16 v[82:83], v32 offset:57344
s_waitcnt lgkmcnt(6)
v_mfma_f32_16x16x32_bf16 a[12:15], v[56:59], v[84:87], a[12:15]
v_mfma_f32_16x16x32_bf16 a[68:71], v[60:63], v[84:87], a[68:71]
ds_read_b64_tr_b16 v[84:85], v25 offset:57344
ds_read_b64_tr_b16 v[86:87], v33 offset:57344
s_waitcnt lgkmcnt(6)
v_mfma_f32_16x16x32_bf16 a[16:19], v[56:59], v[88:91], a[16:19]
v_mfma_f32_16x16x32_bf16 a[72:75], v[60:63], v[88:91], a[72:75]
ds_read_b64_tr_b16 v[88:89], v18 offset:57600
ds_read_b64_tr_b16 v[90:91], v26 offset:57600
s_waitcnt lgkmcnt(6)
v_mfma_f32_16x16x32_bf16 a[20:23], v[56:59], v[92:95], a[20:23]
v_mfma_f32_16x16x32_bf16 a[76:79], v[60:63], v[92:95], a[76:79]
ds_read_b64_tr_b16 v[92:93], v19 offset:57600
ds_read_b64_tr_b16 v[94:95], v27 offset:57600
s_waitcnt lgkmcnt(6)
v_mfma_f32_16x16x32_bf16 a[24:27], v[56:59], v[80:83], a[24:27]
v_mfma_f32_16x16x32_bf16 a[80:83], v[60:63], v[80:83], a[80:83]
ds_read_b64_tr_b16 v[80:81], v20 offset:57600
ds_read_b64_tr_b16 v[82:83], v28 offset:57600
s_waitcnt lgkmcnt(6)
v_mfma_f32_16x16x32_bf16 a[28:31], v[56:59], v[84:87], a[28:31]
v_mfma_f32_16x16x32_bf16 a[84:87], v[60:63], v[84:87], a[84:87]
ds_read_b64_tr_b16 v[84:85], v21 offset:57600
ds_read_b64_tr_b16 v[86:87], v29 offset:57600
s_waitcnt lgkmcnt(6)
v_mfma_f32_16x16x32_bf16 a[32:35], v[56:59], v[88:91], a[32:35]
v_mfma_f32_16x16x32_bf16 a[88:91], v[60:63], v[88:91], a[88:91]
ds_read_b64_tr_b16 v[88:89], v22 offset:57600
ds_read_b64_tr_b16 v[90:91], v30 offset:57600
s_waitcnt lgkmcnt(6)
v_mfma_f32_16x16x32_bf16 a[36:39], v[56:59], v[92:95], a[36:39]
v_mfma_f32_16x16x32_bf16 a[92:95], v[60:63], v[92:95], a[92:95]
ds_read_b64_tr_b16 v[92:93], v23 offset:57600
ds_read_b64_tr_b16 v[94:95], v31 offset:57600
s_waitcnt lgkmcnt(6)
v_mfma_f32_16x16x32_bf16 a[40:43], v[56:59], v[80:83], a[40:43]
v_mfma_f32_16x16x32_bf16 a[96:99], v[60:63], v[80:83], a[96:99]
s_waitcnt lgkmcnt(4)
v_mfma_f32_16x16x32_bf16 a[44:47], v[56:59], v[84:87], a[44:47]
v_mfma_f32_16x16x32_bf16 a[100:103], v[60:63], v[84:87], a[100:103]
s_waitcnt lgkmcnt(2)
v_mfma_f32_16x16x32_bf16 a[48:51], v[56:59], v[88:91], a[48:51]
v_mfma_f32_16x16x32_bf16 a[104:107], v[60:63], v[88:91], a[104:107]
s_waitcnt lgkmcnt(0)
v_mfma_f32_16x16x32_bf16 a[52:55], v[56:59], v[92:95], a[52:55]
v_mfma_f32_16x16x32_bf16 a[108:111], v[60:63], v[92:95], a[108:111]
s_mov_b32 s50, 2
GL_69:
s_add_u32 s43, s48, 4096
buffer_load_dwordx4 v[56:59], v1, s[8:11], s43 offen offset:1024
s_add_u32 s43, s48, 20480
buffer_load_dwordx4 v[60:63], v1, s[8:11], s43 offen offset:1024
s_waitcnt vmcnt(2)
s_barrier
s_add_u32 s42, s49, 344064
s_add_u32 m0, s51, 57344
s_nop 0
buffer_load_dwordx4 v2, s[12:15], s42 offen lds
s_add_u32 m0, s51, 58368
s_nop 0
buffer_load_dwordx4 v3, s[12:15], s42 offen lds
s_add_u32 m0, s51, 59392
s_nop 0
buffer_load_dwordx4 v4, s[12:15], s42 offen lds
s_add_u32 m0, s51, 60416
s_nop 0
buffer_load_dwordx4 v5, s[12:15], s42 offen lds
s_add_u32 m0, s51, 61440
s_nop 0
buffer_load_dwordx4 v6, s[12:15], s42 offen lds
s_add_u32 m0, s51, 62464
s_nop 0
buffer_load_dwordx4 v7, s[12:15], s42 offen lds
s_add_u32 m0, s51, 63488
s_nop 0
buffer_load_dwordx4 v8, s[12:15], s42 offen lds
s_add_u32 m0, s51, 64512
s_nop 0
buffer_load_dwordx4 v9, s[12:15], s42 offen lds
s_add_u32 m0, s51, 65536
s_nop 0
buffer_load_dwordx4 v10, s[12:15], s42 offen lds
s_add_u32 m0, s51, 66560
s_nop 0
buffer_load_dwordx4 v11, s[12:15], s42 offen lds
s_add_u32 m0, s51, 67584
s_nop 0
buffer_load_dwordx4 v12, s[12:15], s42 offen lds
s_add_u32 m0, s51, 68608
s_nop 0
buffer_load_dwordx4 v13, s[12:15], s42 offen lds
s_add_u32 m0, s51, 69632
s_nop 0
buffer_load_dwordx4 v14, s[12:15], s42 offen lds
s_add_u32 m0, s51, 70656
s_nop 0
buffer_load_dwordx4 v15, s[12:15], s42 offen lds
ds_read_b64_tr_b16 v[80:81], v18 offset:0
ds_read_b64_tr_b16 v[82:83], v26 offset:0
ds_read_b64_tr_b16 v[84:85], v19 offset:0
ds_read_b64_tr_b16 v[86:87], v27 offset:0
ds_read_b64_tr_b16 v[88:89], v20 offset:0
ds_read_b64_tr_b16 v[90:91], v28 offset:0
ds_read_b64_tr_b16 v[92:93], v21 offset:0
ds_read_b64_tr_b16 v[94:95], v29 offset:0
s_waitcnt lgkmcnt(6)
v_mfma_f32_16x16x32_bf16 a[0:3], v[64:67], v[80:83], a[0:3]
v_mfma_f32_16x16x32_bf16 a[56:59], v[68:71], v[80:83], a[56:59]
ds_read_b64_tr_b16 v[80:81], v22 offset:0
ds_read_b64_tr_b16 v[82:83], v30 offset:0
s_waitcnt lgkmcnt(6)
v_mfma_f32_16x16x32_bf16 a[4:7], v[64:67], v[84:87], a[4:7]
v_mfma_f32_16x16x32_bf16 a[60:63], v[68:71], v[84:87], a[60:63]
ds_read_b64_tr_b16 v[84:85], v23 offset:0
ds_read_b64_tr_b16 v[86:87], v31 offset:0
s_waitcnt lgkmcnt(6)
v_mfma_f32_16x16x32_bf16 a[8:11], v[64:67], v[88:91], a[8:11]
v_mfma_f32_16x16x32_bf16 a[64:67], v[68:71], v[88:91], a[64:67]
ds_read_b64_tr_b16 v[88:89], v24 offset:0
ds_read_b64_tr_b16 v[90:91], v32 offset:0
s_waitcnt lgkmcnt(6)
v_mfma_f32_16x16x32_bf16 a[12:15], v[64:67], v[92:95], a[12:15]
v_mfma_f32_16x16x32_bf16 a[68:71], v[68:71], v[92:95], a[68:71]
ds_read_b64_tr_b16 v[92:93], v25 offset:0
ds_read_b64_tr_b16 v[94:95], v33 offset:0
s_waitcnt lgkmcnt(6)
v_mfma_f32_16x16x32_bf16 a[16:19], v[64:67], v[80:83], a[16:19]
v_mfma_f32_16x16x32_bf16 a[72:75], v[68:71], v[80:83], a[72:75]
ds_read_b64_tr_b16 v[80:81], v18 offset:256
ds_read_b64_tr_b16 v[82:83], v26 offset:256
s_waitcnt lgkmcnt(6)
v_mfma_f32_16x16x32_bf16 a[20:23], v[64:67], v[84:87], a[20:23]
v_mfma_f32_16x16x32_bf16 a[76:79], v[68:71], v[84:87], a[76:79]
ds_read_b64_tr_b16 v[84:85], v19 offset:256
ds_read_b64_tr_b16 v[86:87], v27 offset:256
s_waitcnt lgkmcnt(6)
v_mfma_f32_16x16x32_bf16 a[24:27], v[64:67], v[88:91], a[24:27]
v_mfma_f32_16x16x32_bf16 a[80:83], v[68:71], v[88:91], a[80:83]
ds_read_b64_tr_b16 v[88:89], v20 offset:256
ds_read_b64_tr_b16 v[90:91], v28 offset:256
s_waitcnt lgkmcnt(6)
v_mfma_f32_16x16x32_bf16 a[28:31], v[64:67], v[92:95], a[28:31]
v_mfma_f32_16x16x32_bf16 a[84:87], v[68:71], v[92:95], a[84:87]
ds_read_b64_tr_b16 v[92:93], v21 offset:256
ds_read_b64_tr_b16 v[94:95], v29 offset:256
s_waitcnt lgkmcnt(6)
v_mfma_f32_16x16x32_bf16 a[32:35], v[64:67], v[80:83], a[32:35]
v_mfma_f32_16x16x32_bf16 a[88:91], v[68:71], v[80:83], a[88:91]
ds_read_b64_tr_b16 v[80:81], v22 offset:256
ds_read_b64_tr_b16 v[82:83], v30 offset:256
s_waitcnt lgkmcnt(6)
v_mfma_f32_16x16x32_bf16 a[36:39], v[64:67], v[84:87], a[36:39]
v_mfma_f32_16x16x32_bf16 a[92:95], v[68:71], v[84:87], a[92:95]
ds_read_b64_tr_b16 v[84:85], v23 offset:256
ds_read_b64_tr_b16 v[86:87], v31 offset:256
s_waitcnt lgkmcnt(6)
v_mfma_f32_16x16x32_bf16 a[40:43], v[64:67], v[88:91], a[40:43]
v_mfma_f32_16x16x32_bf16 a[96:99], v[68:71], v[88:91], a[96:99]
s_waitcnt lgkmcnt(4)
v_mfma_f32_16x16x32_bf16 a[44:47], v[64:67], v[92:95], a[44:47]
v_mfma_f32_16x16x32_bf16 a[100:103], v[68:71], v[92:95], a[100:103]
s_waitcnt lgkmcnt(2)
v_mfma_f32_16x16x32_bf16 a[48:51], v[64:67], v[80:83], a[48:51]
v_mfma_f32_16x16x32_bf16 a[104:107], v[68:71], v[80:83], a[104:107]
s_waitcnt lgkmcnt(0)
v_mfma_f32_16x16x32_bf16 a[52:55], v[64:67], v[84:87], a[52:55]
v_mfma_f32_16x16x32_bf16 a[108:111], v[68:71], v[84:87], a[108:111]
s_add_u32 s43, s48, 4096
buffer_load_dwordx4 v[64:67], v1, s[8:11], s43 offen offset:2048
s_add_u32 s43, s48, 20480
buffer_load_dwordx4 v[68:71], v1, s[8:11], s43 offen offset:2048
s_waitcnt vmcnt(2)
s_barrier
s_add_u32 s42, s49, 458752
s_add_u32 m0, s51, 0
s_nop 0
buffer_load_dwordx4 v2, s[12:15], s42 offen lds
s_add_u32 m0, s51, 1024
s_nop 0
buffer_load_dwordx4 v3, s[12:15], s42 offen lds
s_add_u32 m0, s51, 2048
s_nop 0
buffer_load_dwordx4 v4, s[12:15], s42 offen lds
s_add_u32 m0, s51, 3072
s_nop 0
buffer_load_dwordx4 v5, s[12:15], s42 offen lds
s_add_u32 m0, s51, 4096
s_nop 0
buffer_load_dwordx4 v6, s[12:15], s42 offen lds
s_add_u32 m0, s51, 5120
s_nop 0
buffer_load_dwordx4 v7, s[12:15], s42 offen lds
s_add_u32 m0, s51, 6144
s_nop 0
buffer_load_dwordx4 v8, s[12:15], s42 offen lds
s_add_u32 m0, s51, 7168
s_nop 0
buffer_load_dwordx4 v9, s[12:15], s42 offen lds
s_add_u32 m0, s51, 8192
s_nop 0
buffer_load_dwordx4 v10, s[12:15], s42 offen lds
s_add_u32 m0, s51, 9216
s_nop 0
buffer_load_dwordx4 v11, s[12:15], s42 offen lds
s_add_u32 m0, s51, 10240
s_nop 0
buffer_load_dwordx4 v12, s[12:15], s42 offen lds
s_add_u32 m0, s51, 11264
s_nop 0
buffer_load_dwordx4 v13, s[12:15], s42 offen lds
s_add_u32 m0, s51, 12288
s_nop 0
buffer_load_dwordx4 v14, s[12:15], s42 offen lds
s_add_u32 m0, s51, 13312
s_nop 0
buffer_load_dwordx4 v15, s[12:15], s42 offen lds
ds_read_b64_tr_b16 v[88:89], v18 offset:57344
ds_read_b64_tr_b16 v[90:91], v26 offset:57344
ds_read_b64_tr_b16 v[92:93], v19 offset:57344
ds_read_b64_tr_b16 v[94:95], v27 offset:57344
ds_read_b64_tr_b16 v[80:81], v20 offset:57344
ds_read_b64_tr_b16 v[82:83], v28 offset:57344
ds_read_b64_tr_b16 v[84:85], v21 offset:57344
ds_read_b64_tr_b16 v[86:87], v29 offset:57344
s_waitcnt lgkmcnt(6)
v_mfma_f32_16x16x32_bf16 a[0:3], v[72:75], v[88:91], a[0:3]
v_mfma_f32_16x16x32_bf16 a[56:59], v[76:79], v[88:91], a[56:59]
ds_read_b64_tr_b16 v[88:89], v22 offset:57344
ds_read_b64_tr_b16 v[90:91], v30 offset:57344
s_waitcnt lgkmcnt(6)
v_mfma_f32_16x16x32_bf16 a[4:7], v[72:75], v[92:95], a[4:7]
v_mfma_f32_16x16x32_bf16 a[60:63], v[76:79], v[92:95], a[60:63]
ds_read_b64_tr_b16 v[92:93], v23 offset:57344
ds_read_b64_tr_b16 v[94:95], v31 offset:57344
s_waitcnt lgkmcnt(6)
v_mfma_f32_16x16x32_bf16 a[8:11], v[72:75], v[80:83], a[8:11]
v_mfma_f32_16x16x32_bf16 a[64:67], v[76:79], v[80:83], a[64:67]
ds_read_b64_tr_b16 v[80:81], v24 offset:57344
ds_read_b64_tr_b16 v[82:83], v32 offset:57344
s_waitcnt lgkmcnt(6)
v_mfma_f32_16x16x32_bf16 a[12:15], v[72:75], v[84:87], a[12:15]
v_mfma_f32_16x16x32_bf16 a[68:71], v[76:79], v[84:87], a[68:71]
ds_read_b64_tr_b16 v[84:85], v25 offset:57344
ds_read_b64_tr_b16 v[86:87], v33 offset:57344
s_waitcnt lgkmcnt(6)
v_mfma_f32_16x16x32_bf16 a[16:19], v[72:75], v[88:91], a[16:19]
v_mfma_f32_16x16x32_bf16 a[72:75], v[76:79], v[88:91], a[72:75]
ds_read_b64_tr_b16 v[88:89], v18 offset:57600
ds_read_b64_tr_b16 v[90:91], v26 offset:57600
s_waitcnt lgkmcnt(6)
v_mfma_f32_16x16x32_bf16 a[20:23], v[72:75], v[92:95], a[20:23]
v_mfma_f32_16x16x32_bf16 a[76:79], v[76:79], v[92:95], a[76:79]
ds_read_b64_tr_b16 v[92:93], v19 offset:57600
ds_read_b64_tr_b16 v[94:95], v27 offset:57600
s_waitcnt lgkmcnt(6)
v_mfma_f32_16x16x32_bf16 a[24:27], v[72:75], v[80:83], a[24:27]
v_mfma_f32_16x16x32_bf16 a[80:83], v[76:79], v[80:83], a[80:83]
ds_read_b64_tr_b16 v[80:81], v20 offset:57600
ds_read_b64_tr_b16 v[82:83], v28 offset:57600
s_waitcnt lgkmcnt(6)
v_mfma_f32_16x16x32_bf16 a[28:31], v[72:75], v[84:87], a[28:31]
v_mfma_f32_16x16x32_bf16 a[84:87], v[76:79], v[84:87], a[84:87]
ds_read_b64_tr_b16 v[84:85], v21 offset:57600
ds_read_b64_tr_b16 v[86:87], v29 offset:57600
s_waitcnt lgkmcnt(6)
v_mfma_f32_16x16x32_bf16 a[32:35], v[72:75], v[88:91], a[32:35]
v_mfma_f32_16x16x32_bf16 a[88:91], v[76:79], v[88:91], a[88:91]
ds_read_b64_tr_b16 v[88:89], v22 offset:57600
ds_read_b64_tr_b16 v[90:91], v30 offset:57600
s_waitcnt lgkmcnt(6)
v_mfma_f32_16x16x32_bf16 a[36:39], v[72:75], v[92:95], a[36:39]
v_mfma_f32_16x16x32_bf16 a[92:95], v[76:79], v[92:95], a[92:95]
ds_read_b64_tr_b16 v[92:93], v23 offset:57600
ds_read_b64_tr_b16 v[94:95], v31 offset:57600
s_waitcnt lgkmcnt(6)
v_mfma_f32_16x16x32_bf16 a[40:43], v[72:75], v[80:83], a[40:43]
v_mfma_f32_16x16x32_bf16 a[96:99], v[76:79], v[80:83], a[96:99]
s_waitcnt lgkmcnt(4)
v_mfma_f32_16x16x32_bf16 a[44:47], v[72:75], v[84:87], a[44:47]
v_mfma_f32_16x16x32_bf16 a[100:103], v[76:79], v[84:87], a[100:103]
s_waitcnt lgkmcnt(2)
v_mfma_f32_16x16x32_bf16 a[48:51], v[72:75], v[88:91], a[48:51]
v_mfma_f32_16x16x32_bf16 a[104:107], v[76:79], v[88:91], a[104:107]
s_waitcnt lgkmcnt(0)
v_mfma_f32_16x16x32_bf16 a[52:55], v[72:75], v[92:95], a[52:55]
v_mfma_f32_16x16x32_bf16 a[108:111], v[76:79], v[92:95], a[108:111]
s_add_u32 s43, s48, 4096
buffer_load_dwordx4 v[72:75], v1, s[8:11], s43 offen offset:3072
s_add_u32 s43, s48, 20480
buffer_load_dwordx4 v[76:79], v1, s[8:11], s43 offen offset:3072
s_waitcnt vmcnt(2)
s_barrier
s_add_u32 s42, s49, 573440
s_add_u32 m0, s51, 57344
s_nop 0
buffer_load_dwordx4 v2, s[12:15], s42 offen lds
s_add_u32 m0, s51, 58368
s_nop 0
buffer_load_dwordx4 v3, s[12:15], s42 offen lds
s_add_u32 m0, s51, 59392
s_nop 0
buffer_load_dwordx4 v4, s[12:15], s42 offen lds
s_add_u32 m0, s51, 60416
s_nop 0
buffer_load_dwordx4 v5, s[12:15], s42 offen lds
s_add_u32 m0, s51, 61440
s_nop 0
buffer_load_dwordx4 v6, s[12:15], s42 offen lds
s_add_u32 m0, s51, 62464
s_nop 0
buffer_load_dwordx4 v7, s[12:15], s42 offen lds
s_add_u32 m0, s51, 63488
s_nop 0
buffer_load_dwordx4 v8, s[12:15], s42 offen lds
s_add_u32 m0, s51, 64512
s_nop 0
buffer_load_dwordx4 v9, s[12:15], s42 offen lds
s_add_u32 m0, s51, 65536
s_nop 0
buffer_load_dwordx4 v10, s[12:15], s42 offen lds
s_add_u32 m0, s51, 66560
s_nop 0
buffer_load_dwordx4 v11, s[12:15], s42 offen lds
s_add_u32 m0, s51, 67584
s_nop 0
buffer_load_dwordx4 v12, s[12:15], s42 offen lds
s_add_u32 m0, s51, 68608
s_nop 0
buffer_load_dwordx4 v13, s[12:15], s42 offen lds
s_add_u32 m0, s51, 69632
s_nop 0
buffer_load_dwordx4 v14, s[12:15], s42 offen lds
s_add_u32 m0, s51, 70656
s_nop 0
buffer_load_dwordx4 v15, s[12:15], s42 offen lds
ds_read_b64_tr_b16 v[80:81], v18 offset:0
ds_read_b64_tr_b16 v[82:83], v26 offset:0
ds_read_b64_tr_b16 v[84:85], v19 offset:0
ds_read_b64_tr_b16 v[86:87], v27 offset:0
ds_read_b64_tr_b16 v[88:89], v20 offset:0
ds_read_b64_tr_b16 v[90:91], v28 offset:0
ds_read_b64_tr_b16 v[92:93], v21 offset:0
ds_read_b64_tr_b16 v[94:95], v29 offset:0
s_waitcnt lgkmcnt(6)
v_mfma_f32_16x16x32_bf16 a[0:3], v[48:51], v[80:83], a[0:3]
v_mfma_f32_16x16x32_bf16 a[56:59], v[52:55], v[80:83], a[56:59]
ds_read_b64_tr_b16 v[80:81], v22 offset:0
ds_read_b64_tr_b16 v[82:83], v30 offset:0
s_waitcnt lgkmcnt(6)
v_mfma_f32_16x16x32_bf16 a[4:7], v[48:51], v[84:87], a[4:7]
v_mfma_f32_16x16x32_bf16 a[60:63], v[52:55], v[84:87], a[60:63]
ds_read_b64_tr_b16 v[84:85], v23 offset:0
ds_read_b64_tr_b16 v[86:87], v31 offset:0
s_waitcnt lgkmcnt(6)
v_mfma_f32_16x16x32_bf16 a[8:11], v[48:51], v[88:91], a[8:11]
v_mfma_f32_16x16x32_bf16 a[64:67], v[52:55], v[88:91], a[64:67]
ds_read_b64_tr_b16 v[88:89], v24 offset:0
ds_read_b64_tr_b16 v[90:91], v32 offset:0
s_waitcnt lgkmcnt(6)
v_mfma_f32_16x16x32_bf16 a[12:15], v[48:51], v[92:95], a[12:15]
v_mfma_f32_16x16x32_bf16 a[68:71], v[52:55], v[92:95], a[68:71]
ds_read_b64_tr_b16 v[92:93], v25 offset:0
ds_read_b64_tr_b16 v[94:95], v33 offset:0
s_waitcnt lgkmcnt(6)
v_mfma_f32_16x16x32_bf16 a[16:19], v[48:51], v[80:83], a[16:19]
v_mfma_f32_16x16x32_bf16 a[72:75], v[52:55], v[80:83], a[72:75]
ds_read_b64_tr_b16 v[80:81], v18 offset:256
ds_read_b64_tr_b16 v[82:83], v26 offset:256
s_waitcnt lgkmcnt(6)
v_mfma_f32_16x16x32_bf16 a[20:23], v[48:51], v[84:87], a[20:23]
v_mfma_f32_16x16x32_bf16 a[76:79], v[52:55], v[84:87], a[76:79]
ds_read_b64_tr_b16 v[84:85], v19 offset:256
ds_read_b64_tr_b16 v[86:87], v27 offset:256
s_waitcnt lgkmcnt(6)
v_mfma_f32_16x16x32_bf16 a[24:27], v[48:51], v[88:91], a[24:27]
v_mfma_f32_16x16x32_bf16 a[80:83], v[52:55], v[88:91], a[80:83]
ds_read_b64_tr_b16 v[88:89], v20 offset:256
ds_read_b64_tr_b16 v[90:91], v28 offset:256
s_waitcnt lgkmcnt(6)
v_mfma_f32_16x16x32_bf16 a[28:31], v[48:51], v[92:95], a[28:31]
v_mfma_f32_16x16x32_bf16 a[84:87], v[52:55], v[92:95], a[84:87]
ds_read_b64_tr_b16 v[92:93], v21 offset:256
ds_read_b64_tr_b16 v[94:95], v29 offset:256
s_waitcnt lgkmcnt(6)
v_mfma_f32_16x16x32_bf16 a[32:35], v[48:51], v[80:83], a[32:35]
v_mfma_f32_16x16x32_bf16 a[88:91], v[52:55], v[80:83], a[88:91]
ds_read_b64_tr_b16 v[80:81], v22 offset:256
ds_read_b64_tr_b16 v[82:83], v30 offset:256
s_waitcnt lgkmcnt(6)
v_mfma_f32_16x16x32_bf16 a[36:39], v[48:51], v[84:87], a[36:39]
v_mfma_f32_16x16x32_bf16 a[92:95], v[52:55], v[84:87], a[92:95]
ds_read_b64_tr_b16 v[84:85], v23 offset:256
ds_read_b64_tr_b16 v[86:87], v31 offset:256
s_waitcnt lgkmcnt(6)
v_mfma_f32_16x16x32_bf16 a[40:43], v[48:51], v[88:91], a[40:43]
v_mfma_f32_16x16x32_bf16 a[96:99], v[52:55], v[88:91], a[96:99]
s_waitcnt lgkmcnt(4)
v_mfma_f32_16x16x32_bf16 a[44:47], v[48:51], v[92:95], a[44:47]
v_mfma_f32_16x16x32_bf16 a[100:103], v[52:55], v[92:95], a[100:103]
s_waitcnt lgkmcnt(2)
v_mfma_f32_16x16x32_bf16 a[48:51], v[48:51], v[80:83], a[48:51]
v_mfma_f32_16x16x32_bf16 a[104:107], v[52:55], v[80:83], a[104:107]
s_waitcnt lgkmcnt(0)
v_mfma_f32_16x16x32_bf16 a[52:55], v[48:51], v[84:87], a[52:55]
v_mfma_f32_16x16x32_bf16 a[108:111], v[52:55], v[84:87], a[108:111]
s_add_u32 s43, s48, 8192
buffer_load_dwordx4 v[48:51], v1, s[8:11], s43 offen offset:0
s_add_u32 s43, s48, 24576
buffer_load_dwordx4 v[52:55], v1, s[8:11], s43 offen offset:0
s_waitcnt vmcnt(2)
s_barrier
s_add_u32 s42, s49, 688128
s_add_u32 m0, s51, 0
s_nop 0
buffer_load_dwordx4 v2, s[12:15], s42 offen lds
s_add_u32 m0, s51, 1024
s_nop 0
buffer_load_dwordx4 v3, s[12:15], s42 offen lds
s_add_u32 m0, s51, 2048
s_nop 0
buffer_load_dwordx4 v4, s[12:15], s42 offen lds
s_add_u32 m0, s51, 3072
s_nop 0
buffer_load_dwordx4 v5, s[12:15], s42 offen lds
s_add_u32 m0, s51, 4096
s_nop 0
buffer_load_dwordx4 v6, s[12:15], s42 offen lds
s_add_u32 m0, s51, 5120
s_nop 0
buffer_load_dwordx4 v7, s[12:15], s42 offen lds
s_add_u32 m0, s51, 6144
s_nop 0
buffer_load_dwordx4 v8, s[12:15], s42 offen lds
s_add_u32 m0, s51, 7168
s_nop 0
buffer_load_dwordx4 v9, s[12:15], s42 offen lds
s_add_u32 m0, s51, 8192
s_nop 0
buffer_load_dwordx4 v10, s[12:15], s42 offen lds
s_add_u32 m0, s51, 9216
s_nop 0
buffer_load_dwordx4 v11, s[12:15], s42 offen lds
s_add_u32 m0, s51, 10240
s_nop 0
buffer_load_dwordx4 v12, s[12:15], s42 offen lds
s_add_u32 m0, s51, 11264
s_nop 0
buffer_load_dwordx4 v13, s[12:15], s42 offen lds
s_add_u32 m0, s51, 12288
s_nop 0
buffer_load_dwordx4 v14, s[12:15], s42 offen lds
s_add_u32 m0, s51, 13312
s_nop 0
buffer_load_dwordx4 v15, s[12:15], s42 offen lds
ds_read_b64_tr_b16 v[88:89], v18 offset:57344
ds_read_b64_tr_b16 v[90:91], v26 offset:57344
ds_read_b64_tr_b16 v[92:93], v19 offset:57344
ds_read_b64_tr_b16 v[94:95], v27 offset:57344
ds_read_b64_tr_b16 v[80:81], v20 offset:57344
ds_read_b64_tr_b16 v[82:83], v28 offset:57344
ds_read_b64_tr_b16 v[84:85], v21 offset:57344
ds_read_b64_tr_b16 v[86:87], v29 offset:57344
s_waitcnt lgkmcnt(6)
v_mfma_f32_16x16x32_bf16 a[0:3], v[56:59], v[88:91], a[0:3]
v_mfma_f32_16x16x32_bf16 a[56:59], v[60:63], v[88:91], a[56:59]
ds_read_b64_tr_b16 v[88:89], v22 offset:57344
ds_read_b64_tr_b16 v[90:91], v30 offset:57344
s_waitcnt lgkmcnt(6)
v_mfma_f32_16x16x32_bf16 a[4:7], v[56:59], v[92:95], a[4:7]
v_mfma_f32_16x16x32_bf16 a[60:63], v[60:63], v[92:95], a[60:63]
ds_read_b64_tr_b16 v[92:93], v23 offset:57344
ds_read_b64_tr_b16 v[94:95], v31 offset:57344
s_waitcnt lgkmcnt(6)
v_mfma_f32_16x16x32_bf16 a[8:11], v[56:59], v[80:83], a[8:11]
v_mfma_f32_16x16x32_bf16 a[64:67], v[60:63], v[80:83], a[64:67]
ds_read_b64_tr_b16 v[80:81], v24 offset:57344
ds_read_b64_tr_b16 v[82:83], v32 offset:57344
s_waitcnt lgkmcnt(6)
v_mfma_f32_16x16x32_bf16 a[12:15], v[56:59], v[84:87], a[12:15]
v_mfma_f32_16x16x32_bf16 a[68:71], v[60:63], v[84:87], a[68:71]
ds_read_b64_tr_b16 v[84:85], v25 offset:57344
ds_read_b64_tr_b16 v[86:87], v33 offset:57344
s_waitcnt lgkmcnt(6)
v_mfma_f32_16x16x32_bf16 a[16:19], v[56:59], v[88:91], a[16:19]
v_mfma_f32_16x16x32_bf16 a[72:75], v[60:63], v[88:91], a[72:75]
ds_read_b64_tr_b16 v[88:89], v18 offset:57600
ds_read_b64_tr_b16 v[90:91], v26 offset:57600
s_waitcnt lgkmcnt(6)
v_mfma_f32_16x16x32_bf16 a[20:23], v[56:59], v[92:95], a[20:23]
v_mfma_f32_16x16x32_bf16 a[76:79], v[60:63], v[92:95], a[76:79]
ds_read_b64_tr_b16 v[92:93], v19 offset:57600
ds_read_b64_tr_b16 v[94:95], v27 offset:57600
s_waitcnt lgkmcnt(6)
v_mfma_f32_16x16x32_bf16 a[24:27], v[56:59], v[80:83], a[24:27]
v_mfma_f32_16x16x32_bf16 a[80:83], v[60:63], v[80:83], a[80:83]
ds_read_b64_tr_b16 v[80:81], v20 offset:57600
ds_read_b64_tr_b16 v[82:83], v28 offset:57600
s_waitcnt lgkmcnt(6)
v_mfma_f32_16x16x32_bf16 a[28:31], v[56:59], v[84:87], a[28:31]
v_mfma_f32_16x16x32_bf16 a[84:87], v[60:63], v[84:87], a[84:87]
ds_read_b64_tr_b16 v[84:85], v21 offset:57600
ds_read_b64_tr_b16 v[86:87], v29 offset:57600
s_waitcnt lgkmcnt(6)
v_mfma_f32_16x16x32_bf16 a[32:35], v[56:59], v[88:91], a[32:35]
v_mfma_f32_16x16x32_bf16 a[88:91], v[60:63], v[88:91], a[88:91]
ds_read_b64_tr_b16 v[88:89], v22 offset:57600
ds_read_b64_tr_b16 v[90:91], v30 offset:57600
s_waitcnt lgkmcnt(6)
v_mfma_f32_16x16x32_bf16 a[36:39], v[56:59], v[92:95], a[36:39]
v_mfma_f32_16x16x32_bf16 a[92:95], v[60:63], v[92:95], a[92:95]
ds_read_b64_tr_b16 v[92:93], v23 offset:57600
ds_read_b64_tr_b16 v[94:95], v31 offset:57600
s_waitcnt lgkmcnt(6)
v_mfma_f32_16x16x32_bf16 a[40:43], v[56:59], v[80:83], a[40:43]
v_mfma_f32_16x16x32_bf16 a[96:99], v[60:63], v[80:83], a[96:99]
s_waitcnt lgkmcnt(4)
v_mfma_f32_16x16x32_bf16 a[44:47], v[56:59], v[84:87], a[44:47]
v_mfma_f32_16x16x32_bf16 a[100:103], v[60:63], v[84:87], a[100:103]
s_waitcnt lgkmcnt(2)
v_mfma_f32_16x16x32_bf16 a[48:51], v[56:59], v[88:91], a[48:51]
v_mfma_f32_16x16x32_bf16 a[104:107], v[60:63], v[88:91], a[104:107]
s_waitcnt lgkmcnt(0)
v_mfma_f32_16x16x32_bf16 a[52:55], v[56:59], v[92:95], a[52:55]
v_mfma_f32_16x16x32_bf16 a[108:111], v[60:63], v[92:95], a[108:111]
s_add_u32 s48, s48, 4096
s_add_u32 s49, s49, 458752
s_sub_u32 s50, s50, 1
s_cmp_lg_u32 s50, 0
s_cbranch_scc1 GL_69
s_add_u32 s43, s48, 4096
buffer_load_dwordx4 v[56:59], v1, s[8:11], s43 offen offset:1024
s_add_u32 s43, s48, 20480
buffer_load_dwordx4 v[60:63], v1, s[8:11], s43 offen offset:1024
s_waitcnt vmcnt(2)
s_barrier
s_add_u32 s42, s49, 344064
s_add_u32 m0, s51, 57344
s_nop 0
buffer_load_dwordx4 v2, s[12:15], s42 offen lds
s_add_u32 m0, s51, 58368
s_nop 0
buffer_load_dwordx4 v3, s[12:15], s42 offen lds
s_add_u32 m0, s51, 59392
s_nop 0
buffer_load_dwordx4 v4, s[12:15], s42 offen lds
s_add_u32 m0, s51, 60416
s_nop 0
buffer_load_dwordx4 v5, s[12:15], s42 offen lds
s_add_u32 m0, s51, 61440
s_nop 0
buffer_load_dwordx4 v6, s[12:15], s42 offen lds
s_add_u32 m0, s51, 62464
s_nop 0
buffer_load_dwordx4 v7, s[12:15], s42 offen lds
s_add_u32 m0, s51, 63488
s_nop 0
buffer_load_dwordx4 v8, s[12:15], s42 offen lds
s_add_u32 m0, s51, 64512
s_nop 0
buffer_load_dwordx4 v9, s[12:15], s42 offen lds
s_add_u32 m0, s51, 65536
s_nop 0
buffer_load_dwordx4 v10, s[12:15], s42 offen lds
s_add_u32 m0, s51, 66560
s_nop 0
buffer_load_dwordx4 v11, s[12:15], s42 offen lds
s_add_u32 m0, s51, 67584
s_nop 0
buffer_load_dwordx4 v12, s[12:15], s42 offen lds
s_add_u32 m0, s51, 68608
s_nop 0
buffer_load_dwordx4 v13, s[12:15], s42 offen lds
s_add_u32 m0, s51, 69632
s_nop 0
buffer_load_dwordx4 v14, s[12:15], s42 offen lds
s_add_u32 m0, s51, 70656
s_nop 0
buffer_load_dwordx4 v15, s[12:15], s42 offen lds
ds_read_b64_tr_b16 v[80:81], v18 offset:0
ds_read_b64_tr_b16 v[82:83], v26 offset:0
ds_read_b64_tr_b16 v[84:85], v19 offset:0
ds_read_b64_tr_b16 v[86:87], v27 offset:0
ds_read_b64_tr_b16 v[88:89], v20 offset:0
ds_read_b64_tr_b16 v[90:91], v28 offset:0
ds_read_b64_tr_b16 v[92:93], v21 offset:0
ds_read_b64_tr_b16 v[94:95], v29 offset:0
s_waitcnt lgkmcnt(6)
v_mfma_f32_16x16x32_bf16 a[0:3], v[64:67], v[80:83], a[0:3]
v_mfma_f32_16x16x32_bf16 a[56:59], v[68:71], v[80:83], a[56:59]
ds_read_b64_tr_b16 v[80:81], v22 offset:0
ds_read_b64_tr_b16 v[82:83], v30 offset:0
s_waitcnt lgkmcnt(6)
v_mfma_f32_16x16x32_bf16 a[4:7], v[64:67], v[84:87], a[4:7]
v_mfma_f32_16x16x32_bf16 a[60:63], v[68:71], v[84:87], a[60:63]
ds_read_b64_tr_b16 v[84:85], v23 offset:0
ds_read_b64_tr_b16 v[86:87], v31 offset:0
s_waitcnt lgkmcnt(6)
v_mfma_f32_16x16x32_bf16 a[8:11], v[64:67], v[88:91], a[8:11]
v_mfma_f32_16x16x32_bf16 a[64:67], v[68:71], v[88:91], a[64:67]
ds_read_b64_tr_b16 v[88:89], v24 offset:0
ds_read_b64_tr_b16 v[90:91], v32 offset:0
s_waitcnt lgkmcnt(6)
v_mfma_f32_16x16x32_bf16 a[12:15], v[64:67], v[92:95], a[12:15]
v_mfma_f32_16x16x32_bf16 a[68:71], v[68:71], v[92:95], a[68:71]
ds_read_b64_tr_b16 v[92:93], v25 offset:0
ds_read_b64_tr_b16 v[94:95], v33 offset:0
s_waitcnt lgkmcnt(6)
v_mfma_f32_16x16x32_bf16 a[16:19], v[64:67], v[80:83], a[16:19]
v_mfma_f32_16x16x32_bf16 a[72:75], v[68:71], v[80:83], a[72:75]
ds_read_b64_tr_b16 v[80:81], v18 offset:256
ds_read_b64_tr_b16 v[82:83], v26 offset:256
s_waitcnt lgkmcnt(6)
v_mfma_f32_16x16x32_bf16 a[20:23], v[64:67], v[84:87], a[20:23]
v_mfma_f32_16x16x32_bf16 a[76:79], v[68:71], v[84:87], a[76:79]
ds_read_b64_tr_b16 v[84:85], v19 offset:256
ds_read_b64_tr_b16 v[86:87], v27 offset:256
s_waitcnt lgkmcnt(6)
v_mfma_f32_16x16x32_bf16 a[24:27], v[64:67], v[88:91], a[24:27]
v_mfma_f32_16x16x32_bf16 a[80:83], v[68:71], v[88:91], a[80:83]
ds_read_b64_tr_b16 v[88:89], v20 offset:256
ds_read_b64_tr_b16 v[90:91], v28 offset:256
s_waitcnt lgkmcnt(6)
v_mfma_f32_16x16x32_bf16 a[28:31], v[64:67], v[92:95], a[28:31]
v_mfma_f32_16x16x32_bf16 a[84:87], v[68:71], v[92:95], a[84:87]
ds_read_b64_tr_b16 v[92:93], v21 offset:256
ds_read_b64_tr_b16 v[94:95], v29 offset:256
s_waitcnt lgkmcnt(6)
v_mfma_f32_16x16x32_bf16 a[32:35], v[64:67], v[80:83], a[32:35]
v_mfma_f32_16x16x32_bf16 a[88:91], v[68:71], v[80:83], a[88:91]
ds_read_b64_tr_b16 v[80:81], v22 offset:256
ds_read_b64_tr_b16 v[82:83], v30 offset:256
s_waitcnt lgkmcnt(6)
v_mfma_f32_16x16x32_bf16 a[36:39], v[64:67], v[84:87], a[36:39]
v_mfma_f32_16x16x32_bf16 a[92:95], v[68:71], v[84:87], a[92:95]
ds_read_b64_tr_b16 v[84:85], v23 offset:256
ds_read_b64_tr_b16 v[86:87], v31 offset:256
s_waitcnt lgkmcnt(6)
v_mfma_f32_16x16x32_bf16 a[40:43], v[64:67], v[88:91], a[40:43]
v_mfma_f32_16x16x32_bf16 a[96:99], v[68:71], v[88:91], a[96:99]
s_waitcnt lgkmcnt(4)
v_mfma_f32_16x16x32_bf16 a[44:47], v[64:67], v[92:95], a[44:47]
v_mfma_f32_16x16x32_bf16 a[100:103], v[68:71], v[92:95], a[100:103]
s_waitcnt lgkmcnt(2)
v_mfma_f32_16x16x32_bf16 a[48:51], v[64:67], v[80:83], a[48:51]
v_mfma_f32_16x16x32_bf16 a[104:107], v[68:71], v[80:83], a[104:107]
s_waitcnt lgkmcnt(0)
v_mfma_f32_16x16x32_bf16 a[52:55], v[64:67], v[84:87], a[52:55]
v_mfma_f32_16x16x32_bf16 a[108:111], v[68:71], v[84:87], a[108:111]
s_add_u32 s43, s48, 4096
buffer_load_dwordx4 v[64:67], v1, s[8:11], s43 offen offset:2048
s_add_u32 s43, s48, 20480
buffer_load_dwordx4 v[68:71], v1, s[8:11], s43 offen offset:2048
s_waitcnt vmcnt(2)
s_barrier
s_add_u32 s42, s49, 458752
s_add_u32 m0, s51, 0
s_nop 0
buffer_load_dwordx4 v2, s[12:15], s42 offen lds
s_add_u32 m0, s51, 1024
s_nop 0
buffer_load_dwordx4 v3, s[12:15], s42 offen lds
s_add_u32 m0, s51, 2048
s_nop 0
buffer_load_dwordx4 v4, s[12:15], s42 offen lds
s_add_u32 m0, s51, 3072
s_nop 0
buffer_load_dwordx4 v5, s[12:15], s42 offen lds
s_add_u32 m0, s51, 4096
s_nop 0
buffer_load_dwordx4 v6, s[12:15], s42 offen lds
s_add_u32 m0, s51, 5120
s_nop 0
buffer_load_dwordx4 v7, s[12:15], s42 offen lds
s_add_u32 m0, s51, 6144
s_nop 0
buffer_load_dwordx4 v8, s[12:15], s42 offen lds
s_add_u32 m0, s51, 7168
s_nop 0
buffer_load_dwordx4 v9, s[12:15], s42 offen lds
s_add_u32 m0, s51, 8192
s_nop 0
buffer_load_dwordx4 v10, s[12:15], s42 offen lds
s_add_u32 m0, s51, 9216
s_nop 0
buffer_load_dwordx4 v11, s[12:15], s42 offen lds
s_add_u32 m0, s51, 10240
s_nop 0
buffer_load_dwordx4 v12, s[12:15], s42 offen lds
s_add_u32 m0, s51, 11264
s_nop 0
buffer_load_dwordx4 v13, s[12:15], s42 offen lds
s_add_u32 m0, s51, 12288
s_nop 0
buffer_load_dwordx4 v14, s[12:15], s42 offen lds
s_add_u32 m0, s51, 13312
s_nop 0
buffer_load_dwordx4 v15, s[12:15], s42 offen lds
ds_read_b64_tr_b16 v[88:89], v18 offset:57344
ds_read_b64_tr_b16 v[90:91], v26 offset:57344
ds_read_b64_tr_b16 v[92:93], v19 offset:57344
ds_read_b64_tr_b16 v[94:95], v27 offset:57344
ds_read_b64_tr_b16 v[80:81], v20 offset:57344
ds_read_b64_tr_b16 v[82:83], v28 offset:57344
ds_read_b64_tr_b16 v[84:85], v21 offset:57344
ds_read_b64_tr_b16 v[86:87], v29 offset:57344
s_waitcnt lgkmcnt(6)
v_mfma_f32_16x16x32_bf16 a[0:3], v[72:75], v[88:91], a[0:3]
v_mfma_f32_16x16x32_bf16 a[56:59], v[76:79], v[88:91], a[56:59]
ds_read_b64_tr_b16 v[88:89], v22 offset:57344
ds_read_b64_tr_b16 v[90:91], v30 offset:57344
s_waitcnt lgkmcnt(6)
v_mfma_f32_16x16x32_bf16 a[4:7], v[72:75], v[92:95], a[4:7]
v_mfma_f32_16x16x32_bf16 a[60:63], v[76:79], v[92:95], a[60:63]
ds_read_b64_tr_b16 v[92:93], v23 offset:57344
ds_read_b64_tr_b16 v[94:95], v31 offset:57344
s_waitcnt lgkmcnt(6)
v_mfma_f32_16x16x32_bf16 a[8:11], v[72:75], v[80:83], a[8:11]
v_mfma_f32_16x16x32_bf16 a[64:67], v[76:79], v[80:83], a[64:67]
ds_read_b64_tr_b16 v[80:81], v24 offset:57344
ds_read_b64_tr_b16 v[82:83], v32 offset:57344
s_waitcnt lgkmcnt(6)
v_mfma_f32_16x16x32_bf16 a[12:15], v[72:75], v[84:87], a[12:15]
v_mfma_f32_16x16x32_bf16 a[68:71], v[76:79], v[84:87], a[68:71]
ds_read_b64_tr_b16 v[84:85], v25 offset:57344
ds_read_b64_tr_b16 v[86:87], v33 offset:57344
s_waitcnt lgkmcnt(6)
v_mfma_f32_16x16x32_bf16 a[16:19], v[72:75], v[88:91], a[16:19]
v_mfma_f32_16x16x32_bf16 a[72:75], v[76:79], v[88:91], a[72:75]
ds_read_b64_tr_b16 v[88:89], v18 offset:57600
ds_read_b64_tr_b16 v[90:91], v26 offset:57600
s_waitcnt lgkmcnt(6)
v_mfma_f32_16x16x32_bf16 a[20:23], v[72:75], v[92:95], a[20:23]
v_mfma_f32_16x16x32_bf16 a[76:79], v[76:79], v[92:95], a[76:79]
ds_read_b64_tr_b16 v[92:93], v19 offset:57600
ds_read_b64_tr_b16 v[94:95], v27 offset:57600
s_waitcnt lgkmcnt(6)
v_mfma_f32_16x16x32_bf16 a[24:27], v[72:75], v[80:83], a[24:27]
v_mfma_f32_16x16x32_bf16 a[80:83], v[76:79], v[80:83], a[80:83]
ds_read_b64_tr_b16 v[80:81], v20 offset:57600
ds_read_b64_tr_b16 v[82:83], v28 offset:57600
s_waitcnt lgkmcnt(6)
v_mfma_f32_16x16x32_bf16 a[28:31], v[72:75], v[84:87], a[28:31]
v_mfma_f32_16x16x32_bf16 a[84:87], v[76:79], v[84:87], a[84:87]
ds_read_b64_tr_b16 v[84:85], v21 offset:57600
ds_read_b64_tr_b16 v[86:87], v29 offset:57600
s_waitcnt lgkmcnt(6)
v_mfma_f32_16x16x32_bf16 a[32:35], v[72:75], v[88:91], a[32:35]
v_mfma_f32_16x16x32_bf16 a[88:91], v[76:79], v[88:91], a[88:91]
ds_read_b64_tr_b16 v[88:89], v22 offset:57600
ds_read_b64_tr_b16 v[90:91], v30 offset:57600
s_waitcnt lgkmcnt(6)
v_mfma_f32_16x16x32_bf16 a[36:39], v[72:75], v[92:95], a[36:39]
v_mfma_f32_16x16x32_bf16 a[92:95], v[76:79], v[92:95], a[92:95]
ds_read_b64_tr_b16 v[92:93], v23 offset:57600
ds_read_b64_tr_b16 v[94:95], v31 offset:57600
s_waitcnt lgkmcnt(6)
v_mfma_f32_16x16x32_bf16 a[40:43], v[72:75], v[80:83], a[40:43]
v_mfma_f32_16x16x32_bf16 a[96:99], v[76:79], v[80:83], a[96:99]
s_waitcnt lgkmcnt(4)
v_mfma_f32_16x16x32_bf16 a[44:47], v[72:75], v[84:87], a[44:47]
v_mfma_f32_16x16x32_bf16 a[100:103], v[76:79], v[84:87], a[100:103]
s_waitcnt lgkmcnt(2)
v_mfma_f32_16x16x32_bf16 a[48:51], v[72:75], v[88:91], a[48:51]
v_mfma_f32_16x16x32_bf16 a[104:107], v[76:79], v[88:91], a[104:107]
s_waitcnt lgkmcnt(0)
v_mfma_f32_16x16x32_bf16 a[52:55], v[72:75], v[92:95], a[52:55]
v_mfma_f32_16x16x32_bf16 a[108:111], v[76:79], v[92:95], a[108:111]
s_add_u32 s43, s48, 4096
buffer_load_dwordx4 v[72:75], v1, s[8:11], s43 offen offset:3072
s_add_u32 s43, s48, 20480
buffer_load_dwordx4 v[76:79], v1, s[8:11], s43 offen offset:3072
s_waitcnt vmcnt(2)
s_barrier
s_add_u32 s42, s49, 573440
s_add_u32 m0, s51, 57344
s_nop 0
buffer_load_dwordx4 v2, s[12:15], s42 offen lds
s_add_u32 m0, s51, 58368
s_nop 0
buffer_load_dwordx4 v3, s[12:15], s42 offen lds
s_add_u32 m0, s51, 59392
s_nop 0
buffer_load_dwordx4 v4, s[12:15], s42 offen lds
s_add_u32 m0, s51, 60416
s_nop 0
buffer_load_dwordx4 v5, s[12:15], s42 offen lds
s_add_u32 m0, s51, 61440
s_nop 0
buffer_load_dwordx4 v6, s[12:15], s42 offen lds
s_add_u32 m0, s51, 62464
s_nop 0
buffer_load_dwordx4 v7, s[12:15], s42 offen lds
s_add_u32 m0, s51, 63488
s_nop 0
buffer_load_dwordx4 v8, s[12:15], s42 offen lds
s_add_u32 m0, s51, 64512
s_nop 0
buffer_load_dwordx4 v9, s[12:15], s42 offen lds
s_add_u32 m0, s51, 65536
s_nop 0
buffer_load_dwordx4 v10, s[12:15], s42 offen lds
s_add_u32 m0, s51, 66560
s_nop 0
buffer_load_dwordx4 v11, s[12:15], s42 offen lds
s_add_u32 m0, s51, 67584
s_nop 0
buffer_load_dwordx4 v12, s[12:15], s42 offen lds
s_add_u32 m0, s51, 68608
s_nop 0
buffer_load_dwordx4 v13, s[12:15], s42 offen lds
s_add_u32 m0, s51, 69632
s_nop 0
buffer_load_dwordx4 v14, s[12:15], s42 offen lds
s_add_u32 m0, s51, 70656
s_nop 0
buffer_load_dwordx4 v15, s[12:15], s42 offen lds
ds_read_b64_tr_b16 v[80:81], v18 offset:0
ds_read_b64_tr_b16 v[82:83], v26 offset:0
ds_read_b64_tr_b16 v[84:85], v19 offset:0
ds_read_b64_tr_b16 v[86:87], v27 offset:0
ds_read_b64_tr_b16 v[88:89], v20 offset:0
ds_read_b64_tr_b16 v[90:91], v28 offset:0
ds_read_b64_tr_b16 v[92:93], v21 offset:0
ds_read_b64_tr_b16 v[94:95], v29 offset:0
s_waitcnt lgkmcnt(6)
v_mfma_f32_16x16x32_bf16 a[0:3], v[48:51], v[80:83], a[0:3]
v_mfma_f32_16x16x32_bf16 a[56:59], v[52:55], v[80:83], a[56:59]
ds_read_b64_tr_b16 v[80:81], v22 offset:0
ds_read_b64_tr_b16 v[82:83], v30 offset:0
s_waitcnt lgkmcnt(6)
v_mfma_f32_16x16x32_bf16 a[4:7], v[48:51], v[84:87], a[4:7]
v_mfma_f32_16x16x32_bf16 a[60:63], v[52:55], v[84:87], a[60:63]
ds_read_b64_tr_b16 v[84:85], v23 offset:0
ds_read_b64_tr_b16 v[86:87], v31 offset:0
s_waitcnt lgkmcnt(6)
v_mfma_f32_16x16x32_bf16 a[8:11], v[48:51], v[88:91], a[8:11]
v_mfma_f32_16x16x32_bf16 a[64:67], v[52:55], v[88:91], a[64:67]
ds_read_b64_tr_b16 v[88:89], v24 offset:0
ds_read_b64_tr_b16 v[90:91], v32 offset:0
s_waitcnt lgkmcnt(6)
v_mfma_f32_16x16x32_bf16 a[12:15], v[48:51], v[92:95], a[12:15]
v_mfma_f32_16x16x32_bf16 a[68:71], v[52:55], v[92:95], a[68:71]
ds_read_b64_tr_b16 v[92:93], v25 offset:0
ds_read_b64_tr_b16 v[94:95], v33 offset:0
s_waitcnt lgkmcnt(6)
v_mfma_f32_16x16x32_bf16 a[16:19], v[48:51], v[80:83], a[16:19]
v_mfma_f32_16x16x32_bf16 a[72:75], v[52:55], v[80:83], a[72:75]
ds_read_b64_tr_b16 v[80:81], v18 offset:256
ds_read_b64_tr_b16 v[82:83], v26 offset:256
s_waitcnt lgkmcnt(6)
v_mfma_f32_16x16x32_bf16 a[20:23], v[48:51], v[84:87], a[20:23]
v_mfma_f32_16x16x32_bf16 a[76:79], v[52:55], v[84:87], a[76:79]
ds_read_b64_tr_b16 v[84:85], v19 offset:256
ds_read_b64_tr_b16 v[86:87], v27 offset:256
s_waitcnt lgkmcnt(6)
v_mfma_f32_16x16x32_bf16 a[24:27], v[48:51], v[88:91], a[24:27]
v_mfma_f32_16x16x32_bf16 a[80:83], v[52:55], v[88:91], a[80:83]
ds_read_b64_tr_b16 v[88:89], v20 offset:256
ds_read_b64_tr_b16 v[90:91], v28 offset:256
s_waitcnt lgkmcnt(6)
v_mfma_f32_16x16x32_bf16 a[28:31], v[48:51], v[92:95], a[28:31]
v_mfma_f32_16x16x32_bf16 a[84:87], v[52:55], v[92:95], a[84:87]
ds_read_b64_tr_b16 v[92:93], v21 offset:256
ds_read_b64_tr_b16 v[94:95], v29 offset:256
s_waitcnt lgkmcnt(6)
v_mfma_f32_16x16x32_bf16 a[32:35], v[48:51], v[80:83], a[32:35]
v_mfma_f32_16x16x32_bf16 a[88:91], v[52:55], v[80:83], a[88:91]
ds_read_b64_tr_b16 v[80:81], v22 offset:256
ds_read_b64_tr_b16 v[82:83], v30 offset:256
s_waitcnt lgkmcnt(6)
v_mfma_f32_16x16x32_bf16 a[36:39], v[48:51], v[84:87], a[36:39]
v_mfma_f32_16x16x32_bf16 a[92:95], v[52:55], v[84:87], a[92:95]
ds_read_b64_tr_b16 v[84:85], v23 offset:256
ds_read_b64_tr_b16 v[86:87], v31 offset:256
s_waitcnt lgkmcnt(6)
v_mfma_f32_16x16x32_bf16 a[40:43], v[48:51], v[88:91], a[40:43]
v_mfma_f32_16x16x32_bf16 a[96:99], v[52:55], v[88:91], a[96:99]
s_waitcnt lgkmcnt(4)
v_mfma_f32_16x16x32_bf16 a[44:47], v[48:51], v[92:95], a[44:47]
v_mfma_f32_16x16x32_bf16 a[100:103], v[52:55], v[92:95], a[100:103]
s_waitcnt lgkmcnt(2)
v_mfma_f32_16x16x32_bf16 a[48:51], v[48:51], v[80:83], a[48:51]
v_mfma_f32_16x16x32_bf16 a[104:107], v[52:55], v[80:83], a[104:107]
s_waitcnt lgkmcnt(0)
v_mfma_f32_16x16x32_bf16 a[52:55], v[48:51], v[84:87], a[52:55]
v_mfma_f32_16x16x32_bf16 a[108:111], v[52:55], v[84:87], a[108:111]
s_waitcnt vmcnt(0)
s_barrier
s_add_u32 s42, s49, 688128
s_add_u32 m0, s51, 0
s_nop 0
buffer_load_dwordx4 v2, s[12:15], s42 offen lds
s_add_u32 m0, s51, 1024
s_nop 0
buffer_load_dwordx4 v3, s[12:15], s42 offen lds
s_add_u32 m0, s51, 2048
s_nop 0
buffer_load_dwordx4 v4, s[12:15], s42 offen lds
s_add_u32 m0, s51, 3072
s_nop 0
buffer_load_dwordx4 v5, s[12:15], s42 offen lds
s_add_u32 m0, s51, 4096
s_nop 0
buffer_load_dwordx4 v6, s[12:15], s42 offen lds
s_add_u32 m0, s51, 5120
s_nop 0
buffer_load_dwordx4 v7, s[12:15], s42 offen lds
s_add_u32 m0, s51, 6144
s_nop 0
buffer_load_dwordx4 v8, s[12:15], s42 offen lds
s_add_u32 m0, s51, 7168
s_nop 0
buffer_load_dwordx4 v9, s[12:15], s42 offen lds
s_add_u32 m0, s51, 8192
s_nop 0
buffer_load_dwordx4 v10, s[12:15], s42 offen lds
s_add_u32 m0, s51, 9216
s_nop 0
buffer_load_dwordx4 v11, s[12:15], s42 offen lds
s_add_u32 m0, s51, 10240
s_nop 0
buffer_load_dwordx4 v12, s[12:15], s42 offen lds
s_add_u32 m0, s51, 11264
s_nop 0
buffer_load_dwordx4 v13, s[12:15], s42 offen lds
s_add_u32 m0, s51, 12288
s_nop 0
buffer_load_dwordx4 v14, s[12:15], s42 offen lds
s_add_u32 m0, s51, 13312
s_nop 0
buffer_load_dwordx4 v15, s[12:15], s42 offen lds
ds_read_b64_tr_b16 v[88:89], v18 offset:57344
ds_read_b64_tr_b16 v[90:91], v26 offset:57344
ds_read_b64_tr_b16 v[92:93], v19 offset:57344
ds_read_b64_tr_b16 v[94:95], v27 offset:57344
ds_read_b64_tr_b16 v[80:81], v20 offset:57344
ds_read_b64_tr_b16 v[82:83], v28 offset:57344
ds_read_b64_tr_b16 v[84:85], v21 offset:57344
ds_read_b64_tr_b16 v[86:87], v29 offset:57344
s_waitcnt lgkmcnt(6)
v_mfma_f32_16x16x32_bf16 a[0:3], v[56:59], v[88:91], a[0:3]
v_mfma_f32_16x16x32_bf16 a[56:59], v[60:63], v[88:91], a[56:59]
ds_read_b64_tr_b16 v[88:89], v22 offset:57344
ds_read_b64_tr_b16 v[90:91], v30 offset:57344
s_waitcnt lgkmcnt(6)
v_mfma_f32_16x16x32_bf16 a[4:7], v[56:59], v[92:95], a[4:7]
v_mfma_f32_16x16x32_bf16 a[60:63], v[60:63], v[92:95], a[60:63]
ds_read_b64_tr_b16 v[92:93], v23 offset:57344
ds_read_b64_tr_b16 v[94:95], v31 offset:57344
s_waitcnt lgkmcnt(6)
v_mfma_f32_16x16x32_bf16 a[8:11], v[56:59], v[80:83], a[8:11]
v_mfma_f32_16x16x32_bf16 a[64:67], v[60:63], v[80:83], a[64:67]
ds_read_b64_tr_b16 v[80:81], v24 offset:57344
ds_read_b64_tr_b16 v[82:83], v32 offset:57344
s_waitcnt lgkmcnt(6)
v_mfma_f32_16x16x32_bf16 a[12:15], v[56:59], v[84:87], a[12:15]
v_mfma_f32_16x16x32_bf16 a[68:71], v[60:63], v[84:87], a[68:71]
ds_read_b64_tr_b16 v[84:85], v25 offset:57344
ds_read_b64_tr_b16 v[86:87], v33 offset:57344
s_waitcnt lgkmcnt(6)
v_mfma_f32_16x16x32_bf16 a[16:19], v[56:59], v[88:91], a[16:19]
v_mfma_f32_16x16x32_bf16 a[72:75], v[60:63], v[88:91], a[72:75]
ds_read_b64_tr_b16 v[88:89], v18 offset:57600
ds_read_b64_tr_b16 v[90:91], v26 offset:57600
s_waitcnt lgkmcnt(6)
v_mfma_f32_16x16x32_bf16 a[20:23], v[56:59], v[92:95], a[20:23]
v_mfma_f32_16x16x32_bf16 a[76:79], v[60:63], v[92:95], a[76:79]
ds_read_b64_tr_b16 v[92:93], v19 offset:57600
ds_read_b64_tr_b16 v[94:95], v27 offset:57600
s_waitcnt lgkmcnt(6)
v_mfma_f32_16x16x32_bf16 a[24:27], v[56:59], v[80:83], a[24:27]
v_mfma_f32_16x16x32_bf16 a[80:83], v[60:63], v[80:83], a[80:83]
ds_read_b64_tr_b16 v[80:81], v20 offset:57600
ds_read_b64_tr_b16 v[82:83], v28 offset:57600
s_waitcnt lgkmcnt(6)
v_mfma_f32_16x16x32_bf16 a[28:31], v[56:59], v[84:87], a[28:31]
v_mfma_f32_16x16x32_bf16 a[84:87], v[60:63], v[84:87], a[84:87]
ds_read_b64_tr_b16 v[84:85], v21 offset:57600
ds_read_b64_tr_b16 v[86:87], v29 offset:57600
s_waitcnt lgkmcnt(6)
v_mfma_f32_16x16x32_bf16 a[32:35], v[56:59], v[88:91], a[32:35]
v_mfma_f32_16x16x32_bf16 a[88:91], v[60:63], v[88:91], a[88:91]
ds_read_b64_tr_b16 v[88:89], v22 offset:57600
ds_read_b64_tr_b16 v[90:91], v30 offset:57600
s_waitcnt lgkmcnt(6)
v_mfma_f32_16x16x32_bf16 a[36:39], v[56:59], v[92:95], a[36:39]
v_mfma_f32_16x16x32_bf16 a[92:95], v[60:63], v[92:95], a[92:95]
ds_read_b64_tr_b16 v[92:93], v23 offset:57600
ds_read_b64_tr_b16 v[94:95], v31 offset:57600
s_waitcnt lgkmcnt(6)
v_mfma_f32_16x16x32_bf16 a[40:43], v[56:59], v[80:83], a[40:43]
v_mfma_f32_16x16x32_bf16 a[96:99], v[60:63], v[80:83], a[96:99]
s_waitcnt lgkmcnt(4)
v_mfma_f32_16x16x32_bf16 a[44:47], v[56:59], v[84:87], a[44:47]
v_mfma_f32_16x16x32_bf16 a[100:103], v[60:63], v[84:87], a[100:103]
s_waitcnt lgkmcnt(2)
v_mfma_f32_16x16x32_bf16 a[48:51], v[56:59], v[88:91], a[48:51]
v_mfma_f32_16x16x32_bf16 a[104:107], v[60:63], v[88:91], a[104:107]
s_waitcnt lgkmcnt(0)
v_mfma_f32_16x16x32_bf16 a[52:55], v[56:59], v[92:95], a[52:55]
v_mfma_f32_16x16x32_bf16 a[108:111], v[60:63], v[92:95], a[108:111]
s_waitcnt vmcnt(0)
s_barrier
s_add_u32 s42, s49, 802816
s_add_u32 m0, s51, 57344
s_nop 0
buffer_load_dwordx4 v2, s[12:15], s42 offen lds
s_add_u32 m0, s51, 58368
s_nop 0
buffer_load_dwordx4 v3, s[12:15], s42 offen lds
s_add_u32 m0, s51, 59392
s_nop 0
buffer_load_dwordx4 v4, s[12:15], s42 offen lds
s_add_u32 m0, s51, 60416
s_nop 0
buffer_load_dwordx4 v5, s[12:15], s42 offen lds
s_add_u32 m0, s51, 61440
s_nop 0
buffer_load_dwordx4 v6, s[12:15], s42 offen lds
s_add_u32 m0, s51, 62464
s_nop 0
buffer_load_dwordx4 v7, s[12:15], s42 offen lds
s_add_u32 m0, s51, 63488
s_nop 0
buffer_load_dwordx4 v8, s[12:15], s42 offen lds
s_add_u32 m0, s51, 64512
s_nop 0
buffer_load_dwordx4 v9, s[12:15], s42 offen lds
s_add_u32 m0, s51, 65536
s_nop 0
buffer_load_dwordx4 v10, s[12:15], s42 offen lds
s_add_u32 m0, s51, 66560
s_nop 0
buffer_load_dwordx4 v11, s[12:15], s42 offen lds
s_add_u32 m0, s51, 67584
s_nop 0
buffer_load_dwordx4 v12, s[12:15], s42 offen lds
s_add_u32 m0, s51, 68608
s_nop 0
buffer_load_dwordx4 v13, s[12:15], s42 offen lds
s_add_u32 m0, s51, 69632
s_nop 0
buffer_load_dwordx4 v14, s[12:15], s42 offen lds
s_add_u32 m0, s51, 70656
s_nop 0
buffer_load_dwordx4 v15, s[12:15], s42 offen lds
ds_read_b64_tr_b16 v[80:81], v18 offset:0
ds_read_b64_tr_b16 v[82:83], v26 offset:0
ds_read_b64_tr_b16 v[84:85], v19 offset:0
ds_read_b64_tr_b16 v[86:87], v27 offset:0
ds_read_b64_tr_b16 v[88:89], v20 offset:0
ds_read_b64_tr_b16 v[90:91], v28 offset:0
ds_read_b64_tr_b16 v[92:93], v21 offset:0
ds_read_b64_tr_b16 v[94:95], v29 offset:0
s_waitcnt lgkmcnt(6)
v_mfma_f32_16x16x32_bf16 a[0:3], v[64:67], v[80:83], a[0:3]
v_mfma_f32_16x16x32_bf16 a[56:59], v[68:71], v[80:83], a[56:59]
ds_read_b64_tr_b16 v[80:81], v22 offset:0
ds_read_b64_tr_b16 v[82:83], v30 offset:0
s_waitcnt lgkmcnt(6)
v_mfma_f32_16x16x32_bf16 a[4:7], v[64:67], v[84:87], a[4:7]
v_mfma_f32_16x16x32_bf16 a[60:63], v[68:71], v[84:87], a[60:63]
ds_read_b64_tr_b16 v[84:85], v23 offset:0
ds_read_b64_tr_b16 v[86:87], v31 offset:0
s_waitcnt lgkmcnt(6)
v_mfma_f32_16x16x32_bf16 a[8:11], v[64:67], v[88:91], a[8:11]
v_mfma_f32_16x16x32_bf16 a[64:67], v[68:71], v[88:91], a[64:67]
ds_read_b64_tr_b16 v[88:89], v24 offset:0
ds_read_b64_tr_b16 v[90:91], v32 offset:0
s_waitcnt lgkmcnt(6)
v_mfma_f32_16x16x32_bf16 a[12:15], v[64:67], v[92:95], a[12:15]
v_mfma_f32_16x16x32_bf16 a[68:71], v[68:71], v[92:95], a[68:71]
ds_read_b64_tr_b16 v[92:93], v25 offset:0
ds_read_b64_tr_b16 v[94:95], v33 offset:0
s_waitcnt lgkmcnt(6)
v_mfma_f32_16x16x32_bf16 a[16:19], v[64:67], v[80:83], a[16:19]
v_mfma_f32_16x16x32_bf16 a[72:75], v[68:71], v[80:83], a[72:75]
ds_read_b64_tr_b16 v[80:81], v18 offset:256
ds_read_b64_tr_b16 v[82:83], v26 offset:256
s_waitcnt lgkmcnt(6)
v_mfma_f32_16x16x32_bf16 a[20:23], v[64:67], v[84:87], a[20:23]
v_mfma_f32_16x16x32_bf16 a[76:79], v[68:71], v[84:87], a[76:79]
ds_read_b64_tr_b16 v[84:85], v19 offset:256
ds_read_b64_tr_b16 v[86:87], v27 offset:256
s_waitcnt lgkmcnt(6)
v_mfma_f32_16x16x32_bf16 a[24:27], v[64:67], v[88:91], a[24:27]
v_mfma_f32_16x16x32_bf16 a[80:83], v[68:71], v[88:91], a[80:83]
ds_read_b64_tr_b16 v[88:89], v20 offset:256
ds_read_b64_tr_b16 v[90:91], v28 offset:256
s_waitcnt lgkmcnt(6)
v_mfma_f32_16x16x32_bf16 a[28:31], v[64:67], v[92:95], a[28:31]
v_mfma_f32_16x16x32_bf16 a[84:87], v[68:71], v[92:95], a[84:87]
ds_read_b64_tr_b16 v[92:93], v21 offset:256
ds_read_b64_tr_b16 v[94:95], v29 offset:256
s_waitcnt lgkmcnt(6)
v_mfma_f32_16x16x32_bf16 a[32:35], v[64:67], v[80:83], a[32:35]
v_mfma_f32_16x16x32_bf16 a[88:91], v[68:71], v[80:83], a[88:91]
ds_read_b64_tr_b16 v[80:81], v22 offset:256
ds_read_b64_tr_b16 v[82:83], v30 offset:256
s_waitcnt lgkmcnt(6)
v_mfma_f32_16x16x32_bf16 a[36:39], v[64:67], v[84:87], a[36:39]
v_mfma_f32_16x16x32_bf16 a[92:95], v[68:71], v[84:87], a[92:95]
ds_read_b64_tr_b16 v[84:85], v23 offset:256
ds_read_b64_tr_b16 v[86:87], v31 offset:256
s_waitcnt lgkmcnt(6)
v_mfma_f32_16x16x32_bf16 a[40:43], v[64:67], v[88:91], a[40:43]
v_mfma_f32_16x16x32_bf16 a[96:99], v[68:71], v[88:91], a[96:99]
s_waitcnt lgkmcnt(4)
v_mfma_f32_16x16x32_bf16 a[44:47], v[64:67], v[92:95], a[44:47]
v_mfma_f32_16x16x32_bf16 a[100:103], v[68:71], v[92:95], a[100:103]
s_waitcnt lgkmcnt(2)
v_mfma_f32_16x16x32_bf16 a[48:51], v[64:67], v[80:83], a[48:51]
v_mfma_f32_16x16x32_bf16 a[104:107], v[68:71], v[80:83], a[104:107]
s_waitcnt lgkmcnt(0)
v_mfma_f32_16x16x32_bf16 a[52:55], v[64:67], v[84:87], a[52:55]
v_mfma_f32_16x16x32_bf16 a[108:111], v[68:71], v[84:87], a[108:111]
s_waitcnt vmcnt(0)
s_barrier
ds_read_b64_tr_b16 v[88:89], v18 offset:57344
ds_read_b64_tr_b16 v[90:91], v26 offset:57344
ds_read_b64_tr_b16 v[92:93], v19 offset:57344
ds_read_b64_tr_b16 v[94:95], v27 offset:57344
ds_read_b64_tr_b16 v[80:81], v20 offset:57344
ds_read_b64_tr_b16 v[82:83], v28 offset:57344
ds_read_b64_tr_b16 v[84:85], v21 offset:57344
ds_read_b64_tr_b16 v[86:87], v29 offset:57344
s_waitcnt lgkmcnt(6)
v_mfma_f32_16x16x32_bf16 a[0:3], v[72:75], v[88:91], a[0:3]
v_mfma_f32_16x16x32_bf16 a[56:59], v[76:79], v[88:91], a[56:59]
ds_read_b64_tr_b16 v[88:89], v22 offset:57344
ds_read_b64_tr_b16 v[90:91], v30 offset:57344
s_waitcnt lgkmcnt(6)
v_mfma_f32_16x16x32_bf16 a[4:7], v[72:75], v[92:95], a[4:7]
v_mfma_f32_16x16x32_bf16 a[60:63], v[76:79], v[92:95], a[60:63]
ds_read_b64_tr_b16 v[92:93], v23 offset:57344
ds_read_b64_tr_b16 v[94:95], v31 offset:57344
s_waitcnt lgkmcnt(6)
v_mfma_f32_16x16x32_bf16 a[8:11], v[72:75], v[80:83], a[8:11]
v_mfma_f32_16x16x32_bf16 a[64:67], v[76:79], v[80:83], a[64:67]
ds_read_b64_tr_b16 v[80:81], v24 offset:57344
ds_read_b64_tr_b16 v[82:83], v32 offset:57344
s_waitcnt lgkmcnt(6)
v_mfma_f32_16x16x32_bf16 a[12:15], v[72:75], v[84:87], a[12:15]
v_mfma_f32_16x16x32_bf16 a[68:71], v[76:79], v[84:87], a[68:71]
ds_read_b64_tr_b16 v[84:85], v25 offset:57344
ds_read_b64_tr_b16 v[86:87], v33 offset:57344
s_waitcnt lgkmcnt(6)
v_mfma_f32_16x16x32_bf16 a[16:19], v[72:75], v[88:91], a[16:19]
v_mfma_f32_16x16x32_bf16 a[72:75], v[76:79], v[88:91], a[72:75]
ds_read_b64_tr_b16 v[88:89], v18 offset:57600
ds_read_b64_tr_b16 v[90:91], v26 offset:57600
s_waitcnt lgkmcnt(6)
v_mfma_f32_16x16x32_bf16 a[20:23], v[72:75], v[92:95], a[20:23]
v_mfma_f32_16x16x32_bf16 a[76:79], v[76:79], v[92:95], a[76:79]
ds_read_b64_tr_b16 v[92:93], v19 offset:57600
ds_read_b64_tr_b16 v[94:95], v27 offset:57600
s_waitcnt lgkmcnt(6)
v_mfma_f32_16x16x32_bf16 a[24:27], v[72:75], v[80:83], a[24:27]
v_mfma_f32_16x16x32_bf16 a[80:83], v[76:79], v[80:83], a[80:83]
ds_read_b64_tr_b16 v[80:81], v20 offset:57600
ds_read_b64_tr_b16 v[82:83], v28 offset:57600
s_waitcnt lgkmcnt(6)
v_mfma_f32_16x16x32_bf16 a[28:31], v[72:75], v[84:87], a[28:31]
v_mfma_f32_16x16x32_bf16 a[84:87], v[76:79], v[84:87], a[84:87]
ds_read_b64_tr_b16 v[84:85], v21 offset:57600
ds_read_b64_tr_b16 v[86:87], v29 offset:57600
s_waitcnt lgkmcnt(6)
v_mfma_f32_16x16x32_bf16 a[32:35], v[72:75], v[88:91], a[32:35]
v_mfma_f32_16x16x32_bf16 a[88:91], v[76:79], v[88:91], a[88:91]
ds_read_b64_tr_b16 v[88:89], v22 offset:57600
ds_read_b64_tr_b16 v[90:91], v30 offset:57600
s_waitcnt lgkmcnt(6)
v_mfma_f32_16x16x32_bf16 a[36:39], v[72:75], v[92:95], a[36:39]
v_mfma_f32_16x16x32_bf16 a[92:95], v[76:79], v[92:95], a[92:95]
ds_read_b64_tr_b16 v[92:93], v23 offset:57600
ds_read_b64_tr_b16 v[94:95], v31 offset:57600
s_waitcnt lgkmcnt(6)
v_mfma_f32_16x16x32_bf16 a[40:43], v[72:75], v[80:83], a[40:43]
v_mfma_f32_16x16x32_bf16 a[96:99], v[76:79], v[80:83], a[96:99]
s_waitcnt lgkmcnt(4)
v_mfma_f32_16x16x32_bf16 a[44:47], v[72:75], v[84:87], a[44:47]
v_mfma_f32_16x16x32_bf16 a[100:103], v[76:79], v[84:87], a[100:103]
s_waitcnt lgkmcnt(2)
v_mfma_f32_16x16x32_bf16 a[48:51], v[72:75], v[88:91], a[48:51]
v_mfma_f32_16x16x32_bf16 a[104:107], v[76:79], v[88:91], a[104:107]
s_waitcnt lgkmcnt(0)
v_mfma_f32_16x16x32_bf16 a[52:55], v[72:75], v[92:95], a[52:55]
v_mfma_f32_16x16x32_bf16 a[108:111], v[76:79], v[92:95], a[108:111]
s_nop 7
v_accvgpr_read_b32 v80, a0
v_accvgpr_read_b32 v81, a1
v_accvgpr_read_b32 v82, a2
v_accvgpr_read_b32 v83, a3
v_accvgpr_read_b32 v84, a56
v_accvgpr_read_b32 v85, a57
v_accvgpr_read_b32 v86, a58
v_accvgpr_read_b32 v87, a59
v_mov_b32 v104, s54
v_mul_f32 v96, v80, v80
v_mul_f32 v97, v81, v81
v_mul_f32 v98, v82, v82
v_mul_f32 v99, v83, v83
v_mul_f32 v100, v84, v84
v_mul_f32 v101, v85, v85
v_mul_f32 v102, v86, v86
v_mul_f32 v103, v87, v87
v_fma_f32 v96, v96, s55, v104
v_fma_f32 v97, v97, s55, v104
v_fma_f32 v98, v98, s55, v104
v_fma_f32 v99, v99, s55, v104
v_fma_f32 v100, v100, s55, v104
v_fma_f32 v101, v101, s55, v104
v_fma_f32 v102, v102, s55, v104
v_fma_f32 v103, v103, s55, v104
v_mul_f32 v96, v96, v80
v_mul_f32 v97, v97, v81
v_mul_f32 v98, v98, v82
v_mul_f32 v99, v99, v83
v_mul_f32 v100, v100, v84
v_mul_f32 v101, v101, v85
v_mul_f32 v102, v102, v86
v_mul_f32 v103, v103, v87
v_exp_f32 v96, v96
v_exp_f32 v97, v97
v_exp_f32 v98, v98
v_exp_f32 v99, v99
v_exp_f32 v100, v100
v_exp_f32 v101, v101
v_exp_f32 v102, v102
v_exp_f32 v103, v103
v_add_f32 v96, 1.0, v96
v_add_f32 v97, 1.0, v97
v_add_f32 v98, 1.0, v98
v_add_f32 v99, 1.0, v99
v_add_f32 v100, 1.0, v100
v_add_f32 v101, 1.0, v101
v_add_f32 v102, 1.0, v102
v_add_f32 v103, 1.0, v103
v_rcp_f32 v96, v96
v_rcp_f32 v97, v97
v_rcp_f32 v98, v98
v_rcp_f32 v99, v99
v_rcp_f32 v100, v100
v_rcp_f32 v101, v101
v_rcp_f32 v102, v102
v_rcp_f32 v103, v103
s_nop 0
v_mul_f32 v80, v80, v96
v_mul_f32 v81, v81, v97
v_mul_f32 v82, v82, v98
v_mul_f32 v83, v83, v99
v_mul_f32 v84, v84, v100
v_mul_f32 v85, v85, v101
v_mul_f32 v86, v86, v102
v_mul_f32 v87, v87, v103
v_mov_b32 v48, v80
v_mul_f32 v64, v80, v80
v_accvgpr_write_b32 a0, v80
v_mov_b32 v49, v81
v_mul_f32 v65, v81, v81
v_accvgpr_write_b32 a1, v81
v_mov_b32 v50, v82
v_mul_f32 v66, v82, v82
v_accvgpr_write_b32 a2, v82
v_mov_b32 v51, v83
v_mul_f32 v67, v83, v83
v_accvgpr_write_b32 a3, v83
v_mov_b32 v52, v84
v_mul_f32 v68, v84, v84
v_accvgpr_write_b32 a56, v84
v_mov_b32 v53, v85
v_mul_f32 v69, v85, v85
v_accvgpr_write_b32 a57, v85
v_mov_b32 v54, v86
v_mul_f32 v70, v86, v86
v_accvgpr_write_b32 a58, v86
v_mov_b32 v55, v87
v_mul_f32 v71, v87, v87
v_accvgpr_write_b32 a59, v87
v_accvgpr_read_b32 v80, a4
v_accvgpr_read_b32 v81, a5
v_accvgpr_read_b32 v82, a6
v_accvgpr_read_b32 v83, a7
v_accvgpr_read_b32 v84, a60
v_accvgpr_read_b32 v85, a61
v_accvgpr_read_b32 v86, a62
v_accvgpr_read_b32 v87, a63
v_mov_b32 v104, s54
v_mul_f32 v96, v80, v80
v_mul_f32 v97, v81, v81
v_mul_f32 v98, v82, v82
v_mul_f32 v99, v83, v83
v_mul_f32 v100, v84, v84
v_mul_f32 v101, v85, v85
v_mul_f32 v102, v86, v86
v_mul_f32 v103, v87, v87
v_fma_f32 v96, v96, s55, v104
v_fma_f32 v97, v97, s55, v104
v_fma_f32 v98, v98, s55, v104
v_fma_f32 v99, v99, s55, v104
v_fma_f32 v100, v100, s55, v104
v_fma_f32 v101, v101, s55, v104
v_fma_f32 v102, v102, s55, v104
v_fma_f32 v103, v103, s55, v104
v_mul_f32 v96, v96, v80
v_mul_f32 v97, v97, v81
v_mul_f32 v98, v98, v82
v_mul_f32 v99, v99, v83
v_mul_f32 v100, v100, v84
v_mul_f32 v101, v101, v85
v_mul_f32 v102, v102, v86
v_mul_f32 v103, v103, v87
v_exp_f32 v96, v96
v_exp_f32 v97, v97
v_exp_f32 v98, v98
v_exp_f32 v99, v99
v_exp_f32 v100, v100
v_exp_f32 v101, v101
v_exp_f32 v102, v102
v_exp_f32 v103, v103
v_add_f32 v96, 1.0, v96
v_add_f32 v97, 1.0, v97
v_add_f32 v98, 1.0, v98
v_add_f32 v99, 1.0, v99
v_add_f32 v100, 1.0, v100
v_add_f32 v101, 1.0, v101
v_add_f32 v102, 1.0, v102
v_add_f32 v103, 1.0, v103
v_rcp_f32 v96, v96
v_rcp_f32 v97, v97
v_rcp_f32 v98, v98
v_rcp_f32 v99, v99
v_rcp_f32 v100, v100
v_rcp_f32 v101, v101
v_rcp_f32 v102, v102
v_rcp_f32 v103, v103
s_nop 0
v_mul_f32 v80, v80, v96
v_mul_f32 v81, v81, v97
v_mul_f32 v82, v82, v98
v_mul_f32 v83, v83, v99
v_mul_f32 v84, v84, v100
v_mul_f32 v85, v85, v101
v_mul_f32 v86, v86, v102
v_mul_f32 v87, v87, v103
v_add_f32 v48, v48, v80
v_fmac_f32 v64, v80, v80
v_accvgpr_write_b32 a4, v80
v_add_f32 v49, v49, v81
v_fmac_f32 v65, v81, v81
v_accvgpr_write_b32 a5, v81
v_add_f32 v50, v50, v82
v_fmac_f32 v66, v82, v82
v_accvgpr_write_b32 a6, v82
v_add_f32 v51, v51, v83
v_fmac_f32 v67, v83, v83
v_accvgpr_write_b32 a7, v83
v_add_f32 v52, v52, v84
v_fmac_f32 v68, v84, v84
v_accvgpr_write_b32 a60, v84
v_add_f32 v53, v53, v85
v_fmac_f32 v69, v85, v85
v_accvgpr_write_b32 a61, v85
v_add_f32 v54, v54, v86
v_fmac_f32 v70, v86, v86
v_accvgpr_write_b32 a62, v86
v_add_f32 v55, v55, v87
v_fmac_f32 v71, v87, v87
v_accvgpr_write_b32 a63, v87
v_accvgpr_read_b32 v80, a8
v_accvgpr_read_b32 v81, a9
v_accvgpr_read_b32 v82, a10
v_accvgpr_read_b32 v83, a11
v_accvgpr_read_b32 v84, a64
v_accvgpr_read_b32 v85, a65
v_accvgpr_read_b32 v86, a66
v_accvgpr_read_b32 v87, a67
v_mov_b32 v104, s54
v_mul_f32 v96, v80, v80
v_mul_f32 v97, v81, v81
v_mul_f32 v98, v82, v82
v_mul_f32 v99, v83, v83
v_mul_f32 v100, v84, v84
v_mul_f32 v101, v85, v85
v_mul_f32 v102, v86, v86
v_mul_f32 v103, v87, v87
v_fma_f32 v96, v96, s55, v104
v_fma_f32 v97, v97, s55, v104
v_fma_f32 v98, v98, s55, v104
v_fma_f32 v99, v99, s55, v104
v_fma_f32 v100, v100, s55, v104
v_fma_f32 v101, v101, s55, v104
v_fma_f32 v102, v102, s55, v104
v_fma_f32 v103, v103, s55, v104
v_mul_f32 v96, v96, v80
v_mul_f32 v97, v97, v81
v_mul_f32 v98, v98, v82
v_mul_f32 v99, v99, v83
v_mul_f32 v100, v100, v84
v_mul_f32 v101, v101, v85
v_mul_f32 v102, v102, v86
v_mul_f32 v103, v103, v87
v_exp_f32 v96, v96
v_exp_f32 v97, v97
v_exp_f32 v98, v98
v_exp_f32 v99, v99
v_exp_f32 v100, v100
v_exp_f32 v101, v101
v_exp_f32 v102, v102
v_exp_f32 v103, v103
v_add_f32 v96, 1.0, v96
v_add_f32 v97, 1.0, v97
v_add_f32 v98, 1.0, v98
v_add_f32 v99, 1.0, v99
v_add_f32 v100, 1.0, v100
v_add_f32 v101, 1.0, v101
v_add_f32 v102, 1.0, v102
v_add_f32 v103, 1.0, v103
v_rcp_f32 v96, v96
v_rcp_f32 v97, v97
v_rcp_f32 v98, v98
v_rcp_f32 v99, v99
v_rcp_f32 v100, v100
v_rcp_f32 v101, v101
v_rcp_f32 v102, v102
v_rcp_f32 v103, v103
s_nop 0
v_mul_f32 v80, v80, v96
v_mul_f32 v81, v81, v97
v_mul_f32 v82, v82, v98
v_mul_f32 v83, v83, v99
v_mul_f32 v84, v84, v100
v_mul_f32 v85, v85, v101
v_mul_f32 v86, v86, v102
v_mul_f32 v87, v87, v103
v_add_f32 v48, v48, v80
v_fmac_f32 v64, v80, v80
v_accvgpr_write_b32 a8, v80
v_add_f32 v49, v49, v81
v_fmac_f32 v65, v81, v81
v_accvgpr_write_b32 a9, v81
v_add_f32 v50, v50, v82
v_fmac_f32 v66, v82, v82
v_accvgpr_write_b32 a10, v82
v_add_f32 v51, v51, v83
v_fmac_f32 v67, v83, v83
v_accvgpr_write_b32 a11, v83
v_add_f32 v52, v52, v84
v_fmac_f32 v68, v84, v84
v_accvgpr_write_b32 a64, v84
v_add_f32 v53, v53, v85
v_fmac_f32 v69, v85, v85
v_accvgpr_write_b32 a65, v85
v_add_f32 v54, v54, v86
v_fmac_f32 v70, v86, v86
v_accvgpr_write_b32 a66, v86
v_add_f32 v55, v55, v87
v_fmac_f32 v71, v87, v87
v_accvgpr_write_b32 a67, v87
v_accvgpr_read_b32 v80, a12
v_accvgpr_read_b32 v81, a13
v_accvgpr_read_b32 v82, a14
v_accvgpr_read_b32 v83, a15
v_accvgpr_read_b32 v84, a68
v_accvgpr_read_b32 v85, a69
v_accvgpr_read_b32 v86, a70
v_accvgpr_read_b32 v87, a71
v_mov_b32 v104, s54
v_mul_f32 v96, v80, v80
v_mul_f32 v97, v81, v81
v_mul_f32 v98, v82, v82
v_mul_f32 v99, v83, v83
v_mul_f32 v100, v84, v84
v_mul_f32 v101, v85, v85
v_mul_f32 v102, v86, v86
v_mul_f32 v103, v87, v87
v_fma_f32 v96, v96, s55, v104
v_fma_f32 v97, v97, s55, v104
v_fma_f32 v98, v98, s55, v104
v_fma_f32 v99, v99, s55, v104
v_fma_f32 v100, v100, s55, v104
v_fma_f32 v101, v101, s55, v104
v_fma_f32 v102, v102, s55, v104
v_fma_f32 v103, v103, s55, v104
v_mul_f32 v96, v96, v80
v_mul_f32 v97, v97, v81
v_mul_f32 v98, v98, v82
v_mul_f32 v99, v99, v83
v_mul_f32 v100, v100, v84
v_mul_f32 v101, v101, v85
v_mul_f32 v102, v102, v86
v_mul_f32 v103, v103, v87
v_exp_f32 v96, v96
v_exp_f32 v97, v97
v_exp_f32 v98, v98
v_exp_f32 v99, v99
v_exp_f32 v100, v100
v_exp_f32 v101, v101
v_exp_f32 v102, v102
v_exp_f32 v103, v103
v_add_f32 v96, 1.0, v96
v_add_f32 v97, 1.0, v97
v_add_f32 v98, 1.0, v98
v_add_f32 v99, 1.0, v99
v_add_f32 v100, 1.0, v100
v_add_f32 v101, 1.0, v101
v_add_f32 v102, 1.0, v102
v_add_f32 v103, 1.0, v103
v_rcp_f32 v96, v96
v_rcp_f32 v97, v97
v_rcp_f32 v98, v98
v_rcp_f32 v99, v99
v_rcp_f32 v100, v100
v_rcp_f32 v101, v101
v_rcp_f32 v102, v102
v_rcp_f32 v103, v103
s_nop 0
v_mul_f32 v80, v80, v96
v_mul_f32 v81, v81, v97
v_mul_f32 v82, v82, v98
v_mul_f32 v83, v83, v99
v_mul_f32 v84, v84, v100
v_mul_f32 v85, v85, v101
v_mul_f32 v86, v86, v102
v_mul_f32 v87, v87, v103
v_add_f32 v48, v48, v80
v_fmac_f32 v64, v80, v80
v_accvgpr_write_b32 a12, v80
v_add_f32 v49, v49, v81
v_fmac_f32 v65, v81, v81
v_accvgpr_write_b32 a13, v81
v_add_f32 v50, v50, v82
v_fmac_f32 v66, v82, v82
v_accvgpr_write_b32 a14, v82
v_add_f32 v51, v51, v83
v_fmac_f32 v67, v83, v83
v_accvgpr_write_b32 a15, v83
v_add_f32 v52, v52, v84
v_fmac_f32 v68, v84, v84
v_accvgpr_write_b32 a68, v84
v_add_f32 v53, v53, v85
v_fmac_f32 v69, v85, v85
v_accvgpr_write_b32 a69, v85
v_add_f32 v54, v54, v86
v_fmac_f32 v70, v86, v86
v_accvgpr_write_b32 a70, v86
v_add_f32 v55, v55, v87
v_fmac_f32 v71, v87, v87
v_accvgpr_write_b32 a71, v87
v_accvgpr_read_b32 v80, a16
v_accvgpr_read_b32 v81, a17
v_accvgpr_read_b32 v82, a18
v_accvgpr_read_b32 v83, a19
v_accvgpr_read_b32 v84, a72
v_accvgpr_read_b32 v85, a73
v_accvgpr_read_b32 v86, a74
v_accvgpr_read_b32 v87, a75
v_mov_b32 v104, s54
v_mul_f32 v96, v80, v80
v_mul_f32 v97, v81, v81
v_mul_f32 v98, v82, v82
v_mul_f32 v99, v83, v83
v_mul_f32 v100, v84, v84
v_mul_f32 v101, v85, v85
v_mul_f32 v102, v86, v86
v_mul_f32 v103, v87, v87
v_fma_f32 v96, v96, s55, v104
v_fma_f32 v97, v97, s55, v104
v_fma_f32 v98, v98, s55, v104
v_fma_f32 v99, v99, s55, v104
v_fma_f32 v100, v100, s55, v104
v_fma_f32 v101, v101, s55, v104
v_fma_f32 v102, v102, s55, v104
v_fma_f32 v103, v103, s55, v104
v_mul_f32 v96, v96, v80
v_mul_f32 v97, v97, v81
v_mul_f32 v98, v98, v82
v_mul_f32 v99, v99, v83
v_mul_f32 v100, v100, v84
v_mul_f32 v101, v101, v85
v_mul_f32 v102, v102, v86
v_mul_f32 v103, v103, v87
v_exp_f32 v96, v96
v_exp_f32 v97, v97
v_exp_f32 v98, v98
v_exp_f32 v99, v99
v_exp_f32 v100, v100
v_exp_f32 v101, v101
v_exp_f32 v102, v102
v_exp_f32 v103, v103
v_add_f32 v96, 1.0, v96
v_add_f32 v97, 1.0, v97
v_add_f32 v98, 1.0, v98
v_add_f32 v99, 1.0, v99
v_add_f32 v100, 1.0, v100
v_add_f32 v101, 1.0, v101
v_add_f32 v102, 1.0, v102
v_add_f32 v103, 1.0, v103
v_rcp_f32 v96, v96
v_rcp_f32 v97, v97
v_rcp_f32 v98, v98
v_rcp_f32 v99, v99
v_rcp_f32 v100, v100
v_rcp_f32 v101, v101
v_rcp_f32 v102, v102
v_rcp_f32 v103, v103
s_nop 0
v_mul_f32 v80, v80, v96
v_mul_f32 v81, v81, v97
v_mul_f32 v82, v82, v98
v_mul_f32 v83, v83, v99
v_mul_f32 v84, v84, v100
v_mul_f32 v85, v85, v101
v_mul_f32 v86, v86, v102
v_mul_f32 v87, v87, v103
v_add_f32 v48, v48, v80
v_fmac_f32 v64, v80, v80
v_accvgpr_write_b32 a16, v80
v_add_f32 v49, v49, v81
v_fmac_f32 v65, v81, v81
v_accvgpr_write_b32 a17, v81
v_add_f32 v50, v50, v82
v_fmac_f32 v66, v82, v82
v_accvgpr_write_b32 a18, v82
v_add_f32 v51, v51, v83
v_fmac_f32 v67, v83, v83
v_accvgpr_write_b32 a19, v83
v_add_f32 v52, v52, v84
v_fmac_f32 v68, v84, v84
v_accvgpr_write_b32 a72, v84
v_add_f32 v53, v53, v85
v_fmac_f32 v69, v85, v85
v_accvgpr_write_b32 a73, v85
v_add_f32 v54, v54, v86
v_fmac_f32 v70, v86, v86
v_accvgpr_write_b32 a74, v86
v_add_f32 v55, v55, v87
v_fmac_f32 v71, v87, v87
v_accvgpr_write_b32 a75, v87
v_accvgpr_read_b32 v80, a20
v_accvgpr_read_b32 v81, a21
v_accvgpr_read_b32 v82, a22
v_accvgpr_read_b32 v83, a23
v_accvgpr_read_b32 v84, a76
v_accvgpr_read_b32 v85, a77
v_accvgpr_read_b32 v86, a78
v_accvgpr_read_b32 v87, a79
v_mov_b32 v104, s54
v_mul_f32 v96, v80, v80
v_mul_f32 v97, v81, v81
v_mul_f32 v98, v82, v82
v_mul_f32 v99, v83, v83
v_mul_f32 v100, v84, v84
v_mul_f32 v101, v85, v85
v_mul_f32 v102, v86, v86
v_mul_f32 v103, v87, v87
v_fma_f32 v96, v96, s55, v104
v_fma_f32 v97, v97, s55, v104
v_fma_f32 v98, v98, s55, v104
v_fma_f32 v99, v99, s55, v104
v_fma_f32 v100, v100, s55, v104
v_fma_f32 v101, v101, s55, v104
v_fma_f32 v102, v102, s55, v104
v_fma_f32 v103, v103, s55, v104
v_mul_f32 v96, v96, v80
v_mul_f32 v97, v97, v81
v_mul_f32 v98, v98, v82
v_mul_f32 v99, v99, v83
v_mul_f32 v100, v100, v84
v_mul_f32 v101, v101, v85
v_mul_f32 v102, v102, v86
v_mul_f32 v103, v103, v87
v_exp_f32 v96, v96
v_exp_f32 v97, v97
v_exp_f32 v98, v98
v_exp_f32 v99, v99
v_exp_f32 v100, v100
v_exp_f32 v101, v101
v_exp_f32 v102, v102
v_exp_f32 v103, v103
v_add_f32 v96, 1.0, v96
v_add_f32 v97, 1.0, v97
v_add_f32 v98, 1.0, v98
v_add_f32 v99, 1.0, v99
v_add_f32 v100, 1.0, v100
v_add_f32 v101, 1.0, v101
v_add_f32 v102, 1.0, v102
v_add_f32 v103, 1.0, v103
v_rcp_f32 v96, v96
v_rcp_f32 v97, v97
v_rcp_f32 v98, v98
v_rcp_f32 v99, v99
v_rcp_f32 v100, v100
v_rcp_f32 v101, v101
v_rcp_f32 v102, v102
v_rcp_f32 v103, v103
s_nop 0
v_mul_f32 v80, v80, v96
v_mul_f32 v81, v81, v97
v_mul_f32 v82, v82, v98
v_mul_f32 v83, v83, v99
v_mul_f32 v84, v84, v100
v_mul_f32 v85, v85, v101
v_mul_f32 v86, v86, v102
v_mul_f32 v87, v87, v103
v_add_f32 v48, v48, v80
v_fmac_f32 v64, v80, v80
v_accvgpr_write_b32 a20, v80
v_add_f32 v49, v49, v81
v_fmac_f32 v65, v81, v81
v_accvgpr_write_b32 a21, v81
v_add_f32 v50, v50, v82
v_fmac_f32 v66, v82, v82
v_accvgpr_write_b32 a22, v82
v_add_f32 v51, v51, v83
v_fmac_f32 v67, v83, v83
v_accvgpr_write_b32 a23, v83
v_add_f32 v52, v52, v84
v_fmac_f32 v68, v84, v84
v_accvgpr_write_b32 a76, v84
v_add_f32 v53, v53, v85
v_fmac_f32 v69, v85, v85
v_accvgpr_write_b32 a77, v85
v_add_f32 v54, v54, v86
v_fmac_f32 v70, v86, v86
v_accvgpr_write_b32 a78, v86
v_add_f32 v55, v55, v87
v_fmac_f32 v71, v87, v87
v_accvgpr_write_b32 a79, v87
v_accvgpr_read_b32 v80, a24
v_accvgpr_read_b32 v81, a25
v_accvgpr_read_b32 v82, a26
v_accvgpr_read_b32 v83, a27
v_accvgpr_read_b32 v84, a80
v_accvgpr_read_b32 v85, a81
v_accvgpr_read_b32 v86, a82
v_accvgpr_read_b32 v87, a83
v_mov_b32 v104, s54
v_mul_f32 v96, v80, v80
v_mul_f32 v97, v81, v81
v_mul_f32 v98, v82, v82
v_mul_f32 v99, v83, v83
v_mul_f32 v100, v84, v84
v_mul_f32 v101, v85, v85
v_mul_f32 v102, v86, v86
v_mul_f32 v103, v87, v87
v_fma_f32 v96, v96, s55, v104
v_fma_f32 v97, v97, s55, v104
v_fma_f32 v98, v98, s55, v104
v_fma_f32 v99, v99, s55, v104
v_fma_f32 v100, v100, s55, v104
v_fma_f32 v101, v101, s55, v104
v_fma_f32 v102, v102, s55, v104
v_fma_f32 v103, v103, s55, v104
v_mul_f32 v96, v96, v80
v_mul_f32 v97, v97, v81
v_mul_f32 v98, v98, v82
v_mul_f32 v99, v99, v83
v_mul_f32 v100, v100, v84
v_mul_f32 v101, v101, v85
v_mul_f32 v102, v102, v86
v_mul_f32 v103, v103, v87
v_exp_f32 v96, v96
v_exp_f32 v97, v97
v_exp_f32 v98, v98
v_exp_f32 v99, v99
v_exp_f32 v100, v100
v_exp_f32 v101, v101
v_exp_f32 v102, v102
v_exp_f32 v103, v103
v_add_f32 v96, 1.0, v96
v_add_f32 v97, 1.0, v97
v_add_f32 v98, 1.0, v98
v_add_f32 v99, 1.0, v99
v_add_f32 v100, 1.0, v100
v_add_f32 v101, 1.0, v101
v_add_f32 v102, 1.0, v102
v_add_f32 v103, 1.0, v103
v_rcp_f32 v96, v96
v_rcp_f32 v97, v97
v_rcp_f32 v98, v98
v_rcp_f32 v99, v99
v_rcp_f32 v100, v100
v_rcp_f32 v101, v101
v_rcp_f32 v102, v102
v_rcp_f32 v103, v103
s_nop 0
v_mul_f32 v80, v80, v96
v_mul_f32 v81, v81, v97
v_mul_f32 v82, v82, v98
v_mul_f32 v83, v83, v99
v_mul_f32 v84, v84, v100
v_mul_f32 v85, v85, v101
v_mul_f32 v86, v86, v102
v_mul_f32 v87, v87, v103
v_add_f32 v48, v48, v80
v_fmac_f32 v64, v80, v80
v_accvgpr_write_b32 a24, v80
v_add_f32 v49, v49, v81
v_fmac_f32 v65, v81, v81
v_accvgpr_write_b32 a25, v81
v_add_f32 v50, v50, v82
v_fmac_f32 v66, v82, v82
v_accvgpr_write_b32 a26, v82
v_add_f32 v51, v51, v83
v_fmac_f32 v67, v83, v83
v_accvgpr_write_b32 a27, v83
v_add_f32 v52, v52, v84
v_fmac_f32 v68, v84, v84
v_accvgpr_write_b32 a80, v84
v_add_f32 v53, v53, v85
v_fmac_f32 v69, v85, v85
v_accvgpr_write_b32 a81, v85
v_add_f32 v54, v54, v86
v_fmac_f32 v70, v86, v86
v_accvgpr_write_b32 a82, v86
v_add_f32 v55, v55, v87
v_fmac_f32 v71, v87, v87
v_accvgpr_write_b32 a83, v87
v_accvgpr_read_b32 v80, a28
v_accvgpr_read_b32 v81, a29
v_accvgpr_read_b32 v82, a30
v_accvgpr_read_b32 v83, a31
v_accvgpr_read_b32 v84, a84
v_accvgpr_read_b32 v85, a85
v_accvgpr_read_b32 v86, a86
v_accvgpr_read_b32 v87, a87
v_mov_b32 v104, s54
v_mul_f32 v96, v80, v80
v_mul_f32 v97, v81, v81
v_mul_f32 v98, v82, v82
v_mul_f32 v99, v83, v83
v_mul_f32 v100, v84, v84
v_mul_f32 v101, v85, v85
v_mul_f32 v102, v86, v86
v_mul_f32 v103, v87, v87
v_fma_f32 v96, v96, s55, v104
v_fma_f32 v97, v97, s55, v104
v_fma_f32 v98, v98, s55, v104
v_fma_f32 v99, v99, s55, v104
v_fma_f32 v100, v100, s55, v104
v_fma_f32 v101, v101, s55, v104
v_fma_f32 v102, v102, s55, v104
v_fma_f32 v103, v103, s55, v104
v_mul_f32 v96, v96, v80
v_mul_f32 v97, v97, v81
v_mul_f32 v98, v98, v82
v_mul_f32 v99, v99, v83
v_mul_f32 v100, v100, v84
v_mul_f32 v101, v101, v85
v_mul_f32 v102, v102, v86
v_mul_f32 v103, v103, v87
v_exp_f32 v96, v96
v_exp_f32 v97, v97
v_exp_f32 v98, v98
v_exp_f32 v99, v99
v_exp_f32 v100, v100
v_exp_f32 v101, v101
v_exp_f32 v102, v102
v_exp_f32 v103, v103
v_add_f32 v96, 1.0, v96
v_add_f32 v97, 1.0, v97
v_add_f32 v98, 1.0, v98
v_add_f32 v99, 1.0, v99
v_add_f32 v100, 1.0, v100
v_add_f32 v101, 1.0, v101
v_add_f32 v102, 1.0, v102
v_add_f32 v103, 1.0, v103
v_rcp_f32 v96, v96
v_rcp_f32 v97, v97
v_rcp_f32 v98, v98
v_rcp_f32 v99, v99
v_rcp_f32 v100, v100
v_rcp_f32 v101, v101
v_rcp_f32 v102, v102
v_rcp_f32 v103, v103
s_nop 0
v_mul_f32 v80, v80, v96
v_mul_f32 v81, v81, v97
v_mul_f32 v82, v82, v98
v_mul_f32 v83, v83, v99
v_mul_f32 v84, v84, v100
v_mul_f32 v85, v85, v101
v_mul_f32 v86, v86, v102
v_mul_f32 v87, v87, v103
v_add_f32 v48, v48, v80
v_fmac_f32 v64, v80, v80
v_accvgpr_write_b32 a28, v80
v_add_f32 v49, v49, v81
v_fmac_f32 v65, v81, v81
v_accvgpr_write_b32 a29, v81
v_add_f32 v50, v50, v82
v_fmac_f32 v66, v82, v82
v_accvgpr_write_b32 a30, v82
v_add_f32 v51, v51, v83
v_fmac_f32 v67, v83, v83
v_accvgpr_write_b32 a31, v83
v_add_f32 v52, v52, v84
v_fmac_f32 v68, v84, v84
v_accvgpr_write_b32 a84, v84
v_add_f32 v53, v53, v85
v_fmac_f32 v69, v85, v85
v_accvgpr_write_b32 a85, v85
v_add_f32 v54, v54, v86
v_fmac_f32 v70, v86, v86
v_accvgpr_write_b32 a86, v86
v_add_f32 v55, v55, v87
v_fmac_f32 v71, v87, v87
v_accvgpr_write_b32 a87, v87
v_accvgpr_read_b32 v80, a32
v_accvgpr_read_b32 v81, a33
v_accvgpr_read_b32 v82, a34
v_accvgpr_read_b32 v83, a35
v_accvgpr_read_b32 v84, a88
v_accvgpr_read_b32 v85, a89
v_accvgpr_read_b32 v86, a90
v_accvgpr_read_b32 v87, a91
v_mov_b32 v104, s54
v_mul_f32 v96, v80, v80
v_mul_f32 v97, v81, v81
v_mul_f32 v98, v82, v82
v_mul_f32 v99, v83, v83
v_mul_f32 v100, v84, v84
v_mul_f32 v101, v85, v85
v_mul_f32 v102, v86, v86
v_mul_f32 v103, v87, v87
v_fma_f32 v96, v96, s55, v104
v_fma_f32 v97, v97, s55, v104
v_fma_f32 v98, v98, s55, v104
v_fma_f32 v99, v99, s55, v104
v_fma_f32 v100, v100, s55, v104
v_fma_f32 v101, v101, s55, v104
v_fma_f32 v102, v102, s55, v104
v_fma_f32 v103, v103, s55, v104
v_mul_f32 v96, v96, v80
v_mul_f32 v97, v97, v81
v_mul_f32 v98, v98, v82
v_mul_f32 v99, v99, v83
v_mul_f32 v100, v100, v84
v_mul_f32 v101, v101, v85
v_mul_f32 v102, v102, v86
v_mul_f32 v103, v103, v87
v_exp_f32 v96, v96
v_exp_f32 v97, v97
v_exp_f32 v98, v98
v_exp_f32 v99, v99
v_exp_f32 v100, v100
v_exp_f32 v101, v101
v_exp_f32 v102, v102
v_exp_f32 v103, v103
v_add_f32 v96, 1.0, v96
v_add_f32 v97, 1.0, v97
v_add_f32 v98, 1.0, v98
v_add_f32 v99, 1.0, v99
v_add_f32 v100, 1.0, v100
v_add_f32 v101, 1.0, v101
v_add_f32 v102, 1.0, v102
v_add_f32 v103, 1.0, v103
v_rcp_f32 v96, v96
v_rcp_f32 v97, v97
v_rcp_f32 v98, v98
v_rcp_f32 v99, v99
v_rcp_f32 v100, v100
v_rcp_f32 v101, v101
v_rcp_f32 v102, v102
v_rcp_f32 v103, v103
s_nop 0
v_mul_f32 v80, v80, v96
v_mul_f32 v81, v81, v97
v_mul_f32 v82, v82, v98
v_mul_f32 v83, v83, v99
v_mul_f32 v84, v84, v100
v_mul_f32 v85, v85, v101
v_mul_f32 v86, v86, v102
v_mul_f32 v87, v87, v103
v_add_f32 v48, v48, v80
v_fmac_f32 v64, v80, v80
v_accvgpr_write_b32 a32, v80
v_add_f32 v49, v49, v81
v_fmac_f32 v65, v81, v81
v_accvgpr_write_b32 a33, v81
v_add_f32 v50, v50, v82
v_fmac_f32 v66, v82, v82
v_accvgpr_write_b32 a34, v82
v_add_f32 v51, v51, v83
v_fmac_f32 v67, v83, v83
v_accvgpr_write_b32 a35, v83
v_add_f32 v52, v52, v84
v_fmac_f32 v68, v84, v84
v_accvgpr_write_b32 a88, v84
v_add_f32 v53, v53, v85
v_fmac_f32 v69, v85, v85
v_accvgpr_write_b32 a89, v85
v_add_f32 v54, v54, v86
v_fmac_f32 v70, v86, v86
v_accvgpr_write_b32 a90, v86
v_add_f32 v55, v55, v87
v_fmac_f32 v71, v87, v87
v_accvgpr_write_b32 a91, v87
v_accvgpr_read_b32 v80, a36
v_accvgpr_read_b32 v81, a37
v_accvgpr_read_b32 v82, a38
v_accvgpr_read_b32 v83, a39
v_accvgpr_read_b32 v84, a92
v_accvgpr_read_b32 v85, a93
v_accvgpr_read_b32 v86, a94
v_accvgpr_read_b32 v87, a95
v_mov_b32 v104, s54
v_mul_f32 v96, v80, v80
v_mul_f32 v97, v81, v81
v_mul_f32 v98, v82, v82
v_mul_f32 v99, v83, v83
v_mul_f32 v100, v84, v84
v_mul_f32 v101, v85, v85
v_mul_f32 v102, v86, v86
v_mul_f32 v103, v87, v87
v_fma_f32 v96, v96, s55, v104
v_fma_f32 v97, v97, s55, v104
v_fma_f32 v98, v98, s55, v104
v_fma_f32 v99, v99, s55, v104
v_fma_f32 v100, v100, s55, v104
v_fma_f32 v101, v101, s55, v104
v_fma_f32 v102, v102, s55, v104
v_fma_f32 v103, v103, s55, v104
v_mul_f32 v96, v96, v80
v_mul_f32 v97, v97, v81
v_mul_f32 v98, v98, v82
v_mul_f32 v99, v99, v83
v_mul_f32 v100, v100, v84
v_mul_f32 v101, v101, v85
v_mul_f32 v102, v102, v86
v_mul_f32 v103, v103, v87
v_exp_f32 v96, v96
v_exp_f32 v97, v97
v_exp_f32 v98, v98
v_exp_f32 v99, v99
v_exp_f32 v100, v100
v_exp_f32 v101, v101
v_exp_f32 v102, v102
v_exp_f32 v103, v103
v_add_f32 v96, 1.0, v96
v_add_f32 v97, 1.0, v97
v_add_f32 v98, 1.0, v98
v_add_f32 v99, 1.0, v99
v_add_f32 v100, 1.0, v100
v_add_f32 v101, 1.0, v101
v_add_f32 v102, 1.0, v102
v_add_f32 v103, 1.0, v103
v_rcp_f32 v96, v96
v_rcp_f32 v97, v97
v_rcp_f32 v98, v98
v_rcp_f32 v99, v99
v_rcp_f32 v100, v100
v_rcp_f32 v101, v101
v_rcp_f32 v102, v102
v_rcp_f32 v103, v103
s_nop 0
v_mul_f32 v80, v80, v96
v_mul_f32 v81, v81, v97
v_mul_f32 v82, v82, v98
v_mul_f32 v83, v83, v99
v_mul_f32 v84, v84, v100
v_mul_f32 v85, v85, v101
v_mul_f32 v86, v86, v102
v_mul_f32 v87, v87, v103
v_add_f32 v48, v48, v80
v_fmac_f32 v64, v80, v80
v_accvgpr_write_b32 a36, v80
v_add_f32 v49, v49, v81
v_fmac_f32 v65, v81, v81
v_accvgpr_write_b32 a37, v81
v_add_f32 v50, v50, v82
v_fmac_f32 v66, v82, v82
v_accvgpr_write_b32 a38, v82
v_add_f32 v51, v51, v83
v_fmac_f32 v67, v83, v83
v_accvgpr_write_b32 a39, v83
v_add_f32 v52, v52, v84
v_fmac_f32 v68, v84, v84
v_accvgpr_write_b32 a92, v84
v_add_f32 v53, v53, v85
v_fmac_f32 v69, v85, v85
v_accvgpr_write_b32 a93, v85
v_add_f32 v54, v54, v86
v_fmac_f32 v70, v86, v86
v_accvgpr_write_b32 a94, v86
v_add_f32 v55, v55, v87
v_fmac_f32 v71, v87, v87
v_accvgpr_write_b32 a95, v87
v_accvgpr_read_b32 v80, a40
v_accvgpr_read_b32 v81, a41
v_accvgpr_read_b32 v82, a42
v_accvgpr_read_b32 v83, a43
v_accvgpr_read_b32 v84, a96
v_accvgpr_read_b32 v85, a97
v_accvgpr_read_b32 v86, a98
v_accvgpr_read_b32 v87, a99
v_mov_b32 v104, s54
v_mul_f32 v96, v80, v80
v_mul_f32 v97, v81, v81
v_mul_f32 v98, v82, v82
v_mul_f32 v99, v83, v83
v_mul_f32 v100, v84, v84
v_mul_f32 v101, v85, v85
v_mul_f32 v102, v86, v86
v_mul_f32 v103, v87, v87
v_fma_f32 v96, v96, s55, v104
v_fma_f32 v97, v97, s55, v104
v_fma_f32 v98, v98, s55, v104
v_fma_f32 v99, v99, s55, v104
v_fma_f32 v100, v100, s55, v104
v_fma_f32 v101, v101, s55, v104
v_fma_f32 v102, v102, s55, v104
v_fma_f32 v103, v103, s55, v104
v_mul_f32 v96, v96, v80
v_mul_f32 v97, v97, v81
v_mul_f32 v98, v98, v82
v_mul_f32 v99, v99, v83
v_mul_f32 v100, v100, v84
v_mul_f32 v101, v101, v85
v_mul_f32 v102, v102, v86
v_mul_f32 v103, v103, v87
v_exp_f32 v96, v96
v_exp_f32 v97, v97
v_exp_f32 v98, v98
v_exp_f32 v99, v99
v_exp_f32 v100, v100
v_exp_f32 v101, v101
v_exp_f32 v102, v102
v_exp_f32 v103, v103
v_add_f32 v96, 1.0, v96
v_add_f32 v97, 1.0, v97
v_add_f32 v98, 1.0, v98
v_add_f32 v99, 1.0, v99
v_add_f32 v100, 1.0, v100
v_add_f32 v101, 1.0, v101
v_add_f32 v102, 1.0, v102
v_add_f32 v103, 1.0, v103
v_rcp_f32 v96, v96
v_rcp_f32 v97, v97
v_rcp_f32 v98, v98
v_rcp_f32 v99, v99
v_rcp_f32 v100, v100
v_rcp_f32 v101, v101
v_rcp_f32 v102, v102
v_rcp_f32 v103, v103
s_nop 0
v_mul_f32 v80, v80, v96
v_mul_f32 v81, v81, v97
v_mul_f32 v82, v82, v98
v_mul_f32 v83, v83, v99
v_mul_f32 v84, v84, v100
v_mul_f32 v85, v85, v101
v_mul_f32 v86, v86, v102
v_mul_f32 v87, v87, v103
v_add_f32 v48, v48, v80
v_fmac_f32 v64, v80, v80
v_accvgpr_write_b32 a40, v80
v_add_f32 v49, v49, v81
v_fmac_f32 v65, v81, v81
v_accvgpr_write_b32 a41, v81
v_add_f32 v50, v50, v82
v_fmac_f32 v66, v82, v82
v_accvgpr_write_b32 a42, v82
v_add_f32 v51, v51, v83
v_fmac_f32 v67, v83, v83
v_accvgpr_write_b32 a43, v83
v_add_f32 v52, v52, v84
v_fmac_f32 v68, v84, v84
v_accvgpr_write_b32 a96, v84
v_add_f32 v53, v53, v85
v_fmac_f32 v69, v85, v85
v_accvgpr_write_b32 a97, v85
v_add_f32 v54, v54, v86
v_fmac_f32 v70, v86, v86
v_accvgpr_write_b32 a98, v86
v_add_f32 v55, v55, v87
v_fmac_f32 v71, v87, v87
v_accvgpr_write_b32 a99, v87
v_accvgpr_read_b32 v80, a44
v_accvgpr_read_b32 v81, a45
v_accvgpr_read_b32 v82, a46
v_accvgpr_read_b32 v83, a47
v_accvgpr_read_b32 v84, a100
v_accvgpr_read_b32 v85, a101
v_accvgpr_read_b32 v86, a102
v_accvgpr_read_b32 v87, a103
v_mov_b32 v104, s54
v_mul_f32 v96, v80, v80
v_mul_f32 v97, v81, v81
v_mul_f32 v98, v82, v82
v_mul_f32 v99, v83, v83
v_mul_f32 v100, v84, v84
v_mul_f32 v101, v85, v85
v_mul_f32 v102, v86, v86
v_mul_f32 v103, v87, v87
v_fma_f32 v96, v96, s55, v104
v_fma_f32 v97, v97, s55, v104
v_fma_f32 v98, v98, s55, v104
v_fma_f32 v99, v99, s55, v104
v_fma_f32 v100, v100, s55, v104
v_fma_f32 v101, v101, s55, v104
v_fma_f32 v102, v102, s55, v104
v_fma_f32 v103, v103, s55, v104
v_mul_f32 v96, v96, v80
v_mul_f32 v97, v97, v81
v_mul_f32 v98, v98, v82
v_mul_f32 v99, v99, v83
v_mul_f32 v100, v100, v84
v_mul_f32 v101, v101, v85
v_mul_f32 v102, v102, v86
v_mul_f32 v103, v103, v87
v_exp_f32 v96, v96
v_exp_f32 v97, v97
v_exp_f32 v98, v98
v_exp_f32 v99, v99
v_exp_f32 v100, v100
v_exp_f32 v101, v101
v_exp_f32 v102, v102
v_exp_f32 v103, v103
v_add_f32 v96, 1.0, v96
v_add_f32 v97, 1.0, v97
v_add_f32 v98, 1.0, v98
v_add_f32 v99, 1.0, v99
v_add_f32 v100, 1.0, v100
v_add_f32 v101, 1.0, v101
v_add_f32 v102, 1.0, v102
v_add_f32 v103, 1.0, v103
v_rcp_f32 v96, v96
v_rcp_f32 v97, v97
v_rcp_f32 v98, v98
v_rcp_f32 v99, v99
v_rcp_f32 v100, v100
v_rcp_f32 v101, v101
v_rcp_f32 v102, v102
v_rcp_f32 v103, v103
s_nop 0
v_mul_f32 v80, v80, v96
v_mul_f32 v81, v81, v97
v_mul_f32 v82, v82, v98
v_mul_f32 v83, v83, v99
v_mul_f32 v84, v84, v100
v_mul_f32 v85, v85, v101
v_mul_f32 v86, v86, v102
v_mul_f32 v87, v87, v103
v_add_f32 v48, v48, v80
v_fmac_f32 v64, v80, v80
v_accvgpr_write_b32 a44, v80
v_add_f32 v49, v49, v81
v_fmac_f32 v65, v81, v81
v_accvgpr_write_b32 a45, v81
v_add_f32 v50, v50, v82
v_fmac_f32 v66, v82, v82
v_accvgpr_write_b32 a46, v82
v_add_f32 v51, v51, v83
v_fmac_f32 v67, v83, v83
v_accvgpr_write_b32 a47, v83
v_add_f32 v52, v52, v84
v_fmac_f32 v68, v84, v84
v_accvgpr_write_b32 a100, v84
v_add_f32 v53, v53, v85
v_fmac_f32 v69, v85, v85
v_accvgpr_write_b32 a101, v85
v_add_f32 v54, v54, v86
v_fmac_f32 v70, v86, v86
v_accvgpr_write_b32 a102, v86
v_add_f32 v55, v55, v87
v_fmac_f32 v71, v87, v87
v_accvgpr_write_b32 a103, v87
v_accvgpr_read_b32 v80, a48
v_accvgpr_read_b32 v81, a49
v_accvgpr_read_b32 v82, a50
v_accvgpr_read_b32 v83, a51
v_accvgpr_read_b32 v84, a104
v_accvgpr_read_b32 v85, a105
v_accvgpr_read_b32 v86, a106
v_accvgpr_read_b32 v87, a107
v_mov_b32 v104, s54
v_mul_f32 v96, v80, v80
v_mul_f32 v97, v81, v81
v_mul_f32 v98, v82, v82
v_mul_f32 v99, v83, v83
v_mul_f32 v100, v84, v84
v_mul_f32 v101, v85, v85
v_mul_f32 v102, v86, v86
v_mul_f32 v103, v87, v87
v_fma_f32 v96, v96, s55, v104
v_fma_f32 v97, v97, s55, v104
v_fma_f32 v98, v98, s55, v104
v_fma_f32 v99, v99, s55, v104
v_fma_f32 v100, v100, s55, v104
v_fma_f32 v101, v101, s55, v104
v_fma_f32 v102, v102, s55, v104
v_fma_f32 v103, v103, s55, v104
v_mul_f32 v96, v96, v80
v_mul_f32 v97, v97, v81
v_mul_f32 v98, v98, v82
v_mul_f32 v99, v99, v83
v_mul_f32 v100, v100, v84
v_mul_f32 v101, v101, v85
v_mul_f32 v102, v102, v86
v_mul_f32 v103, v103, v87
v_exp_f32 v96, v96
v_exp_f32 v97, v97
v_exp_f32 v98, v98
v_exp_f32 v99, v99
v_exp_f32 v100, v100
v_exp_f32 v101, v101
v_exp_f32 v102, v102
v_exp_f32 v103, v103
v_add_f32 v96, 1.0, v96
v_add_f32 v97, 1.0, v97
v_add_f32 v98, 1.0, v98
v_add_f32 v99, 1.0, v99
v_add_f32 v100, 1.0, v100
v_add_f32 v101, 1.0, v101
v_add_f32 v102, 1.0, v102
v_add_f32 v103, 1.0, v103
v_rcp_f32 v96, v96
v_rcp_f32 v97, v97
v_rcp_f32 v98, v98
v_rcp_f32 v99, v99
v_rcp_f32 v100, v100
v_rcp_f32 v101, v101
v_rcp_f32 v102, v102
v_rcp_f32 v103, v103
s_nop 0
v_mul_f32 v80, v80, v96
v_mul_f32 v81, v81, v97
v_mul_f32 v82, v82, v98
v_mul_f32 v83, v83, v99
v_mul_f32 v84, v84, v100
v_mul_f32 v85, v85, v101
v_mul_f32 v86, v86, v102
v_mul_f32 v87, v87, v103
v_add_f32 v48, v48, v80
v_fmac_f32 v64, v80, v80
v_accvgpr_write_b32 a48, v80
v_add_f32 v49, v49, v81
v_fmac_f32 v65, v81, v81
v_accvgpr_write_b32 a49, v81
v_add_f32 v50, v50, v82
v_fmac_f32 v66, v82, v82
v_accvgpr_write_b32 a50, v82
v_add_f32 v51, v51, v83
v_fmac_f32 v67, v83, v83
v_accvgpr_write_b32 a51, v83
v_add_f32 v52, v52, v84
v_fmac_f32 v68, v84, v84
v_accvgpr_write_b32 a104, v84
v_add_f32 v53, v53, v85
v_fmac_f32 v69, v85, v85
v_accvgpr_write_b32 a105, v85
v_add_f32 v54, v54, v86
v_fmac_f32 v70, v86, v86
v_accvgpr_write_b32 a106, v86
v_add_f32 v55, v55, v87
v_fmac_f32 v71, v87, v87
v_accvgpr_write_b32 a107, v87
v_accvgpr_read_b32 v80, a52
v_accvgpr_read_b32 v81, a53
v_accvgpr_read_b32 v82, a54
v_accvgpr_read_b32 v83, a55
v_accvgpr_read_b32 v84, a108
v_accvgpr_read_b32 v85, a109
v_accvgpr_read_b32 v86, a110
v_accvgpr_read_b32 v87, a111
v_mov_b32 v104, s54
v_mul_f32 v96, v80, v80
v_mul_f32 v97, v81, v81
v_mul_f32 v98, v82, v82
v_mul_f32 v99, v83, v83
v_mul_f32 v100, v84, v84
v_mul_f32 v101, v85, v85
v_mul_f32 v102, v86, v86
v_mul_f32 v103, v87, v87
v_fma_f32 v96, v96, s55, v104
v_fma_f32 v97, v97, s55, v104
v_fma_f32 v98, v98, s55, v104
v_fma_f32 v99, v99, s55, v104
v_fma_f32 v100, v100, s55, v104
v_fma_f32 v101, v101, s55, v104
v_fma_f32 v102, v102, s55, v104
v_fma_f32 v103, v103, s55, v104
v_mul_f32 v96, v96, v80
v_mul_f32 v97, v97, v81
v_mul_f32 v98, v98, v82
v_mul_f32 v99, v99, v83
v_mul_f32 v100, v100, v84
v_mul_f32 v101, v101, v85
v_mul_f32 v102, v102, v86
v_mul_f32 v103, v103, v87
v_exp_f32 v96, v96
v_exp_f32 v97, v97
v_exp_f32 v98, v98
v_exp_f32 v99, v99
v_exp_f32 v100, v100
v_exp_f32 v101, v101
v_exp_f32 v102, v102
v_exp_f32 v103, v103
v_add_f32 v96, 1.0, v96
v_add_f32 v97, 1.0, v97
v_add_f32 v98, 1.0, v98
v_add_f32 v99, 1.0, v99
v_add_f32 v100, 1.0, v100
v_add_f32 v101, 1.0, v101
v_add_f32 v102, 1.0, v102
v_add_f32 v103, 1.0, v103
v_rcp_f32 v96, v96
v_rcp_f32 v97, v97
v_rcp_f32 v98, v98
v_rcp_f32 v99, v99
v_rcp_f32 v100, v100
v_rcp_f32 v101, v101
v_rcp_f32 v102, v102
v_rcp_f32 v103, v103
s_nop 0
v_mul_f32 v80, v80, v96
v_mul_f32 v81, v81, v97
v_mul_f32 v82, v82, v98
v_mul_f32 v83, v83, v99
v_mul_f32 v84, v84, v100
v_mul_f32 v85, v85, v101
v_mul_f32 v86, v86, v102
v_mul_f32 v87, v87, v103
v_add_f32 v48, v48, v80
v_fmac_f32 v64, v80, v80
v_accvgpr_write_b32 a52, v80
v_add_f32 v49, v49, v81
v_fmac_f32 v65, v81, v81
v_accvgpr_write_b32 a53, v81
v_add_f32 v50, v50, v82
v_fmac_f32 v66, v82, v82
v_accvgpr_write_b32 a54, v82
v_add_f32 v51, v51, v83
v_fmac_f32 v67, v83, v83
v_accvgpr_write_b32 a55, v83
v_add_f32 v52, v52, v84
v_fmac_f32 v68, v84, v84
v_accvgpr_write_b32 a108, v84
v_add_f32 v53, v53, v85
v_fmac_f32 v69, v85, v85
v_accvgpr_write_b32 a109, v85
v_add_f32 v54, v54, v86
v_fmac_f32 v70, v86, v86
v_accvgpr_write_b32 a110, v86
v_add_f32 v55, v55, v87
v_fmac_f32 v71, v87, v87
v_accvgpr_write_b32 a111, v87
v_add_f32_dpp v48, v48, v48 quad_perm:[1,0,3,2] row_mask:0xf bank_mask:0xf
v_add_f32_dpp v49, v49, v49 quad_perm:[1,0,3,2] row_mask:0xf bank_mask:0xf
v_add_f32_dpp v50, v50, v50 quad_perm:[1,0,3,2] row_mask:0xf bank_mask:0xf
v_add_f32_dpp v51, v51, v51 quad_perm:[1,0,3,2] row_mask:0xf bank_mask:0xf
v_add_f32_dpp v52, v52, v52 quad_perm:[1,0,3,2] row_mask:0xf bank_mask:0xf
v_add_f32_dpp v53, v53, v53 quad_perm:[1,0,3,2] row_mask:0xf bank_mask:0xf
v_add_f32_dpp v54, v54, v54 quad_perm:[1,0,3,2] row_mask:0xf bank_mask:0xf
v_add_f32_dpp v55, v55, v55 quad_perm:[1,0,3,2] row_mask:0xf bank_mask:0xf
v_add_f32_dpp v64, v64, v64 quad_perm:[1,0,3,2] row_mask:0xf bank_mask:0xf
v_add_f32_dpp v65, v65, v65 quad_perm:[1,0,3,2] row_mask:0xf bank_mask:0xf
v_add_f32_dpp v66, v66, v66 quad_perm:[1,0,3,2] row_mask:0xf bank_mask:0xf
v_add_f32_dpp v67, v67, v67 quad_perm:[1,0,3,2] row_mask:0xf bank_mask:0xf
v_add_f32_dpp v68, v68, v68 quad_perm:[1,0,3,2] row_mask:0xf bank_mask:0xf
v_add_f32_dpp v69, v69, v69 quad_perm:[1,0,3,2] row_mask:0xf bank_mask:0xf
v_add_f32_dpp v70, v70, v70 quad_perm:[1,0,3,2] row_mask:0xf bank_mask:0xf
v_add_f32_dpp v71, v71, v71 quad_perm:[1,0,3,2] row_mask:0xf bank_mask:0xf
v_add_f32_dpp v48, v48, v48 quad_perm:[2,3,0,1] row_mask:0xf bank_mask:0xf
v_add_f32_dpp v49, v49, v49 quad_perm:[2,3,0,1] row_mask:0xf bank_mask:0xf
v_add_f32_dpp v50, v50, v50 quad_perm:[2,3,0,1] row_mask:0xf bank_mask:0xf
v_add_f32_dpp v51, v51, v51 quad_perm:[2,3,0,1] row_mask:0xf bank_mask:0xf
v_add_f32_dpp v52, v52, v52 quad_perm:[2,3,0,1] row_mask:0xf bank_mask:0xf
v_add_f32_dpp v53, v53, v53 quad_perm:[2,3,0,1] row_mask:0xf bank_mask:0xf
v_add_f32_dpp v54, v54, v54 quad_perm:[2,3,0,1] row_mask:0xf bank_mask:0xf
v_add_f32_dpp v55, v55, v55 quad_perm:[2,3,0,1] row_mask:0xf bank_mask:0xf
v_add_f32_dpp v64, v64, v64 quad_perm:[2,3,0,1] row_mask:0xf bank_mask:0xf
v_add_f32_dpp v65, v65, v65 quad_perm:[2,3,0,1] row_mask:0xf bank_mask:0xf
v_add_f32_dpp v66, v66, v66 quad_perm:[2,3,0,1] row_mask:0xf bank_mask:0xf
v_add_f32_dpp v67, v67, v67 quad_perm:[2,3,0,1] row_mask:0xf bank_mask:0xf
v_add_f32_dpp v68, v68, v68 quad_perm:[2,3,0,1] row_mask:0xf bank_mask:0xf
v_add_f32_dpp v69, v69, v69 quad_perm:[2,3,0,1] row_mask:0xf bank_mask:0xf
v_add_f32_dpp v70, v70, v70 quad_perm:[2,3,0,1] row_mask:0xf bank_mask:0xf
v_add_f32_dpp v71, v71, v71 quad_perm:[2,3,0,1] row_mask:0xf bank_mask:0xf
v_add_f32_dpp v48, v48, v48 row_half_mirror row_mask:0xf bank_mask:0xf
v_add_f32_dpp v49, v49, v49 row_half_mirror row_mask:0xf bank_mask:0xf
v_add_f32_dpp v50, v50, v50 row_half_mirror row_mask:0xf bank_mask:0xf
v_add_f32_dpp v51, v51, v51 row_half_mirror row_mask:0xf bank_mask:0xf
v_add_f32_dpp v52, v52, v52 row_half_mirror row_mask:0xf bank_mask:0xf
v_add_f32_dpp v53, v53, v53 row_half_mirror row_mask:0xf bank_mask:0xf
v_add_f32_dpp v54, v54, v54 row_half_mirror row_mask:0xf bank_mask:0xf
v_add_f32_dpp v55, v55, v55 row_half_mirror row_mask:0xf bank_mask:0xf
v_add_f32_dpp v64, v64, v64 row_half_mirror row_mask:0xf bank_mask:0xf
v_add_f32_dpp v65, v65, v65 row_half_mirror row_mask:0xf bank_mask:0xf
v_add_f32_dpp v66, v66, v66 row_half_mirror row_mask:0xf bank_mask:0xf
v_add_f32_dpp v67, v67, v67 row_half_mirror row_mask:0xf bank_mask:0xf
v_add_f32_dpp v68, v68, v68 row_half_mirror row_mask:0xf bank_mask:0xf
v_add_f32_dpp v69, v69, v69 row_half_mirror row_mask:0xf bank_mask:0xf
v_add_f32_dpp v70, v70, v70 row_half_mirror row_mask:0xf bank_mask:0xf
v_add_f32_dpp v71, v71, v71 row_half_mirror row_mask:0xf bank_mask:0xf
v_add_f32_dpp v48, v48, v48 row_mirror row_mask:0xf bank_mask:0xf
v_add_f32_dpp v49, v49, v49 row_mirror row_mask:0xf bank_mask:0xf
v_add_f32_dpp v50, v50, v50 row_mirror row_mask:0xf bank_mask:0xf
v_add_f32_dpp v51, v51, v51 row_mirror row_mask:0xf bank_mask:0xf
v_add_f32_dpp v52, v52, v52 row_mirror row_mask:0xf bank_mask:0xf
v_add_f32_dpp v53, v53, v53 row_mirror row_mask:0xf bank_mask:0xf
v_add_f32_dpp v54, v54, v54 row_mirror row_mask:0xf bank_mask:0xf
v_add_f32_dpp v55, v55, v55 row_mirror row_mask:0xf bank_mask:0xf
v_add_f32_dpp v64, v64, v64 row_mirror row_mask:0xf bank_mask:0xf
v_add_f32_dpp v65, v65, v65 row_mirror row_mask:0xf bank_mask:0xf
v_add_f32_dpp v66, v66, v66 row_mirror row_mask:0xf bank_mask:0xf
v_add_f32_dpp v67, v67, v67 row_mirror row_mask:0xf bank_mask:0xf
v_add_f32_dpp v68, v68, v68 row_mirror row_mask:0xf bank_mask:0xf
v_add_f32_dpp v69, v69, v69 row_mirror row_mask:0xf bank_mask:0xf
v_add_f32_dpp v70, v70, v70 row_mirror row_mask:0xf bank_mask:0xf
v_add_f32_dpp v71, v71, v71 row_mirror row_mask:0xf bank_mask:0xf
v_and_b32 v96, 15, v0
v_mov_b32 v80, v48
v_mov_b32 v81, v64
v_cmp_eq_u32 vcc, 1, v96
s_nop 1
v_cndmask_b32 v80, v80, v49, vcc
v_cndmask_b32 v81, v81, v65, vcc
v_cmp_eq_u32 vcc, 2, v96
s_nop 1
v_cndmask_b32 v80, v80, v50, vcc
v_cndmask_b32 v81, v81, v66, vcc
v_cmp_eq_u32 vcc, 3, v96
s_nop 1
v_cndmask_b32 v80, v80, v51, vcc
v_cndmask_b32 v81, v81, v67, vcc
v_cmp_eq_u32 vcc, 4, v96
s_nop 1
v_cndmask_b32 v80, v80, v52, vcc
v_cndmask_b32 v81, v81, v68, vcc
v_cmp_eq_u32 vcc, 5, v96
s_nop 1
v_cndmask_b32 v80, v80, v53, vcc
v_cndmask_b32 v81, v81, v69, vcc
v_cmp_eq_u32 vcc, 6, v96
s_nop 1
v_cndmask_b32 v80, v80, v54, vcc
v_cndmask_b32 v81, v81, v70, vcc
v_cmp_eq_u32 vcc, 7, v96
s_nop 1
v_cndmask_b32 v80, v80, v55, vcc
v_cndmask_b32 v81, v81, v71, vcc
v_lshlrev_b32 v96, 3, v0
v_add_u32 v96, 114688, v96
ds_write_b64 v96, v[80:81]
v_lshrrev_b32 v97, 1, v1
v_add_u32 v97, 114688, v97
s_waitcnt lgkmcnt(0)
s_barrier
ds_read_b64 v[80:81], v97
ds_read_b64 v[82:83], v97 offset:512
ds_read_b64 v[84:85], v97 offset:1024
ds_read_b64 v[86:87], v97 offset:1536
s_mov_b32 s42, 0x3a924925
s_waitcnt lgkmcnt(0)
v_add_f32 v80, v80, v82
v_add_f32 v81, v81, v83
v_add_f32 v84, v84, v86
v_add_f32 v85, v85, v87
v_add_f32 v80, v80, v84
v_add_f32 v81, v81, v85
v_mul_f32 v80, s42, v80
v_mul_f32 v81, s42, v81
v_fma_f32 v81, -v80, v80, v81
v_max_f32 v81, 0, v81
v_add_f32 v81, 0x3727c5ac, v81
v_rsq_f32 v81, v81
s_nop 0
v_mul_f32 v80, v80, v81
s_nop 1
v_mov_b32_dpp v48, v80 row_newbcast:0 row_mask:0xf bank_mask:0xf
v_mov_b32_dpp v64, v81 row_newbcast:0 row_mask:0xf bank_mask:0xf
v_mov_b32_dpp v49, v80 row_newbcast:1 row_mask:0xf bank_mask:0xf
v_mov_b32_dpp v65, v81 row_newbcast:1 row_mask:0xf bank_mask:0xf
v_mov_b32_dpp v50, v80 row_newbcast:2 row_mask:0xf bank_mask:0xf
v_mov_b32_dpp v66, v81 row_newbcast:2 row_mask:0xf bank_mask:0xf
v_mov_b32_dpp v51, v80 row_newbcast:3 row_mask:0xf bank_mask:0xf
v_mov_b32_dpp v67, v81 row_newbcast:3 row_mask:0xf bank_mask:0xf
v_mov_b32_dpp v52, v80 row_newbcast:4 row_mask:0xf bank_mask:0xf
v_mov_b32_dpp v68, v81 row_newbcast:4 row_mask:0xf bank_mask:0xf
v_mov_b32_dpp v53, v80 row_newbcast:5 row_mask:0xf bank_mask:0xf
v_mov_b32_dpp v69, v81 row_newbcast:5 row_mask:0xf bank_mask:0xf
v_mov_b32_dpp v54, v80 row_newbcast:6 row_mask:0xf bank_mask:0xf
v_mov_b32_dpp v70, v81 row_newbcast:6 row_mask:0xf bank_mask:0xf
v_mov_b32_dpp v55, v80 row_newbcast:7 row_mask:0xf bank_mask:0xf
v_mov_b32_dpp v71, v81 row_newbcast:7 row_mask:0xf bank_mask:0xf
s_mul_i32 s42, s29, 917504
s_mul_i32 s43, s52, 1024
s_add_u32 s42, s42, s43
s_add_u32 s42, s42, 104857600
s_add_u32 s43, s42, 0
v_accvgpr_read_b32 v80, a0
v_accvgpr_read_b32 v81, a1
v_accvgpr_read_b32 v82, a2
v_accvgpr_read_b32 v83, a3
v_accvgpr_read_b32 v84, a56
v_accvgpr_read_b32 v85, a57
v_accvgpr_read_b32 v86, a58
v_accvgpr_read_b32 v87, a59
v_fma_f32 v80, v80, v64, -v48
v_fma_f32 v81, v81, v65, -v49
v_fma_f32 v82, v82, v66, -v50
v_fma_f32 v83, v83, v67, -v51
v_fma_f32 v84, v84, v68, -v52
v_fma_f32 v85, v85, v69, -v53
v_fma_f32 v86, v86, v70, -v54
v_fma_f32 v87, v87, v71, -v55
v_cvt_pk_bf16_f32 v88, v80, v81
v_cvt_pk_bf16_f32 v89, v82, v83
v_cvt_pk_bf16_f32 v90, v84, v85
v_cvt_pk_bf16_f32 v91, v86, v87
buffer_store_dwordx4 v[88:91], v1, s[8:11], s43 offen offset:0 sc1
s_add_u32 s43, s42, 65536
v_accvgpr_read_b32 v92, a4
v_accvgpr_read_b32 v93, a5
v_accvgpr_read_b32 v94, a6
v_accvgpr_read_b32 v95, a7
v_accvgpr_read_b32 v96, a60
v_accvgpr_read_b32 v97, a61
v_accvgpr_read_b32 v98, a62
v_accvgpr_read_b32 v99, a63
v_fma_f32 v92, v92, v64, -v48
v_fma_f32 v93, v93, v65, -v49
v_fma_f32 v94, v94, v66, -v50
v_fma_f32 v95, v95, v67, -v51
v_fma_f32 v96, v96, v68, -v52
v_fma_f32 v97, v97, v69, -v53
v_fma_f32 v98, v98, v70, -v54
v_fma_f32 v99, v99, v71, -v55
v_cvt_pk_bf16_f32 v100, v92, v93
v_cvt_pk_bf16_f32 v101, v94, v95
v_cvt_pk_bf16_f32 v102, v96, v97
v_cvt_pk_bf16_f32 v103, v98, v99
buffer_store_dwordx4 v[100:103], v1, s[8:11], s43 offen offset:0 sc1
s_add_u32 s43, s42, 131072
v_accvgpr_read_b32 v104, a8
v_accvgpr_read_b32 v105, a9
v_accvgpr_read_b32 v106, a10
v_accvgpr_read_b32 v107, a11
v_accvgpr_read_b32 v108, a64
v_accvgpr_read_b32 v109, a65
v_accvgpr_read_b32 v110, a66
v_accvgpr_read_b32 v111, a67
v_fma_f32 v104, v104, v64, -v48
v_fma_f32 v105, v105, v65, -v49
v_fma_f32 v106, v106, v66, -v50
v_fma_f32 v107, v107, v67, -v51
v_fma_f32 v108, v108, v68, -v52
v_fma_f32 v109, v109, v69, -v53
v_fma_f32 v110, v110, v70, -v54
v_fma_f32 v111, v111, v71, -v55
v_cvt_pk_bf16_f32 v112, v104, v105
v_cvt_pk_bf16_f32 v113, v106, v107
v_cvt_pk_bf16_f32 v114, v108, v109
v_cvt_pk_bf16_f32 v115, v110, v111
buffer_store_dwordx4 v[112:115], v1, s[8:11], s43 offen offset:0 sc1
s_add_u32 s43, s42, 196608
v_accvgpr_read_b32 v80, a12
v_accvgpr_read_b32 v81, a13
v_accvgpr_read_b32 v82, a14
v_accvgpr_read_b32 v83, a15
v_accvgpr_read_b32 v84, a68
v_accvgpr_read_b32 v85, a69
v_accvgpr_read_b32 v86, a70
v_accvgpr_read_b32 v87, a71
v_fma_f32 v80, v80, v64, -v48
v_fma_f32 v81, v81, v65, -v49
v_fma_f32 v82, v82, v66, -v50
v_fma_f32 v83, v83, v67, -v51
v_fma_f32 v84, v84, v68, -v52
v_fma_f32 v85, v85, v69, -v53
v_fma_f32 v86, v86, v70, -v54
v_fma_f32 v87, v87, v71, -v55
v_cvt_pk_bf16_f32 v88, v80, v81
v_cvt_pk_bf16_f32 v89, v82, v83
v_cvt_pk_bf16_f32 v90, v84, v85
v_cvt_pk_bf16_f32 v91, v86, v87
buffer_store_dwordx4 v[88:91], v1, s[8:11], s43 offen offset:0 sc1
s_add_u32 s43, s42, 262144
v_accvgpr_read_b32 v92, a16
v_accvgpr_read_b32 v93, a17
v_accvgpr_read_b32 v94, a18
v_accvgpr_read_b32 v95, a19
v_accvgpr_read_b32 v96, a72
v_accvgpr_read_b32 v97, a73
v_accvgpr_read_b32 v98, a74
v_accvgpr_read_b32 v99, a75
v_fma_f32 v92, v92, v64, -v48
v_fma_f32 v93, v93, v65, -v49
v_fma_f32 v94, v94, v66, -v50
v_fma_f32 v95, v95, v67, -v51
v_fma_f32 v96, v96, v68, -v52
v_fma_f32 v97, v97, v69, -v53
v_fma_f32 v98, v98, v70, -v54
v_fma_f32 v99, v99, v71, -v55
v_cvt_pk_bf16_f32 v100, v92, v93
v_cvt_pk_bf16_f32 v101, v94, v95
v_cvt_pk_bf16_f32 v102, v96, v97
v_cvt_pk_bf16_f32 v103, v98, v99
buffer_store_dwordx4 v[100:103], v1, s[8:11], s43 offen offset:0 sc1
s_add_u32 s43, s42, 327680
v_accvgpr_read_b32 v104, a20
v_accvgpr_read_b32 v105, a21
v_accvgpr_read_b32 v106, a22
v_accvgpr_read_b32 v107, a23
v_accvgpr_read_b32 v108, a76
v_accvgpr_read_b32 v109, a77
v_accvgpr_read_b32 v110, a78
v_accvgpr_read_b32 v111, a79
v_fma_f32 v104, v104, v64, -v48
v_fma_f32 v105, v105, v65, -v49
v_fma_f32 v106, v106, v66, -v50
v_fma_f32 v107, v107, v67, -v51
v_fma_f32 v108, v108, v68, -v52
v_fma_f32 v109, v109, v69, -v53
v_fma_f32 v110, v110, v70, -v54
v_fma_f32 v111, v111, v71, -v55
v_cvt_pk_bf16_f32 v112, v104, v105
v_cvt_pk_bf16_f32 v113, v106, v107
v_cvt_pk_bf16_f32 v114, v108, v109
v_cvt_pk_bf16_f32 v115, v110, v111
buffer_store_dwordx4 v[112:115], v1, s[8:11], s43 offen offset:0 sc1
s_add_u32 s43, s42, 393216
v_accvgpr_read_b32 v80, a24
v_accvgpr_read_b32 v81, a25
v_accvgpr_read_b32 v82, a26
v_accvgpr_read_b32 v83, a27
v_accvgpr_read_b32 v84, a80
v_accvgpr_read_b32 v85, a81
v_accvgpr_read_b32 v86, a82
v_accvgpr_read_b32 v87, a83
v_fma_f32 v80, v80, v64, -v48
v_fma_f32 v81, v81, v65, -v49
v_fma_f32 v82, v82, v66, -v50
v_fma_f32 v83, v83, v67, -v51
v_fma_f32 v84, v84, v68, -v52
v_fma_f32 v85, v85, v69, -v53
v_fma_f32 v86, v86, v70, -v54
v_fma_f32 v87, v87, v71, -v55
v_cvt_pk_bf16_f32 v88, v80, v81
v_cvt_pk_bf16_f32 v89, v82, v83
v_cvt_pk_bf16_f32 v90, v84, v85
v_cvt_pk_bf16_f32 v91, v86, v87
buffer_store_dwordx4 v[88:91], v1, s[8:11], s43 offen offset:0 sc1
s_add_u32 s43, s42, 458752
v_accvgpr_read_b32 v92, a28
v_accvgpr_read_b32 v93, a29
v_accvgpr_read_b32 v94, a30
v_accvgpr_read_b32 v95, a31
v_accvgpr_read_b32 v96, a84
v_accvgpr_read_b32 v97, a85
v_accvgpr_read_b32 v98, a86
v_accvgpr_read_b32 v99, a87
v_fma_f32 v92, v92, v64, -v48
v_fma_f32 v93, v93, v65, -v49
v_fma_f32 v94, v94, v66, -v50
v_fma_f32 v95, v95, v67, -v51
v_fma_f32 v96, v96, v68, -v52
v_fma_f32 v97, v97, v69, -v53
v_fma_f32 v98, v98, v70, -v54
v_fma_f32 v99, v99, v71, -v55
v_cvt_pk_bf16_f32 v100, v92, v93
v_cvt_pk_bf16_f32 v101, v94, v95
v_cvt_pk_bf16_f32 v102, v96, v97
v_cvt_pk_bf16_f32 v103, v98, v99
buffer_store_dwordx4 v[100:103], v1, s[8:11], s43 offen offset:0 sc1
s_add_u32 s43, s42, 524288
v_accvgpr_read_b32 v104, a32
v_accvgpr_read_b32 v105, a33
v_accvgpr_read_b32 v106, a34
v_accvgpr_read_b32 v107, a35
v_accvgpr_read_b32 v108, a88
v_accvgpr_read_b32 v109, a89
v_accvgpr_read_b32 v110, a90
v_accvgpr_read_b32 v111, a91
v_fma_f32 v104, v104, v64, -v48
v_fma_f32 v105, v105, v65, -v49
v_fma_f32 v106, v106, v66, -v50
v_fma_f32 v107, v107, v67, -v51
v_fma_f32 v108, v108, v68, -v52
v_fma_f32 v109, v109, v69, -v53
v_fma_f32 v110, v110, v70, -v54
v_fma_f32 v111, v111, v71, -v55
v_cvt_pk_bf16_f32 v112, v104, v105
v_cvt_pk_bf16_f32 v113, v106, v107
v_cvt_pk_bf16_f32 v114, v108, v109
v_cvt_pk_bf16_f32 v115, v110, v111
buffer_store_dwordx4 v[112:115], v1, s[8:11], s43 offen offset:0 sc1
s_add_u32 s43, s42, 589824
v_accvgpr_read_b32 v80, a36
v_accvgpr_read_b32 v81, a37
v_accvgpr_read_b32 v82, a38
v_accvgpr_read_b32 v83, a39
v_accvgpr_read_b32 v84, a92
v_accvgpr_read_b32 v85, a93
v_accvgpr_read_b32 v86, a94
v_accvgpr_read_b32 v87, a95
v_fma_f32 v80, v80, v64, -v48
v_fma_f32 v81, v81, v65, -v49
v_fma_f32 v82, v82, v66, -v50
v_fma_f32 v83, v83, v67, -v51
v_fma_f32 v84, v84, v68, -v52
v_fma_f32 v85, v85, v69, -v53
v_fma_f32 v86, v86, v70, -v54
v_fma_f32 v87, v87, v71, -v55
v_cvt_pk_bf16_f32 v88, v80, v81
v_cvt_pk_bf16_f32 v89, v82, v83
v_cvt_pk_bf16_f32 v90, v84, v85
v_cvt_pk_bf16_f32 v91, v86, v87
buffer_store_dwordx4 v[88:91], v1, s[8:11], s43 offen offset:0 sc1
s_add_u32 s43, s42, 655360
v_accvgpr_read_b32 v92, a40
v_accvgpr_read_b32 v93, a41
v_accvgpr_read_b32 v94, a42
v_accvgpr_read_b32 v95, a43
v_accvgpr_read_b32 v96, a96
v_accvgpr_read_b32 v97, a97
v_accvgpr_read_b32 v98, a98
v_accvgpr_read_b32 v99, a99
v_fma_f32 v92, v92, v64, -v48
v_fma_f32 v93, v93, v65, -v49
v_fma_f32 v94, v94, v66, -v50
v_fma_f32 v95, v95, v67, -v51
v_fma_f32 v96, v96, v68, -v52
v_fma_f32 v97, v97, v69, -v53
v_fma_f32 v98, v98, v70, -v54
v_fma_f32 v99, v99, v71, -v55
v_cvt_pk_bf16_f32 v100, v92, v93
v_cvt_pk_bf16_f32 v101, v94, v95
v_cvt_pk_bf16_f32 v102, v96, v97
v_cvt_pk_bf16_f32 v103, v98, v99
buffer_store_dwordx4 v[100:103], v1, s[8:11], s43 offen offset:0 sc1
s_add_u32 s43, s42, 720896
v_accvgpr_read_b32 v104, a44
v_accvgpr_read_b32 v105, a45
v_accvgpr_read_b32 v106, a46
v_accvgpr_read_b32 v107, a47
v_accvgpr_read_b32 v108, a100
v_accvgpr_read_b32 v109, a101
v_accvgpr_read_b32 v110, a102
v_accvgpr_read_b32 v111, a103
v_fma_f32 v104, v104, v64, -v48
v_fma_f32 v105, v105, v65, -v49
v_fma_f32 v106, v106, v66, -v50
v_fma_f32 v107, v107, v67, -v51
v_fma_f32 v108, v108, v68, -v52
v_fma_f32 v109, v109, v69, -v53
v_fma_f32 v110, v110, v70, -v54
v_fma_f32 v111, v111, v71, -v55
v_cvt_pk_bf16_f32 v112, v104, v105
v_cvt_pk_bf16_f32 v113, v106, v107
v_cvt_pk_bf16_f32 v114, v108, v109
v_cvt_pk_bf16_f32 v115, v110, v111
buffer_store_dwordx4 v[112:115], v1, s[8:11], s43 offen offset:0 sc1
s_add_u32 s43, s42, 786432
v_accvgpr_read_b32 v80, a48
v_accvgpr_read_b32 v81, a49
v_accvgpr_read_b32 v82, a50
v_accvgpr_read_b32 v83, a51
v_accvgpr_read_b32 v84, a104
v_accvgpr_read_b32 v85, a105
v_accvgpr_read_b32 v86, a106
v_accvgpr_read_b32 v87, a107
v_fma_f32 v80, v80, v64, -v48
v_fma_f32 v81, v81, v65, -v49
v_fma_f32 v82, v82, v66, -v50
v_fma_f32 v83, v83, v67, -v51
v_fma_f32 v84, v84, v68, -v52
v_fma_f32 v85, v85, v69, -v53
v_fma_f32 v86, v86, v70, -v54
v_fma_f32 v87, v87, v71, -v55
v_cvt_pk_bf16_f32 v88, v80, v81
v_cvt_pk_bf16_f32 v89, v82, v83
v_cvt_pk_bf16_f32 v90, v84, v85
v_cvt_pk_bf16_f32 v91, v86, v87
buffer_store_dwordx4 v[88:91], v1, s[8:11], s43 offen offset:0 sc1
s_add_u32 s43, s42, 851968
v_accvgpr_read_b32 v92, a52
v_accvgpr_read_b32 v93, a53
v_accvgpr_read_b32 v94, a54
v_accvgpr_read_b32 v95, a55
v_accvgpr_read_b32 v96, a108
v_accvgpr_read_b32 v97, a109
v_accvgpr_read_b32 v98, a110
v_accvgpr_read_b32 v99, a111
v_fma_f32 v92, v92, v64, -v48
v_fma_f32 v93, v93, v65, -v49
v_fma_f32 v94, v94, v66, -v50
v_fma_f32 v95, v95, v67, -v51
v_fma_f32 v96, v96, v68, -v52
v_fma_f32 v97, v97, v69, -v53
v_fma_f32 v98, v98, v70, -v54
v_fma_f32 v99, v99, v71, -v55
v_cvt_pk_bf16_f32 v100, v92, v93
v_cvt_pk_bf16_f32 v101, v94, v95
v_cvt_pk_bf16_f32 v102, v96, v97
v_cvt_pk_bf16_f32 v103, v98, v99
buffer_store_dwordx4 v[100:103], v1, s[8:11], s43 offen offset:0 sc1
s_waitcnt vmcnt(0)
s_barrier
s_cmp_lg_u32 s29, 0
s_cbranch_scc1 SG_70
v_mov_b32 v2, 1280
v_mov_b32 v4, 1
s_mov_b32 s42, 4194304
s_mov_b64 exec, 1
buffer_atomic_add v4, v2, s[84:87], s42 offen sc1
s_mov_b64 exec, -1
SG_70:
s_getpc_b64 s[90:91]
LJ_71:
s_add_u32 s90, s90, L_m_next-LJ_71
s_addc_u32 s91, s91, -1
s_setpc_b64 s[90:91]
L_w_Z1:
s_load_dwordx2 s[16:17], s[0:1], 64
v_and_b32 v34, 63, v0
v_lshlrev_b32 v1, 4, v34
s_mul_i32 s42, s29, 256
s_add_u32 s42, s42, 0
v_add_u32 v35, s42, v34
v_lshrrev_b32 v36, 4, v35
v_and_b32 v37, 15, v35
v_lshrrev_b32 v38, 2, v36
v_lshrrev_b32 v39, 3, v36
v_xor_b32 v38, v38, v39
v_and_b32 v38, 1, v38
v_and_b32 v39, 3, v36
v_lshl_or_b32 v38, v38, 2, v39
v_lshlrev_b32 v38, 1, v38
v_xor_b32 v37, v37, v38
s_mov_b32 s42, 3584
v_mul_lo_u32 v36, v36, s42
v_lshl_add_u32 v2, v37, 4, v36
s_mul_i32 s42, s29, 256
s_add_u32 s42, s42, 64
v_add_u32 v35, s42, v34
v_lshrrev_b32 v36, 4, v35
v_and_b32 v37, 15, v35
v_lshrrev_b32 v38, 2, v36
v_lshrrev_b32 v39, 3, v36
v_xor_b32 v38, v38, v39
v_and_b32 v38, 1, v38
v_and_b32 v39, 3, v36
v_lshl_or_b32 v38, v38, 2, v39
v_lshlrev_b32 v38, 1, v38
v_xor_b32 v37, v37, v38
s_mov_b32 s42, 3584
v_mul_lo_u32 v36, v36, s42
v_lshl_add_u32 v3, v37, 4, v36
s_mul_i32 s42, s29, 256
s_add_u32 s42, s42, 128
v_add_u32 v35, s42, v34
v_lshrrev_b32 v36, 4, v35
v_and_b32 v37, 15, v35
v_lshrrev_b32 v38, 2, v36
v_lshrrev_b32 v39, 3, v36
v_xor_b32 v38, v38, v39
v_and_b32 v38, 1, v38
v_and_b32 v39, 3, v36
v_lshl_or_b32 v38, v38, 2, v39
v_lshlrev_b32 v38, 1, v38
v_xor_b32 v37, v37, v38
s_mov_b32 s42, 3584
v_mul_lo_u32 v36, v36, s42
v_lshl_add_u32 v4, v37, 4, v36
s_mul_i32 s42, s29, 256
s_add_u32 s42, s42, 192
v_add_u32 v35, s42, v34
v_lshrrev_b32 v36, 4, v35
v_and_b32 v37, 15, v35
v_lshrrev_b32 v38, 2, v36
v_lshrrev_b32 v39, 3, v36
v_xor_b32 v38, v38, v39
v_and_b32 v38, 1, v38
v_and_b32 v39, 3, v36
v_lshl_or_b32 v38, v38, 2, v39
v_lshlrev_b32 v38, 1, v38
v_xor_b32 v37, v37, v38
s_mov_b32 s42, 3584
v_mul_lo_u32 v36, v36, s42
v_lshl_add_u32 v5, v37, 4, v36
v_bfe_u32 v35, v34, 2, 2
v_lshrrev_b32 v36, 4, v34
v_lshl_add_u32 v37, v36, 3, v35
v_lshrrev_b32 v38, 2, v37
v_lshrrev_b32 v39, 3, v37
v_xor_b32 v38, v38, v39
v_and_b32 v38, 1, v38
v_and_b32 v39, 3, v37
v_lshl_or_b32 v38, v38, 2, v39
v_mul_u32_u24 v37, 256, v37
v_and_b32 v39, 3, v34
v_lshl_add_u32 v37, v39, 3, v37
v_xor_b32 v39, 0, v38
v_lshl_add_u32 v18, v39, 5, v37
v_xor_b32 v39, 1, v38
v_lshl_add_u32 v19, v39, 5, v37
v_xor_b32 v39, 2, v38
v_lshl_add_u32 v20, v39, 5, v37
v_xor_b32 v39, 3, v38
v_lshl_add_u32 v21, v39, 5, v37
v_xor_b32 v39, 4, v38
v_lshl_add_u32 v22, v39, 5, v37
v_xor_b32 v39, 5, v38
v_lshl_add_u32 v23, v39, 5, v37
v_xor_b32 v39, 6, v38
v_lshl_add_u32 v24, v39, 5, v37
v_xor_b32 v39, 7, v38
v_lshl_add_u32 v25, v39, 5, v37
v_lshl_add_u32 v37, v36, 3, v35
v_add_u32 v37, 4, v37
v_lshrrev_b32 v38, 2, v37
v_lshrrev_b32 v39, 3, v37
v_xor_b32 v38, v38, v39
v_and_b32 v38, 1, v38
v_and_b32 v39, 3, v37
v_lshl_or_b32 v38, v38, 2, v39
v_mul_u32_u24 v37, 256, v37
v_and_b32 v39, 3, v34
v_lshl_add_u32 v37, v39, 3, v37
v_xor_b32 v39, 0, v38
v_lshl_add_u32 v26, v39, 5, v37
v_xor_b32 v39, 1, v38
v_lshl_add_u32 v27, v39, 5, v37
v_xor_b32 v39, 2, v38
v_lshl_add_u32 v28, v39, 5, v37
v_xor_b32 v39, 3, v38
v_lshl_add_u32 v29, v39, 5, v37
v_xor_b32 v39, 4, v38
v_lshl_add_u32 v30, v39, 5, v37
v_xor_b32 v39, 5, v38
v_lshl_add_u32 v31, v39, 5, v37
v_xor_b32 v39, 6, v38
v_lshl_add_u32 v32, v39, 5, v37
v_xor_b32 v39, 7, v38
v_lshl_add_u32 v33, v39, 5, v37
s_and_b32 s52, s3, 7
s_lshr_b32 s53, s3, 3
s_waitcnt lgkmcnt(0)
s_mov_b32 s12, s16
s_and_b32 s13, s17, 0xffff
s_mov_b32 s14, 0x1c0000
s_mov_b32 s15, 0x00020000
s_lshl_b32 s48, s52, 2
s_add_u32 s48, s48, s29
s_lshl_b32 s48, s48, 16
s_add_u32 s48, s48, 0
s_lshl_b32 s49, s53, 8
s_mul_i32 s51, s29, 4096
s_add_u32 s42, s49, 0
s_add_u32 m0, s51, 0
s_nop 0
buffer_load_dwordx4 v2, s[12:15], s42 offen lds
s_add_u32 m0, s51, 1024
s_nop 0
buffer_load_dwordx4 v3, s[12:15], s42 offen lds
s_add_u32 m0, s51, 2048
s_nop 0
buffer_load_dwordx4 v4, s[12:15], s42 offen lds
s_add_u32 m0, s51, 3072
s_nop 0
buffer_load_dwordx4 v5, s[12:15], s42 offen lds
s_add_u32 s42, s49, 229376
s_add_u32 m0, s51, 16384
s_nop 0
buffer_load_dwordx4 v2, s[12:15], s42 offen lds
s_add_u32 m0, s51, 17408
s_nop 0
buffer_load_dwordx4 v3, s[12:15], s42 offen lds
s_add_u32 m0, s51, 18432
s_nop 0
buffer_load_dwordx4 v4, s[12:15], s42 offen lds
s_add_u32 m0, s51, 19456
s_nop 0
buffer_load_dwordx4 v5, s[12:15], s42 offen lds
buffer_load_dwordx4 v[48:51], v1, s[8:11], s48 offen offset:0
s_add_u32 s43, s48, 16384
buffer_load_dwordx4 v[52:55], v1, s[8:11], s43 offen offset:0
s_add_u32 s43, s48, 32768
buffer_load_dwordx4 v[56:59], v1, s[8:11], s43 offen offset:0
s_add_u32 s43, s48, 49152
buffer_load_dwordx4 v[60:63], v1, s[8:11], s43 offen offset:0
buffer_load_dwordx4 v[64:67], v1, s[8:11], s48 offen offset:1024
s_add_u32 s43, s48, 16384
buffer_load_dwordx4 v[68:71], v1, s[8:11], s43 offen offset:1024
s_add_u32 s43, s48, 32768
buffer_load_dwordx4 v[72:75], v1, s[8:11], s43 offen offset:1024
s_add_u32 s43, s48, 49152
buffer_load_dwordx4 v[76:79], v1, s[8:11], s43 offen offset:1024
buffer_load_dwordx4 v[80:83], v1, s[8:11], s48 offen offset:2048
s_add_u32 s43, s48, 16384
buffer_load_dwordx4 v[84:87], v1, s[8:11], s43 offen offset:2048
s_add_u32 s43, s48, 32768
buffer_load_dwordx4 v[88:91], v1, s[8:11], s43 offen offset:2048
s_add_u32 s43, s48, 49152
buffer_load_dwordx4 v[92:95], v1, s[8:11], s43 offen offset:2048
s_waitcnt vmcnt(16)
s_barrier
s_add_u32 s42, s49, 458752
s_add_u32 m0, s51, 32768
s_nop 0
buffer_load_dwordx4 v2, s[12:15], s42 offen lds
s_add_u32 m0, s51, 33792
s_nop 0
buffer_load_dwordx4 v3, s[12:15], s42 offen lds
s_add_u32 m0, s51, 34816
s_nop 0
buffer_load_dwordx4 v4, s[12:15], s42 offen lds
s_add_u32 m0, s51, 35840
s_nop 0
buffer_load_dwordx4 v5, s[12:15], s42 offen lds
ds_read_b64_tr_b16 v[96:97], v18 offset:0
ds_read_b64_tr_b16 v[98:99], v26 offset:0
ds_read_b64_tr_b16 v[100:101], v19 offset:0
ds_read_b64_tr_b16 v[102:103], v27 offset:0
ds_read_b64_tr_b16 v[104:105], v20 offset:0
ds_read_b64_tr_b16 v[106:107], v28 offset:0
ds_read_b64_tr_b16 v[108:109], v21 offset:0
ds_read_b64_tr_b16 v[110:111], v29 offset:0
s_waitcnt vmcnt(12)
s_waitcnt lgkmcnt(6)
v_mfma_f32_16x16x32_bf16 a[0:3], v[96:99], v[48:51], 0
v_mfma_f32_16x16x32_bf16 a[32:35], v[96:99], v[52:55], 0
v_mfma_f32_16x16x32_bf16 a[64:67], v[96:99], v[56:59], 0
v_mfma_f32_16x16x32_bf16 a[96:99], v[96:99], v[60:63], 0
ds_read_b64_tr_b16 v[96:97], v22 offset:0
ds_read_b64_tr_b16 v[98:99], v30 offset:0
s_waitcnt lgkmcnt(6)
v_mfma_f32_16x16x32_bf16 a[4:7], v[100:103], v[48:51], 0
v_mfma_f32_16x16x32_bf16 a[36:39], v[100:103], v[52:55], 0
v_mfma_f32_16x16x32_bf16 a[68:71], v[100:103], v[56:59], 0
v_mfma_f32_16x16x32_bf16 a[100:103], v[100:103], v[60:63], 0
ds_read_b64_tr_b16 v[100:101], v23 offset:0
ds_read_b64_tr_b16 v[102:103], v31 offset:0
s_waitcnt lgkmcnt(6)
v_mfma_f32_16x16x32_bf16 a[8:11], v[104:107], v[48:51], 0
v_mfma_f32_16x16x32_bf16 a[40:43], v[104:107], v[52:55], 0
v_mfma_f32_16x16x32_bf16 a[72:75], v[104:107], v[56:59], 0
v_mfma_f32_16x16x32_bf16 a[104:107], v[104:107], v[60:63], 0
ds_read_b64_tr_b16 v[104:105], v24 offset:0
ds_read_b64_tr_b16 v[106:107], v32 offset:0
s_waitcnt lgkmcnt(6)
v_mfma_f32_16x16x32_bf16 a[12:15], v[108:111], v[48:51], 0
v_mfma_f32_16x16x32_bf16 a[44:47], v[108:111], v[52:55], 0
v_mfma_f32_16x16x32_bf16 a[76:79], v[108:111], v[56:59], 0
v_mfma_f32_16x16x32_bf16 a[108:111], v[108:111], v[60:63], 0
ds_read_b64_tr_b16 v[108:109], v25 offset:0
ds_read_b64_tr_b16 v[110:111], v33 offset:0
s_waitcnt lgkmcnt(6)
v_mfma_f32_16x16x32_bf16 a[16:19], v[96:99], v[48:51], 0
v_mfma_f32_16x16x32_bf16 a[48:51], v[96:99], v[52:55], 0
v_mfma_f32_16x16x32_bf16 a[80:83], v[96:99], v[56:59], 0
v_mfma_f32_16x16x32_bf16 a[112:115], v[96:99], v[60:63], 0
ds_read_b64_tr_b16 v[96:97], v18 offset:8192
ds_read_b64_tr_b16 v[98:99], v26 offset:8192
s_waitcnt lgkmcnt(6)
v_mfma_f32_16x16x32_bf16 a[20:23], v[100:103], v[48:51], 0
v_mfma_f32_16x16x32_bf16 a[52:55], v[100:103], v[52:55], 0
v_mfma_f32_16x16x32_bf16 a[84:87], v[100:103], v[56:59], 0
v_mfma_f32_16x16x32_bf16 a[116:119], v[100:103], v[60:63], 0
ds_read_b64_tr_b16 v[100:101], v19 offset:8192
ds_read_b64_tr_b16 v[102:103], v27 offset:8192
s_waitcnt lgkmcnt(6)
v_mfma_f32_16x16x32_bf16 a[24:27], v[104:107], v[48:51], 0
v_mfma_f32_16x16x32_bf16 a[56:59], v[104:107], v[52:55], 0
v_mfma_f32_16x16x32_bf16 a[88:91], v[104:107], v[56:59], 0
v_mfma_f32_16x16x32_bf16 a[120:123], v[104:107], v[60:63], 0
ds_read_b64_tr_b16 v[104:105], v20 offset:8192
ds_read_b64_tr_b16 v[106:107], v28 offset:8192
s_waitcnt lgkmcnt(6)
v_mfma_f32_16x16x32_bf16 a[28:31], v[108:111], v[48:51], 0
v_mfma_f32_16x16x32_bf16 a[60:63], v[108:111], v[52:55], 0
v_mfma_f32_16x16x32_bf16 a[92:95], v[108:111], v[56:59], 0
v_mfma_f32_16x16x32_bf16 a[124:127], v[108:111], v[60:63], 0
buffer_load_dwordx4 v[48:51], v1, s[8:11], s48 offen offset:3072
s_add_u32 s43, s48, 16384
buffer_load_dwordx4 v[52:55], v1, s[8:11], s43 offen offset:3072
s_add_u32 s43, s48, 32768
buffer_load_dwordx4 v[56:59], v1, s[8:11], s43 offen offset:3072
s_add_u32 s43, s48, 49152
buffer_load_dwordx4 v[60:63], v1, s[8:11], s43 offen offset:3072
ds_read_b64_tr_b16 v[108:109], v21 offset:8192
ds_read_b64_tr_b16 v[110:111], v29 offset:8192
s_waitcnt vmcnt(12)
s_waitcnt lgkmcnt(6)
v_mfma_f32_16x16x32_bf16 a[0:3], v[96:99], v[64:67], a[0:3]
v_mfma_f32_16x16x32_bf16 a[32:35], v[96:99], v[68:71], a[32:35]
v_mfma_f32_16x16x32_bf16 a[64:67], v[96:99], v[72:75], a[64:67]
v_mfma_f32_16x16x32_bf16 a[96:99], v[96:99], v[76:79], a[96:99]
ds_read_b64_tr_b16 v[96:97], v22 offset:8192
ds_read_b64_tr_b16 v[98:99], v30 offset:8192
s_waitcnt lgkmcnt(6)
v_mfma_f32_16x16x32_bf16 a[4:7], v[100:103], v[64:67], a[4:7]
v_mfma_f32_16x16x32_bf16 a[36:39], v[100:103], v[68:71], a[36:39]
v_mfma_f32_16x16x32_bf16 a[68:71], v[100:103], v[72:75], a[68:71]
v_mfma_f32_16x16x32_bf16 a[100:103], v[100:103], v[76:79], a[100:103]
ds_read_b64_tr_b16 v[100:101], v23 offset:8192
ds_read_b64_tr_b16 v[102:103], v31 offset:8192
s_waitcnt lgkmcnt(6)
v_mfma_f32_16x16x32_bf16 a[8:11], v[104:107], v[64:67], a[8:11]
v_mfma_f32_16x16x32_bf16 a[40:43], v[104:107], v[68:71], a[40:43]
v_mfma_f32_16x16x32_bf16 a[72:75], v[104:107], v[72:75], a[72:75]
v_mfma_f32_16x16x32_bf16 a[104:107], v[104:107], v[76:79], a[104:107]
ds_read_b64_tr_b16 v[104:105], v24 offset:8192
ds_read_b64_tr_b16 v[106:107], v32 offset:8192
s_waitcnt lgkmcnt(6)
v_mfma_f32_16x16x32_bf16 a[12:15], v[108:111], v[64:67], a[12:15]
v_mfma_f32_16x16x32_bf16 a[44:47], v[108:111], v[68:71], a[44:47]
v_mfma_f32_16x16x32_bf16 a[76:79], v[108:111], v[72:75], a[76:79]
v_mfma_f32_16x16x32_bf16 a[108:111], v[108:111], v[76:79], a[108:111]
ds_read_b64_tr_b16 v[108:109], v25 offset:8192
ds_read_b64_tr_b16 v[110:111], v33 offset:8192
s_waitcnt lgkmcnt(6)
v_mfma_f32_16x16x32_bf16 a[16:19], v[96:99], v[64:67], a[16:19]
v_mfma_f32_16x16x32_bf16 a[48:51], v[96:99], v[68:71], a[48:51]
v_mfma_f32_16x16x32_bf16 a[80:83], v[96:99], v[72:75], a[80:83]
v_mfma_f32_16x16x32_bf16 a[112:115], v[96:99], v[76:79], a[112:115]
s_barrier
s_add_u32 s42, s49, 688128
s_add_u32 m0, s51, 49152
s_nop 0
buffer_load_dwordx4 v2, s[12:15], s42 offen lds
s_add_u32 m0, s51, 50176
s_nop 0
buffer_load_dwordx4 v3, s[12:15], s42 offen lds
s_add_u32 m0, s51, 51200
s_nop 0
buffer_load_dwordx4 v4, s[12:15], s42 offen lds
s_add_u32 m0, s51, 52224
s_nop 0
buffer_load_dwordx4 v5, s[12:15], s42 offen lds
ds_read_b64_tr_b16 v[96:97], v18 offset:16384
ds_read_b64_tr_b16 v[98:99], v26 offset:16384
s_waitcnt lgkmcnt(6)
v_mfma_f32_16x16x32_bf16 a[20:23], v[100:103], v[64:67], a[20:23]
v_mfma_f32_16x16x32_bf16 a[52:55], v[100:103], v[68:71], a[52:55]
v_mfma_f32_16x16x32_bf16 a[84:87], v[100:103], v[72:75], a[84:87]
v_mfma_f32_16x16x32_bf16 a[116:119], v[100:103], v[76:79], a[116:119]
ds_read_b64_tr_b16 v[100:101], v19 offset:16384
ds_read_b64_tr_b16 v[102:103], v27 offset:16384
s_waitcnt lgkmcnt(6)
v_mfma_f32_16x16x32_bf16 a[24:27], v[104:107], v[64:67], a[24:27]
v_mfma_f32_16x16x32_bf16 a[56:59], v[104:107], v[68:71], a[56:59]
v_mfma_f32_16x16x32_bf16 a[88:91], v[104:107], v[72:75], a[88:91]
v_mfma_f32_16x16x32_bf16 a[120:123], v[104:107], v[76:79], a[120:123]
ds_read_b64_tr_b16 v[104:105], v20 offset:16384
ds_read_b64_tr_b16 v[106:107], v28 offset:16384
s_waitcnt lgkmcnt(6)
v_mfma_f32_16x16x32_bf16 a[28:31], v[108:111], v[64:67], a[28:31]
v_mfma_f32_16x16x32_bf16 a[60:63], v[108:111], v[68:71], a[60:63]
v_mfma_f32_16x16x32_bf16 a[92:95], v[108:111], v[72:75], a[92:95]
v_mfma_f32_16x16x32_bf16 a[124:127], v[108:111], v[76:79], a[124:127]
s_add_u32 s43, s48, 4096
buffer_load_dwordx4 v[64:67], v1, s[8:11], s43 offen offset:0
s_add_u32 s43, s48, 20480
buffer_load_dwordx4 v[68:71], v1, s[8:11], s43 offen offset:0
s_add_u32 s43, s48, 36864
buffer_load_dwordx4 v[72:75], v1, s[8:11], s43 offen offset:0
s_add_u32 s43, s48, 53248
buffer_load_dwordx4 v[76:79], v1, s[8:11], s43 offen offset:0
ds_read_b64_tr_b16 v[108:109], v21 offset:16384
ds_read_b64_tr_b16 v[110:111], v29 offset:16384
s_waitcnt vmcnt(16)
s_waitcnt lgkmcnt(6)
v_mfma_f32_16x16x32_bf16 a[0:3], v[96:99], v[80:83], a[0:3]
v_mfma_f32_16x16x32_bf16 a[32:35], v[96:99], v[84:87], a[32:35]
v_mfma_f32_16x16x32_bf16 a[64:67], v[96:99], v[88:91], a[64:67]
v_mfma_f32_16x16x32_bf16 a[96:99], v[96:99], v[92:95], a[96:99]
ds_read_b64_tr_b16 v[96:97], v22 offset:16384
ds_read_b64_tr_b16 v[98:99], v30 offset:16384
s_waitcnt lgkmcnt(6)
v_mfma_f32_16x16x32_bf16 a[4:7], v[100:103], v[80:83], a[4:7]
v_mfma_f32_16x16x32_bf16 a[36:39], v[100:103], v[84:87], a[36:39]
v_mfma_f32_16x16x32_bf16 a[68:71], v[100:103], v[88:91], a[68:71]
v_mfma_f32_16x16x32_bf16 a[100:103], v[100:103], v[92:95], a[100:103]
ds_read_b64_tr_b16 v[100:101], v23 offset:16384
ds_read_b64_tr_b16 v[102:103], v31 offset:16384
s_waitcnt lgkmcnt(6)
v_mfma_f32_16x16x32_bf16 a[8:11], v[104:107], v[80:83], a[8:11]
v_mfma_f32_16x16x32_bf16 a[40:43], v[104:107], v[84:87], a[40:43]
v_mfma_f32_16x16x32_bf16 a[72:75], v[104:107], v[88:91], a[72:75]
v_mfma_f32_16x16x32_bf16 a[104:107], v[104:107], v[92:95], a[104:107]
ds_read_b64_tr_b16 v[104:105], v24 offset:16384
ds_read_b64_tr_b16 v[106:107], v32 offset:16384
s_waitcnt lgkmcnt(6)
v_mfma_f32_16x16x32_bf16 a[12:15], v[108:111], v[80:83], a[12:15]
v_mfma_f32_16x16x32_bf16 a[44:47], v[108:111], v[84:87], a[44:47]
v_mfma_f32_16x16x32_bf16 a[76:79], v[108:111], v[88:91], a[76:79]
v_mfma_f32_16x16x32_bf16 a[108:111], v[108:111], v[92:95], a[108:111]
ds_read_b64_tr_b16 v[108:109], v25 offset:16384
ds_read_b64_tr_b16 v[110:111], v33 offset:16384
s_waitcnt lgkmcnt(6)
v_mfma_f32_16x16x32_bf16 a[16:19], v[96:99], v[80:83], a[16:19]
v_mfma_f32_16x16x32_bf16 a[48:51], v[96:99], v[84:87], a[48:51]
v_mfma_f32_16x16x32_bf16 a[80:83], v[96:99], v[88:91], a[80:83]
v_mfma_f32_16x16x32_bf16 a[112:115], v[96:99], v[92:95], a[112:115]
ds_read_b64_tr_b16 v[96:97], v18 offset:24576
ds_read_b64_tr_b16 v[98:99], v26 offset:24576
s_waitcnt lgkmcnt(6)
v_mfma_f32_16x16x32_bf16 a[20:23], v[100:103], v[80:83], a[20:23]
v_mfma_f32_16x16x32_bf16 a[52:55], v[100:103], v[84:87], a[52:55]
v_mfma_f32_16x16x32_bf16 a[84:87], v[100:103], v[88:91], a[84:87]
v_mfma_f32_16x16x32_bf16 a[116:119], v[100:103], v[92:95], a[116:119]
ds_read_b64_tr_b16 v[100:101], v19 offset:24576
ds_read_b64_tr_b16 v[102:103], v27 offset:24576
s_waitcnt lgkmcnt(6)
v_mfma_f32_16x16x32_bf16 a[24:27], v[104:107], v[80:83], a[24:27]
v_mfma_f32_16x16x32_bf16 a[56:59], v[104:107], v[84:87], a[56:59]
v_mfma_f32_16x16x32_bf16 a[88:91], v[104:107], v[88:91], a[88:91]
v_mfma_f32_16x16x32_bf16 a[120:123], v[104:107], v[92:95], a[120:123]
ds_read_b64_tr_b16 v[104:105], v20 offset:24576
ds_read_b64_tr_b16 v[106:107], v28 offset:24576
s_waitcnt lgkmcnt(6)
v_mfma_f32_16x16x32_bf16 a[28:31], v[108:111], v[80:83], a[28:31]
v_mfma_f32_16x16x32_bf16 a[60:63], v[108:111], v[84:87], a[60:63]
v_mfma_f32_16x16x32_bf16 a[92:95], v[108:111], v[88:91], a[92:95]
v_mfma_f32_16x16x32_bf16 a[124:127], v[108:111], v[92:95], a[124:127]
s_add_u32 s43, s48, 4096
buffer_load_dwordx4 v[80:83], v1, s[8:11], s43 offen offset:1024
s_add_u32 s43, s48, 20480
buffer_load_dwordx4 v[84:87], v1, s[8:11], s43 offen offset:1024
s_add_u32 s43, s48, 36864
buffer_load_dwordx4 v[88:91], v1, s[8:11], s43 offen offset:1024
s_add_u32 s43, s48, 53248
buffer_load_dwordx4 v[92:95], v1, s[8:11], s43 offen offset:1024
ds_read_b64_tr_b16 v[108:109], v21 offset:24576
ds_read_b64_tr_b16 v[110:111], v29 offset:24576
s_waitcnt vmcnt(12)
s_waitcnt lgkmcnt(6)
v_mfma_f32_16x16x32_bf16 a[0:3], v[96:99], v[48:51], a[0:3]
v_mfma_f32_16x16x32_bf16 a[32:35], v[96:99], v[52:55], a[32:35]
v_mfma_f32_16x16x32_bf16 a[64:67], v[96:99], v[56:59], a[64:67]
v_mfma_f32_16x16x32_bf16 a[96:99], v[96:99], v[60:63], a[96:99]
ds_read_b64_tr_b16 v[96:97], v22 offset:24576
ds_read_b64_tr_b16 v[98:99], v30 offset:24576
s_waitcnt lgkmcnt(6)
v_mfma_f32_16x16x32_bf16 a[4:7], v[100:103], v[48:51], a[4:7]
v_mfma_f32_16x16x32_bf16 a[36:39], v[100:103], v[52:55], a[36:39]
v_mfma_f32_16x16x32_bf16 a[68:71], v[100:103], v[56:59], a[68:71]
v_mfma_f32_16x16x32_bf16 a[100:103], v[100:103], v[60:63], a[100:103]
ds_read_b64_tr_b16 v[100:101], v23 offset:24576
ds_read_b64_tr_b16 v[102:103], v31 offset:24576
s_waitcnt lgkmcnt(6)
v_mfma_f32_16x16x32_bf16 a[8:11], v[104:107], v[48:51], a[8:11]
v_mfma_f32_16x16x32_bf16 a[40:43], v[104:107], v[52:55], a[40:43]
v_mfma_f32_16x16x32_bf16 a[72:75], v[104:107], v[56:59], a[72:75]
v_mfma_f32_16x16x32_bf16 a[104:107], v[104:107], v[60:63], a[104:107]
ds_read_b64_tr_b16 v[104:105], v24 offset:24576
ds_read_b64_tr_b16 v[106:107], v32 offset:24576
s_waitcnt lgkmcnt(6)
v_mfma_f32_16x16x32_bf16 a[12:15], v[108:111], v[48:51], a[12:15]
v_mfma_f32_16x16x32_bf16 a[44:47], v[108:111], v[52:55], a[44:47]
v_mfma_f32_16x16x32_bf16 a[76:79], v[108:111], v[56:59], a[76:79]
v_mfma_f32_16x16x32_bf16 a[108:111], v[108:111], v[60:63], a[108:111]
ds_read_b64_tr_b16 v[108:109], v25 offset:24576
ds_read_b64_tr_b16 v[110:111], v33 offset:24576
s_waitcnt lgkmcnt(6)
v_mfma_f32_16x16x32_bf16 a[16:19], v[96:99], v[48:51], a[16:19]
v_mfma_f32_16x16x32_bf16 a[48:51], v[96:99], v[52:55], a[48:51]
v_mfma_f32_16x16x32_bf16 a[80:83], v[96:99], v[56:59], a[80:83]
v_mfma_f32_16x16x32_bf16 a[112:115], v[96:99], v[60:63], a[112:115]
s_barrier
s_add_u32 s42, s49, 917504
s_add_u32 m0, s51, 0
s_nop 0
buffer_load_dwordx4 v2, s[12:15], s42 offen lds
s_add_u32 m0, s51, 1024
s_nop 0
buffer_load_dwordx4 v3, s[12:15], s42 offen lds
s_add_u32 m0, s51, 2048
s_nop 0
buffer_load_dwordx4 v4, s[12:15], s42 offen lds
s_add_u32 m0, s51, 3072
s_nop 0
buffer_load_dwordx4 v5, s[12:15], s42 offen lds
ds_read_b64_tr_b16 v[96:97], v18 offset:32768
ds_read_b64_tr_b16 v[98:99], v26 offset:32768
s_waitcnt lgkmcnt(6)
v_mfma_f32_16x16x32_bf16 a[20:23], v[100:103], v[48:51], a[20:23]
v_mfma_f32_16x16x32_bf16 a[52:55], v[100:103], v[52:55], a[52:55]
v_mfma_f32_16x16x32_bf16 a[84:87], v[100:103], v[56:59], a[84:87]
v_mfma_f32_16x16x32_bf16 a[116:119], v[100:103], v[60:63], a[116:119]
ds_read_b64_tr_b16 v[100:101], v19 offset:32768
ds_read_b64_tr_b16 v[102:103], v27 offset:32768
s_waitcnt lgkmcnt(6)
v_mfma_f32_16x16x32_bf16 a[24:27], v[104:107], v[48:51], a[24:27]
v_mfma_f32_16x16x32_bf16 a[56:59], v[104:107], v[52:55], a[56:59]
v_mfma_f32_16x16x32_bf16 a[88:91], v[104:107], v[56:59], a[88:91]
v_mfma_f32_16x16x32_bf16 a[120:123], v[104:107], v[60:63], a[120:123]
ds_read_b64_tr_b16 v[104:105], v20 offset:32768
ds_read_b64_tr_b16 v[106:107], v28 offset:32768
s_waitcnt lgkmcnt(6)
v_mfma_f32_16x16x32_bf16 a[28:31], v[108:111], v[48:51], a[28:31]
v_mfma_f32_16x16x32_bf16 a[60:63], v[108:111], v[52:55], a[60:63]
v_mfma_f32_16x16x32_bf16 a[92:95], v[108:111], v[56:59], a[92:95]
v_mfma_f32_16x16x32_bf16 a[124:127], v[108:111], v[60:63], a[124:127]
s_add_u32 s43, s48, 4096
buffer_load_dwordx4 v[48:51], v1, s[8:11], s43 offen offset:2048
s_add_u32 s43, s48, 20480
buffer_load_dwordx4 v[52:55], v1, s[8:11], s43 offen offset:2048
s_add_u32 s43, s48, 36864
buffer_load_dwordx4 v[56:59], v1, s[8:11], s43 offen offset:2048
s_add_u32 s43, s48, 53248
buffer_load_dwordx4 v[60:63], v1, s[8:11], s43 offen offset:2048
ds_read_b64_tr_b16 v[108:109], v21 offset:32768
ds_read_b64_tr_b16 v[110:111], v29 offset:32768
s_waitcnt vmcnt(12)
s_waitcnt lgkmcnt(6)
v_mfma_f32_16x16x32_bf16 a[0:3], v[96:99], v[64:67], a[0:3]
v_mfma_f32_16x16x32_bf16 a[32:35], v[96:99], v[68:71], a[32:35]
v_mfma_f32_16x16x32_bf16 a[64:67], v[96:99], v[72:75], a[64:67]
v_mfma_f32_16x16x32_bf16 a[96:99], v[96:99], v[76:79], a[96:99]
ds_read_b64_tr_b16 v[96:97], v22 offset:32768
ds_read_b64_tr_b16 v[98:99], v30 offset:32768
s_waitcnt lgkmcnt(6)
v_mfma_f32_16x16x32_bf16 a[4:7], v[100:103], v[64:67], a[4:7]
v_mfma_f32_16x16x32_bf16 a[36:39], v[100:103], v[68:71], a[36:39]
v_mfma_f32_16x16x32_bf16 a[68:71], v[100:103], v[72:75], a[68:71]
v_mfma_f32_16x16x32_bf16 a[100:103], v[100:103], v[76:79], a[100:103]
ds_read_b64_tr_b16 v[100:101], v23 offset:32768
ds_read_b64_tr_b16 v[102:103], v31 offset:32768
s_waitcnt lgkmcnt(6)
v_mfma_f32_16x16x32_bf16 a[8:11], v[104:107], v[64:67], a[8:11]
v_mfma_f32_16x16x32_bf16 a[40:43], v[104:107], v[68:71], a[40:43]
v_mfma_f32_16x16x32_bf16 a[72:75], v[104:107], v[72:75], a[72:75]
v_mfma_f32_16x16x32_bf16 a[104:107], v[104:107], v[76:79], a[104:107]
ds_read_b64_tr_b16 v[104:105], v24 offset:32768
ds_read_b64_tr_b16 v[106:107], v32 offset:32768
s_waitcnt lgkmcnt(6)
v_mfma_f32_16x16x32_bf16 a[12:15], v[108:111], v[64:67], a[12:15]
v_mfma_f32_16x16x32_bf16 a[44:47], v[108:111], v[68:71], a[44:47]
v_mfma_f32_16x16x32_bf16 a[76:79], v[108:111], v[72:75], a[76:79]
v_mfma_f32_16x16x32_bf16 a[108:111], v[108:111], v[76:79], a[108:111]
ds_read_b64_tr_b16 v[108:109], v25 offset:32768
ds_read_b64_tr_b16 v[110:111], v33 offset:32768
s_waitcnt lgkmcnt(6)
v_mfma_f32_16x16x32_bf16 a[16:19], v[96:99], v[64:67], a[16:19]
v_mfma_f32_16x16x32_bf16 a[48:51], v[96:99], v[68:71], a[48:51]
v_mfma_f32_16x16x32_bf16 a[80:83], v[96:99], v[72:75], a[80:83]
v_mfma_f32_16x16x32_bf16 a[112:115], v[96:99], v[76:79], a[112:115]
ds_read_b64_tr_b16 v[96:97], v18 offset:40960
ds_read_b64_tr_b16 v[98:99], v26 offset:40960
s_waitcnt lgkmcnt(6)
v_mfma_f32_16x16x32_bf16 a[20:23], v[100:103], v[64:67], a[20:23]
v_mfma_f32_16x16x32_bf16 a[52:55], v[100:103], v[68:71], a[52:55]
v_mfma_f32_16x16x32_bf16 a[84:87], v[100:103], v[72:75], a[84:87]
v_mfma_f32_16x16x32_bf16 a[116:119], v[100:103], v[76:79], a[116:119]
ds_read_b64_tr_b16 v[100:101], v19 offset:40960
ds_read_b64_tr_b16 v[102:103], v27 offset:40960
s_waitcnt lgkmcnt(6)
v_mfma_f32_16x16x32_bf16 a[24:27], v[104:107], v[64:67], a[24:27]
v_mfma_f32_16x16x32_bf16 a[56:59], v[104:107], v[68:71], a[56:59]
v_mfma_f32_16x16x32_bf16 a[88:91], v[104:107], v[72:75], a[88:91]
v_mfma_f32_16x16x32_bf16 a[120:123], v[104:107], v[76:79], a[120:123]
ds_read_b64_tr_b16 v[104:105], v20 offset:40960
ds_read_b64_tr_b16 v[106:107], v28 offset:40960
s_waitcnt lgkmcnt(6)
v_mfma_f32_16x16x32_bf16 a[28:31], v[108:111], v[64:67], a[28:31]
v_mfma_f32_16x16x32_bf16 a[60:63], v[108:111], v[68:71], a[60:63]
v_mfma_f32_16x16x32_bf16 a[92:95], v[108:111], v[72:75], a[92:95]
v_mfma_f32_16x16x32_bf16 a[124:127], v[108:111], v[76:79], a[124:127]
s_add_u32 s43, s48, 4096
buffer_load_dwordx4 v[64:67], v1, s[8:11], s43 offen offset:3072
s_add_u32 s43, s48, 20480
buffer_load_dwordx4 v[68:71], v1, s[8:11], s43 offen offset:3072
s_add_u32 s43, s48, 36864
buffer_load_dwordx4 v[72:75], v1, s[8:11], s43 offen offset:3072
s_add_u32 s43, s48, 53248
buffer_load_dwordx4 v[76:79], v1, s[8:11], s43 offen offset:3072
ds_read_b64_tr_b16 v[108:109], v21 offset:40960
ds_read_b64_tr_b16 v[110:111], v29 offset:40960
s_waitcnt vmcnt(12)
s_waitcnt lgkmcnt(6)
v_mfma_f32_16x16x32_bf16 a[0:3], v[96:99], v[80:83], a[0:3]
v_mfma_f32_16x16x32_bf16 a[32:35], v[96:99], v[84:87], a[32:35]
v_mfma_f32_16x16x32_bf16 a[64:67], v[96:99], v[88:91], a[64:67]
v_mfma_f32_16x16x32_bf16 a[96:99], v[96:99], v[92:95], a[96:99]
ds_read_b64_tr_b16 v[96:97], v22 offset:40960
ds_read_b64_tr_b16 v[98:99], v30 offset:40960
s_waitcnt lgkmcnt(6)
v_mfma_f32_16x16x32_bf16 a[4:7], v[100:103], v[80:83], a[4:7]
v_mfma_f32_16x16x32_bf16 a[36:39], v[100:103], v[84:87], a[36:39]
v_mfma_f32_16x16x32_bf16 a[68:71], v[100:103], v[88:91], a[68:71]
v_mfma_f32_16x16x32_bf16 a[100:103], v[100:103], v[92:95], a[100:103]
ds_read_b64_tr_b16 v[100:101], v23 offset:40960
ds_read_b64_tr_b16 v[102:103], v31 offset:40960
s_waitcnt lgkmcnt(6)
v_mfma_f32_16x16x32_bf16 a[8:11], v[104:107], v[80:83], a[8:11]
v_mfma_f32_16x16x32_bf16 a[40:43], v[104:107], v[84:87], a[40:43]
v_mfma_f32_16x16x32_bf16 a[72:75], v[104:107], v[88:91], a[72:75]
v_mfma_f32_16x16x32_bf16 a[104:107], v[104:107], v[92:95], a[104:107]
ds_read_b64_tr_b16 v[104:105], v24 offset:40960
ds_read_b64_tr_b16 v[106:107], v32 offset:40960
s_waitcnt lgkmcnt(6)
v_mfma_f32_16x16x32_bf16 a[12:15], v[108:111], v[80:83], a[12:15]
v_mfma_f32_16x16x32_bf16 a[44:47], v[108:111], v[84:87], a[44:47]
v_mfma_f32_16x16x32_bf16 a[76:79], v[108:111], v[88:91], a[76:79]
v_mfma_f32_16x16x32_bf16 a[108:111], v[108:111], v[92:95], a[108:111]
ds_read_b64_tr_b16 v[108:109], v25 offset:40960
ds_read_b64_tr_b16 v[110:111], v33 offset:40960
s_waitcnt lgkmcnt(6)
v_mfma_f32_16x16x32_bf16 a[16:19], v[96:99], v[80:83], a[16:19]
v_mfma_f32_16x16x32_bf16 a[48:51], v[96:99], v[84:87], a[48:51]
v_mfma_f32_16x16x32_bf16 a[80:83], v[96:99], v[88:91], a[80:83]
v_mfma_f32_16x16x32_bf16 a[112:115], v[96:99], v[92:95], a[112:115]
s_barrier
s_add_u32 s42, s49, 1146880
s_add_u32 m0, s51, 16384
s_nop 0
buffer_load_dwordx4 v2, s[12:15], s42 offen lds
s_add_u32 m0, s51, 17408
s_nop 0
buffer_load_dwordx4 v3, s[12:15], s42 offen lds
s_add_u32 m0, s51, 18432
s_nop 0
buffer_load_dwordx4 v4, s[12:15], s42 offen lds
s_add_u32 m0, s51, 19456
s_nop 0
buffer_load_dwordx4 v5, s[12:15], s42 offen lds
ds_read_b64_tr_b16 v[96:97], v18 offset:49152
ds_read_b64_tr_b16 v[98:99], v26 offset:49152
s_waitcnt lgkmcnt(6)
v_mfma_f32_16x16x32_bf16 a[20:23], v[100:103], v[80:83], a[20:23]
v_mfma_f32_16x16x32_bf16 a[52:55], v[100:103], v[84:87], a[52:55]
v_mfma_f32_16x16x32_bf16 a[84:87], v[100:103], v[88:91], a[84:87]
v_mfma_f32_16x16x32_bf16 a[116:119], v[100:103], v[92:95], a[116:119]
ds_read_b64_tr_b16 v[100:101], v19 offset:49152
ds_read_b64_tr_b16 v[102:103], v27 offset:49152
s_waitcnt lgkmcnt(6)
v_mfma_f32_16x16x32_bf16 a[24:27], v[104:107], v[80:83], a[24:27]
v_mfma_f32_16x16x32_bf16 a[56:59], v[104:107], v[84:87], a[56:59]
v_mfma_f32_16x16x32_bf16 a[88:91], v[104:107], v[88:91], a[88:91]
v_mfma_f32_16x16x32_bf16 a[120:123], v[104:107], v[92:95], a[120:123]
ds_read_b64_tr_b16 v[104:105], v20 offset:49152
ds_read_b64_tr_b16 v[106:107], v28 offset:49152
s_waitcnt lgkmcnt(6)
v_mfma_f32_16x16x32_bf16 a[28:31], v[108:111], v[80:83], a[28:31]
v_mfma_f32_16x16x32_bf16 a[60:63], v[108:111], v[84:87], a[60:63]
v_mfma_f32_16x16x32_bf16 a[92:95], v[108:111], v[88:91], a[92:95]
v_mfma_f32_16x16x32_bf16 a[124:127], v[108:111], v[92:95], a[124:127]
s_add_u32 s43, s48, 8192
buffer_load_dwordx4 v[80:83], v1, s[8:11], s43 offen offset:0
s_add_u32 s43, s48, 24576
buffer_load_dwordx4 v[84:87], v1, s[8:11], s43 offen offset:0
s_add_u32 s43, s48, 40960
buffer_load_dwordx4 v[88:91], v1, s[8:11], s43 offen offset:0
s_add_u32 s43, s48, 57344
buffer_load_dwordx4 v[92:95], v1, s[8:11], s43 offen offset:0
ds_read_b64_tr_b16 v[108:109], v21 offset:49152
ds_read_b64_tr_b16 v[110:111], v29 offset:49152
s_waitcnt vmcnt(12)
s_waitcnt lgkmcnt(6)
v_mfma_f32_16x16x32_bf16 a[0:3], v[96:99], v[48:51], a[0:3]
v_mfma_f32_16x16x32_bf16 a[32:35], v[96:99], v[52:55], a[32:35]
v_mfma_f32_16x16x32_bf16 a[64:67], v[96:99], v[56:59], a[64:67]
v_mfma_f32_16x16x32_bf16 a[96:99], v[96:99], v[60:63], a[96:99]
ds_read_b64_tr_b16 v[96:97], v22 offset:49152
ds_read_b64_tr_b16 v[98:99], v30 offset:49152
s_waitcnt lgkmcnt(6)
v_mfma_f32_16x16x32_bf16 a[4:7], v[100:103], v[48:51], a[4:7]
v_mfma_f32_16x16x32_bf16 a[36:39], v[100:103], v[52:55], a[36:39]
v_mfma_f32_16x16x32_bf16 a[68:71], v[100:103], v[56:59], a[68:71]
v_mfma_f32_16x16x32_bf16 a[100:103], v[100:103], v[60:63], a[100:103]
ds_read_b64_tr_b16 v[100:101], v23 offset:49152
ds_read_b64_tr_b16 v[102:103], v31 offset:49152
s_waitcnt lgkmcnt(6)
v_mfma_f32_16x16x32_bf16 a[8:11], v[104:107], v[48:51], a[8:11]
v_mfma_f32_16x16x32_bf16 a[40:43], v[104:107], v[52:55], a[40:43]
v_mfma_f32_16x16x32_bf16 a[72:75], v[104:107], v[56:59], a[72:75]
v_mfma_f32_16x16x32_bf16 a[104:107], v[104:107], v[60:63], a[104:107]
ds_read_b64_tr_b16 v[104:105], v24 offset:49152
ds_read_b64_tr_b16 v[106:107], v32 offset:49152
s_waitcnt lgkmcnt(6)
v_mfma_f32_16x16x32_bf16 a[12:15], v[108:111], v[48:51], a[12:15]
v_mfma_f32_16x16x32_bf16 a[44:47], v[108:111], v[52:55], a[44:47]
v_mfma_f32_16x16x32_bf16 a[76:79], v[108:111], v[56:59], a[76:79]
v_mfma_f32_16x16x32_bf16 a[108:111], v[108:111], v[60:63], a[108:111]
ds_read_b64_tr_b16 v[108:109], v25 offset:49152
ds_read_b64_tr_b16 v[110:111], v33 offset:49152
s_waitcnt lgkmcnt(6)
v_mfma_f32_16x16x32_bf16 a[16:19], v[96:99], v[48:51], a[16:19]
v_mfma_f32_16x16x32_bf16 a[48:51], v[96:99], v[52:55], a[48:51]
v_mfma_f32_16x16x32_bf16 a[80:83], v[96:99], v[56:59], a[80:83]
v_mfma_f32_16x16x32_bf16 a[112:115], v[96:99], v[60:63], a[112:115]
ds_read_b64_tr_b16 v[96:97], v18 offset:57344
ds_read_b64_tr_b16 v[98:99], v26 offset:57344
s_waitcnt lgkmcnt(6)
v_mfma_f32_16x16x32_bf16 a[20:23], v[100:103], v[48:51], a[20:23]
v_mfma_f32_16x16x32_bf16 a[52:55], v[100:103], v[52:55], a[52:55]
v_mfma_f32_16x16x32_bf16 a[84:87], v[100:103], v[56:59], a[84:87]
v_mfma_f32_16x16x32_bf16 a[116:119], v[100:103], v[60:63], a[116:119]
ds_read_b64_tr_b16 v[100:101], v19 offset:57344
ds_read_b64_tr_b16 v[102:103], v27 offset:57344
s_waitcnt lgkmcnt(6)
v_mfma_f32_16x16x32_bf16 a[24:27], v[104:107], v[48:51], a[24:27]
v_mfma_f32_16x16x32_bf16 a[56:59], v[104:107], v[52:55], a[56:59]
v_mfma_f32_16x16x32_bf16 a[88:91], v[104:107], v[56:59], a[88:91]
v_mfma_f32_16x16x32_bf16 a[120:123], v[104:107], v[60:63], a[120:123]
ds_read_b64_tr_b16 v[104:105], v20 offset:57344
ds_read_b64_tr_b16 v[106:107], v28 offset:57344
s_waitcnt lgkmcnt(6)
v_mfma_f32_16x16x32_bf16 a[28:31], v[108:111], v[48:51], a[28:31]
v_mfma_f32_16x16x32_bf16 a[60:63], v[108:111], v[52:55], a[60:63]
v_mfma_f32_16x16x32_bf16 a[92:95], v[108:111], v[56:59], a[92:95]
v_mfma_f32_16x16x32_bf16 a[124:127], v[108:111], v[60:63], a[124:127]
s_add_u32 s43, s48, 8192
buffer_load_dwordx4 v[48:51], v1, s[8:11], s43 offen offset:1024
s_add_u32 s43, s48, 24576
buffer_load_dwordx4 v[52:55], v1, s[8:11], s43 offen offset:1024
s_add_u32 s43, s48, 40960
buffer_load_dwordx4 v[56:59], v1, s[8:11], s43 offen offset:1024
s_add_u32 s43, s48, 57344
buffer_load_dwordx4 v[60:63], v1, s[8:11], s43 offen offset:1024
ds_read_b64_tr_b16 v[108:109], v21 offset:57344
ds_read_b64_tr_b16 v[110:111], v29 offset:57344
s_waitcnt vmcnt(12)
s_waitcnt lgkmcnt(6)
v_mfma_f32_16x16x32_bf16 a[0:3], v[96:99], v[64:67], a[0:3]
v_mfma_f32_16x16x32_bf16 a[32:35], v[96:99], v[68:71], a[32:35]
v_mfma_f32_16x16x32_bf16 a[64:67], v[96:99], v[72:75], a[64:67]
v_mfma_f32_16x16x32_bf16 a[96:99], v[96:99], v[76:79], a[96:99]
ds_read_b64_tr_b16 v[96:97], v22 offset:57344
ds_read_b64_tr_b16 v[98:99], v30 offset:57344
s_waitcnt lgkmcnt(6)
v_mfma_f32_16x16x32_bf16 a[4:7], v[100:103], v[64:67], a[4:7]
v_mfma_f32_16x16x32_bf16 a[36:39], v[100:103], v[68:71], a[36:39]
v_mfma_f32_16x16x32_bf16 a[68:71], v[100:103], v[72:75], a[68:71]
v_mfma_f32_16x16x32_bf16 a[100:103], v[100:103], v[76:79], a[100:103]
ds_read_b64_tr_b16 v[100:101], v23 offset:57344
ds_read_b64_tr_b16 v[102:103], v31 offset:57344
s_waitcnt lgkmcnt(6)
v_mfma_f32_16x16x32_bf16 a[8:11], v[104:107], v[64:67], a[8:11]
v_mfma_f32_16x16x32_bf16 a[40:43], v[104:107], v[68:71], a[40:43]
v_mfma_f32_16x16x32_bf16 a[72:75], v[104:107], v[72:75], a[72:75]
v_mfma_f32_16x16x32_bf16 a[104:107], v[104:107], v[76:79], a[104:107]
ds_read_b64_tr_b16 v[104:105], v24 offset:57344
ds_read_b64_tr_b16 v[106:107], v32 offset:57344
s_waitcnt lgkmcnt(6)
v_mfma_f32_16x16x32_bf16 a[12:15], v[108:111], v[64:67], a[12:15]
v_mfma_f32_16x16x32_bf16 a[44:47], v[108:111], v[68:71], a[44:47]
v_mfma_f32_16x16x32_bf16 a[76:79], v[108:111], v[72:75], a[76:79]
v_mfma_f32_16x16x32_bf16 a[108:111], v[108:111], v[76:79], a[108:111]
ds_read_b64_tr_b16 v[108:109], v25 offset:57344
ds_read_b64_tr_b16 v[110:111], v33 offset:57344
s_waitcnt lgkmcnt(6)
v_mfma_f32_16x16x32_bf16 a[16:19], v[96:99], v[64:67], a[16:19]
v_mfma_f32_16x16x32_bf16 a[48:51], v[96:99], v[68:71], a[48:51]
v_mfma_f32_16x16x32_bf16 a[80:83], v[96:99], v[72:75], a[80:83]
v_mfma_f32_16x16x32_bf16 a[112:115], v[96:99], v[76:79], a[112:115]
s_barrier
s_add_u32 s42, s49, 1376256
s_add_u32 m0, s51, 32768
s_nop 0
buffer_load_dwordx4 v2, s[12:15], s42 offen lds
s_add_u32 m0, s51, 33792
s_nop 0
buffer_load_dwordx4 v3, s[12:15], s42 offen lds
s_add_u32 m0, s51, 34816
s_nop 0
buffer_load_dwordx4 v4, s[12:15], s42 offen lds
s_add_u32 m0, s51, 35840
s_nop 0
buffer_load_dwordx4 v5, s[12:15], s42 offen lds
ds_read_b64_tr_b16 v[96:97], v18 offset:0
ds_read_b64_tr_b16 v[98:99], v26 offset:0
s_waitcnt lgkmcnt(6)
v_mfma_f32_16x16x32_bf16 a[20:23], v[100:103], v[64:67], a[20:23]
v_mfma_f32_16x16x32_bf16 a[52:55], v[100:103], v[68:71], a[52:55]
v_mfma_f32_16x16x32_bf16 a[84:87], v[100:103], v[72:75], a[84:87]
v_mfma_f32_16x16x32_bf16 a[116:119], v[100:103], v[76:79], a[116:119]
ds_read_b64_tr_b16 v[100:101], v19 offset:0
ds_read_b64_tr_b16 v[102:103], v27 offset:0
s_waitcnt lgkmcnt(6)
v_mfma_f32_16x16x32_bf16 a[24:27], v[104:107], v[64:67], a[24:27]
v_mfma_f32_16x16x32_bf16 a[56:59], v[104:107], v[68:71], a[56:59]
v_mfma_f32_16x16x32_bf16 a[88:91], v[104:107], v[72:75], a[88:91]
v_mfma_f32_16x16x32_bf16 a[120:123], v[104:107], v[76:79], a[120:123]
ds_read_b64_tr_b16 v[104:105], v20 offset:0
ds_read_b64_tr_b16 v[106:107], v28 offset:0
s_waitcnt lgkmcnt(6)
v_mfma_f32_16x16x32_bf16 a[28:31], v[108:111], v[64:67], a[28:31]
v_mfma_f32_16x16x32_bf16 a[60:63], v[108:111], v[68:71], a[60:63]
v_mfma_f32_16x16x32_bf16 a[92:95], v[108:111], v[72:75], a[92:95]
v_mfma_f32_16x16x32_bf16 a[124:127], v[108:111], v[76:79], a[124:127]
s_add_u32 s43, s48, 8192
buffer_load_dwordx4 v[64:67], v1, s[8:11], s43 offen offset:2048
s_add_u32 s43, s48, 24576
buffer_load_dwordx4 v[68:71], v1, s[8:11], s43 offen offset:2048
s_add_u32 s43, s48, 40960
buffer_load_dwordx4 v[72:75], v1, s[8:11], s43 offen offset:2048
s_add_u32 s43, s48, 57344
buffer_load_dwordx4 v[76:79], v1, s[8:11], s43 offen offset:2048
ds_read_b64_tr_b16 v[108:109], v21 offset:0
ds_read_b64_tr_b16 v[110:111], v29 offset:0
s_waitcnt vmcnt(12)
s_waitcnt lgkmcnt(6)
v_mfma_f32_16x16x32_bf16 a[0:3], v[96:99], v[80:83], a[0:3]
v_mfma_f32_16x16x32_bf16 a[32:35], v[96:99], v[84:87], a[32:35]
v_mfma_f32_16x16x32_bf16 a[64:67], v[96:99], v[88:91], a[64:67]
v_mfma_f32_16x16x32_bf16 a[96:99], v[96:99], v[92:95], a[96:99]
ds_read_b64_tr_b16 v[96:97], v22 offset:0
ds_read_b64_tr_b16 v[98:99], v30 offset:0
s_waitcnt lgkmcnt(6)
v_mfma_f32_16x16x32_bf16 a[4:7], v[100:103], v[80:83], a[4:7]
v_mfma_f32_16x16x32_bf16 a[36:39], v[100:103], v[84:87], a[36:39]
v_mfma_f32_16x16x32_bf16 a[68:71], v[100:103], v[88:91], a[68:71]
v_mfma_f32_16x16x32_bf16 a[100:103], v[100:103], v[92:95], a[100:103]
ds_read_b64_tr_b16 v[100:101], v23 offset:0
ds_read_b64_tr_b16 v[102:103], v31 offset:0
s_waitcnt lgkmcnt(6)
v_mfma_f32_16x16x32_bf16 a[8:11], v[104:107], v[80:83], a[8:11]
v_mfma_f32_16x16x32_bf16 a[40:43], v[104:107], v[84:87], a[40:43]
v_mfma_f32_16x16x32_bf16 a[72:75], v[104:107], v[88:91], a[72:75]
v_mfma_f32_16x16x32_bf16 a[104:107], v[104:107], v[92:95], a[104:107]
ds_read_b64_tr_b16 v[104:105], v24 offset:0
ds_read_b64_tr_b16 v[106:107], v32 offset:0
s_waitcnt lgkmcnt(6)
v_mfma_f32_16x16x32_bf16 a[12:15], v[108:111], v[80:83], a[12:15]
v_mfma_f32_16x16x32_bf16 a[44:47], v[108:111], v[84:87], a[44:47]
v_mfma_f32_16x16x32_bf16 a[76:79], v[108:111], v[88:91], a[76:79]
v_mfma_f32_16x16x32_bf16 a[108:111], v[108:111], v[92:95], a[108:111]
ds_read_b64_tr_b16 v[108:109], v25 offset:0
ds_read_b64_tr_b16 v[110:111], v33 offset:0
s_waitcnt lgkmcnt(6)
v_mfma_f32_16x16x32_bf16 a[16:19], v[96:99], v[80:83], a[16:19]
v_mfma_f32_16x16x32_bf16 a[48:51], v[96:99], v[84:87], a[48:51]
v_mfma_f32_16x16x32_bf16 a[80:83], v[96:99], v[88:91], a[80:83]
v_mfma_f32_16x16x32_bf16 a[112:115], v[96:99], v[92:95], a[112:115]
ds_read_b64_tr_b16 v[96:97], v18 offset:8192
ds_read_b64_tr_b16 v[98:99], v26 offset:8192
s_waitcnt lgkmcnt(6)
v_mfma_f32_16x16x32_bf16 a[20:23], v[100:103], v[80:83], a[20:23]
v_mfma_f32_16x16x32_bf16 a[52:55], v[100:103], v[84:87], a[52:55]
v_mfma_f32_16x16x32_bf16 a[84:87], v[100:103], v[88:91], a[84:87]
v_mfma_f32_16x16x32_bf16 a[116:119], v[100:103], v[92:95], a[116:119]
ds_read_b64_tr_b16 v[100:101], v19 offset:8192
ds_read_b64_tr_b16 v[102:103], v27 offset:8192
s_waitcnt lgkmcnt(6)
v_mfma_f32_16x16x32_bf16 a[24:27], v[104:107], v[80:83], a[24:27]
v_mfma_f32_16x16x32_bf16 a[56:59], v[104:107], v[84:87], a[56:59]
v_mfma_f32_16x16x32_bf16 a[88:91], v[104:107], v[88:91], a[88:91]
v_mfma_f32_16x16x32_bf16 a[120:123], v[104:107], v[92:95], a[120:123]
ds_read_b64_tr_b16 v[104:105], v20 offset:8192
ds_read_b64_tr_b16 v[106:107], v28 offset:8192
s_waitcnt lgkmcnt(6)
v_mfma_f32_16x16x32_bf16 a[28:31], v[108:111], v[80:83], a[28:31]
v_mfma_f32_16x16x32_bf16 a[60:63], v[108:111], v[84:87], a[60:63]
v_mfma_f32_16x16x32_bf16 a[92:95], v[108:111], v[88:91], a[92:95]
v_mfma_f32_16x16x32_bf16 a[124:127], v[108:111], v[92:95], a[124:127]
s_add_u32 s43, s48, 8192
buffer_load_dwordx4 v[80:83], v1, s[8:11], s43 offen offset:3072
s_add_u32 s43, s48, 24576
buffer_load_dwordx4 v[84:87], v1, s[8:11], s43 offen offset:3072
s_add_u32 s43, s48, 40960
buffer_load_dwordx4 v[88:91], v1, s[8:11], s43 offen offset:3072
s_add_u32 s43, s48, 57344
buffer_load_dwordx4 v[92:95], v1, s[8:11], s43 offen offset:3072
ds_read_b64_tr_b16 v[108:109], v21 offset:8192
ds_read_b64_tr_b16 v[110:111], v29 offset:8192
s_waitcnt vmcnt(12)
s_waitcnt lgkmcnt(6)
v_mfma_f32_16x16x32_bf16 a[0:3], v[96:99], v[48:51], a[0:3]
v_mfma_f32_16x16x32_bf16 a[32:35], v[96:99], v[52:55], a[32:35]
v_mfma_f32_16x16x32_bf16 a[64:67], v[96:99], v[56:59], a[64:67]
v_mfma_f32_16x16x32_bf16 a[96:99], v[96:99], v[60:63], a[96:99]
ds_read_b64_tr_b16 v[96:97], v22 offset:8192
ds_read_b64_tr_b16 v[98:99], v30 offset:8192
s_waitcnt lgkmcnt(6)
v_mfma_f32_16x16x32_bf16 a[4:7], v[100:103], v[48:51], a[4:7]
v_mfma_f32_16x16x32_bf16 a[36:39], v[100:103], v[52:55], a[36:39]
v_mfma_f32_16x16x32_bf16 a[68:71], v[100:103], v[56:59], a[68:71]
v_mfma_f32_16x16x32_bf16 a[100:103], v[100:103], v[60:63], a[100:103]
ds_read_b64_tr_b16 v[100:101], v23 offset:8192
ds_read_b64_tr_b16 v[102:103], v31 offset:8192
s_waitcnt lgkmcnt(6)
v_mfma_f32_16x16x32_bf16 a[8:11], v[104:107], v[48:51], a[8:11]
v_mfma_f32_16x16x32_bf16 a[40:43], v[104:107], v[52:55], a[40:43]
v_mfma_f32_16x16x32_bf16 a[72:75], v[104:107], v[56:59], a[72:75]
v_mfma_f32_16x16x32_bf16 a[104:107], v[104:107], v[60:63], a[104:107]
ds_read_b64_tr_b16 v[104:105], v24 offset:8192
ds_read_b64_tr_b16 v[106:107], v32 offset:8192
s_waitcnt lgkmcnt(6)
v_mfma_f32_16x16x32_bf16 a[12:15], v[108:111], v[48:51], a[12:15]
v_mfma_f32_16x16x32_bf16 a[44:47], v[108:111], v[52:55], a[44:47]
v_mfma_f32_16x16x32_bf16 a[76:79], v[108:111], v[56:59], a[76:79]
v_mfma_f32_16x16x32_bf16 a[108:111], v[108:111], v[60:63], a[108:111]
ds_read_b64_tr_b16 v[108:109], v25 offset:8192
ds_read_b64_tr_b16 v[110:111], v33 offset:8192
s_waitcnt lgkmcnt(6)
v_mfma_f32_16x16x32_bf16 a[16:19], v[96:99], v[48:51], a[16:19]
v_mfma_f32_16x16x32_bf16 a[48:51], v[96:99], v[52:55], a[48:51]
v_mfma_f32_16x16x32_bf16 a[80:83], v[96:99], v[56:59], a[80:83]
v_mfma_f32_16x16x32_bf16 a[112:115], v[96:99], v[60:63], a[112:115]
s_barrier
s_add_u32 s42, s49, 1605632
s_add_u32 m0, s51, 49152
s_nop 0
buffer_load_dwordx4 v2, s[12:15], s42 offen lds
s_add_u32 m0, s51, 50176
s_nop 0
buffer_load_dwordx4 v3, s[12:15], s42 offen lds
s_add_u32 m0, s51, 51200
s_nop 0
buffer_load_dwordx4 v4, s[12:15], s42 offen lds
s_add_u32 m0, s51, 52224
s_nop 0
buffer_load_dwordx4 v5, s[12:15], s42 offen lds
ds_read_b64_tr_b16 v[96:97], v18 offset:16384
ds_read_b64_tr_b16 v[98:99], v26 offset:16384
s_waitcnt lgkmcnt(6)
v_mfma_f32_16x16x32_bf16 a[20:23], v[100:103], v[48:51], a[20:23]
v_mfma_f32_16x16x32_bf16 a[52:55], v[100:103], v[52:55], a[52:55]
v_mfma_f32_16x16x32_bf16 a[84:87], v[100:103], v[56:59], a[84:87]
v_mfma_f32_16x16x32_bf16 a[116:119], v[100:103], v[60:63], a[116:119]
ds_read_b64_tr_b16 v[100:101], v19 offset:16384
ds_read_b64_tr_b16 v[102:103], v27 offset:16384
s_waitcnt lgkmcnt(6)
v_mfma_f32_16x16x32_bf16 a[24:27], v[104:107], v[48:51], a[24:27]
v_mfma_f32_16x16x32_bf16 a[56:59], v[104:107], v[52:55], a[56:59]
v_mfma_f32_16x16x32_bf16 a[88:91], v[104:107], v[56:59], a[88:91]
v_mfma_f32_16x16x32_bf16 a[120:123], v[104:107], v[60:63], a[120:123]
ds_read_b64_tr_b16 v[104:105], v20 offset:16384
ds_read_b64_tr_b16 v[106:107], v28 offset:16384
s_waitcnt lgkmcnt(6)
v_mfma_f32_16x16x32_bf16 a[28:31], v[108:111], v[48:51], a[28:31]
v_mfma_f32_16x16x32_bf16 a[60:63], v[108:111], v[52:55], a[60:63]
v_mfma_f32_16x16x32_bf16 a[92:95], v[108:111], v[56:59], a[92:95]
v_mfma_f32_16x16x32_bf16 a[124:127], v[108:111], v[60:63], a[124:127]
s_add_u32 s43, s48, 12288
buffer_load_dwordx4 v[48:51], v1, s[8:11], s43 offen offset:0
s_add_u32 s43, s48, 28672
buffer_load_dwordx4 v[52:55], v1, s[8:11], s43 offen offset:0
s_add_u32 s43, s48, 45056
buffer_load_dwordx4 v[56:59], v1, s[8:11], s43 offen offset:0
s_add_u32 s43, s48, 61440
buffer_load_dwordx4 v[60:63], v1, s[8:11], s43 offen offset:0
ds_read_b64_tr_b16 v[108:109], v21 offset:16384
ds_read_b64_tr_b16 v[110:111], v29 offset:16384
s_waitcnt vmcnt(12)
s_waitcnt lgkmcnt(6)
v_mfma_f32_16x16x32_bf16 a[0:3], v[96:99], v[64:67], a[0:3]
v_mfma_f32_16x16x32_bf16 a[32:35], v[96:99], v[68:71], a[32:35]
v_mfma_f32_16x16x32_bf16 a[64:67], v[96:99], v[72:75], a[64:67]
v_mfma_f32_16x16x32_bf16 a[96:99], v[96:99], v[76:79], a[96:99]
ds_read_b64_tr_b16 v[96:97], v22 offset:16384
ds_read_b64_tr_b16 v[98:99], v30 offset:16384
s_waitcnt lgkmcnt(6)
v_mfma_f32_16x16x32_bf16 a[4:7], v[100:103], v[64:67], a[4:7]
v_mfma_f32_16x16x32_bf16 a[36:39], v[100:103], v[68:71], a[36:39]
v_mfma_f32_16x16x32_bf16 a[68:71], v[100:103], v[72:75], a[68:71]
v_mfma_f32_16x16x32_bf16 a[100:103], v[100:103], v[76:79], a[100:103]
ds_read_b64_tr_b16 v[100:101], v23 offset:16384
ds_read_b64_tr_b16 v[102:103], v31 offset:16384
s_waitcnt lgkmcnt(6)
v_mfma_f32_16x16x32_bf16 a[8:11], v[104:107], v[64:67], a[8:11]
v_mfma_f32_16x16x32_bf16 a[40:43], v[104:107], v[68:71], a[40:43]
v_mfma_f32_16x16x32_bf16 a[72:75], v[104:107], v[72:75], a[72:75]
v_mfma_f32_16x16x32_bf16 a[104:107], v[104:107], v[76:79], a[104:107]
ds_read_b64_tr_b16 v[104:105], v24 offset:16384
ds_read_b64_tr_b16 v[106:107], v32 offset:16384
s_waitcnt lgkmcnt(6)
v_mfma_f32_16x16x32_bf16 a[12:15], v[108:111], v[64:67], a[12:15]
v_mfma_f32_16x16x32_bf16 a[44:47], v[108:111], v[68:71], a[44:47]
v_mfma_f32_16x16x32_bf16 a[76:79], v[108:111], v[72:75], a[76:79]
v_mfma_f32_16x16x32_bf16 a[108:111], v[108:111], v[76:79], a[108:111]
ds_read_b64_tr_b16 v[108:109], v25 offset:16384
ds_read_b64_tr_b16 v[110:111], v33 offset:16384
s_waitcnt lgkmcnt(6)
v_mfma_f32_16x16x32_bf16 a[16:19], v[96:99], v[64:67], a[16:19]
v_mfma_f32_16x16x32_bf16 a[48:51], v[96:99], v[68:71], a[48:51]
v_mfma_f32_16x16x32_bf16 a[80:83], v[96:99], v[72:75], a[80:83]
v_mfma_f32_16x16x32_bf16 a[112:115], v[96:99], v[76:79], a[112:115]
ds_read_b64_tr_b16 v[96:97], v18 offset:24576
ds_read_b64_tr_b16 v[98:99], v26 offset:24576
s_waitcnt lgkmcnt(6)
v_mfma_f32_16x16x32_bf16 a[20:23], v[100:103], v[64:67], a[20:23]
v_mfma_f32_16x16x32_bf16 a[52:55], v[100:103], v[68:71], a[52:55]
v_mfma_f32_16x16x32_bf16 a[84:87], v[100:103], v[72:75], a[84:87]
v_mfma_f32_16x16x32_bf16 a[116:119], v[100:103], v[76:79], a[116:119]
ds_read_b64_tr_b16 v[100:101], v19 offset:24576
ds_read_b64_tr_b16 v[102:103], v27 offset:24576
s_waitcnt lgkmcnt(6)
v_mfma_f32_16x16x32_bf16 a[24:27], v[104:107], v[64:67], a[24:27]
v_mfma_f32_16x16x32_bf16 a[56:59], v[104:107], v[68:71], a[56:59]
v_mfma_f32_16x16x32_bf16 a[88:91], v[104:107], v[72:75], a[88:91]
v_mfma_f32_16x16x32_bf16 a[120:123], v[104:107], v[76:79], a[120:123]
ds_read_b64_tr_b16 v[104:105], v20 offset:24576
ds_read_b64_tr_b16 v[106:107], v28 offset:24576
s_waitcnt lgkmcnt(6)
v_mfma_f32_16x16x32_bf16 a[28:31], v[108:111], v[64:67], a[28:31]
v_mfma_f32_16x16x32_bf16 a[60:63], v[108:111], v[68:71], a[60:63]
v_mfma_f32_16x16x32_bf16 a[92:95], v[108:111], v[72:75], a[92:95]
v_mfma_f32_16x16x32_bf16 a[124:127], v[108:111], v[76:79], a[124:127]
s_add_u32 s43, s48, 12288
buffer_load_dwordx4 v[64:67], v1, s[8:11], s43 offen offset:1024
s_add_u32 s43, s48, 28672
buffer_load_dwordx4 v[68:71], v1, s[8:11], s43 offen offset:1024
s_add_u32 s43, s48, 45056
buffer_load_dwordx4 v[72:75], v1, s[8:11], s43 offen offset:1024
s_add_u32 s43, s48, 61440
buffer_load_dwordx4 v[76:79], v1, s[8:11], s43 offen offset:1024
ds_read_b64_tr_b16 v[108:109], v21 offset:24576
ds_read_b64_tr_b16 v[110:111], v29 offset:24576
s_waitcnt vmcnt(12)
s_waitcnt lgkmcnt(6)
v_mfma_f32_16x16x32_bf16 a[0:3], v[96:99], v[80:83], a[0:3]
v_mfma_f32_16x16x32_bf16 a[32:35], v[96:99], v[84:87], a[32:35]
v_mfma_f32_16x16x32_bf16 a[64:67], v[96:99], v[88:91], a[64:67]
v_mfma_f32_16x16x32_bf16 a[96:99], v[96:99], v[92:95], a[96:99]
ds_read_b64_tr_b16 v[96:97], v22 offset:24576
ds_read_b64_tr_b16 v[98:99], v30 offset:24576
s_waitcnt lgkmcnt(6)
v_mfma_f32_16x16x32_bf16 a[4:7], v[100:103], v[80:83], a[4:7]
v_mfma_f32_16x16x32_bf16 a[36:39], v[100:103], v[84:87], a[36:39]
v_mfma_f32_16x16x32_bf16 a[68:71], v[100:103], v[88:91], a[68:71]
v_mfma_f32_16x16x32_bf16 a[100:103], v[100:103], v[92:95], a[100:103]
ds_read_b64_tr_b16 v[100:101], v23 offset:24576
ds_read_b64_tr_b16 v[102:103], v31 offset:24576
s_waitcnt lgkmcnt(6)
v_mfma_f32_16x16x32_bf16 a[8:11], v[104:107], v[80:83], a[8:11]
v_mfma_f32_16x16x32_bf16 a[40:43], v[104:107], v[84:87], a[40:43]
v_mfma_f32_16x16x32_bf16 a[72:75], v[104:107], v[88:91], a[72:75]
v_mfma_f32_16x16x32_bf16 a[104:107], v[104:107], v[92:95], a[104:107]
ds_read_b64_tr_b16 v[104:105], v24 offset:24576
ds_read_b64_tr_b16 v[106:107], v32 offset:24576
s_waitcnt lgkmcnt(6)
v_mfma_f32_16x16x32_bf16 a[12:15], v[108:111], v[80:83], a[12:15]
v_mfma_f32_16x16x32_bf16 a[44:47], v[108:111], v[84:87], a[44:47]
v_mfma_f32_16x16x32_bf16 a[76:79], v[108:111], v[88:91], a[76:79]
v_mfma_f32_16x16x32_bf16 a[108:111], v[108:111], v[92:95], a[108:111]
ds_read_b64_tr_b16 v[108:109], v25 offset:24576
ds_read_b64_tr_b16 v[110:111], v33 offset:24576
s_waitcnt lgkmcnt(6)
v_mfma_f32_16x16x32_bf16 a[16:19], v[96:99], v[80:83], a[16:19]
v_mfma_f32_16x16x32_bf16 a[48:51], v[96:99], v[84:87], a[48:51]
v_mfma_f32_16x16x32_bf16 a[80:83], v[96:99], v[88:91], a[80:83]
v_mfma_f32_16x16x32_bf16 a[112:115], v[96:99], v[92:95], a[112:115]
s_barrier
ds_read_b64_tr_b16 v[96:97], v18 offset:32768
ds_read_b64_tr_b16 v[98:99], v26 offset:32768
s_waitcnt lgkmcnt(6)
v_mfma_f32_16x16x32_bf16 a[20:23], v[100:103], v[80:83], a[20:23]
v_mfma_f32_16x16x32_bf16 a[52:55], v[100:103], v[84:87], a[52:55]
v_mfma_f32_16x16x32_bf16 a[84:87], v[100:103], v[88:91], a[84:87]
v_mfma_f32_16x16x32_bf16 a[116:119], v[100:103], v[92:95], a[116:119]
ds_read_b64_tr_b16 v[100:101], v19 offset:32768
ds_read_b64_tr_b16 v[102:103], v27 offset:32768
s_waitcnt lgkmcnt(6)
v_mfma_f32_16x16x32_bf16 a[24:27], v[104:107], v[80:83], a[24:27]
v_mfma_f32_16x16x32_bf16 a[56:59], v[104:107], v[84:87], a[56:59]
v_mfma_f32_16x16x32_bf16 a[88:91], v[104:107], v[88:91], a[88:91]
v_mfma_f32_16x16x32_bf16 a[120:123], v[104:107], v[92:95], a[120:123]
ds_read_b64_tr_b16 v[104:105], v20 offset:32768
ds_read_b64_tr_b16 v[106:107], v28 offset:32768
s_waitcnt lgkmcnt(6)
v_mfma_f32_16x16x32_bf16 a[28:31], v[108:111], v[80:83], a[28:31]
v_mfma_f32_16x16x32_bf16 a[60:63], v[108:111], v[84:87], a[60:63]
v_mfma_f32_16x16x32_bf16 a[92:95], v[108:111], v[88:91], a[92:95]
v_mfma_f32_16x16x32_bf16 a[124:127], v[108:111], v[92:95], a[124:127]
s_add_u32 s43, s48, 12288
buffer_load_dwordx4 v[80:83], v1, s[8:11], s43 offen offset:2048
s_add_u32 s43, s48, 28672
buffer_load_dwordx4 v[84:87], v1, s[8:11], s43 offen offset:2048
s_add_u32 s43, s48, 45056
buffer_load_dwordx4 v[88:91], v1, s[8:11], s43 offen offset:2048
s_add_u32 s43, s48, 61440
buffer_load_dwordx4 v[92:95], v1, s[8:11], s43 offen offset:2048
ds_read_b64_tr_b16 v[108:109], v21 offset:32768
ds_read_b64_tr_b16 v[110:111], v29 offset:32768
s_waitcnt vmcnt(8)
s_waitcnt lgkmcnt(6)
v_mfma_f32_16x16x32_bf16 a[0:3], v[96:99], v[48:51], a[0:3]
v_mfma_f32_16x16x32_bf16 a[32:35], v[96:99], v[52:55], a[32:35]
v_mfma_f32_16x16x32_bf16 a[64:67], v[96:99], v[56:59], a[64:67]
v_mfma_f32_16x16x32_bf16 a[96:99], v[96:99], v[60:63], a[96:99]
ds_read_b64_tr_b16 v[96:97], v22 offset:32768
ds_read_b64_tr_b16 v[98:99], v30 offset:32768
s_waitcnt lgkmcnt(6)
v_mfma_f32_16x16x32_bf16 a[4:7], v[100:103], v[48:51], a[4:7]
v_mfma_f32_16x16x32_bf16 a[36:39], v[100:103], v[52:55], a[36:39]
v_mfma_f32_16x16x32_bf16 a[68:71], v[100:103], v[56:59], a[68:71]
v_mfma_f32_16x16x32_bf16 a[100:103], v[100:103], v[60:63], a[100:103]
ds_read_b64_tr_b16 v[100:101], v23 offset:32768
ds_read_b64_tr_b16 v[102:103], v31 offset:32768
s_waitcnt lgkmcnt(6)
v_mfma_f32_16x16x32_bf16 a[8:11], v[104:107], v[48:51], a[8:11]
v_mfma_f32_16x16x32_bf16 a[40:43], v[104:107], v[52:55], a[40:43]
v_mfma_f32_16x16x32_bf16 a[72:75], v[104:107], v[56:59], a[72:75]
v_mfma_f32_16x16x32_bf16 a[104:107], v[104:107], v[60:63], a[104:107]
ds_read_b64_tr_b16 v[104:105], v24 offset:32768
ds_read_b64_tr_b16 v[106:107], v32 offset:32768
s_waitcnt lgkmcnt(6)
v_mfma_f32_16x16x32_bf16 a[12:15], v[108:111], v[48:51], a[12:15]
v_mfma_f32_16x16x32_bf16 a[44:47], v[108:111], v[52:55], a[44:47]
v_mfma_f32_16x16x32_bf16 a[76:79], v[108:111], v[56:59], a[76:79]
v_mfma_f32_16x16x32_bf16 a[108:111], v[108:111], v[60:63], a[108:111]
ds_read_b64_tr_b16 v[108:109], v25 offset:32768
ds_read_b64_tr_b16 v[110:111], v33 offset:32768
s_waitcnt lgkmcnt(6)
v_mfma_f32_16x16x32_bf16 a[16:19], v[96:99], v[48:51], a[16:19]
v_mfma_f32_16x16x32_bf16 a[48:51], v[96:99], v[52:55], a[48:51]
v_mfma_f32_16x16x32_bf16 a[80:83], v[96:99], v[56:59], a[80:83]
v_mfma_f32_16x16x32_bf16 a[112:115], v[96:99], v[60:63], a[112:115]
ds_read_b64_tr_b16 v[96:97], v18 offset:40960
ds_read_b64_tr_b16 v[98:99], v26 offset:40960
s_waitcnt lgkmcnt(6)
v_mfma_f32_16x16x32_bf16 a[20:23], v[100:103], v[48:51], a[20:23]
v_mfma_f32_16x16x32_bf16 a[52:55], v[100:103], v[52:55], a[52:55]
v_mfma_f32_16x16x32_bf16 a[84:87], v[100:103], v[56:59], a[84:87]
v_mfma_f32_16x16x32_bf16 a[116:119], v[100:103], v[60:63], a[116:119]
ds_read_b64_tr_b16 v[100:101], v19 offset:40960
ds_read_b64_tr_b16 v[102:103], v27 offset:40960
s_waitcnt lgkmcnt(6)
v_mfma_f32_16x16x32_bf16 a[24:27], v[104:107], v[48:51], a[24:27]
v_mfma_f32_16x16x32_bf16 a[56:59], v[104:107], v[52:55], a[56:59]
v_mfma_f32_16x16x32_bf16 a[88:91], v[104:107], v[56:59], a[88:91]
v_mfma_f32_16x16x32_bf16 a[120:123], v[104:107], v[60:63], a[120:123]
ds_read_b64_tr_b16 v[104:105], v20 offset:40960
ds_read_b64_tr_b16 v[106:107], v28 offset:40960
s_waitcnt lgkmcnt(6)
v_mfma_f32_16x16x32_bf16 a[28:31], v[108:111], v[48:51], a[28:31]
v_mfma_f32_16x16x32_bf16 a[60:63], v[108:111], v[52:55], a[60:63]
v_mfma_f32_16x16x32_bf16 a[92:95], v[108:111], v[56:59], a[92:95]
v_mfma_f32_16x16x32_bf16 a[124:127], v[108:111], v[60:63], a[124:127]
s_add_u32 s43, s48, 12288
buffer_load_dwordx4 v[48:51], v1, s[8:11], s43 offen offset:3072
s_add_u32 s43, s48, 28672
buffer_load_dwordx4 v[52:55], v1, s[8:11], s43 offen offset:3072
s_add_u32 s43, s48, 45056
buffer_load_dwordx4 v[56:59], v1, s[8:11], s43 offen offset:3072
s_add_u32 s43, s48, 61440
buffer_load_dwordx4 v[60:63], v1, s[8:11], s43 offen offset:3072
ds_read_b64_tr_b16 v[108:109], v21 offset:40960
ds_read_b64_tr_b16 v[110:111], v29 offset:40960
s_waitcnt vmcnt(8)
s_waitcnt lgkmcnt(6)
v_mfma_f32_16x16x32_bf16 a[0:3], v[96:99], v[64:67], a[0:3]
v_mfma_f32_16x16x32_bf16 a[32:35], v[96:99], v[68:71], a[32:35]
v_mfma_f32_16x16x32_bf16 a[64:67], v[96:99], v[72:75], a[64:67]
v_mfma_f32_16x16x32_bf16 a[96:99], v[96:99], v[76:79], a[96:99]
ds_read_b64_tr_b16 v[96:97], v22 offset:40960
ds_read_b64_tr_b16 v[98:99], v30 offset:40960
s_waitcnt lgkmcnt(6)
v_mfma_f32_16x16x32_bf16 a[4:7], v[100:103], v[64:67], a[4:7]
v_mfma_f32_16x16x32_bf16 a[36:39], v[100:103], v[68:71], a[36:39]
v_mfma_f32_16x16x32_bf16 a[68:71], v[100:103], v[72:75], a[68:71]
v_mfma_f32_16x16x32_bf16 a[100:103], v[100:103], v[76:79], a[100:103]
ds_read_b64_tr_b16 v[100:101], v23 offset:40960
ds_read_b64_tr_b16 v[102:103], v31 offset:40960
s_waitcnt lgkmcnt(6)
v_mfma_f32_16x16x32_bf16 a[8:11], v[104:107], v[64:67], a[8:11]
v_mfma_f32_16x16x32_bf16 a[40:43], v[104:107], v[68:71], a[40:43]
v_mfma_f32_16x16x32_bf16 a[72:75], v[104:107], v[72:75], a[72:75]
v_mfma_f32_16x16x32_bf16 a[104:107], v[104:107], v[76:79], a[104:107]
ds_read_b64_tr_b16 v[104:105], v24 offset:40960
ds_read_b64_tr_b16 v[106:107], v32 offset:40960
s_waitcnt lgkmcnt(6)
v_mfma_f32_16x16x32_bf16 a[12:15], v[108:111], v[64:67], a[12:15]
v_mfma_f32_16x16x32_bf16 a[44:47], v[108:111], v[68:71], a[44:47]
v_mfma_f32_16x16x32_bf16 a[76:79], v[108:111], v[72:75], a[76:79]
v_mfma_f32_16x16x32_bf16 a[108:111], v[108:111], v[76:79], a[108:111]
ds_read_b64_tr_b16 v[108:109], v25 offset:40960
ds_read_b64_tr_b16 v[110:111], v33 offset:40960
s_waitcnt lgkmcnt(6)
v_mfma_f32_16x16x32_bf16 a[16:19], v[96:99], v[64:67], a[16:19]
v_mfma_f32_16x16x32_bf16 a[48:51], v[96:99], v[68:71], a[48:51]
v_mfma_f32_16x16x32_bf16 a[80:83], v[96:99], v[72:75], a[80:83]
v_mfma_f32_16x16x32_bf16 a[112:115], v[96:99], v[76:79], a[112:115]
s_barrier
ds_read_b64_tr_b16 v[96:97], v18 offset:49152
ds_read_b64_tr_b16 v[98:99], v26 offset:49152
s_waitcnt lgkmcnt(6)
v_mfma_f32_16x16x32_bf16 a[20:23], v[100:103], v[64:67], a[20:23]
v_mfma_f32_16x16x32_bf16 a[52:55], v[100:103], v[68:71], a[52:55]
v_mfma_f32_16x16x32_bf16 a[84:87], v[100:103], v[72:75], a[84:87]
v_mfma_f32_16x16x32_bf16 a[116:119], v[100:103], v[76:79], a[116:119]
ds_read_b64_tr_b16 v[100:101], v19 offset:49152
ds_read_b64_tr_b16 v[102:103], v27 offset:49152
s_waitcnt lgkmcnt(6)
v_mfma_f32_16x16x32_bf16 a[24:27], v[104:107], v[64:67], a[24:27]
v_mfma_f32_16x16x32_bf16 a[56:59], v[104:107], v[68:71], a[56:59]
v_mfma_f32_16x16x32_bf16 a[88:91], v[104:107], v[72:75], a[88:91]
v_mfma_f32_16x16x32_bf16 a[120:123], v[104:107], v[76:79], a[120:123]
ds_read_b64_tr_b16 v[104:105], v20 offset:49152
ds_read_b64_tr_b16 v[106:107], v28 offset:49152
s_waitcnt lgkmcnt(6)
v_mfma_f32_16x16x32_bf16 a[28:31], v[108:111], v[64:67], a[28:31]
v_mfma_f32_16x16x32_bf16 a[60:63], v[108:111], v[68:71], a[60:63]
v_mfma_f32_16x16x32_bf16 a[92:95], v[108:111], v[72:75], a[92:95]
v_mfma_f32_16x16x32_bf16 a[124:127], v[108:111], v[76:79], a[124:127]
ds_read_b64_tr_b16 v[108:109], v21 offset:49152
ds_read_b64_tr_b16 v[110:111], v29 offset:49152
s_waitcnt vmcnt(4)
s_waitcnt lgkmcnt(6)
v_mfma_f32_16x16x32_bf16 a[0:3], v[96:99], v[80:83], a[0:3]
v_mfma_f32_16x16x32_bf16 a[32:35], v[96:99], v[84:87], a[32:35]
v_mfma_f32_16x16x32_bf16 a[64:67], v[96:99], v[88:91], a[64:67]
v_mfma_f32_16x16x32_bf16 a[96:99], v[96:99], v[92:95], a[96:99]
ds_read_b64_tr_b16 v[96:97], v22 offset:49152
ds_read_b64_tr_b16 v[98:99], v30 offset:49152
s_waitcnt lgkmcnt(6)
v_mfma_f32_16x16x32_bf16 a[4:7], v[100:103], v[80:83], a[4:7]
v_mfma_f32_16x16x32_bf16 a[36:39], v[100:103], v[84:87], a[36:39]
v_mfma_f32_16x16x32_bf16 a[68:71], v[100:103], v[88:91], a[68:71]
v_mfma_f32_16x16x32_bf16 a[100:103], v[100:103], v[92:95], a[100:103]
ds_read_b64_tr_b16 v[100:101], v23 offset:49152
ds_read_b64_tr_b16 v[102:103], v31 offset:49152
s_waitcnt lgkmcnt(6)
v_mfma_f32_16x16x32_bf16 a[8:11], v[104:107], v[80:83], a[8:11]
v_mfma_f32_16x16x32_bf16 a[40:43], v[104:107], v[84:87], a[40:43]
v_mfma_f32_16x16x32_bf16 a[72:75], v[104:107], v[88:91], a[72:75]
v_mfma_f32_16x16x32_bf16 a[104:107], v[104:107], v[92:95], a[104:107]
ds_read_b64_tr_b16 v[104:105], v24 offset:49152
ds_read_b64_tr_b16 v[106:107], v32 offset:49152
s_waitcnt lgkmcnt(6)
v_mfma_f32_16x16x32_bf16 a[12:15], v[108:111], v[80:83], a[12:15]
v_mfma_f32_16x16x32_bf16 a[44:47], v[108:111], v[84:87], a[44:47]
v_mfma_f32_16x16x32_bf16 a[76:79], v[108:111], v[88:91], a[76:79]
v_mfma_f32_16x16x32_bf16 a[108:111], v[108:111], v[92:95], a[108:111]
ds_read_b64_tr_b16 v[108:109], v25 offset:49152
ds_read_b64_tr_b16 v[110:111], v33 offset:49152
s_waitcnt lgkmcnt(6)
v_mfma_f32_16x16x32_bf16 a[16:19], v[96:99], v[80:83], a[16:19]
v_mfma_f32_16x16x32_bf16 a[48:51], v[96:99], v[84:87], a[48:51]
v_mfma_f32_16x16x32_bf16 a[80:83], v[96:99], v[88:91], a[80:83]
v_mfma_f32_16x16x32_bf16 a[112:115], v[96:99], v[92:95], a[112:115]
ds_read_b64_tr_b16 v[96:97], v18 offset:57344
ds_read_b64_tr_b16 v[98:99], v26 offset:57344
s_waitcnt lgkmcnt(6)
v_mfma_f32_16x16x32_bf16 a[20:23], v[100:103], v[80:83], a[20:23]
v_mfma_f32_16x16x32_bf16 a[52:55], v[100:103], v[84:87], a[52:55]
v_mfma_f32_16x16x32_bf16 a[84:87], v[100:103], v[88:91], a[84:87]
v_mfma_f32_16x16x32_bf16 a[116:119], v[100:103], v[92:95], a[116:119]
ds_read_b64_tr_b16 v[100:101], v19 offset:57344
ds_read_b64_tr_b16 v[102:103], v27 offset:57344
s_waitcnt lgkmcnt(6)
v_mfma_f32_16x16x32_bf16 a[24:27], v[104:107], v[80:83], a[24:27]
v_mfma_f32_16x16x32_bf16 a[56:59], v[104:107], v[84:87], a[56:59]
v_mfma_f32_16x16x32_bf16 a[88:91], v[104:107], v[88:91], a[88:91]
v_mfma_f32_16x16x32_bf16 a[120:123], v[104:107], v[92:95], a[120:123]
ds_read_b64_tr_b16 v[104:105], v20 offset:57344
ds_read_b64_tr_b16 v[106:107], v28 offset:57344
s_waitcnt lgkmcnt(6)
v_mfma_f32_16x16x32_bf16 a[28:31], v[108:111], v[80:83], a[28:31]
v_mfma_f32_16x16x32_bf16 a[60:63], v[108:111], v[84:87], a[60:63]
v_mfma_f32_16x16x32_bf16 a[92:95], v[108:111], v[88:91], a[92:95]
v_mfma_f32_16x16x32_bf16 a[124:127], v[108:111], v[92:95], a[124:127]
ds_read_b64_tr_b16 v[108:109], v21 offset:57344
ds_read_b64_tr_b16 v[110:111], v29 offset:57344
s_waitcnt vmcnt(0)
s_waitcnt lgkmcnt(6)
v_mfma_f32_16x16x32_bf16 a[0:3], v[96:99], v[48:51], a[0:3]
v_mfma_f32_16x16x32_bf16 a[32:35], v[96:99], v[52:55], a[32:35]
v_mfma_f32_16x16x32_bf16 a[64:67], v[96:99], v[56:59], a[64:67]
v_mfma_f32_16x16x32_bf16 a[96:99], v[96:99], v[60:63], a[96:99]
ds_read_b64_tr_b16 v[96:97], v22 offset:57344
ds_read_b64_tr_b16 v[98:99], v30 offset:57344
s_waitcnt lgkmcnt(6)
v_mfma_f32_16x16x32_bf16 a[4:7], v[100:103], v[48:51], a[4:7]
v_mfma_f32_16x16x32_bf16 a[36:39], v[100:103], v[52:55], a[36:39]
v_mfma_f32_16x16x32_bf16 a[68:71], v[100:103], v[56:59], a[68:71]
v_mfma_f32_16x16x32_bf16 a[100:103], v[100:103], v[60:63], a[100:103]
ds_read_b64_tr_b16 v[100:101], v23 offset:57344
ds_read_b64_tr_b16 v[102:103], v31 offset:57344
s_waitcnt lgkmcnt(6)
v_mfma_f32_16x16x32_bf16 a[8:11], v[104:107], v[48:51], a[8:11]
v_mfma_f32_16x16x32_bf16 a[40:43], v[104:107], v[52:55], a[40:43]
v_mfma_f32_16x16x32_bf16 a[72:75], v[104:107], v[56:59], a[72:75]
v_mfma_f32_16x16x32_bf16 a[104:107], v[104:107], v[60:63], a[104:107]
ds_read_b64_tr_b16 v[104:105], v24 offset:57344
ds_read_b64_tr_b16 v[106:107], v32 offset:57344
s_waitcnt lgkmcnt(6)
v_mfma_f32_16x16x32_bf16 a[12:15], v[108:111], v[48:51], a[12:15]
v_mfma_f32_16x16x32_bf16 a[44:47], v[108:111], v[52:55], a[44:47]
v_mfma_f32_16x16x32_bf16 a[76:79], v[108:111], v[56:59], a[76:79]
v_mfma_f32_16x16x32_bf16 a[108:111], v[108:111], v[60:63], a[108:111]
ds_read_b64_tr_b16 v[108:109], v25 offset:57344
ds_read_b64_tr_b16 v[110:111], v33 offset:57344
s_waitcnt lgkmcnt(6)
v_mfma_f32_16x16x32_bf16 a[16:19], v[96:99], v[48:51], a[16:19]
v_mfma_f32_16x16x32_bf16 a[48:51], v[96:99], v[52:55], a[48:51]
v_mfma_f32_16x16x32_bf16 a[80:83], v[96:99], v[56:59], a[80:83]
v_mfma_f32_16x16x32_bf16 a[112:115], v[96:99], v[60:63], a[112:115]
s_waitcnt lgkmcnt(4)
v_mfma_f32_16x16x32_bf16 a[20:23], v[100:103], v[48:51], a[20:23]
v_mfma_f32_16x16x32_bf16 a[52:55], v[100:103], v[52:55], a[52:55]
v_mfma_f32_16x16x32_bf16 a[84:87], v[100:103], v[56:59], a[84:87]
v_mfma_f32_16x16x32_bf16 a[116:119], v[100:103], v[60:63], a[116:119]
s_waitcnt lgkmcnt(2)
v_mfma_f32_16x16x32_bf16 a[24:27], v[104:107], v[48:51], a[24:27]
v_mfma_f32_16x16x32_bf16 a[56:59], v[104:107], v[52:55], a[56:59]
v_mfma_f32_16x16x32_bf16 a[88:91], v[104:107], v[56:59], a[88:91]
v_mfma_f32_16x16x32_bf16 a[120:123], v[104:107], v[60:63], a[120:123]
s_waitcnt lgkmcnt(0)
v_mfma_f32_16x16x32_bf16 a[28:31], v[108:111], v[48:51], a[28:31]
v_mfma_f32_16x16x32_bf16 a[60:63], v[108:111], v[52:55], a[60:63]
v_mfma_f32_16x16x32_bf16 a[92:95], v[108:111], v[56:59], a[92:95]
v_mfma_f32_16x16x32_bf16 a[124:127], v[108:111], v[60:63], a[124:127]
s_lshl_b32 s42, s52, 2
s_add_u32 s42, s42, s29
s_mul_i32 s42, s42, 114688
s_lshl_b32 s43, s53, 12
s_add_u32 s42, s42, s43
s_add_u32 s42, s42, 100663296
s_nop 7
v_accvgpr_read_b32 v48, a0
v_accvgpr_read_b32 v52, a4
v_accvgpr_read_b32 v49, a1
v_accvgpr_read_b32 v53, a5
v_accvgpr_read_b32 v50, a2
v_accvgpr_read_b32 v54, a6
v_accvgpr_read_b32 v51, a3
v_accvgpr_read_b32 v55, a7
v_mov_b32 v64, s54
v_mul_f32 v56, v48, v48
v_mul_f32 v57, v49, v49
v_mul_f32 v58, v50, v50
v_mul_f32 v59, v51, v51
v_mul_f32 v60, v52, v52
v_mul_f32 v61, v53, v53
v_mul_f32 v62, v54, v54
v_mul_f32 v63, v55, v55
v_fma_f32 v56, v56, s55, v64
v_fma_f32 v57, v57, s55, v64
v_fma_f32 v58, v58, s55, v64
v_fma_f32 v59, v59, s55, v64
v_fma_f32 v60, v60, s55, v64
v_fma_f32 v61, v61, s55, v64
v_fma_f32 v62, v62, s55, v64
v_fma_f32 v63, v63, s55, v64
v_mul_f32 v56, v56, v48
v_mul_f32 v57, v57, v49
v_mul_f32 v58, v58, v50
v_mul_f32 v59, v59, v51
v_mul_f32 v60, v60, v52
v_mul_f32 v61, v61, v53
v_mul_f32 v62, v62, v54
v_mul_f32 v63, v63, v55
v_exp_f32 v56, v56
v_exp_f32 v57, v57
v_exp_f32 v58, v58
v_exp_f32 v59, v59
v_exp_f32 v60, v60
v_exp_f32 v61, v61
v_exp_f32 v62, v62
v_exp_f32 v63, v63
v_add_f32 v56, 1.0, v56
v_add_f32 v57, 1.0, v57
v_add_f32 v58, 1.0, v58
v_add_f32 v59, 1.0, v59
v_add_f32 v60, 1.0, v60
v_add_f32 v61, 1.0, v61
v_add_f32 v62, 1.0, v62
v_add_f32 v63, 1.0, v63
v_rcp_f32 v56, v56
v_rcp_f32 v57, v57
v_rcp_f32 v58, v58
v_rcp_f32 v59, v59
v_rcp_f32 v60, v60
v_rcp_f32 v61, v61
v_rcp_f32 v62, v62
v_rcp_f32 v63, v63
s_nop 0
v_mul_f32 v48, v48, v56
v_mul_f32 v49, v49, v57
v_mul_f32 v50, v50, v58
v_mul_f32 v51, v51, v59
v_mul_f32 v52, v52, v60
v_mul_f32 v53, v53, v61
v_mul_f32 v54, v54, v62
v_mul_f32 v55, v55, v63
v_cvt_pk_bf16_f32 v68, v48, v49
v_cvt_pk_bf16_f32 v69, v50, v51
v_cvt_pk_bf16_f32 v70, v52, v53
v_cvt_pk_bf16_f32 v71, v54, v55
s_add_u32 s43, s42, 0
buffer_store_dwordx4 v[68:71], v1, s[8:11], s43 offen offset:0 sc1
v_accvgpr_read_b32 v72, a8
v_accvgpr_read_b32 v76, a12
v_accvgpr_read_b32 v73, a9
v_accvgpr_read_b32 v77, a13
v_accvgpr_read_b32 v74, a10
v_accvgpr_read_b32 v78, a14
v_accvgpr_read_b32 v75, a11
v_accvgpr_read_b32 v79, a15
v_mov_b32 v88, s54
v_mul_f32 v80, v72, v72
v_mul_f32 v81, v73, v73
v_mul_f32 v82, v74, v74
v_mul_f32 v83, v75, v75
v_mul_f32 v84, v76, v76
v_mul_f32 v85, v77, v77
v_mul_f32 v86, v78, v78
v_mul_f32 v87, v79, v79
v_fma_f32 v80, v80, s55, v88
v_fma_f32 v81, v81, s55, v88
v_fma_f32 v82, v82, s55, v88
v_fma_f32 v83, v83, s55, v88
v_fma_f32 v84, v84, s55, v88
v_fma_f32 v85, v85, s55, v88
v_fma_f32 v86, v86, s55, v88
v_fma_f32 v87, v87, s55, v88
v_mul_f32 v80, v80, v72
v_mul_f32 v81, v81, v73
v_mul_f32 v82, v82, v74
v_mul_f32 v83, v83, v75
v_mul_f32 v84, v84, v76
v_mul_f32 v85, v85, v77
v_mul_f32 v86, v86, v78
v_mul_f32 v87, v87, v79
v_exp_f32 v80, v80
v_exp_f32 v81, v81
v_exp_f32 v82, v82
v_exp_f32 v83, v83
v_exp_f32 v84, v84
v_exp_f32 v85, v85
v_exp_f32 v86, v86
v_exp_f32 v87, v87
v_add_f32 v80, 1.0, v80
v_add_f32 v81, 1.0, v81
v_add_f32 v82, 1.0, v82
v_add_f32 v83, 1.0, v83
v_add_f32 v84, 1.0, v84
v_add_f32 v85, 1.0, v85
v_add_f32 v86, 1.0, v86
v_add_f32 v87, 1.0, v87
v_rcp_f32 v80, v80
v_rcp_f32 v81, v81
v_rcp_f32 v82, v82
v_rcp_f32 v83, v83
v_rcp_f32 v84, v84
v_rcp_f32 v85, v85
v_rcp_f32 v86, v86
v_rcp_f32 v87, v87
s_nop 0
v_mul_f32 v72, v72, v80
v_mul_f32 v73, v73, v81
v_mul_f32 v74, v74, v82
v_mul_f32 v75, v75, v83
v_mul_f32 v76, v76, v84
v_mul_f32 v77, v77, v85
v_mul_f32 v78, v78, v86
v_mul_f32 v79, v79, v87
v_cvt_pk_bf16_f32 v92, v72, v73
v_cvt_pk_bf16_f32 v93, v74, v75
v_cvt_pk_bf16_f32 v94, v76, v77
v_cvt_pk_bf16_f32 v95, v78, v79
s_add_u32 s43, s42, 0
buffer_store_dwordx4 v[92:95], v1, s[8:11], s43 offen offset:1024 sc1
v_accvgpr_read_b32 v48, a16
v_accvgpr_read_b32 v52, a20
v_accvgpr_read_b32 v49, a17
v_accvgpr_read_b32 v53, a21
v_accvgpr_read_b32 v50, a18
v_accvgpr_read_b32 v54, a22
v_accvgpr_read_b32 v51, a19
v_accvgpr_read_b32 v55, a23
v_mov_b32 v64, s54
v_mul_f32 v56, v48, v48
v_mul_f32 v57, v49, v49
v_mul_f32 v58, v50, v50
v_mul_f32 v59, v51, v51
v_mul_f32 v60, v52, v52
v_mul_f32 v61, v53, v53
v_mul_f32 v62, v54, v54
v_mul_f32 v63, v55, v55
v_fma_f32 v56, v56, s55, v64
v_fma_f32 v57, v57, s55, v64
v_fma_f32 v58, v58, s55, v64
v_fma_f32 v59, v59, s55, v64
v_fma_f32 v60, v60, s55, v64
v_fma_f32 v61, v61, s55, v64
v_fma_f32 v62, v62, s55, v64
v_fma_f32 v63, v63, s55, v64
v_mul_f32 v56, v56, v48
v_mul_f32 v57, v57, v49
v_mul_f32 v58, v58, v50
v_mul_f32 v59, v59, v51
v_mul_f32 v60, v60, v52
v_mul_f32 v61, v61, v53
v_mul_f32 v62, v62, v54
v_mul_f32 v63, v63, v55
v_exp_f32 v56, v56
v_exp_f32 v57, v57
v_exp_f32 v58, v58
v_exp_f32 v59, v59
v_exp_f32 v60, v60
v_exp_f32 v61, v61
v_exp_f32 v62, v62
v_exp_f32 v63, v63
v_add_f32 v56, 1.0, v56
v_add_f32 v57, 1.0, v57
v_add_f32 v58, 1.0, v58
v_add_f32 v59, 1.0, v59
v_add_f32 v60, 1.0, v60
v_add_f32 v61, 1.0, v61
v_add_f32 v62, 1.0, v62
v_add_f32 v63, 1.0, v63
v_rcp_f32 v56, v56
v_rcp_f32 v57, v57
v_rcp_f32 v58, v58
v_rcp_f32 v59, v59
v_rcp_f32 v60, v60
v_rcp_f32 v61, v61
v_rcp_f32 v62, v62
v_rcp_f32 v63, v63
s_nop 0
v_mul_f32 v48, v48, v56
v_mul_f32 v49, v49, v57
v_mul_f32 v50, v50, v58
v_mul_f32 v51, v51, v59
v_mul_f32 v52, v52, v60
v_mul_f32 v53, v53, v61
v_mul_f32 v54, v54, v62
v_mul_f32 v55, v55, v63
v_cvt_pk_bf16_f32 v68, v48, v49
v_cvt_pk_bf16_f32 v69, v50, v51
v_cvt_pk_bf16_f32 v70, v52, v53
v_cvt_pk_bf16_f32 v71, v54, v55
s_add_u32 s43, s42, 0
buffer_store_dwordx4 v[68:71], v1, s[8:11], s43 offen offset:2048 sc1
v_accvgpr_read_b32 v72, a24
v_accvgpr_read_b32 v76, a28
v_accvgpr_read_b32 v73, a25
v_accvgpr_read_b32 v77, a29
v_accvgpr_read_b32 v74, a26
v_accvgpr_read_b32 v78, a30
v_accvgpr_read_b32 v75, a27
v_accvgpr_read_b32 v79, a31
v_mov_b32 v88, s54
v_mul_f32 v80, v72, v72
v_mul_f32 v81, v73, v73
v_mul_f32 v82, v74, v74
v_mul_f32 v83, v75, v75
v_mul_f32 v84, v76, v76
v_mul_f32 v85, v77, v77
v_mul_f32 v86, v78, v78
v_mul_f32 v87, v79, v79
v_fma_f32 v80, v80, s55, v88
v_fma_f32 v81, v81, s55, v88
v_fma_f32 v82, v82, s55, v88
v_fma_f32 v83, v83, s55, v88
v_fma_f32 v84, v84, s55, v88
v_fma_f32 v85, v85, s55, v88
v_fma_f32 v86, v86, s55, v88
v_fma_f32 v87, v87, s55, v88
v_mul_f32 v80, v80, v72
v_mul_f32 v81, v81, v73
v_mul_f32 v82, v82, v74
v_mul_f32 v83, v83, v75
v_mul_f32 v84, v84, v76
v_mul_f32 v85, v85, v77
v_mul_f32 v86, v86, v78
v_mul_f32 v87, v87, v79
v_exp_f32 v80, v80
v_exp_f32 v81, v81
v_exp_f32 v82, v82
v_exp_f32 v83, v83
v_exp_f32 v84, v84
v_exp_f32 v85, v85
v_exp_f32 v86, v86
v_exp_f32 v87, v87
v_add_f32 v80, 1.0, v80
v_add_f32 v81, 1.0, v81
v_add_f32 v82, 1.0, v82
v_add_f32 v83, 1.0, v83
v_add_f32 v84, 1.0, v84
v_add_f32 v85, 1.0, v85
v_add_f32 v86, 1.0, v86
v_add_f32 v87, 1.0, v87
v_rcp_f32 v80, v80
v_rcp_f32 v81, v81
v_rcp_f32 v82, v82
v_rcp_f32 v83, v83
v_rcp_f32 v84, v84
v_rcp_f32 v85, v85
v_rcp_f32 v86, v86
v_rcp_f32 v87, v87
s_nop 0
v_mul_f32 v72, v72, v80
v_mul_f32 v73, v73, v81
v_mul_f32 v74, v74, v82
v_mul_f32 v75, v75, v83
v_mul_f32 v76, v76, v84
v_mul_f32 v77, v77, v85
v_mul_f32 v78, v78, v86
v_mul_f32 v79, v79, v87
v_cvt_pk_bf16_f32 v92, v72, v73
v_cvt_pk_bf16_f32 v93, v74, v75
v_cvt_pk_bf16_f32 v94, v76, v77
v_cvt_pk_bf16_f32 v95, v78, v79
s_add_u32 s43, s42, 0
buffer_store_dwordx4 v[92:95], v1, s[8:11], s43 offen offset:3072 sc1
v_accvgpr_read_b32 v48, a32
v_accvgpr_read_b32 v52, a36
v_accvgpr_read_b32 v49, a33
v_accvgpr_read_b32 v53, a37
v_accvgpr_read_b32 v50, a34
v_accvgpr_read_b32 v54, a38
v_accvgpr_read_b32 v51, a35
v_accvgpr_read_b32 v55, a39
v_mov_b32 v64, s54
v_mul_f32 v56, v48, v48
v_mul_f32 v57, v49, v49
v_mul_f32 v58, v50, v50
v_mul_f32 v59, v51, v51
v_mul_f32 v60, v52, v52
v_mul_f32 v61, v53, v53
v_mul_f32 v62, v54, v54
v_mul_f32 v63, v55, v55
v_fma_f32 v56, v56, s55, v64
v_fma_f32 v57, v57, s55, v64
v_fma_f32 v58, v58, s55, v64
v_fma_f32 v59, v59, s55, v64
v_fma_f32 v60, v60, s55, v64
v_fma_f32 v61, v61, s55, v64
v_fma_f32 v62, v62, s55, v64
v_fma_f32 v63, v63, s55, v64
v_mul_f32 v56, v56, v48
v_mul_f32 v57, v57, v49
v_mul_f32 v58, v58, v50
v_mul_f32 v59, v59, v51
v_mul_f32 v60, v60, v52
v_mul_f32 v61, v61, v53
v_mul_f32 v62, v62, v54
v_mul_f32 v63, v63, v55
v_exp_f32 v56, v56
v_exp_f32 v57, v57
v_exp_f32 v58, v58
v_exp_f32 v59, v59
v_exp_f32 v60, v60
v_exp_f32 v61, v61
v_exp_f32 v62, v62
v_exp_f32 v63, v63
v_add_f32 v56, 1.0, v56
v_add_f32 v57, 1.0, v57
v_add_f32 v58, 1.0, v58
v_add_f32 v59, 1.0, v59
v_add_f32 v60, 1.0, v60
v_add_f32 v61, 1.0, v61
v_add_f32 v62, 1.0, v62
v_add_f32 v63, 1.0, v63
v_rcp_f32 v56, v56
v_rcp_f32 v57, v57
v_rcp_f32 v58, v58
v_rcp_f32 v59, v59
v_rcp_f32 v60, v60
v_rcp_f32 v61, v61
v_rcp_f32 v62, v62
v_rcp_f32 v63, v63
s_nop 0
v_mul_f32 v48, v48, v56
v_mul_f32 v49, v49, v57
v_mul_f32 v50, v50, v58
v_mul_f32 v51, v51, v59
v_mul_f32 v52, v52, v60
v_mul_f32 v53, v53, v61
v_mul_f32 v54, v54, v62
v_mul_f32 v55, v55, v63
v_cvt_pk_bf16_f32 v68, v48, v49
v_cvt_pk_bf16_f32 v69, v50, v51
v_cvt_pk_bf16_f32 v70, v52, v53
v_cvt_pk_bf16_f32 v71, v54, v55
s_add_u32 s43, s42, 28672
buffer_store_dwordx4 v[68:71], v1, s[8:11], s43 offen offset:0 sc1
v_accvgpr_read_b32 v72, a40
v_accvgpr_read_b32 v76, a44
v_accvgpr_read_b32 v73, a41
v_accvgpr_read_b32 v77, a45
v_accvgpr_read_b32 v74, a42
v_accvgpr_read_b32 v78, a46
v_accvgpr_read_b32 v75, a43
v_accvgpr_read_b32 v79, a47
v_mov_b32 v88, s54
v_mul_f32 v80, v72, v72
v_mul_f32 v81, v73, v73
v_mul_f32 v82, v74, v74
v_mul_f32 v83, v75, v75
v_mul_f32 v84, v76, v76
v_mul_f32 v85, v77, v77
v_mul_f32 v86, v78, v78
v_mul_f32 v87, v79, v79
v_fma_f32 v80, v80, s55, v88
v_fma_f32 v81, v81, s55, v88
v_fma_f32 v82, v82, s55, v88
v_fma_f32 v83, v83, s55, v88
v_fma_f32 v84, v84, s55, v88
v_fma_f32 v85, v85, s55, v88
v_fma_f32 v86, v86, s55, v88
v_fma_f32 v87, v87, s55, v88
v_mul_f32 v80, v80, v72
v_mul_f32 v81, v81, v73
v_mul_f32 v82, v82, v74
v_mul_f32 v83, v83, v75
v_mul_f32 v84, v84, v76
v_mul_f32 v85, v85, v77
v_mul_f32 v86, v86, v78
v_mul_f32 v87, v87, v79
v_exp_f32 v80, v80
v_exp_f32 v81, v81
v_exp_f32 v82, v82
v_exp_f32 v83, v83
v_exp_f32 v84, v84
v_exp_f32 v85, v85
v_exp_f32 v86, v86
v_exp_f32 v87, v87
v_add_f32 v80, 1.0, v80
v_add_f32 v81, 1.0, v81
v_add_f32 v82, 1.0, v82
v_add_f32 v83, 1.0, v83
v_add_f32 v84, 1.0, v84
v_add_f32 v85, 1.0, v85
v_add_f32 v86, 1.0, v86
v_add_f32 v87, 1.0, v87
v_rcp_f32 v80, v80
v_rcp_f32 v81, v81
v_rcp_f32 v82, v82
v_rcp_f32 v83, v83
v_rcp_f32 v84, v84
v_rcp_f32 v85, v85
v_rcp_f32 v86, v86
v_rcp_f32 v87, v87
s_nop 0
v_mul_f32 v72, v72, v80
v_mul_f32 v73, v73, v81
v_mul_f32 v74, v74, v82
v_mul_f32 v75, v75, v83
v_mul_f32 v76, v76, v84
v_mul_f32 v77, v77, v85
v_mul_f32 v78, v78, v86
v_mul_f32 v79, v79, v87
v_cvt_pk_bf16_f32 v92, v72, v73
v_cvt_pk_bf16_f32 v93, v74, v75
v_cvt_pk_bf16_f32 v94, v76, v77
v_cvt_pk_bf16_f32 v95, v78, v79
s_add_u32 s43, s42, 28672
buffer_store_dwordx4 v[92:95], v1, s[8:11], s43 offen offset:1024 sc1
v_accvgpr_read_b32 v48, a48
v_accvgpr_read_b32 v52, a52
v_accvgpr_read_b32 v49, a49
v_accvgpr_read_b32 v53, a53
v_accvgpr_read_b32 v50, a50
v_accvgpr_read_b32 v54, a54
v_accvgpr_read_b32 v51, a51
v_accvgpr_read_b32 v55, a55
v_mov_b32 v64, s54
v_mul_f32 v56, v48, v48
v_mul_f32 v57, v49, v49
v_mul_f32 v58, v50, v50
v_mul_f32 v59, v51, v51
v_mul_f32 v60, v52, v52
v_mul_f32 v61, v53, v53
v_mul_f32 v62, v54, v54
v_mul_f32 v63, v55, v55
v_fma_f32 v56, v56, s55, v64
v_fma_f32 v57, v57, s55, v64
v_fma_f32 v58, v58, s55, v64
v_fma_f32 v59, v59, s55, v64
v_fma_f32 v60, v60, s55, v64
v_fma_f32 v61, v61, s55, v64
v_fma_f32 v62, v62, s55, v64
v_fma_f32 v63, v63, s55, v64
v_mul_f32 v56, v56, v48
v_mul_f32 v57, v57, v49
v_mul_f32 v58, v58, v50
v_mul_f32 v59, v59, v51
v_mul_f32 v60, v60, v52
v_mul_f32 v61, v61, v53
v_mul_f32 v62, v62, v54
v_mul_f32 v63, v63, v55
v_exp_f32 v56, v56
v_exp_f32 v57, v57
v_exp_f32 v58, v58
v_exp_f32 v59, v59
v_exp_f32 v60, v60
v_exp_f32 v61, v61
v_exp_f32 v62, v62
v_exp_f32 v63, v63
v_add_f32 v56, 1.0, v56
v_add_f32 v57, 1.0, v57
v_add_f32 v58, 1.0, v58
v_add_f32 v59, 1.0, v59
v_add_f32 v60, 1.0, v60
v_add_f32 v61, 1.0, v61
v_add_f32 v62, 1.0, v62
v_add_f32 v63, 1.0, v63
v_rcp_f32 v56, v56
v_rcp_f32 v57, v57
v_rcp_f32 v58, v58
v_rcp_f32 v59, v59
v_rcp_f32 v60, v60
v_rcp_f32 v61, v61
v_rcp_f32 v62, v62
v_rcp_f32 v63, v63
s_nop 0
v_mul_f32 v48, v48, v56
v_mul_f32 v49, v49, v57
v_mul_f32 v50, v50, v58
v_mul_f32 v51, v51, v59
v_mul_f32 v52, v52, v60
v_mul_f32 v53, v53, v61
v_mul_f32 v54, v54, v62
v_mul_f32 v55, v55, v63
v_cvt_pk_bf16_f32 v68, v48, v49
v_cvt_pk_bf16_f32 v69, v50, v51
v_cvt_pk_bf16_f32 v70, v52, v53
v_cvt_pk_bf16_f32 v71, v54, v55
s_add_u32 s43, s42, 28672
buffer_store_dwordx4 v[68:71], v1, s[8:11], s43 offen offset:2048 sc1
v_accvgpr_read_b32 v72, a56
v_accvgpr_read_b32 v76, a60
v_accvgpr_read_b32 v73, a57
v_accvgpr_read_b32 v77, a61
v_accvgpr_read_b32 v74, a58
v_accvgpr_read_b32 v78, a62
v_accvgpr_read_b32 v75, a59
v_accvgpr_read_b32 v79, a63
v_mov_b32 v88, s54
v_mul_f32 v80, v72, v72
v_mul_f32 v81, v73, v73
v_mul_f32 v82, v74, v74
v_mul_f32 v83, v75, v75
v_mul_f32 v84, v76, v76
v_mul_f32 v85, v77, v77
v_mul_f32 v86, v78, v78
v_mul_f32 v87, v79, v79
v_fma_f32 v80, v80, s55, v88
v_fma_f32 v81, v81, s55, v88
v_fma_f32 v82, v82, s55, v88
v_fma_f32 v83, v83, s55, v88
v_fma_f32 v84, v84, s55, v88
v_fma_f32 v85, v85, s55, v88
v_fma_f32 v86, v86, s55, v88
v_fma_f32 v87, v87, s55, v88
v_mul_f32 v80, v80, v72
v_mul_f32 v81, v81, v73
v_mul_f32 v82, v82, v74
v_mul_f32 v83, v83, v75
v_mul_f32 v84, v84, v76
v_mul_f32 v85, v85, v77
v_mul_f32 v86, v86, v78
v_mul_f32 v87, v87, v79
v_exp_f32 v80, v80
v_exp_f32 v81, v81
v_exp_f32 v82, v82
v_exp_f32 v83, v83
v_exp_f32 v84, v84
v_exp_f32 v85, v85
v_exp_f32 v86, v86
v_exp_f32 v87, v87
v_add_f32 v80, 1.0, v80
v_add_f32 v81, 1.0, v81
v_add_f32 v82, 1.0, v82
v_add_f32 v83, 1.0, v83
v_add_f32 v84, 1.0, v84
v_add_f32 v85, 1.0, v85
v_add_f32 v86, 1.0, v86
v_add_f32 v87, 1.0, v87
v_rcp_f32 v80, v80
v_rcp_f32 v81, v81
v_rcp_f32 v82, v82
v_rcp_f32 v83, v83
v_rcp_f32 v84, v84
v_rcp_f32 v85, v85
v_rcp_f32 v86, v86
v_rcp_f32 v87, v87
s_nop 0
v_mul_f32 v72, v72, v80
v_mul_f32 v73, v73, v81
v_mul_f32 v74, v74, v82
v_mul_f32 v75, v75, v83
v_mul_f32 v76, v76, v84
v_mul_f32 v77, v77, v85
v_mul_f32 v78, v78, v86
v_mul_f32 v79, v79, v87
v_cvt_pk_bf16_f32 v92, v72, v73
v_cvt_pk_bf16_f32 v93, v74, v75
v_cvt_pk_bf16_f32 v94, v76, v77
v_cvt_pk_bf16_f32 v95, v78, v79
s_add_u32 s43, s42, 28672
buffer_store_dwordx4 v[92:95], v1, s[8:11], s43 offen offset:3072 sc1
v_accvgpr_read_b32 v48, a64
v_accvgpr_read_b32 v52, a68
v_accvgpr_read_b32 v49, a65
v_accvgpr_read_b32 v53, a69
v_accvgpr_read_b32 v50, a66
v_accvgpr_read_b32 v54, a70
v_accvgpr_read_b32 v51, a67
v_accvgpr_read_b32 v55, a71
v_mov_b32 v64, s54
v_mul_f32 v56, v48, v48
v_mul_f32 v57, v49, v49
v_mul_f32 v58, v50, v50
v_mul_f32 v59, v51, v51
v_mul_f32 v60, v52, v52
v_mul_f32 v61, v53, v53
v_mul_f32 v62, v54, v54
v_mul_f32 v63, v55, v55
v_fma_f32 v56, v56, s55, v64
v_fma_f32 v57, v57, s55, v64
v_fma_f32 v58, v58, s55, v64
v_fma_f32 v59, v59, s55, v64
v_fma_f32 v60, v60, s55, v64
v_fma_f32 v61, v61, s55, v64
v_fma_f32 v62, v62, s55, v64
v_fma_f32 v63, v63, s55, v64
v_mul_f32 v56, v56, v48
v_mul_f32 v57, v57, v49
v_mul_f32 v58, v58, v50
v_mul_f32 v59, v59, v51
v_mul_f32 v60, v60, v52
v_mul_f32 v61, v61, v53
v_mul_f32 v62, v62, v54
v_mul_f32 v63, v63, v55
v_exp_f32 v56, v56
v_exp_f32 v57, v57
v_exp_f32 v58, v58
v_exp_f32 v59, v59
v_exp_f32 v60, v60
v_exp_f32 v61, v61
v_exp_f32 v62, v62
v_exp_f32 v63, v63
v_add_f32 v56, 1.0, v56
v_add_f32 v57, 1.0, v57
v_add_f32 v58, 1.0, v58
v_add_f32 v59, 1.0, v59
v_add_f32 v60, 1.0, v60
v_add_f32 v61, 1.0, v61
v_add_f32 v62, 1.0, v62
v_add_f32 v63, 1.0, v63
v_rcp_f32 v56, v56
v_rcp_f32 v57, v57
v_rcp_f32 v58, v58
v_rcp_f32 v59, v59
v_rcp_f32 v60, v60
v_rcp_f32 v61, v61
v_rcp_f32 v62, v62
v_rcp_f32 v63, v63
s_nop 0
v_mul_f32 v48, v48, v56
v_mul_f32 v49, v49, v57
v_mul_f32 v50, v50, v58
v_mul_f32 v51, v51, v59
v_mul_f32 v52, v52, v60
v_mul_f32 v53, v53, v61
v_mul_f32 v54, v54, v62
v_mul_f32 v55, v55, v63
v_cvt_pk_bf16_f32 v68, v48, v49
v_cvt_pk_bf16_f32 v69, v50, v51
v_cvt_pk_bf16_f32 v70, v52, v53
v_cvt_pk_bf16_f32 v71, v54, v55
s_add_u32 s43, s42, 57344
buffer_store_dwordx4 v[68:71], v1, s[8:11], s43 offen offset:0 sc1
v_accvgpr_read_b32 v72, a72
v_accvgpr_read_b32 v76, a76
v_accvgpr_read_b32 v73, a73
v_accvgpr_read_b32 v77, a77
v_accvgpr_read_b32 v74, a74
v_accvgpr_read_b32 v78, a78
v_accvgpr_read_b32 v75, a75
v_accvgpr_read_b32 v79, a79
v_mov_b32 v88, s54
v_mul_f32 v80, v72, v72
v_mul_f32 v81, v73, v73
v_mul_f32 v82, v74, v74
v_mul_f32 v83, v75, v75
v_mul_f32 v84, v76, v76
v_mul_f32 v85, v77, v77
v_mul_f32 v86, v78, v78
v_mul_f32 v87, v79, v79
v_fma_f32 v80, v80, s55, v88
v_fma_f32 v81, v81, s55, v88
v_fma_f32 v82, v82, s55, v88
v_fma_f32 v83, v83, s55, v88
v_fma_f32 v84, v84, s55, v88
v_fma_f32 v85, v85, s55, v88
v_fma_f32 v86, v86, s55, v88
v_fma_f32 v87, v87, s55, v88
v_mul_f32 v80, v80, v72
v_mul_f32 v81, v81, v73
v_mul_f32 v82, v82, v74
v_mul_f32 v83, v83, v75
v_mul_f32 v84, v84, v76
v_mul_f32 v85, v85, v77
v_mul_f32 v86, v86, v78
v_mul_f32 v87, v87, v79
v_exp_f32 v80, v80
v_exp_f32 v81, v81
v_exp_f32 v82, v82
v_exp_f32 v83, v83
v_exp_f32 v84, v84
v_exp_f32 v85, v85
v_exp_f32 v86, v86
v_exp_f32 v87, v87
v_add_f32 v80, 1.0, v80
v_add_f32 v81, 1.0, v81
v_add_f32 v82, 1.0, v82
v_add_f32 v83, 1.0, v83
v_add_f32 v84, 1.0, v84
v_add_f32 v85, 1.0, v85
v_add_f32 v86, 1.0, v86
v_add_f32 v87, 1.0, v87
v_rcp_f32 v80, v80
v_rcp_f32 v81, v81
v_rcp_f32 v82, v82
v_rcp_f32 v83, v83
v_rcp_f32 v84, v84
v_rcp_f32 v85, v85
v_rcp_f32 v86, v86
v_rcp_f32 v87, v87
s_nop 0
v_mul_f32 v72, v72, v80
v_mul_f32 v73, v73, v81
v_mul_f32 v74, v74, v82
v_mul_f32 v75, v75, v83
v_mul_f32 v76, v76, v84
v_mul_f32 v77, v77, v85
v_mul_f32 v78, v78, v86
v_mul_f32 v79, v79, v87
v_cvt_pk_bf16_f32 v92, v72, v73
v_cvt_pk_bf16_f32 v93, v74, v75
v_cvt_pk_bf16_f32 v94, v76, v77
v_cvt_pk_bf16_f32 v95, v78, v79
s_add_u32 s43, s42, 57344
buffer_store_dwordx4 v[92:95], v1, s[8:11], s43 offen offset:1024 sc1
v_accvgpr_read_b32 v48, a80
v_accvgpr_read_b32 v52, a84
v_accvgpr_read_b32 v49, a81
v_accvgpr_read_b32 v53, a85
v_accvgpr_read_b32 v50, a82
v_accvgpr_read_b32 v54, a86
v_accvgpr_read_b32 v51, a83
v_accvgpr_read_b32 v55, a87
v_mov_b32 v64, s54
v_mul_f32 v56, v48, v48
v_mul_f32 v57, v49, v49
v_mul_f32 v58, v50, v50
v_mul_f32 v59, v51, v51
v_mul_f32 v60, v52, v52
v_mul_f32 v61, v53, v53
v_mul_f32 v62, v54, v54
v_mul_f32 v63, v55, v55
v_fma_f32 v56, v56, s55, v64
v_fma_f32 v57, v57, s55, v64
v_fma_f32 v58, v58, s55, v64
v_fma_f32 v59, v59, s55, v64
v_fma_f32 v60, v60, s55, v64
v_fma_f32 v61, v61, s55, v64
v_fma_f32 v62, v62, s55, v64
v_fma_f32 v63, v63, s55, v64
v_mul_f32 v56, v56, v48
v_mul_f32 v57, v57, v49
v_mul_f32 v58, v58, v50
v_mul_f32 v59, v59, v51
v_mul_f32 v60, v60, v52
v_mul_f32 v61, v61, v53
v_mul_f32 v62, v62, v54
v_mul_f32 v63, v63, v55
v_exp_f32 v56, v56
v_exp_f32 v57, v57
v_exp_f32 v58, v58
v_exp_f32 v59, v59
v_exp_f32 v60, v60
v_exp_f32 v61, v61
v_exp_f32 v62, v62
v_exp_f32 v63, v63
v_add_f32 v56, 1.0, v56
v_add_f32 v57, 1.0, v57
v_add_f32 v58, 1.0, v58
v_add_f32 v59, 1.0, v59
v_add_f32 v60, 1.0, v60
v_add_f32 v61, 1.0, v61
v_add_f32 v62, 1.0, v62
v_add_f32 v63, 1.0, v63
v_rcp_f32 v56, v56
v_rcp_f32 v57, v57
v_rcp_f32 v58, v58
v_rcp_f32 v59, v59
v_rcp_f32 v60, v60
v_rcp_f32 v61, v61
v_rcp_f32 v62, v62
v_rcp_f32 v63, v63
s_nop 0
v_mul_f32 v48, v48, v56
v_mul_f32 v49, v49, v57
v_mul_f32 v50, v50, v58
v_mul_f32 v51, v51, v59
v_mul_f32 v52, v52, v60
v_mul_f32 v53, v53, v61
v_mul_f32 v54, v54, v62
v_mul_f32 v55, v55, v63
v_cvt_pk_bf16_f32 v68, v48, v49
v_cvt_pk_bf16_f32 v69, v50, v51
v_cvt_pk_bf16_f32 v70, v52, v53
v_cvt_pk_bf16_f32 v71, v54, v55
s_add_u32 s43, s42, 57344
buffer_store_dwordx4 v[68:71], v1, s[8:11], s43 offen offset:2048 sc1
v_accvgpr_read_b32 v72, a88
v_accvgpr_read_b32 v76, a92
v_accvgpr_read_b32 v73, a89
v_accvgpr_read_b32 v77, a93
v_accvgpr_read_b32 v74, a90
v_accvgpr_read_b32 v78, a94
v_accvgpr_read_b32 v75, a91
v_accvgpr_read_b32 v79, a95
v_mov_b32 v88, s54
v_mul_f32 v80, v72, v72
v_mul_f32 v81, v73, v73
v_mul_f32 v82, v74, v74
v_mul_f32 v83, v75, v75
v_mul_f32 v84, v76, v76
v_mul_f32 v85, v77, v77
v_mul_f32 v86, v78, v78
v_mul_f32 v87, v79, v79
v_fma_f32 v80, v80, s55, v88
v_fma_f32 v81, v81, s55, v88
v_fma_f32 v82, v82, s55, v88
v_fma_f32 v83, v83, s55, v88
v_fma_f32 v84, v84, s55, v88
v_fma_f32 v85, v85, s55, v88
v_fma_f32 v86, v86, s55, v88
v_fma_f32 v87, v87, s55, v88
v_mul_f32 v80, v80, v72
v_mul_f32 v81, v81, v73
v_mul_f32 v82, v82, v74
v_mul_f32 v83, v83, v75
v_mul_f32 v84, v84, v76
v_mul_f32 v85, v85, v77
v_mul_f32 v86, v86, v78
v_mul_f32 v87, v87, v79
v_exp_f32 v80, v80
v_exp_f32 v81, v81
v_exp_f32 v82, v82
v_exp_f32 v83, v83
v_exp_f32 v84, v84
v_exp_f32 v85, v85
v_exp_f32 v86, v86
v_exp_f32 v87, v87
v_add_f32 v80, 1.0, v80
v_add_f32 v81, 1.0, v81
v_add_f32 v82, 1.0, v82
v_add_f32 v83, 1.0, v83
v_add_f32 v84, 1.0, v84
v_add_f32 v85, 1.0, v85
v_add_f32 v86, 1.0, v86
v_add_f32 v87, 1.0, v87
v_rcp_f32 v80, v80
v_rcp_f32 v81, v81
v_rcp_f32 v82, v82
v_rcp_f32 v83, v83
v_rcp_f32 v84, v84
v_rcp_f32 v85, v85
v_rcp_f32 v86, v86
v_rcp_f32 v87, v87
s_nop 0
v_mul_f32 v72, v72, v80
v_mul_f32 v73, v73, v81
v_mul_f32 v74, v74, v82
v_mul_f32 v75, v75, v83
v_mul_f32 v76, v76, v84
v_mul_f32 v77, v77, v85
v_mul_f32 v78, v78, v86
v_mul_f32 v79, v79, v87
v_cvt_pk_bf16_f32 v92, v72, v73
v_cvt_pk_bf16_f32 v93, v74, v75
v_cvt_pk_bf16_f32 v94, v76, v77
v_cvt_pk_bf16_f32 v95, v78, v79
s_add_u32 s43, s42, 57344
buffer_store_dwordx4 v[92:95], v1, s[8:11], s43 offen offset:3072 sc1
v_accvgpr_read_b32 v48, a96
v_accvgpr_read_b32 v52, a100
v_accvgpr_read_b32 v49, a97
v_accvgpr_read_b32 v53, a101
v_accvgpr_read_b32 v50, a98
v_accvgpr_read_b32 v54, a102
v_accvgpr_read_b32 v51, a99
v_accvgpr_read_b32 v55, a103
v_mov_b32 v64, s54
v_mul_f32 v56, v48, v48
v_mul_f32 v57, v49, v49
v_mul_f32 v58, v50, v50
v_mul_f32 v59, v51, v51
v_mul_f32 v60, v52, v52
v_mul_f32 v61, v53, v53
v_mul_f32 v62, v54, v54
v_mul_f32 v63, v55, v55
v_fma_f32 v56, v56, s55, v64
v_fma_f32 v57, v57, s55, v64
v_fma_f32 v58, v58, s55, v64
v_fma_f32 v59, v59, s55, v64
v_fma_f32 v60, v60, s55, v64
v_fma_f32 v61, v61, s55, v64
v_fma_f32 v62, v62, s55, v64
v_fma_f32 v63, v63, s55, v64
v_mul_f32 v56, v56, v48
v_mul_f32 v57, v57, v49
v_mul_f32 v58, v58, v50
v_mul_f32 v59, v59, v51
v_mul_f32 v60, v60, v52
v_mul_f32 v61, v61, v53
v_mul_f32 v62, v62, v54
v_mul_f32 v63, v63, v55
v_exp_f32 v56, v56
v_exp_f32 v57, v57
v_exp_f32 v58, v58
v_exp_f32 v59, v59
v_exp_f32 v60, v60
v_exp_f32 v61, v61
v_exp_f32 v62, v62
v_exp_f32 v63, v63
v_add_f32 v56, 1.0, v56
v_add_f32 v57, 1.0, v57
v_add_f32 v58, 1.0, v58
v_add_f32 v59, 1.0, v59
v_add_f32 v60, 1.0, v60
v_add_f32 v61, 1.0, v61
v_add_f32 v62, 1.0, v62
v_add_f32 v63, 1.0, v63
v_rcp_f32 v56, v56
v_rcp_f32 v57, v57
v_rcp_f32 v58, v58
v_rcp_f32 v59, v59
v_rcp_f32 v60, v60
v_rcp_f32 v61, v61
v_rcp_f32 v62, v62
v_rcp_f32 v63, v63
s_nop 0
v_mul_f32 v48, v48, v56
v_mul_f32 v49, v49, v57
v_mul_f32 v50, v50, v58
v_mul_f32 v51, v51, v59
v_mul_f32 v52, v52, v60
v_mul_f32 v53, v53, v61
v_mul_f32 v54, v54, v62
v_mul_f32 v55, v55, v63
v_cvt_pk_bf16_f32 v68, v48, v49
v_cvt_pk_bf16_f32 v69, v50, v51
v_cvt_pk_bf16_f32 v70, v52, v53
v_cvt_pk_bf16_f32 v71, v54, v55
s_add_u32 s43, s42, 86016
buffer_store_dwordx4 v[68:71], v1, s[8:11], s43 offen offset:0 sc1
v_accvgpr_read_b32 v72, a104
v_accvgpr_read_b32 v76, a108
v_accvgpr_read_b32 v73, a105
v_accvgpr_read_b32 v77, a109
v_accvgpr_read_b32 v74, a106
v_accvgpr_read_b32 v78, a110
v_accvgpr_read_b32 v75, a107
v_accvgpr_read_b32 v79, a111
v_mov_b32 v88, s54
v_mul_f32 v80, v72, v72
v_mul_f32 v81, v73, v73
v_mul_f32 v82, v74, v74
v_mul_f32 v83, v75, v75
v_mul_f32 v84, v76, v76
v_mul_f32 v85, v77, v77
v_mul_f32 v86, v78, v78
v_mul_f32 v87, v79, v79
v_fma_f32 v80, v80, s55, v88
v_fma_f32 v81, v81, s55, v88
v_fma_f32 v82, v82, s55, v88
v_fma_f32 v83, v83, s55, v88
v_fma_f32 v84, v84, s55, v88
v_fma_f32 v85, v85, s55, v88
v_fma_f32 v86, v86, s55, v88
v_fma_f32 v87, v87, s55, v88
v_mul_f32 v80, v80, v72
v_mul_f32 v81, v81, v73
v_mul_f32 v82, v82, v74
v_mul_f32 v83, v83, v75
v_mul_f32 v84, v84, v76
v_mul_f32 v85, v85, v77
v_mul_f32 v86, v86, v78
v_mul_f32 v87, v87, v79
v_exp_f32 v80, v80
v_exp_f32 v81, v81
v_exp_f32 v82, v82
v_exp_f32 v83, v83
v_exp_f32 v84, v84
v_exp_f32 v85, v85
v_exp_f32 v86, v86
v_exp_f32 v87, v87
v_add_f32 v80, 1.0, v80
v_add_f32 v81, 1.0, v81
v_add_f32 v82, 1.0, v82
v_add_f32 v83, 1.0, v83
v_add_f32 v84, 1.0, v84
v_add_f32 v85, 1.0, v85
v_add_f32 v86, 1.0, v86
v_add_f32 v87, 1.0, v87
v_rcp_f32 v80, v80
v_rcp_f32 v81, v81
v_rcp_f32 v82, v82
v_rcp_f32 v83, v83
v_rcp_f32 v84, v84
v_rcp_f32 v85, v85
v_rcp_f32 v86, v86
v_rcp_f32 v87, v87
s_nop 0
v_mul_f32 v72, v72, v80
v_mul_f32 v73, v73, v81
v_mul_f32 v74, v74, v82
v_mul_f32 v75, v75, v83
v_mul_f32 v76, v76, v84
v_mul_f32 v77, v77, v85
v_mul_f32 v78, v78, v86
v_mul_f32 v79, v79, v87
v_cvt_pk_bf16_f32 v92, v72, v73
v_cvt_pk_bf16_f32 v93, v74, v75
v_cvt_pk_bf16_f32 v94, v76, v77
v_cvt_pk_bf16_f32 v95, v78, v79
s_add_u32 s43, s42, 86016
buffer_store_dwordx4 v[92:95], v1, s[8:11], s43 offen offset:1024 sc1
v_accvgpr_read_b32 v48, a112
v_accvgpr_read_b32 v52, a116
v_accvgpr_read_b32 v49, a113
v_accvgpr_read_b32 v53, a117
v_accvgpr_read_b32 v50, a114
v_accvgpr_read_b32 v54, a118
v_accvgpr_read_b32 v51, a115
v_accvgpr_read_b32 v55, a119
v_mov_b32 v64, s54
v_mul_f32 v56, v48, v48
v_mul_f32 v57, v49, v49
v_mul_f32 v58, v50, v50
v_mul_f32 v59, v51, v51
v_mul_f32 v60, v52, v52
v_mul_f32 v61, v53, v53
v_mul_f32 v62, v54, v54
v_mul_f32 v63, v55, v55
v_fma_f32 v56, v56, s55, v64
v_fma_f32 v57, v57, s55, v64
v_fma_f32 v58, v58, s55, v64
v_fma_f32 v59, v59, s55, v64
v_fma_f32 v60, v60, s55, v64
v_fma_f32 v61, v61, s55, v64
v_fma_f32 v62, v62, s55, v64
v_fma_f32 v63, v63, s55, v64
v_mul_f32 v56, v56, v48
v_mul_f32 v57, v57, v49
v_mul_f32 v58, v58, v50
v_mul_f32 v59, v59, v51
v_mul_f32 v60, v60, v52
v_mul_f32 v61, v61, v53
v_mul_f32 v62, v62, v54
v_mul_f32 v63, v63, v55
v_exp_f32 v56, v56
v_exp_f32 v57, v57
v_exp_f32 v58, v58
v_exp_f32 v59, v59
v_exp_f32 v60, v60
v_exp_f32 v61, v61
v_exp_f32 v62, v62
v_exp_f32 v63, v63
v_add_f32 v56, 1.0, v56
v_add_f32 v57, 1.0, v57
v_add_f32 v58, 1.0, v58
v_add_f32 v59, 1.0, v59
v_add_f32 v60, 1.0, v60
v_add_f32 v61, 1.0, v61
v_add_f32 v62, 1.0, v62
v_add_f32 v63, 1.0, v63
v_rcp_f32 v56, v56
v_rcp_f32 v57, v57
v_rcp_f32 v58, v58
v_rcp_f32 v59, v59
v_rcp_f32 v60, v60
v_rcp_f32 v61, v61
v_rcp_f32 v62, v62
v_rcp_f32 v63, v63
s_nop 0
v_mul_f32 v48, v48, v56
v_mul_f32 v49, v49, v57
v_mul_f32 v50, v50, v58
v_mul_f32 v51, v51, v59
v_mul_f32 v52, v52, v60
v_mul_f32 v53, v53, v61
v_mul_f32 v54, v54, v62
v_mul_f32 v55, v55, v63
v_cvt_pk_bf16_f32 v68, v48, v49
v_cvt_pk_bf16_f32 v69, v50, v51
v_cvt_pk_bf16_f32 v70, v52, v53
v_cvt_pk_bf16_f32 v71, v54, v55
s_add_u32 s43, s42, 86016
buffer_store_dwordx4 v[68:71], v1, s[8:11], s43 offen offset:2048 sc1
v_accvgpr_read_b32 v72, a120
v_accvgpr_read_b32 v76, a124
v_accvgpr_read_b32 v73, a121
v_accvgpr_read_b32 v77, a125
v_accvgpr_read_b32 v74, a122
v_accvgpr_read_b32 v78, a126
v_accvgpr_read_b32 v75, a123
v_accvgpr_read_b32 v79, a127
v_mov_b32 v88, s54
v_mul_f32 v80, v72, v72
v_mul_f32 v81, v73, v73
v_mul_f32 v82, v74, v74
v_mul_f32 v83, v75, v75
v_mul_f32 v84, v76, v76
v_mul_f32 v85, v77, v77
v_mul_f32 v86, v78, v78
v_mul_f32 v87, v79, v79
v_fma_f32 v80, v80, s55, v88
v_fma_f32 v81, v81, s55, v88
v_fma_f32 v82, v82, s55, v88
v_fma_f32 v83, v83, s55, v88
v_fma_f32 v84, v84, s55, v88
v_fma_f32 v85, v85, s55, v88
v_fma_f32 v86, v86, s55, v88
v_fma_f32 v87, v87, s55, v88
v_mul_f32 v80, v80, v72
v_mul_f32 v81, v81, v73
v_mul_f32 v82, v82, v74
v_mul_f32 v83, v83, v75
v_mul_f32 v84, v84, v76
v_mul_f32 v85, v85, v77
v_mul_f32 v86, v86, v78
v_mul_f32 v87, v87, v79
v_exp_f32 v80, v80
v_exp_f32 v81, v81
v_exp_f32 v82, v82
v_exp_f32 v83, v83
v_exp_f32 v84, v84
v_exp_f32 v85, v85
v_exp_f32 v86, v86
v_exp_f32 v87, v87
v_add_f32 v80, 1.0, v80
v_add_f32 v81, 1.0, v81
v_add_f32 v82, 1.0, v82
v_add_f32 v83, 1.0, v83
v_add_f32 v84, 1.0, v84
v_add_f32 v85, 1.0, v85
v_add_f32 v86, 1.0, v86
v_add_f32 v87, 1.0, v87
v_rcp_f32 v80, v80
v_rcp_f32 v81, v81
v_rcp_f32 v82, v82
v_rcp_f32 v83, v83
v_rcp_f32 v84, v84
v_rcp_f32 v85, v85
v_rcp_f32 v86, v86
v_rcp_f32 v87, v87
s_nop 0
v_mul_f32 v72, v72, v80
v_mul_f32 v73, v73, v81
v_mul_f32 v74, v74, v82
v_mul_f32 v75, v75, v83
v_mul_f32 v76, v76, v84
v_mul_f32 v77, v77, v85
v_mul_f32 v78, v78, v86
v_mul_f32 v79, v79, v87
v_cvt_pk_bf16_f32 v92, v72, v73
v_cvt_pk_bf16_f32 v93, v74, v75
v_cvt_pk_bf16_f32 v94, v76, v77
v_cvt_pk_bf16_f32 v95, v78, v79
s_add_u32 s43, s42, 86016
buffer_store_dwordx4 v[92:95], v1, s[8:11], s43 offen offset:3072 sc1
s_waitcnt vmcnt(0)
s_barrier
s_cmp_lg_u32 s29, 0
s_cbranch_scc1 SG_72
v_mov_b32 v2, 1280
v_mov_b32 v4, 1
s_mov_b32 s42, 4194304
s_mov_b64 exec, 1
buffer_atomic_add v4, v2, s[84:87], s42 offen sc1
s_mov_b64 exec, -1
SG_72:
s_getpc_b64 s[90:91]
LJ_73:
s_add_u32 s90, s90, L_m_next-LJ_73
s_addc_u32 s91, s91, -1
s_setpc_b64 s[90:91]
L_w_SP:
s_load_dwordx2 s[16:17], s[0:1], 72
s_load_dwordx2 s[18:19], s[0:1], 80
v_and_b32 v34, 63, v0
v_lshlrev_b32 v1, 4, v34
v_lshrrev_b32 v35, 3, v34
v_and_b32 v36, 7, v34
v_lshrrev_b32 v37, 1, v35
v_xor_b32 v37, v37, v36
s_mov_b32 s42, 4096
v_mul_lo_u32 v38, v35, s42
v_lshl_add_u32 v2, v37, 4, v38
s_mul_i32 s42, s29, 131072
v_add_u32 v2, s42, v2
v_lshrrev_b32 v37, 1, v35
v_add_u32 v37, 4, v37
v_xor_b32 v37, v37, v36
s_mov_b32 s42, 4096
v_mul_lo_u32 v38, v35, s42
v_lshl_add_u32 v3, v37, 4, v38
s_mul_i32 s42, s29, 131072
v_add_u32 v3, s42, v3
v_and_b32 v35, 15, v34
v_lshrrev_b32 v36, 4, v34
v_lshrrev_b32 v37, 1, v36
v_add_u32 v37, 0, v37
v_lshrrev_b32 v38, 1, v35
v_xor_b32 v37, v37, v38
v_lshlrev_b32 v37, 4, v37
v_and_b32 v38, 1, v36
v_lshl_add_u32 v37, v38, 3, v37
v_lshl_add_u32 v18, v35, 7, v37
v_add_u32 v22, 65536, v18
v_lshrrev_b32 v37, 1, v36
v_add_u32 v37, 2, v37
v_lshrrev_b32 v38, 1, v35
v_xor_b32 v37, v37, v38
v_lshlrev_b32 v37, 4, v37
v_and_b32 v38, 1, v36
v_lshl_add_u32 v37, v38, 3, v37
v_lshl_add_u32 v19, v35, 7, v37
v_add_u32 v23, 65536, v19
v_lshrrev_b32 v37, 1, v36
v_add_u32 v37, 4, v37
v_lshrrev_b32 v38, 1, v35
v_xor_b32 v37, v37, v38
v_lshlrev_b32 v37, 4, v37
v_and_b32 v38, 1, v36
v_lshl_add_u32 v37, v38, 3, v37
v_lshl_add_u32 v20, v35, 7, v37
v_add_u32 v24, 65536, v20
v_lshrrev_b32 v37, 1, v36
v_add_u32 v37, 6, v37
v_lshrrev_b32 v38, 1, v35
v_xor_b32 v37, v37, v38
v_lshlrev_b32 v37, 4, v37
v_and_b32 v38, 1, v36
v_lshl_add_u32 v37, v38, 3, v37
v_lshl_add_u32 v21, v35, 7, v37
v_add_u32 v25, 65536, v21
s_and_b32 s52, s3, 15
s_lshr_b32 s53, s3, 4
s_waitcnt lgkmcnt(0)
s_mov_b32 s12, s16
s_and_b32 s13, s17, 0xffff
s_mov_b32 s14, 0x800000
s_mov_b32 s15, 0x00020000
s_mov_b32 s56, s18
s_and_b32 s57, s19, 0xffff
s_mov_b32 s58, 0x1000
s_mov_b32 s59, 0x00020000
s_cmp_lg_u32 s29, 0
s_cbranch_scc1 WWd_75
v_mov_b32 v34, 4195584
s_mov_b32 s43, 0
WW_74:
buffer_load_dword v35, v34, s[84:87], 0 offen sc1
s_add_u32 s43, s43, 1
s_waitcnt vmcnt(0)
v_readfirstlane_b32 s42, v35
s_cmp_ge_u32 s42, 120
s_cbranch_scc1 WWd_75
s_cmp_gt_u32 s43, 400000
s_cbranch_scc1 WWd_75
s_cmp_lg_u32 s42, 0
s_cbranch_scc1 WWs_76
s_sleep 32
s_branch WW_74
WWs_76:
s_sleep 16
s_branch WW_74
WWd_75:
s_waitcnt vmcnt(0)
s_barrier
s_barrier
s_lshl_b32 s48, s53, 2
s_add_u32 s48, s48, s29
s_lshl_b32 s48, s48, 17
s_add_u32 s48, s48, 104857600
s_mul_i32 s49, s52, 524288
s_mul_i32 s51, s29, 4096
s_add_u32 s42, s49, 0
s_add_u32 m0, s51, 0
s_nop 0
buffer_load_dwordx4 v2, s[12:15], s42 offen lds
s_add_u32 m0, s51, 1024
s_add_u32 s42, s42, 32768
buffer_load_dwordx4 v3, s[12:15], s42 offen lds
s_add_u32 m0, s51, 2048
s_add_u32 s42, s42, 32768
buffer_load_dwordx4 v2, s[12:15], s42 offen lds
s_add_u32 m0, s51, 3072
s_add_u32 s42, s42, 32768
buffer_load_dwordx4 v3, s[12:15], s42 offen lds
s_add_u32 s42, s49, 128
s_add_u32 m0, s51, 16384
s_nop 0
buffer_load_dwordx4 v2, s[12:15], s42 offen lds
s_add_u32 m0, s51, 17408
s_add_u32 s42, s42, 32768
buffer_load_dwordx4 v3, s[12:15], s42 offen lds
s_add_u32 m0, s51, 18432
s_add_u32 s42, s42, 32768
buffer_load_dwordx4 v2, s[12:15], s42 offen lds
s_add_u32 m0, s51, 19456
s_add_u32 s42, s42, 32768
buffer_load_dwordx4 v3, s[12:15], s42 offen lds
s_add_u32 s42, s49, 256
s_add_u32 m0, s51, 32768
s_nop 0
buffer_load_dwordx4 v2, s[12:15], s42 offen lds
s_add_u32 m0, s51, 33792
s_add_u32 s42, s42, 32768
buffer_load_dwordx4 v3, s[12:15], s42 offen lds
s_add_u32 m0, s51, 34816
s_add_u32 s42, s42, 32768
buffer_load_dwordx4 v2, s[12:15], s42 offen lds
s_add_u32 m0, s51, 35840
s_add_u32 s42, s42, 32768
buffer_load_dwordx4 v3, s[12:15], s42 offen lds
s_add_u32 s42, s49, 384
s_add_u32 m0, s51, 49152
s_nop 0
buffer_load_dwordx4 v2, s[12:15], s42 offen lds
s_add_u32 m0, s51, 50176
s_add_u32 s42, s42, 32768
buffer_load_dwordx4 v3, s[12:15], s42 offen lds
s_add_u32 m0, s51, 51200
s_add_u32 s42, s42, 32768
buffer_load_dwordx4 v2, s[12:15], s42 offen lds
s_add_u32 m0, s51, 52224
s_add_u32 s42, s42, 32768
buffer_load_dwordx4 v3, s[12:15], s42 offen lds
buffer_load_dwordx4 v[48:51], v1, s[8:11], s48 offen offset:0 sc1
s_add_u32 s43, s48, 65536
buffer_load_dwordx4 v[52:55], v1, s[8:11], s43 offen offset:0 sc1
buffer_load_dwordx4 v[56:59], v1, s[8:11], s48 offen offset:1024 sc1
s_add_u32 s43, s48, 65536
buffer_load_dwordx4 v[60:63], v1, s[8:11], s43 offen offset:1024 sc1
buffer_load_dwordx4 v[64:67], v1, s[8:11], s48 offen offset:2048 sc1
s_add_u32 s43, s48, 65536
buffer_load_dwordx4 v[68:71], v1, s[8:11], s43 offen offset:2048 sc1
buffer_load_dwordx4 v[72:75], v1, s[8:11], s48 offen offset:3072 sc1
s_add_u32 s43, s48, 65536
buffer_load_dwordx4 v[76:79], v1, s[8:11], s43 offen offset:3072 sc1
s_add_u32 s43, s48, 4096
buffer_load_dwordx4 v[80:83], v1, s[8:11], s43 offen offset:0 sc1
s_add_u32 s43, s48, 69632
buffer_load_dwordx4 v[84:87], v1, s[8:11], s43 offen offset:0 sc1
s_add_u32 s43, s48, 4096
buffer_load_dwordx4 v[88:91], v1, s[8:11], s43 offen offset:1024 sc1
s_add_u32 s43, s48, 69632
buffer_load_dwordx4 v[92:95], v1, s[8:11], s43 offen offset:1024 sc1
s_waitcnt vmcnt(24)
s_barrier
s_add_u32 s42, s49, 512
s_add_u32 m0, s51, 65536
s_nop 0
buffer_load_dwordx4 v2, s[12:15], s42 offen lds
s_add_u32 m0, s51, 66560
s_add_u32 s42, s42, 32768
buffer_load_dwordx4 v3, s[12:15], s42 offen lds
s_add_u32 m0, s51, 67584
s_add_u32 s42, s42, 32768
buffer_load_dwordx4 v2, s[12:15], s42 offen lds
s_add_u32 m0, s51, 68608
s_add_u32 s42, s42, 32768
buffer_load_dwordx4 v3, s[12:15], s42 offen lds
ds_read_b64 v[96:97], v18 offset:0
ds_read_b64 v[98:99], v19 offset:0
ds_read_b64 v[100:101], v18 offset:2048
ds_read_b64 v[102:103], v19 offset:2048
ds_read_b64 v[104:105], v18 offset:4096
ds_read_b64 v[106:107], v19 offset:4096
ds_read_b64 v[108:109], v18 offset:6144
ds_read_b64 v[110:111], v19 offset:6144
s_waitcnt vmcnt(14)
s_waitcnt lgkmcnt(6)
v_mfma_f32_16x16x32_bf16 a[0:3], v[48:51], v[96:99], 0
v_mfma_f32_16x16x32_bf16 a[32:35], v[52:55], v[96:99], 0
ds_read_b64 v[96:97], v18 offset:8192
ds_read_b64 v[98:99], v19 offset:8192
s_waitcnt lgkmcnt(6)
v_mfma_f32_16x16x32_bf16 a[4:7], v[48:51], v[100:103], 0
v_mfma_f32_16x16x32_bf16 a[36:39], v[52:55], v[100:103], 0
ds_read_b64 v[100:101], v18 offset:10240
ds_read_b64 v[102:103], v19 offset:10240
s_waitcnt lgkmcnt(6)
v_mfma_f32_16x16x32_bf16 a[8:11], v[48:51], v[104:107], 0
v_mfma_f32_16x16x32_bf16 a[40:43], v[52:55], v[104:107], 0
ds_read_b64 v[104:105], v18 offset:12288
ds_read_b64 v[106:107], v19 offset:12288
s_waitcnt lgkmcnt(6)
v_mfma_f32_16x16x32_bf16 a[12:15], v[48:51], v[108:111], 0
v_mfma_f32_16x16x32_bf16 a[44:47], v[52:55], v[108:111], 0
ds_read_b64 v[108:109], v18 offset:14336
ds_read_b64 v[110:111], v19 offset:14336
s_waitcnt lgkmcnt(6)
v_mfma_f32_16x16x32_bf16 a[16:19], v[48:51], v[96:99], 0
v_mfma_f32_16x16x32_bf16 a[48:51], v[52:55], v[96:99], 0
ds_read_b64 v[96:97], v20 offset:0
ds_read_b64 v[98:99], v21 offset:0
s_waitcnt lgkmcnt(6)
v_mfma_f32_16x16x32_bf16 a[20:23], v[48:51], v[100:103], 0
v_mfma_f32_16x16x32_bf16 a[52:55], v[52:55], v[100:103], 0
ds_read_b64 v[100:101], v20 offset:2048
ds_read_b64 v[102:103], v21 offset:2048
s_waitcnt lgkmcnt(6)
v_mfma_f32_16x16x32_bf16 a[24:27], v[48:51], v[104:107], 0
v_mfma_f32_16x16x32_bf16 a[56:59], v[52:55], v[104:107], 0
ds_read_b64 v[104:105], v20 offset:4096
ds_read_b64 v[106:107], v21 offset:4096
s_waitcnt lgkmcnt(6)
v_mfma_f32_16x16x32_bf16 a[28:31], v[48:51], v[108:111], 0
v_mfma_f32_16x16x32_bf16 a[60:63], v[52:55], v[108:111], 0
s_add_u32 s43, s48, 4096
buffer_load_dwordx4 v[48:51], v1, s[8:11], s43 offen offset:2048 sc1
s_add_u32 s43, s48, 69632
buffer_load_dwordx4 v[52:55], v1, s[8:11], s43 offen offset:2048 sc1
ds_read_b64 v[108:109], v20 offset:6144
ds_read_b64 v[110:111], v21 offset:6144
s_waitcnt vmcnt(14)
s_waitcnt lgkmcnt(6)
v_mfma_f32_16x16x32_bf16 a[0:3], v[56:59], v[96:99], a[0:3]
v_mfma_f32_16x16x32_bf16 a[32:35], v[60:63], v[96:99], a[32:35]
ds_read_b64 v[96:97], v20 offset:8192
ds_read_b64 v[98:99], v21 offset:8192
s_waitcnt lgkmcnt(6)
v_mfma_f32_16x16x32_bf16 a[4:7], v[56:59], v[100:103], a[4:7]
v_mfma_f32_16x16x32_bf16 a[36:39], v[60:63], v[100:103], a[36:39]
ds_read_b64 v[100:101], v20 offset:10240
ds_read_b64 v[102:103], v21 offset:10240
s_waitcnt lgkmcnt(6)
v_mfma_f32_16x16x32_bf16 a[8:11], v[56:59], v[104:107], a[8:11]
v_mfma_f32_16x16x32_bf16 a[40:43], v[60:63], v[104:107], a[40:43]
ds_read_b64 v[104:105], v20 offset:12288
ds_read_b64 v[106:107], v21 offset:12288
s_waitcnt lgkmcnt(6)
v_mfma_f32_16x16x32_bf16 a[12:15], v[56:59], v[108:111], a[12:15]
v_mfma_f32_16x16x32_bf16 a[44:47], v[60:63], v[108:111], a[44:47]
ds_read_b64 v[108:109], v20 offset:14336
ds_read_b64 v[110:111], v21 offset:14336
s_waitcnt lgkmcnt(6)
v_mfma_f32_16x16x32_bf16 a[16:19], v[56:59], v[96:99], a[16:19]
v_mfma_f32_16x16x32_bf16 a[48:51], v[60:63], v[96:99], a[48:51]
s_barrier
s_add_u32 s42, s49, 640
s_add_u32 m0, s51, 81920
s_nop 0
buffer_load_dwordx4 v2, s[12:15], s42 offen lds
s_add_u32 m0, s51, 82944
s_add_u32 s42, s42, 32768
buffer_load_dwordx4 v3, s[12:15], s42 offen lds
s_add_u32 m0, s51, 83968
s_add_u32 s42, s42, 32768
buffer_load_dwordx4 v2, s[12:15], s42 offen lds
s_add_u32 m0, s51, 84992
s_add_u32 s42, s42, 32768
buffer_load_dwordx4 v3, s[12:15], s42 offen lds
ds_read_b64 v[96:97], v18 offset:16384
ds_read_b64 v[98:99], v19 offset:16384
s_waitcnt lgkmcnt(6)
v_mfma_f32_16x16x32_bf16 a[20:23], v[56:59], v[100:103], a[20:23]
v_mfma_f32_16x16x32_bf16 a[52:55], v[60:63], v[100:103], a[52:55]
ds_read_b64 v[100:101], v18 offset:18432
ds_read_b64 v[102:103], v19 offset:18432
s_waitcnt lgkmcnt(6)
v_mfma_f32_16x16x32_bf16 a[24:27], v[56:59], v[104:107], a[24:27]
v_mfma_f32_16x16x32_bf16 a[56:59], v[60:63], v[104:107], a[56:59]
ds_read_b64 v[104:105], v18 offset:20480
ds_read_b64 v[106:107], v19 offset:20480
s_waitcnt lgkmcnt(6)
v_mfma_f32_16x16x32_bf16 a[28:31], v[56:59], v[108:111], a[28:31]
v_mfma_f32_16x16x32_bf16 a[60:63], v[60:63], v[108:111], a[60:63]
s_add_u32 s43, s48, 4096
buffer_load_dwordx4 v[56:59], v1, s[8:11], s43 offen offset:3072 sc1
s_add_u32 s43, s48, 69632
buffer_load_dwordx4 v[60:63], v1, s[8:11], s43 offen offset:3072 sc1
ds_read_b64 v[108:109], v18 offset:22528
ds_read_b64 v[110:111], v19 offset:22528
s_waitcnt vmcnt(18)
s_waitcnt lgkmcnt(6)
v_mfma_f32_16x16x32_bf16 a[0:3], v[64:67], v[96:99], a[0:3]
v_mfma_f32_16x16x32_bf16 a[32:35], v[68:71], v[96:99], a[32:35]
ds_read_b64 v[96:97], v18 offset:24576
ds_read_b64 v[98:99], v19 offset:24576
s_waitcnt lgkmcnt(6)
v_mfma_f32_16x16x32_bf16 a[4:7], v[64:67], v[100:103], a[4:7]
v_mfma_f32_16x16x32_bf16 a[36:39], v[68:71], v[100:103], a[36:39]
ds_read_b64 v[100:101], v18 offset:26624
ds_read_b64 v[102:103], v19 offset:26624
s_waitcnt lgkmcnt(6)
v_mfma_f32_16x16x32_bf16 a[8:11], v[64:67], v[104:107], a[8:11]
v_mfma_f32_16x16x32_bf16 a[40:43], v[68:71], v[104:107], a[40:43]
ds_read_b64 v[104:105], v18 offset:28672
ds_read_b64 v[106:107], v19 offset:28672
s_waitcnt lgkmcnt(6)
v_mfma_f32_16x16x32_bf16 a[12:15], v[64:67], v[108:111], a[12:15]
v_mfma_f32_16x16x32_bf16 a[44:47], v[68:71], v[108:111], a[44:47]
ds_read_b64 v[108:109], v18 offset:30720
ds_read_b64 v[110:111], v19 offset:30720
s_waitcnt lgkmcnt(6)
v_mfma_f32_16x16x32_bf16 a[16:19], v[64:67], v[96:99], a[16:19]
v_mfma_f32_16x16x32_bf16 a[48:51], v[68:71], v[96:99], a[48:51]
ds_read_b64 v[96:97], v20 offset:16384
ds_read_b64 v[98:99], v21 offset:16384
s_waitcnt lgkmcnt(6)
v_mfma_f32_16x16x32_bf16 a[20:23], v[64:67], v[100:103], a[20:23]
v_mfma_f32_16x16x32_bf16 a[52:55], v[68:71], v[100:103], a[52:55]
ds_read_b64 v[100:101], v20 offset:18432
ds_read_b64 v[102:103], v21 offset:18432
s_waitcnt lgkmcnt(6)
v_mfma_f32_16x16x32_bf16 a[24:27], v[64:67], v[104:107], a[24:27]
v_mfma_f32_16x16x32_bf16 a[56:59], v[68:71], v[104:107], a[56:59]
ds_read_b64 v[104:105], v20 offset:20480
ds_read_b64 v[106:107], v21 offset:20480
s_waitcnt lgkmcnt(6)
v_mfma_f32_16x16x32_bf16 a[28:31], v[64:67], v[108:111], a[28:31]
v_mfma_f32_16x16x32_bf16 a[60:63], v[68:71], v[108:111], a[60:63]
s_add_u32 s43, s48, 8192
buffer_load_dwordx4 v[64:67], v1, s[8:11], s43 offen offset:0 sc1
s_add_u32 s43, s48, 73728
buffer_load_dwordx4 v[68:71], v1, s[8:11], s43 offen offset:0 sc1
ds_read_b64 v[108:109], v20 offset:22528
ds_read_b64 v[110:111], v21 offset:22528
s_waitcnt vmcnt(18)
s_waitcnt lgkmcnt(6)
v_mfma_f32_16x16x32_bf16 a[0:3], v[72:75], v[96:99], a[0:3]
v_mfma_f32_16x16x32_bf16 a[32:35], v[76:79], v[96:99], a[32:35]
ds_read_b64 v[96:97], v20 offset:24576
ds_read_b64 v[98:99], v21 offset:24576
s_waitcnt lgkmcnt(6)
v_mfma_f32_16x16x32_bf16 a[4:7], v[72:75], v[100:103], a[4:7]
v_mfma_f32_16x16x32_bf16 a[36:39], v[76:79], v[100:103], a[36:39]
ds_read_b64 v[100:101], v20 offset:26624
ds_read_b64 v[102:103], v21 offset:26624
s_waitcnt lgkmcnt(6)
v_mfma_f32_16x16x32_bf16 a[8:11], v[72:75], v[104:107], a[8:11]
v_mfma_f32_16x16x32_bf16 a[40:43], v[76:79], v[104:107], a[40:43]
ds_read_b64 v[104:105], v20 offset:28672
ds_read_b64 v[106:107], v21 offset:28672
s_waitcnt lgkmcnt(6)
v_mfma_f32_16x16x32_bf16 a[12:15], v[72:75], v[108:111], a[12:15]
v_mfma_f32_16x16x32_bf16 a[44:47], v[76:79], v[108:111], a[44:47]
ds_read_b64 v[108:109], v20 offset:30720
ds_read_b64 v[110:111], v21 offset:30720
s_waitcnt lgkmcnt(6)
v_mfma_f32_16x16x32_bf16 a[16:19], v[72:75], v[96:99], a[16:19]
v_mfma_f32_16x16x32_bf16 a[48:51], v[76:79], v[96:99], a[48:51]
s_barrier
s_add_u32 s42, s49, 768
s_add_u32 m0, s51, 0
s_nop 0
buffer_load_dwordx4 v2, s[12:15], s42 offen lds
s_add_u32 m0, s51, 1024
s_add_u32 s42, s42, 32768
buffer_load_dwordx4 v3, s[12:15], s42 offen lds
s_add_u32 m0, s51, 2048
s_add_u32 s42, s42, 32768
buffer_load_dwordx4 v2, s[12:15], s42 offen lds
s_add_u32 m0, s51, 3072
s_add_u32 s42, s42, 32768
buffer_load_dwordx4 v3, s[12:15], s42 offen lds
ds_read_b64 v[96:97], v18 offset:32768
ds_read_b64 v[98:99], v19 offset:32768
s_waitcnt lgkmcnt(6)
v_mfma_f32_16x16x32_bf16 a[20:23], v[72:75], v[100:103], a[20:23]
v_mfma_f32_16x16x32_bf16 a[52:55], v[76:79], v[100:103], a[52:55]
ds_read_b64 v[100:101], v18 offset:34816
ds_read_b64 v[102:103], v19 offset:34816
s_waitcnt lgkmcnt(6)
v_mfma_f32_16x16x32_bf16 a[24:27], v[72:75], v[104:107], a[24:27]
v_mfma_f32_16x16x32_bf16 a[56:59], v[76:79], v[104:107], a[56:59]
ds_read_b64 v[104:105], v18 offset:36864
ds_read_b64 v[106:107], v19 offset:36864
s_waitcnt lgkmcnt(6)
v_mfma_f32_16x16x32_bf16 a[28:31], v[72:75], v[108:111], a[28:31]
v_mfma_f32_16x16x32_bf16 a[60:63], v[76:79], v[108:111], a[60:63]
s_add_u32 s43, s48, 8192
buffer_load_dwordx4 v[72:75], v1, s[8:11], s43 offen offset:1024 sc1
s_add_u32 s43, s48, 73728
buffer_load_dwordx4 v[76:79], v1, s[8:11], s43 offen offset:1024 sc1
ds_read_b64 v[108:109], v18 offset:38912
ds_read_b64 v[110:111], v19 offset:38912
s_waitcnt vmcnt(22)
s_waitcnt lgkmcnt(6)
v_mfma_f32_16x16x32_bf16 a[0:3], v[80:83], v[96:99], a[0:3]
v_mfma_f32_16x16x32_bf16 a[32:35], v[84:87], v[96:99], a[32:35]
ds_read_b64 v[96:97], v18 offset:40960
ds_read_b64 v[98:99], v19 offset:40960
s_waitcnt lgkmcnt(6)
v_mfma_f32_16x16x32_bf16 a[4:7], v[80:83], v[100:103], a[4:7]
v_mfma_f32_16x16x32_bf16 a[36:39], v[84:87], v[100:103], a[36:39]
ds_read_b64 v[100:101], v18 offset:43008
ds_read_b64 v[102:103], v19 offset:43008
s_waitcnt lgkmcnt(6)
v_mfma_f32_16x16x32_bf16 a[8:11], v[80:83], v[104:107], a[8:11]
v_mfma_f32_16x16x32_bf16 a[40:43], v[84:87], v[104:107], a[40:43]
ds_read_b64 v[104:105], v18 offset:45056
ds_read_b64 v[106:107], v19 offset:45056
s_waitcnt lgkmcnt(6)
v_mfma_f32_16x16x32_bf16 a[12:15], v[80:83], v[108:111], a[12:15]
v_mfma_f32_16x16x32_bf16 a[44:47], v[84:87], v[108:111], a[44:47]
ds_read_b64 v[108:109], v18 offset:47104
ds_read_b64 v[110:111], v19 offset:47104
s_waitcnt lgkmcnt(6)
v_mfma_f32_16x16x32_bf16 a[16:19], v[80:83], v[96:99], a[16:19]
v_mfma_f32_16x16x32_bf16 a[48:51], v[84:87], v[96:99], a[48:51]
ds_read_b64 v[96:97], v20 offset:32768
ds_read_b64 v[98:99], v21 offset:32768
s_waitcnt lgkmcnt(6)
v_mfma_f32_16x16x32_bf16 a[20:23], v[80:83], v[100:103], a[20:23]
v_mfma_f32_16x16x32_bf16 a[52:55], v[84:87], v[100:103], a[52:55]
ds_read_b64 v[100:101], v20 offset:34816
ds_read_b64 v[102:103], v21 offset:34816
s_waitcnt lgkmcnt(6)
v_mfma_f32_16x16x32_bf16 a[24:27], v[80:83], v[104:107], a[24:27]
v_mfma_f32_16x16x32_bf16 a[56:59], v[84:87], v[104:107], a[56:59]
ds_read_b64 v[104:105], v20 offset:36864
ds_read_b64 v[106:107], v21 offset:36864
s_waitcnt lgkmcnt(6)
v_mfma_f32_16x16x32_bf16 a[28:31], v[80:83], v[108:111], a[28:31]
v_mfma_f32_16x16x32_bf16 a[60:63], v[84:87], v[108:111], a[60:63]
s_add_u32 s43, s48, 8192
buffer_load_dwordx4 v[80:83], v1, s[8:11], s43 offen offset:2048 sc1
s_add_u32 s43, s48, 73728
buffer_load_dwordx4 v[84:87], v1, s[8:11], s43 offen offset:2048 sc1
ds_read_b64 v[108:109], v20 offset:38912
ds_read_b64 v[110:111], v21 offset:38912
s_waitcnt vmcnt(22)
s_waitcnt lgkmcnt(6)
v_mfma_f32_16x16x32_bf16 a[0:3], v[88:91], v[96:99], a[0:3]
v_mfma_f32_16x16x32_bf16 a[32:35], v[92:95], v[96:99], a[32:35]
ds_read_b64 v[96:97], v20 offset:40960
ds_read_b64 v[98:99], v21 offset:40960
s_waitcnt lgkmcnt(6)
v_mfma_f32_16x16x32_bf16 a[4:7], v[88:91], v[100:103], a[4:7]
v_mfma_f32_16x16x32_bf16 a[36:39], v[92:95], v[100:103], a[36:39]
ds_read_b64 v[100:101], v20 offset:43008
ds_read_b64 v[102:103], v21 offset:43008
s_waitcnt lgkmcnt(6)
v_mfma_f32_16x16x32_bf16 a[8:11], v[88:91], v[104:107], a[8:11]
v_mfma_f32_16x16x32_bf16 a[40:43], v[92:95], v[104:107], a[40:43]
ds_read_b64 v[104:105], v20 offset:45056
ds_read_b64 v[106:107], v21 offset:45056
s_waitcnt lgkmcnt(6)
v_mfma_f32_16x16x32_bf16 a[12:15], v[88:91], v[108:111], a[12:15]
v_mfma_f32_16x16x32_bf16 a[44:47], v[92:95], v[108:111], a[44:47]
ds_read_b64 v[108:109], v20 offset:47104
ds_read_b64 v[110:111], v21 offset:47104
s_waitcnt lgkmcnt(6)
v_mfma_f32_16x16x32_bf16 a[16:19], v[88:91], v[96:99], a[16:19]
v_mfma_f32_16x16x32_bf16 a[48:51], v[92:95], v[96:99], a[48:51]
s_barrier
s_add_u32 s42, s49, 896
s_add_u32 m0, s51, 16384
s_nop 0
buffer_load_dwordx4 v2, s[12:15], s42 offen lds
s_add_u32 m0, s51, 17408
s_add_u32 s42, s42, 32768
buffer_load_dwordx4 v3, s[12:15], s42 offen lds
s_add_u32 m0, s51, 18432
s_add_u32 s42, s42, 32768
buffer_load_dwordx4 v2, s[12:15], s42 offen lds
s_add_u32 m0, s51, 19456
s_add_u32 s42, s42, 32768
buffer_load_dwordx4 v3, s[12:15], s42 offen lds
ds_read_b64 v[96:97], v18 offset:49152
ds_read_b64 v[98:99], v19 offset:49152
s_waitcnt lgkmcnt(6)
v_mfma_f32_16x16x32_bf16 a[20:23], v[88:91], v[100:103], a[20:23]
v_mfma_f32_16x16x32_bf16 a[52:55], v[92:95], v[100:103], a[52:55]
ds_read_b64 v[100:101], v18 offset:51200
ds_read_b64 v[102:103], v19 offset:51200
s_waitcnt lgkmcnt(6)
v_mfma_f32_16x16x32_bf16 a[24:27], v[88:91], v[104:107], a[24:27]
v_mfma_f32_16x16x32_bf16 a[56:59], v[92:95], v[104:107], a[56:59]
ds_read_b64 v[104:105], v18 offset:53248
ds_read_b64 v[106:107], v19 offset:53248
s_waitcnt lgkmcnt(6)
v_mfma_f32_16x16x32_bf16 a[28:31], v[88:91], v[108:111], a[28:31]
v_mfma_f32_16x16x32_bf16 a[60:63], v[92:95], v[108:111], a[60:63]
s_add_u32 s43, s48, 8192
buffer_load_dwordx4 v[88:91], v1, s[8:11], s43 offen offset:3072 sc1
s_add_u32 s43, s48, 73728
buffer_load_dwordx4 v[92:95], v1, s[8:11], s43 offen offset:3072 sc1
ds_read_b64 v[108:109], v18 offset:55296
ds_read_b64 v[110:111], v19 offset:55296
s_waitcnt vmcnt(22)
s_waitcnt lgkmcnt(6)
v_mfma_f32_16x16x32_bf16 a[0:3], v[48:51], v[96:99], a[0:3]
v_mfma_f32_16x16x32_bf16 a[32:35], v[52:55], v[96:99], a[32:35]
ds_read_b64 v[96:97], v18 offset:57344
ds_read_b64 v[98:99], v19 offset:57344
s_waitcnt lgkmcnt(6)
v_mfma_f32_16x16x32_bf16 a[4:7], v[48:51], v[100:103], a[4:7]
v_mfma_f32_16x16x32_bf16 a[36:39], v[52:55], v[100:103], a[36:39]
ds_read_b64 v[100:101], v18 offset:59392
ds_read_b64 v[102:103], v19 offset:59392
s_waitcnt lgkmcnt(6)
v_mfma_f32_16x16x32_bf16 a[8:11], v[48:51], v[104:107], a[8:11]
v_mfma_f32_16x16x32_bf16 a[40:43], v[52:55], v[104:107], a[40:43]
ds_read_b64 v[104:105], v18 offset:61440
ds_read_b64 v[106:107], v19 offset:61440
s_waitcnt lgkmcnt(6)
v_mfma_f32_16x16x32_bf16 a[12:15], v[48:51], v[108:111], a[12:15]
v_mfma_f32_16x16x32_bf16 a[44:47], v[52:55], v[108:111], a[44:47]
ds_read_b64 v[108:109], v18 offset:63488
ds_read_b64 v[110:111], v19 offset:63488
s_waitcnt lgkmcnt(6)
v_mfma_f32_16x16x32_bf16 a[16:19], v[48:51], v[96:99], a[16:19]
v_mfma_f32_16x16x32_bf16 a[48:51], v[52:55], v[96:99], a[48:51]
ds_read_b64 v[96:97], v20 offset:49152
ds_read_b64 v[98:99], v21 offset:49152
s_waitcnt lgkmcnt(6)
v_mfma_f32_16x16x32_bf16 a[20:23], v[48:51], v[100:103], a[20:23]
v_mfma_f32_16x16x32_bf16 a[52:55], v[52:55], v[100:103], a[52:55]
ds_read_b64 v[100:101], v20 offset:51200
ds_read_b64 v[102:103], v21 offset:51200
s_waitcnt lgkmcnt(6)
v_mfma_f32_16x16x32_bf16 a[24:27], v[48:51], v[104:107], a[24:27]
v_mfma_f32_16x16x32_bf16 a[56:59], v[52:55], v[104:107], a[56:59]
ds_read_b64 v[104:105], v20 offset:53248
ds_read_b64 v[106:107], v21 offset:53248
s_waitcnt lgkmcnt(6)
v_mfma_f32_16x16x32_bf16 a[28:31], v[48:51], v[108:111], a[28:31]
v_mfma_f32_16x16x32_bf16 a[60:63], v[52:55], v[108:111], a[60:63]
s_add_u32 s43, s48, 12288
buffer_load_dwordx4 v[48:51], v1, s[8:11], s43 offen offset:0 sc1
s_add_u32 s43, s48, 77824
buffer_load_dwordx4 v[52:55], v1, s[8:11], s43 offen offset:0 sc1
ds_read_b64 v[108:109], v20 offset:55296
ds_read_b64 v[110:111], v21 offset:55296
s_waitcnt vmcnt(18)
s_waitcnt lgkmcnt(6)
v_mfma_f32_16x16x32_bf16 a[0:3], v[56:59], v[96:99], a[0:3]
v_mfma_f32_16x16x32_bf16 a[32:35], v[60:63], v[96:99], a[32:35]
ds_read_b64 v[96:97], v20 offset:57344
ds_read_b64 v[98:99], v21 offset:57344
s_waitcnt lgkmcnt(6)
v_mfma_f32_16x16x32_bf16 a[4:7], v[56:59], v[100:103], a[4:7]
v_mfma_f32_16x16x32_bf16 a[36:39], v[60:63], v[100:103], a[36:39]
ds_read_b64 v[100:101], v20 offset:59392
ds_read_b64 v[102:103], v21 offset:59392
s_waitcnt lgkmcnt(6)
v_mfma_f32_16x16x32_bf16 a[8:11], v[56:59], v[104:107], a[8:11]
v_mfma_f32_16x16x32_bf16 a[40:43], v[60:63], v[104:107], a[40:43]
ds_read_b64 v[104:105], v20 offset:61440
ds_read_b64 v[106:107], v21 offset:61440
s_waitcnt lgkmcnt(6)
v_mfma_f32_16x16x32_bf16 a[12:15], v[56:59], v[108:111], a[12:15]
v_mfma_f32_16x16x32_bf16 a[44:47], v[60:63], v[108:111], a[44:47]
ds_read_b64 v[108:109], v20 offset:63488
ds_read_b64 v[110:111], v21 offset:63488
s_waitcnt lgkmcnt(6)
v_mfma_f32_16x16x32_bf16 a[16:19], v[56:59], v[96:99], a[16:19]
v_mfma_f32_16x16x32_bf16 a[48:51], v[60:63], v[96:99], a[48:51]
s_barrier
s_add_u32 s42, s49, 1024
s_add_u32 m0, s51, 32768
s_nop 0
buffer_load_dwordx4 v2, s[12:15], s42 offen lds
s_add_u32 m0, s51, 33792
s_add_u32 s42, s42, 32768
buffer_load_dwordx4 v3, s[12:15], s42 offen lds
s_add_u32 m0, s51, 34816
s_add_u32 s42, s42, 32768
buffer_load_dwordx4 v2, s[12:15], s42 offen lds
s_add_u32 m0, s51, 35840
s_add_u32 s42, s42, 32768
buffer_load_dwordx4 v3, s[12:15], s42 offen lds
ds_read_b64 v[96:97], v22 offset:0
ds_read_b64 v[98:99], v23 offset:0
s_waitcnt lgkmcnt(6)
v_mfma_f32_16x16x32_bf16 a[20:23], v[56:59], v[100:103], a[20:23]
v_mfma_f32_16x16x32_bf16 a[52:55], v[60:63], v[100:103], a[52:55]
ds_read_b64 v[100:101], v22 offset:2048
ds_read_b64 v[102:103], v23 offset:2048
s_waitcnt lgkmcnt(6)
v_mfma_f32_16x16x32_bf16 a[24:27], v[56:59], v[104:107], a[24:27]
v_mfma_f32_16x16x32_bf16 a[56:59], v[60:63], v[104:107], a[56:59]
ds_read_b64 v[104:105], v22 offset:4096
ds_read_b64 v[106:107], v23 offset:4096
s_waitcnt lgkmcnt(6)
v_mfma_f32_16x16x32_bf16 a[28:31], v[56:59], v[108:111], a[28:31]
v_mfma_f32_16x16x32_bf16 a[60:63], v[60:63], v[108:111], a[60:63]
s_mov_b32 s50, 3
GL_77:
s_add_u32 s43, s48, 12288
buffer_load_dwordx4 v[56:59], v1, s[8:11], s43 offen offset:1024 sc1
s_add_u32 s43, s48, 77824
buffer_load_dwordx4 v[60:63], v1, s[8:11], s43 offen offset:1024 sc1
ds_read_b64 v[108:109], v22 offset:6144
ds_read_b64 v[110:111], v23 offset:6144
s_waitcnt vmcnt(22)
s_waitcnt lgkmcnt(6)
v_mfma_f32_16x16x32_bf16 a[0:3], v[64:67], v[96:99], a[0:3]
v_mfma_f32_16x16x32_bf16 a[32:35], v[68:71], v[96:99], a[32:35]
ds_read_b64 v[96:97], v22 offset:8192
ds_read_b64 v[98:99], v23 offset:8192
s_waitcnt lgkmcnt(6)
v_mfma_f32_16x16x32_bf16 a[4:7], v[64:67], v[100:103], a[4:7]
v_mfma_f32_16x16x32_bf16 a[36:39], v[68:71], v[100:103], a[36:39]
ds_read_b64 v[100:101], v22 offset:10240
ds_read_b64 v[102:103], v23 offset:10240
s_waitcnt lgkmcnt(6)
v_mfma_f32_16x16x32_bf16 a[8:11], v[64:67], v[104:107], a[8:11]
v_mfma_f32_16x16x32_bf16 a[40:43], v[68:71], v[104:107], a[40:43]
ds_read_b64 v[104:105], v22 offset:12288
ds_read_b64 v[106:107], v23 offset:12288
s_waitcnt lgkmcnt(6)
v_mfma_f32_16x16x32_bf16 a[12:15], v[64:67], v[108:111], a[12:15]
v_mfma_f32_16x16x32_bf16 a[44:47], v[68:71], v[108:111], a[44:47]
ds_read_b64 v[108:109], v22 offset:14336
ds_read_b64 v[110:111], v23 offset:14336
s_waitcnt lgkmcnt(6)
v_mfma_f32_16x16x32_bf16 a[16:19], v[64:67], v[96:99], a[16:19]
v_mfma_f32_16x16x32_bf16 a[48:51], v[68:71], v[96:99], a[48:51]
ds_read_b64 v[96:97], v24 offset:0
ds_read_b64 v[98:99], v25 offset:0
s_waitcnt lgkmcnt(6)
v_mfma_f32_16x16x32_bf16 a[20:23], v[64:67], v[100:103], a[20:23]
v_mfma_f32_16x16x32_bf16 a[52:55], v[68:71], v[100:103], a[52:55]
ds_read_b64 v[100:101], v24 offset:2048
ds_read_b64 v[102:103], v25 offset:2048
s_waitcnt lgkmcnt(6)
v_mfma_f32_16x16x32_bf16 a[24:27], v[64:67], v[104:107], a[24:27]
v_mfma_f32_16x16x32_bf16 a[56:59], v[68:71], v[104:107], a[56:59]
ds_read_b64 v[104:105], v24 offset:4096
ds_read_b64 v[106:107], v25 offset:4096
s_waitcnt lgkmcnt(6)
v_mfma_f32_16x16x32_bf16 a[28:31], v[64:67], v[108:111], a[28:31]
v_mfma_f32_16x16x32_bf16 a[60:63], v[68:71], v[108:111], a[60:63]
s_add_u32 s43, s48, 12288
buffer_load_dwordx4 v[64:67], v1, s[8:11], s43 offen offset:2048 sc1
s_add_u32 s43, s48, 77824
buffer_load_dwordx4 v[68:71], v1, s[8:11], s43 offen offset:2048 sc1
ds_read_b64 v[108:109], v24 offset:6144
ds_read_b64 v[110:111], v25 offset:6144
s_waitcnt vmcnt(18)
s_waitcnt lgkmcnt(6)
v_mfma_f32_16x16x32_bf16 a[0:3], v[72:75], v[96:99], a[0:3]
v_mfma_f32_16x16x32_bf16 a[32:35], v[76:79], v[96:99], a[32:35]
ds_read_b64 v[96:97], v24 offset:8192
ds_read_b64 v[98:99], v25 offset:8192
s_waitcnt lgkmcnt(6)
v_mfma_f32_16x16x32_bf16 a[4:7], v[72:75], v[100:103], a[4:7]
v_mfma_f32_16x16x32_bf16 a[36:39], v[76:79], v[100:103], a[36:39]
ds_read_b64 v[100:101], v24 offset:10240
ds_read_b64 v[102:103], v25 offset:10240
s_waitcnt lgkmcnt(6)
v_mfma_f32_16x16x32_bf16 a[8:11], v[72:75], v[104:107], a[8:11]
v_mfma_f32_16x16x32_bf16 a[40:43], v[76:79], v[104:107], a[40:43]
ds_read_b64 v[104:105], v24 offset:12288
ds_read_b64 v[106:107], v25 offset:12288
s_waitcnt lgkmcnt(6)
v_mfma_f32_16x16x32_bf16 a[12:15], v[72:75], v[108:111], a[12:15]
v_mfma_f32_16x16x32_bf16 a[44:47], v[76:79], v[108:111], a[44:47]
ds_read_b64 v[108:109], v24 offset:14336
ds_read_b64 v[110:111], v25 offset:14336
s_waitcnt lgkmcnt(6)
v_mfma_f32_16x16x32_bf16 a[16:19], v[72:75], v[96:99], a[16:19]
v_mfma_f32_16x16x32_bf16 a[48:51], v[76:79], v[96:99], a[48:51]
s_barrier
s_add_u32 s42, s49, 1152
s_add_u32 m0, s51, 49152
s_nop 0
buffer_load_dwordx4 v2, s[12:15], s42 offen lds
s_add_u32 m0, s51, 50176
s_add_u32 s42, s42, 32768
buffer_load_dwordx4 v3, s[12:15], s42 offen lds
s_add_u32 m0, s51, 51200
s_add_u32 s42, s42, 32768
buffer_load_dwordx4 v2, s[12:15], s42 offen lds
s_add_u32 m0, s51, 52224
s_add_u32 s42, s42, 32768
buffer_load_dwordx4 v3, s[12:15], s42 offen lds
ds_read_b64 v[96:97], v22 offset:16384
ds_read_b64 v[98:99], v23 offset:16384
s_waitcnt lgkmcnt(6)
v_mfma_f32_16x16x32_bf16 a[20:23], v[72:75], v[100:103], a[20:23]
v_mfma_f32_16x16x32_bf16 a[52:55], v[76:79], v[100:103], a[52:55]
ds_read_b64 v[100:101], v22 offset:18432
ds_read_b64 v[102:103], v23 offset:18432
s_waitcnt lgkmcnt(6)
v_mfma_f32_16x16x32_bf16 a[24:27], v[72:75], v[104:107], a[24:27]
v_mfma_f32_16x16x32_bf16 a[56:59], v[76:79], v[104:107], a[56:59]
ds_read_b64 v[104:105], v22 offset:20480
ds_read_b64 v[106:107], v23 offset:20480
s_waitcnt lgkmcnt(6)
v_mfma_f32_16x16x32_bf16 a[28:31], v[72:75], v[108:111], a[28:31]
v_mfma_f32_16x16x32_bf16 a[60:63], v[76:79], v[108:111], a[60:63]
s_add_u32 s43, s48, 12288
buffer_load_dwordx4 v[72:75], v1, s[8:11], s43 offen offset:3072 sc1
s_add_u32 s43, s48, 77824
buffer_load_dwordx4 v[76:79], v1, s[8:11], s43 offen offset:3072 sc1
ds_read_b64 v[108:109], v22 offset:22528
ds_read_b64 v[110:111], v23 offset:22528
s_waitcnt vmcnt(22)
s_waitcnt lgkmcnt(6)
v_mfma_f32_16x16x32_bf16 a[0:3], v[80:83], v[96:99], a[0:3]
v_mfma_f32_16x16x32_bf16 a[32:35], v[84:87], v[96:99], a[32:35]
ds_read_b64 v[96:97], v22 offset:24576
ds_read_b64 v[98:99], v23 offset:24576
s_waitcnt lgkmcnt(6)
v_mfma_f32_16x16x32_bf16 a[4:7], v[80:83], v[100:103], a[4:7]
v_mfma_f32_16x16x32_bf16 a[36:39], v[84:87], v[100:103], a[36:39]
ds_read_b64 v[100:101], v22 offset:26624
ds_read_b64 v[102:103], v23 offset:26624
s_waitcnt lgkmcnt(6)
v_mfma_f32_16x16x32_bf16 a[8:11], v[80:83], v[104:107], a[8:11]
v_mfma_f32_16x16x32_bf16 a[40:43], v[84:87], v[104:107], a[40:43]
ds_read_b64 v[104:105], v22 offset:28672
ds_read_b64 v[106:107], v23 offset:28672
s_waitcnt lgkmcnt(6)
v_mfma_f32_16x16x32_bf16 a[12:15], v[80:83], v[108:111], a[12:15]
v_mfma_f32_16x16x32_bf16 a[44:47], v[84:87], v[108:111], a[44:47]
ds_read_b64 v[108:109], v22 offset:30720
ds_read_b64 v[110:111], v23 offset:30720
s_waitcnt lgkmcnt(6)
v_mfma_f32_16x16x32_bf16 a[16:19], v[80:83], v[96:99], a[16:19]
v_mfma_f32_16x16x32_bf16 a[48:51], v[84:87], v[96:99], a[48:51]
ds_read_b64 v[96:97], v24 offset:16384
ds_read_b64 v[98:99], v25 offset:16384
s_waitcnt lgkmcnt(6)
v_mfma_f32_16x16x32_bf16 a[20:23], v[80:83], v[100:103], a[20:23]
v_mfma_f32_16x16x32_bf16 a[52:55], v[84:87], v[100:103], a[52:55]
ds_read_b64 v[100:101], v24 offset:18432
ds_read_b64 v[102:103], v25 offset:18432
s_waitcnt lgkmcnt(6)
v_mfma_f32_16x16x32_bf16 a[24:27], v[80:83], v[104:107], a[24:27]
v_mfma_f32_16x16x32_bf16 a[56:59], v[84:87], v[104:107], a[56:59]
ds_read_b64 v[104:105], v24 offset:20480
ds_read_b64 v[106:107], v25 offset:20480
s_waitcnt lgkmcnt(6)
v_mfma_f32_16x16x32_bf16 a[28:31], v[80:83], v[108:111], a[28:31]
v_mfma_f32_16x16x32_bf16 a[60:63], v[84:87], v[108:111], a[60:63]
s_add_u32 s43, s48, 16384
buffer_load_dwordx4 v[80:83], v1, s[8:11], s43 offen offset:0 sc1
s_add_u32 s43, s48, 81920
buffer_load_dwordx4 v[84:87], v1, s[8:11], s43 offen offset:0 sc1
ds_read_b64 v[108:109], v24 offset:22528
ds_read_b64 v[110:111], v25 offset:22528
s_waitcnt vmcnt(18)
s_waitcnt lgkmcnt(6)
v_mfma_f32_16x16x32_bf16 a[0:3], v[88:91], v[96:99], a[0:3]
v_mfma_f32_16x16x32_bf16 a[32:35], v[92:95], v[96:99], a[32:35]
ds_read_b64 v[96:97], v24 offset:24576
ds_read_b64 v[98:99], v25 offset:24576
s_waitcnt lgkmcnt(6)
v_mfma_f32_16x16x32_bf16 a[4:7], v[88:91], v[100:103], a[4:7]
v_mfma_f32_16x16x32_bf16 a[36:39], v[92:95], v[100:103], a[36:39]
ds_read_b64 v[100:101], v24 offset:26624
ds_read_b64 v[102:103], v25 offset:26624
s_waitcnt lgkmcnt(6)
v_mfma_f32_16x16x32_bf16 a[8:11], v[88:91], v[104:107], a[8:11]
v_mfma_f32_16x16x32_bf16 a[40:43], v[92:95], v[104:107], a[40:43]
ds_read_b64 v[104:105], v24 offset:28672
ds_read_b64 v[106:107], v25 offset:28672
s_waitcnt lgkmcnt(6)
v_mfma_f32_16x16x32_bf16 a[12:15], v[88:91], v[108:111], a[12:15]
v_mfma_f32_16x16x32_bf16 a[44:47], v[92:95], v[108:111], a[44:47]
ds_read_b64 v[108:109], v24 offset:30720
ds_read_b64 v[110:111], v25 offset:30720
s_waitcnt lgkmcnt(6)
v_mfma_f32_16x16x32_bf16 a[16:19], v[88:91], v[96:99], a[16:19]
v_mfma_f32_16x16x32_bf16 a[48:51], v[92:95], v[96:99], a[48:51]
s_barrier
s_add_u32 s42, s49, 1280
s_add_u32 m0, s51, 65536
s_nop 0
buffer_load_dwordx4 v2, s[12:15], s42 offen lds
s_add_u32 m0, s51, 66560
s_add_u32 s42, s42, 32768
buffer_load_dwordx4 v3, s[12:15], s42 offen lds
s_add_u32 m0, s51, 67584
s_add_u32 s42, s42, 32768
buffer_load_dwordx4 v2, s[12:15], s42 offen lds
s_add_u32 m0, s51, 68608
s_add_u32 s42, s42, 32768
buffer_load_dwordx4 v3, s[12:15], s42 offen lds
ds_read_b64 v[96:97], v18 offset:0
ds_read_b64 v[98:99], v19 offset:0
s_waitcnt lgkmcnt(6)
v_mfma_f32_16x16x32_bf16 a[20:23], v[88:91], v[100:103], a[20:23]
v_mfma_f32_16x16x32_bf16 a[52:55], v[92:95], v[100:103], a[52:55]
ds_read_b64 v[100:101], v18 offset:2048
ds_read_b64 v[102:103], v19 offset:2048
s_waitcnt lgkmcnt(6)
v_mfma_f32_16x16x32_bf16 a[24:27], v[88:91], v[104:107], a[24:27]
v_mfma_f32_16x16x32_bf16 a[56:59], v[92:95], v[104:107], a[56:59]
ds_read_b64 v[104:105], v18 offset:4096
ds_read_b64 v[106:107], v19 offset:4096
s_waitcnt lgkmcnt(6)
v_mfma_f32_16x16x32_bf16 a[28:31], v[88:91], v[108:111], a[28:31]
v_mfma_f32_16x16x32_bf16 a[60:63], v[92:95], v[108:111], a[60:63]
s_add_u32 s43, s48, 16384
buffer_load_dwordx4 v[88:91], v1, s[8:11], s43 offen offset:1024 sc1
s_add_u32 s43, s48, 81920
buffer_load_dwordx4 v[92:95], v1, s[8:11], s43 offen offset:1024 sc1
ds_read_b64 v[108:109], v18 offset:6144
ds_read_b64 v[110:111], v19 offset:6144
s_waitcnt vmcnt(22)
s_waitcnt lgkmcnt(6)
v_mfma_f32_16x16x32_bf16 a[0:3], v[48:51], v[96:99], a[0:3]
v_mfma_f32_16x16x32_bf16 a[32:35], v[52:55], v[96:99], a[32:35]
ds_read_b64 v[96:97], v18 offset:8192
ds_read_b64 v[98:99], v19 offset:8192
s_waitcnt lgkmcnt(6)
v_mfma_f32_16x16x32_bf16 a[4:7], v[48:51], v[100:103], a[4:7]
v_mfma_f32_16x16x32_bf16 a[36:39], v[52:55], v[100:103], a[36:39]
ds_read_b64 v[100:101], v18 offset:10240
ds_read_b64 v[102:103], v19 offset:10240
s_waitcnt lgkmcnt(6)
v_mfma_f32_16x16x32_bf16 a[8:11], v[48:51], v[104:107], a[8:11]
v_mfma_f32_16x16x32_bf16 a[40:43], v[52:55], v[104:107], a[40:43]
ds_read_b64 v[104:105], v18 offset:12288
ds_read_b64 v[106:107], v19 offset:12288
s_waitcnt lgkmcnt(6)
v_mfma_f32_16x16x32_bf16 a[12:15], v[48:51], v[108:111], a[12:15]
v_mfma_f32_16x16x32_bf16 a[44:47], v[52:55], v[108:111], a[44:47]
ds_read_b64 v[108:109], v18 offset:14336
ds_read_b64 v[110:111], v19 offset:14336
s_waitcnt lgkmcnt(6)
v_mfma_f32_16x16x32_bf16 a[16:19], v[48:51], v[96:99], a[16:19]
v_mfma_f32_16x16x32_bf16 a[48:51], v[52:55], v[96:99], a[48:51]
ds_read_b64 v[96:97], v20 offset:0
ds_read_b64 v[98:99], v21 offset:0
s_waitcnt lgkmcnt(6)
v_mfma_f32_16x16x32_bf16 a[20:23], v[48:51], v[100:103], a[20:23]
v_mfma_f32_16x16x32_bf16 a[52:55], v[52:55], v[100:103], a[52:55]
ds_read_b64 v[100:101], v20 offset:2048
ds_read_b64 v[102:103], v21 offset:2048
s_waitcnt lgkmcnt(6)
v_mfma_f32_16x16x32_bf16 a[24:27], v[48:51], v[104:107], a[24:27]
v_mfma_f32_16x16x32_bf16 a[56:59], v[52:55], v[104:107], a[56:59]
ds_read_b64 v[104:105], v20 offset:4096
ds_read_b64 v[106:107], v21 offset:4096
s_waitcnt lgkmcnt(6)
v_mfma_f32_16x16x32_bf16 a[28:31], v[48:51], v[108:111], a[28:31]
v_mfma_f32_16x16x32_bf16 a[60:63], v[52:55], v[108:111], a[60:63]
s_add_u32 s43, s48, 16384
buffer_load_dwordx4 v[48:51], v1, s[8:11], s43 offen offset:2048 sc1
s_add_u32 s43, s48, 81920
buffer_load_dwordx4 v[52:55], v1, s[8:11], s43 offen offset:2048 sc1
ds_read_b64 v[108:109], v20 offset:6144
ds_read_b64 v[110:111], v21 offset:6144
s_waitcnt vmcnt(18)
s_waitcnt lgkmcnt(6)
v_mfma_f32_16x16x32_bf16 a[0:3], v[56:59], v[96:99], a[0:3]
v_mfma_f32_16x16x32_bf16 a[32:35], v[60:63], v[96:99], a[32:35]
ds_read_b64 v[96:97], v20 offset:8192
ds_read_b64 v[98:99], v21 offset:8192
s_waitcnt lgkmcnt(6)
v_mfma_f32_16x16x32_bf16 a[4:7], v[56:59], v[100:103], a[4:7]
v_mfma_f32_16x16x32_bf16 a[36:39], v[60:63], v[100:103], a[36:39]
ds_read_b64 v[100:101], v20 offset:10240
ds_read_b64 v[102:103], v21 offset:10240
s_waitcnt lgkmcnt(6)
v_mfma_f32_16x16x32_bf16 a[8:11], v[56:59], v[104:107], a[8:11]
v_mfma_f32_16x16x32_bf16 a[40:43], v[60:63], v[104:107], a[40:43]
ds_read_b64 v[104:105], v20 offset:12288
ds_read_b64 v[106:107], v21 offset:12288
s_waitcnt lgkmcnt(6)
v_mfma_f32_16x16x32_bf16 a[12:15], v[56:59], v[108:111], a[12:15]
v_mfma_f32_16x16x32_bf16 a[44:47], v[60:63], v[108:111], a[44:47]
ds_read_b64 v[108:109], v20 offset:14336
ds_read_b64 v[110:111], v21 offset:14336
s_waitcnt lgkmcnt(6)
v_mfma_f32_16x16x32_bf16 a[16:19], v[56:59], v[96:99], a[16:19]
v_mfma_f32_16x16x32_bf16 a[48:51], v[60:63], v[96:99], a[48:51]
s_barrier
s_add_u32 s42, s49, 1408
s_add_u32 m0, s51, 81920
s_nop 0
buffer_load_dwordx4 v2, s[12:15], s42 offen lds
s_add_u32 m0, s51, 82944
s_add_u32 s42, s42, 32768
buffer_load_dwordx4 v3, s[12:15], s42 offen lds
s_add_u32 m0, s51, 83968
s_add_u32 s42, s42, 32768
buffer_load_dwordx4 v2, s[12:15], s42 offen lds
s_add_u32 m0, s51, 84992
s_add_u32 s42, s42, 32768
buffer_load_dwordx4 v3, s[12:15], s42 offen lds
ds_read_b64 v[96:97], v18 offset:16384
ds_read_b64 v[98:99], v19 offset:16384
s_waitcnt lgkmcnt(6)
v_mfma_f32_16x16x32_bf16 a[20:23], v[56:59], v[100:103], a[20:23]
v_mfma_f32_16x16x32_bf16 a[52:55], v[60:63], v[100:103], a[52:55]
ds_read_b64 v[100:101], v18 offset:18432
ds_read_b64 v[102:103], v19 offset:18432
s_waitcnt lgkmcnt(6)
v_mfma_f32_16x16x32_bf16 a[24:27], v[56:59], v[104:107], a[24:27]
v_mfma_f32_16x16x32_bf16 a[56:59], v[60:63], v[104:107], a[56:59]
ds_read_b64 v[104:105], v18 offset:20480
ds_read_b64 v[106:107], v19 offset:20480
s_waitcnt lgkmcnt(6)
v_mfma_f32_16x16x32_bf16 a[28:31], v[56:59], v[108:111], a[28:31]
v_mfma_f32_16x16x32_bf16 a[60:63], v[60:63], v[108:111], a[60:63]
s_add_u32 s43, s48, 16384
buffer_load_dwordx4 v[56:59], v1, s[8:11], s43 offen offset:3072 sc1
s_add_u32 s43, s48, 81920
buffer_load_dwordx4 v[60:63], v1, s[8:11], s43 offen offset:3072 sc1
ds_read_b64 v[108:109], v18 offset:22528
ds_read_b64 v[110:111], v19 offset:22528
s_waitcnt vmcnt(22)
s_waitcnt lgkmcnt(6)
v_mfma_f32_16x16x32_bf16 a[0:3], v[64:67], v[96:99], a[0:3]
v_mfma_f32_16x16x32_bf16 a[32:35], v[68:71], v[96:99], a[32:35]
ds_read_b64 v[96:97], v18 offset:24576
ds_read_b64 v[98:99], v19 offset:24576
s_waitcnt lgkmcnt(6)
v_mfma_f32_16x16x32_bf16 a[4:7], v[64:67], v[100:103], a[4:7]
v_mfma_f32_16x16x32_bf16 a[36:39], v[68:71], v[100:103], a[36:39]
ds_read_b64 v[100:101], v18 offset:26624
ds_read_b64 v[102:103], v19 offset:26624
s_waitcnt lgkmcnt(6)
v_mfma_f32_16x16x32_bf16 a[8:11], v[64:67], v[104:107], a[8:11]
v_mfma_f32_16x16x32_bf16 a[40:43], v[68:71], v[104:107], a[40:43]
ds_read_b64 v[104:105], v18 offset:28672
ds_read_b64 v[106:107], v19 offset:28672
s_waitcnt lgkmcnt(6)
v_mfma_f32_16x16x32_bf16 a[12:15], v[64:67], v[108:111], a[12:15]
v_mfma_f32_16x16x32_bf16 a[44:47], v[68:71], v[108:111], a[44:47]
ds_read_b64 v[108:109], v18 offset:30720
ds_read_b64 v[110:111], v19 offset:30720
s_waitcnt lgkmcnt(6)
v_mfma_f32_16x16x32_bf16 a[16:19], v[64:67], v[96:99], a[16:19]
v_mfma_f32_16x16x32_bf16 a[48:51], v[68:71], v[96:99], a[48:51]
ds_read_b64 v[96:97], v20 offset:16384
ds_read_b64 v[98:99], v21 offset:16384
s_waitcnt lgkmcnt(6)
v_mfma_f32_16x16x32_bf16 a[20:23], v[64:67], v[100:103], a[20:23]
v_mfma_f32_16x16x32_bf16 a[52:55], v[68:71], v[100:103], a[52:55]
ds_read_b64 v[100:101], v20 offset:18432
ds_read_b64 v[102:103], v21 offset:18432
s_waitcnt lgkmcnt(6)
v_mfma_f32_16x16x32_bf16 a[24:27], v[64:67], v[104:107], a[24:27]
v_mfma_f32_16x16x32_bf16 a[56:59], v[68:71], v[104:107], a[56:59]
ds_read_b64 v[104:105], v20 offset:20480
ds_read_b64 v[106:107], v21 offset:20480
s_waitcnt lgkmcnt(6)
v_mfma_f32_16x16x32_bf16 a[28:31], v[64:67], v[108:111], a[28:31]
v_mfma_f32_16x16x32_bf16 a[60:63], v[68:71], v[108:111], a[60:63]
s_add_u32 s43, s48, 20480
buffer_load_dwordx4 v[64:67], v1, s[8:11], s43 offen offset:0 sc1
s_add_u32 s43, s48, 86016
buffer_load_dwordx4 v[68:71], v1, s[8:11], s43 offen offset:0 sc1
ds_read_b64 v[108:109], v20 offset:22528
ds_read_b64 v[110:111], v21 offset:22528
s_waitcnt vmcnt(18)
s_waitcnt lgkmcnt(6)
v_mfma_f32_16x16x32_bf16 a[0:3], v[72:75], v[96:99], a[0:3]
v_mfma_f32_16x16x32_bf16 a[32:35], v[76:79], v[96:99], a[32:35]
ds_read_b64 v[96:97], v20 offset:24576
ds_read_b64 v[98:99], v21 offset:24576
s_waitcnt lgkmcnt(6)
v_mfma_f32_16x16x32_bf16 a[4:7], v[72:75], v[100:103], a[4:7]
v_mfma_f32_16x16x32_bf16 a[36:39], v[76:79], v[100:103], a[36:39]
ds_read_b64 v[100:101], v20 offset:26624
ds_read_b64 v[102:103], v21 offset:26624
s_waitcnt lgkmcnt(6)
v_mfma_f32_16x16x32_bf16 a[8:11], v[72:75], v[104:107], a[8:11]
v_mfma_f32_16x16x32_bf16 a[40:43], v[76:79], v[104:107], a[40:43]
ds_read_b64 v[104:105], v20 offset:28672
ds_read_b64 v[106:107], v21 offset:28672
s_waitcnt lgkmcnt(6)
v_mfma_f32_16x16x32_bf16 a[12:15], v[72:75], v[108:111], a[12:15]
v_mfma_f32_16x16x32_bf16 a[44:47], v[76:79], v[108:111], a[44:47]
ds_read_b64 v[108:109], v20 offset:30720
ds_read_b64 v[110:111], v21 offset:30720
s_waitcnt lgkmcnt(6)
v_mfma_f32_16x16x32_bf16 a[16:19], v[72:75], v[96:99], a[16:19]
v_mfma_f32_16x16x32_bf16 a[48:51], v[76:79], v[96:99], a[48:51]
s_barrier
s_add_u32 s42, s49, 1536
s_add_u32 m0, s51, 0
s_nop 0
buffer_load_dwordx4 v2, s[12:15], s42 offen lds
s_add_u32 m0, s51, 1024
s_add_u32 s42, s42, 32768
buffer_load_dwordx4 v3, s[12:15], s42 offen lds
s_add_u32 m0, s51, 2048
s_add_u32 s42, s42, 32768
buffer_load_dwordx4 v2, s[12:15], s42 offen lds
s_add_u32 m0, s51, 3072
s_add_u32 s42, s42, 32768
buffer_load_dwordx4 v3, s[12:15], s42 offen lds
ds_read_b64 v[96:97], v18 offset:32768
ds_read_b64 v[98:99], v19 offset:32768
s_waitcnt lgkmcnt(6)
v_mfma_f32_16x16x32_bf16 a[20:23], v[72:75], v[100:103], a[20:23]
v_mfma_f32_16x16x32_bf16 a[52:55], v[76:79], v[100:103], a[52:55]
ds_read_b64 v[100:101], v18 offset:34816
ds_read_b64 v[102:103], v19 offset:34816
s_waitcnt lgkmcnt(6)
v_mfma_f32_16x16x32_bf16 a[24:27], v[72:75], v[104:107], a[24:27]
v_mfma_f32_16x16x32_bf16 a[56:59], v[76:79], v[104:107], a[56:59]
ds_read_b64 v[104:105], v18 offset:36864
ds_read_b64 v[106:107], v19 offset:36864
s_waitcnt lgkmcnt(6)
v_mfma_f32_16x16x32_bf16 a[28:31], v[72:75], v[108:111], a[28:31]
v_mfma_f32_16x16x32_bf16 a[60:63], v[76:79], v[108:111], a[60:63]
s_add_u32 s43, s48, 20480
buffer_load_dwordx4 v[72:75], v1, s[8:11], s43 offen offset:1024 sc1
s_add_u32 s43, s48, 86016
buffer_load_dwordx4 v[76:79], v1, s[8:11], s43 offen offset:1024 sc1
ds_read_b64 v[108:109], v18 offset:38912
ds_read_b64 v[110:111], v19 offset:38912
s_waitcnt vmcnt(22)
s_waitcnt lgkmcnt(6)
v_mfma_f32_16x16x32_bf16 a[0:3], v[80:83], v[96:99], a[0:3]
v_mfma_f32_16x16x32_bf16 a[32:35], v[84:87], v[96:99], a[32:35]
ds_read_b64 v[96:97], v18 offset:40960
ds_read_b64 v[98:99], v19 offset:40960
s_waitcnt lgkmcnt(6)
v_mfma_f32_16x16x32_bf16 a[4:7], v[80:83], v[100:103], a[4:7]
v_mfma_f32_16x16x32_bf16 a[36:39], v[84:87], v[100:103], a[36:39]
ds_read_b64 v[100:101], v18 offset:43008
ds_read_b64 v[102:103], v19 offset:43008
s_waitcnt lgkmcnt(6)
v_mfma_f32_16x16x32_bf16 a[8:11], v[80:83], v[104:107], a[8:11]
v_mfma_f32_16x16x32_bf16 a[40:43], v[84:87], v[104:107], a[40:43]
ds_read_b64 v[104:105], v18 offset:45056
ds_read_b64 v[106:107], v19 offset:45056
s_waitcnt lgkmcnt(6)
v_mfma_f32_16x16x32_bf16 a[12:15], v[80:83], v[108:111], a[12:15]
v_mfma_f32_16x16x32_bf16 a[44:47], v[84:87], v[108:111], a[44:47]
ds_read_b64 v[108:109], v18 offset:47104
ds_read_b64 v[110:111], v19 offset:47104
s_waitcnt lgkmcnt(6)
v_mfma_f32_16x16x32_bf16 a[16:19], v[80:83], v[96:99], a[16:19]
v_mfma_f32_16x16x32_bf16 a[48:51], v[84:87], v[96:99], a[48:51]
ds_read_b64 v[96:97], v20 offset:32768
ds_read_b64 v[98:99], v21 offset:32768
s_waitcnt lgkmcnt(6)
v_mfma_f32_16x16x32_bf16 a[20:23], v[80:83], v[100:103], a[20:23]
v_mfma_f32_16x16x32_bf16 a[52:55], v[84:87], v[100:103], a[52:55]
ds_read_b64 v[100:101], v20 offset:34816
ds_read_b64 v[102:103], v21 offset:34816
s_waitcnt lgkmcnt(6)
v_mfma_f32_16x16x32_bf16 a[24:27], v[80:83], v[104:107], a[24:27]
v_mfma_f32_16x16x32_bf16 a[56:59], v[84:87], v[104:107], a[56:59]
ds_read_b64 v[104:105], v20 offset:36864
ds_read_b64 v[106:107], v21 offset:36864
s_waitcnt lgkmcnt(6)
v_mfma_f32_16x16x32_bf16 a[28:31], v[80:83], v[108:111], a[28:31]
v_mfma_f32_16x16x32_bf16 a[60:63], v[84:87], v[108:111], a[60:63]
s_add_u32 s43, s48, 20480
buffer_load_dwordx4 v[80:83], v1, s[8:11], s43 offen offset:2048 sc1
s_add_u32 s43, s48, 86016
buffer_load_dwordx4 v[84:87], v1, s[8:11], s43 offen offset:2048 sc1
ds_read_b64 v[108:109], v20 offset:38912
ds_read_b64 v[110:111], v21 offset:38912
s_waitcnt vmcnt(18)
s_waitcnt lgkmcnt(6)
v_mfma_f32_16x16x32_bf16 a[0:3], v[88:91], v[96:99], a[0:3]
v_mfma_f32_16x16x32_bf16 a[32:35], v[92:95], v[96:99], a[32:35]
ds_read_b64 v[96:97], v20 offset:40960
ds_read_b64 v[98:99], v21 offset:40960
s_waitcnt lgkmcnt(6)
v_mfma_f32_16x16x32_bf16 a[4:7], v[88:91], v[100:103], a[4:7]
v_mfma_f32_16x16x32_bf16 a[36:39], v[92:95], v[100:103], a[36:39]
ds_read_b64 v[100:101], v20 offset:43008
ds_read_b64 v[102:103], v21 offset:43008
s_waitcnt lgkmcnt(6)
v_mfma_f32_16x16x32_bf16 a[8:11], v[88:91], v[104:107], a[8:11]
v_mfma_f32_16x16x32_bf16 a[40:43], v[92:95], v[104:107], a[40:43]
ds_read_b64 v[104:105], v20 offset:45056
ds_read_b64 v[106:107], v21 offset:45056
s_waitcnt lgkmcnt(6)
v_mfma_f32_16x16x32_bf16 a[12:15], v[88:91], v[108:111], a[12:15]
v_mfma_f32_16x16x32_bf16 a[44:47], v[92:95], v[108:111], a[44:47]
ds_read_b64 v[108:109], v20 offset:47104
ds_read_b64 v[110:111], v21 offset:47104
s_waitcnt lgkmcnt(6)
v_mfma_f32_16x16x32_bf16 a[16:19], v[88:91], v[96:99], a[16:19]
v_mfma_f32_16x16x32_bf16 a[48:51], v[92:95], v[96:99], a[48:51]
s_barrier
s_add_u32 s42, s49, 1664
s_add_u32 m0, s51, 16384
s_nop 0
buffer_load_dwordx4 v2, s[12:15], s42 offen lds
s_add_u32 m0, s51, 17408
s_add_u32 s42, s42, 32768
buffer_load_dwordx4 v3, s[12:15], s42 offen lds
s_add_u32 m0, s51, 18432
s_add_u32 s42, s42, 32768
buffer_load_dwordx4 v2, s[12:15], s42 offen lds
s_add_u32 m0, s51, 19456
s_add_u32 s42, s42, 32768
buffer_load_dwordx4 v3, s[12:15], s42 offen lds
ds_read_b64 v[96:97], v18 offset:49152
ds_read_b64 v[98:99], v19 offset:49152
s_waitcnt lgkmcnt(6)
v_mfma_f32_16x16x32_bf16 a[20:23], v[88:91], v[100:103], a[20:23]
v_mfma_f32_16x16x32_bf16 a[52:55], v[92:95], v[100:103], a[52:55]
ds_read_b64 v[100:101], v18 offset:51200
ds_read_b64 v[102:103], v19 offset:51200
s_waitcnt lgkmcnt(6)
v_mfma_f32_16x16x32_bf16 a[24:27], v[88:91], v[104:107], a[24:27]
v_mfma_f32_16x16x32_bf16 a[56:59], v[92:95], v[104:107], a[56:59]
ds_read_b64 v[104:105], v18 offset:53248
ds_read_b64 v[106:107], v19 offset:53248
s_waitcnt lgkmcnt(6)
v_mfma_f32_16x16x32_bf16 a[28:31], v[88:91], v[108:111], a[28:31]
v_mfma_f32_16x16x32_bf16 a[60:63], v[92:95], v[108:111], a[60:63]
s_add_u32 s43, s48, 20480
buffer_load_dwordx4 v[88:91], v1, s[8:11], s43 offen offset:3072 sc1
s_add_u32 s43, s48, 86016
buffer_load_dwordx4 v[92:95], v1, s[8:11], s43 offen offset:3072 sc1
ds_read_b64 v[108:109], v18 offset:55296
ds_read_b64 v[110:111], v19 offset:55296
s_waitcnt vmcnt(22)
s_waitcnt lgkmcnt(6)
v_mfma_f32_16x16x32_bf16 a[0:3], v[48:51], v[96:99], a[0:3]
v_mfma_f32_16x16x32_bf16 a[32:35], v[52:55], v[96:99], a[32:35]
ds_read_b64 v[96:97], v18 offset:57344
ds_read_b64 v[98:99], v19 offset:57344
s_waitcnt lgkmcnt(6)
v_mfma_f32_16x16x32_bf16 a[4:7], v[48:51], v[100:103], a[4:7]
v_mfma_f32_16x16x32_bf16 a[36:39], v[52:55], v[100:103], a[36:39]
ds_read_b64 v[100:101], v18 offset:59392
ds_read_b64 v[102:103], v19 offset:59392
s_waitcnt lgkmcnt(6)
v_mfma_f32_16x16x32_bf16 a[8:11], v[48:51], v[104:107], a[8:11]
v_mfma_f32_16x16x32_bf16 a[40:43], v[52:55], v[104:107], a[40:43]
ds_read_b64 v[104:105], v18 offset:61440
ds_read_b64 v[106:107], v19 offset:61440
s_waitcnt lgkmcnt(6)
v_mfma_f32_16x16x32_bf16 a[12:15], v[48:51], v[108:111], a[12:15]
v_mfma_f32_16x16x32_bf16 a[44:47], v[52:55], v[108:111], a[44:47]
ds_read_b64 v[108:109], v18 offset:63488
ds_read_b64 v[110:111], v19 offset:63488
s_waitcnt lgkmcnt(6)
v_mfma_f32_16x16x32_bf16 a[16:19], v[48:51], v[96:99], a[16:19]
v_mfma_f32_16x16x32_bf16 a[48:51], v[52:55], v[96:99], a[48:51]
ds_read_b64 v[96:97], v20 offset:49152
ds_read_b64 v[98:99], v21 offset:49152
s_waitcnt lgkmcnt(6)
v_mfma_f32_16x16x32_bf16 a[20:23], v[48:51], v[100:103], a[20:23]
v_mfma_f32_16x16x32_bf16 a[52:55], v[52:55], v[100:103], a[52:55]
ds_read_b64 v[100:101], v20 offset:51200
ds_read_b64 v[102:103], v21 offset:51200
s_waitcnt lgkmcnt(6)
v_mfma_f32_16x16x32_bf16 a[24:27], v[48:51], v[104:107], a[24:27]
v_mfma_f32_16x16x32_bf16 a[56:59], v[52:55], v[104:107], a[56:59]
ds_read_b64 v[104:105], v20 offset:53248
ds_read_b64 v[106:107], v21 offset:53248
s_waitcnt lgkmcnt(6)
v_mfma_f32_16x16x32_bf16 a[28:31], v[48:51], v[108:111], a[28:31]
v_mfma_f32_16x16x32_bf16 a[60:63], v[52:55], v[108:111], a[60:63]
s_add_u32 s43, s48, 24576
buffer_load_dwordx4 v[48:51], v1, s[8:11], s43 offen offset:0 sc1
s_add_u32 s43, s48, 90112
buffer_load_dwordx4 v[52:55], v1, s[8:11], s43 offen offset:0 sc1
ds_read_b64 v[108:109], v20 offset:55296
ds_read_b64 v[110:111], v21 offset:55296
s_waitcnt vmcnt(18)
s_waitcnt lgkmcnt(6)
v_mfma_f32_16x16x32_bf16 a[0:3], v[56:59], v[96:99], a[0:3]
v_mfma_f32_16x16x32_bf16 a[32:35], v[60:63], v[96:99], a[32:35]
ds_read_b64 v[96:97], v20 offset:57344
ds_read_b64 v[98:99], v21 offset:57344
s_waitcnt lgkmcnt(6)
v_mfma_f32_16x16x32_bf16 a[4:7], v[56:59], v[100:103], a[4:7]
v_mfma_f32_16x16x32_bf16 a[36:39], v[60:63], v[100:103], a[36:39]
ds_read_b64 v[100:101], v20 offset:59392
ds_read_b64 v[102:103], v21 offset:59392
s_waitcnt lgkmcnt(6)
v_mfma_f32_16x16x32_bf16 a[8:11], v[56:59], v[104:107], a[8:11]
v_mfma_f32_16x16x32_bf16 a[40:43], v[60:63], v[104:107], a[40:43]
ds_read_b64 v[104:105], v20 offset:61440
ds_read_b64 v[106:107], v21 offset:61440
s_waitcnt lgkmcnt(6)
v_mfma_f32_16x16x32_bf16 a[12:15], v[56:59], v[108:111], a[12:15]
v_mfma_f32_16x16x32_bf16 a[44:47], v[60:63], v[108:111], a[44:47]
ds_read_b64 v[108:109], v20 offset:63488
ds_read_b64 v[110:111], v21 offset:63488
s_waitcnt lgkmcnt(6)
v_mfma_f32_16x16x32_bf16 a[16:19], v[56:59], v[96:99], a[16:19]
v_mfma_f32_16x16x32_bf16 a[48:51], v[60:63], v[96:99], a[48:51]
s_barrier
s_add_u32 s42, s49, 1792
s_add_u32 m0, s51, 32768
s_nop 0
buffer_load_dwordx4 v2, s[12:15], s42 offen lds
s_add_u32 m0, s51, 33792
s_add_u32 s42, s42, 32768
buffer_load_dwordx4 v3, s[12:15], s42 offen lds
s_add_u32 m0, s51, 34816
s_add_u32 s42, s42, 32768
buffer_load_dwordx4 v2, s[12:15], s42 offen lds
s_add_u32 m0, s51, 35840
s_add_u32 s42, s42, 32768
buffer_load_dwordx4 v3, s[12:15], s42 offen lds
ds_read_b64 v[96:97], v22 offset:0
ds_read_b64 v[98:99], v23 offset:0
s_waitcnt lgkmcnt(6)
v_mfma_f32_16x16x32_bf16 a[20:23], v[56:59], v[100:103], a[20:23]
v_mfma_f32_16x16x32_bf16 a[52:55], v[60:63], v[100:103], a[52:55]
ds_read_b64 v[100:101], v22 offset:2048
ds_read_b64 v[102:103], v23 offset:2048
s_waitcnt lgkmcnt(6)
v_mfma_f32_16x16x32_bf16 a[24:27], v[56:59], v[104:107], a[24:27]
v_mfma_f32_16x16x32_bf16 a[56:59], v[60:63], v[104:107], a[56:59]
ds_read_b64 v[104:105], v22 offset:4096
ds_read_b64 v[106:107], v23 offset:4096
s_waitcnt lgkmcnt(6)
v_mfma_f32_16x16x32_bf16 a[28:31], v[56:59], v[108:111], a[28:31]
v_mfma_f32_16x16x32_bf16 a[60:63], v[60:63], v[108:111], a[60:63]
s_add_u32 s48, s48, 12288
s_add_u32 s49, s49, 768
s_sub_u32 s50, s50, 1
s_cmp_lg_u32 s50, 0
s_cbranch_scc1 GL_77
s_add_u32 s43, s48, 12288
buffer_load_dwordx4 v[56:59], v1, s[8:11], s43 offen offset:1024 sc1
s_add_u32 s43, s48, 77824
buffer_load_dwordx4 v[60:63], v1, s[8:11], s43 offen offset:1024 sc1
ds_read_b64 v[108:109], v22 offset:6144
ds_read_b64 v[110:111], v23 offset:6144
s_waitcnt vmcnt(22)
s_waitcnt lgkmcnt(6)
v_mfma_f32_16x16x32_bf16 a[0:3], v[64:67], v[96:99], a[0:3]
v_mfma_f32_16x16x32_bf16 a[32:35], v[68:71], v[96:99], a[32:35]
ds_read_b64 v[96:97], v22 offset:8192
ds_read_b64 v[98:99], v23 offset:8192
s_waitcnt lgkmcnt(6)
v_mfma_f32_16x16x32_bf16 a[4:7], v[64:67], v[100:103], a[4:7]
v_mfma_f32_16x16x32_bf16 a[36:39], v[68:71], v[100:103], a[36:39]
ds_read_b64 v[100:101], v22 offset:10240
ds_read_b64 v[102:103], v23 offset:10240
s_waitcnt lgkmcnt(6)
v_mfma_f32_16x16x32_bf16 a[8:11], v[64:67], v[104:107], a[8:11]
v_mfma_f32_16x16x32_bf16 a[40:43], v[68:71], v[104:107], a[40:43]
ds_read_b64 v[104:105], v22 offset:12288
ds_read_b64 v[106:107], v23 offset:12288
s_waitcnt lgkmcnt(6)
v_mfma_f32_16x16x32_bf16 a[12:15], v[64:67], v[108:111], a[12:15]
v_mfma_f32_16x16x32_bf16 a[44:47], v[68:71], v[108:111], a[44:47]
ds_read_b64 v[108:109], v22 offset:14336
ds_read_b64 v[110:111], v23 offset:14336
s_waitcnt lgkmcnt(6)
v_mfma_f32_16x16x32_bf16 a[16:19], v[64:67], v[96:99], a[16:19]
v_mfma_f32_16x16x32_bf16 a[48:51], v[68:71], v[96:99], a[48:51]
ds_read_b64 v[96:97], v24 offset:0
ds_read_b64 v[98:99], v25 offset:0
s_waitcnt lgkmcnt(6)
v_mfma_f32_16x16x32_bf16 a[20:23], v[64:67], v[100:103], a[20:23]
v_mfma_f32_16x16x32_bf16 a[52:55], v[68:71], v[100:103], a[52:55]
ds_read_b64 v[100:101], v24 offset:2048
ds_read_b64 v[102:103], v25 offset:2048
s_waitcnt lgkmcnt(6)
v_mfma_f32_16x16x32_bf16 a[24:27], v[64:67], v[104:107], a[24:27]
v_mfma_f32_16x16x32_bf16 a[56:59], v[68:71], v[104:107], a[56:59]
ds_read_b64 v[104:105], v24 offset:4096
ds_read_b64 v[106:107], v25 offset:4096
s_waitcnt lgkmcnt(6)
v_mfma_f32_16x16x32_bf16 a[28:31], v[64:67], v[108:111], a[28:31]
v_mfma_f32_16x16x32_bf16 a[60:63], v[68:71], v[108:111], a[60:63]
s_add_u32 s43, s48, 12288
buffer_load_dwordx4 v[64:67], v1, s[8:11], s43 offen offset:2048 sc1
s_add_u32 s43, s48, 77824
buffer_load_dwordx4 v[68:71], v1, s[8:11], s43 offen offset:2048 sc1
ds_read_b64 v[108:109], v24 offset:6144
ds_read_b64 v[110:111], v25 offset:6144
s_waitcnt vmcnt(18)
s_waitcnt lgkmcnt(6)
v_mfma_f32_16x16x32_bf16 a[0:3], v[72:75], v[96:99], a[0:3]
v_mfma_f32_16x16x32_bf16 a[32:35], v[76:79], v[96:99], a[32:35]
ds_read_b64 v[96:97], v24 offset:8192
ds_read_b64 v[98:99], v25 offset:8192
s_waitcnt lgkmcnt(6)
v_mfma_f32_16x16x32_bf16 a[4:7], v[72:75], v[100:103], a[4:7]
v_mfma_f32_16x16x32_bf16 a[36:39], v[76:79], v[100:103], a[36:39]
ds_read_b64 v[100:101], v24 offset:10240
ds_read_b64 v[102:103], v25 offset:10240
s_waitcnt lgkmcnt(6)
v_mfma_f32_16x16x32_bf16 a[8:11], v[72:75], v[104:107], a[8:11]
v_mfma_f32_16x16x32_bf16 a[40:43], v[76:79], v[104:107], a[40:43]
ds_read_b64 v[104:105], v24 offset:12288
ds_read_b64 v[106:107], v25 offset:12288
s_waitcnt lgkmcnt(6)
v_mfma_f32_16x16x32_bf16 a[12:15], v[72:75], v[108:111], a[12:15]
v_mfma_f32_16x16x32_bf16 a[44:47], v[76:79], v[108:111], a[44:47]
ds_read_b64 v[108:109], v24 offset:14336
ds_read_b64 v[110:111], v25 offset:14336
s_waitcnt lgkmcnt(6)
v_mfma_f32_16x16x32_bf16 a[16:19], v[72:75], v[96:99], a[16:19]
v_mfma_f32_16x16x32_bf16 a[48:51], v[76:79], v[96:99], a[48:51]
s_barrier
s_add_u32 s42, s49, 1152
s_add_u32 m0, s51, 49152
s_nop 0
buffer_load_dwordx4 v2, s[12:15], s42 offen lds
s_add_u32 m0, s51, 50176
s_add_u32 s42, s42, 32768
buffer_load_dwordx4 v3, s[12:15], s42 offen lds
s_add_u32 m0, s51, 51200
s_add_u32 s42, s42, 32768
buffer_load_dwordx4 v2, s[12:15], s42 offen lds
s_add_u32 m0, s51, 52224
s_add_u32 s42, s42, 32768
buffer_load_dwordx4 v3, s[12:15], s42 offen lds
ds_read_b64 v[96:97], v22 offset:16384
ds_read_b64 v[98:99], v23 offset:16384
s_waitcnt lgkmcnt(6)
v_mfma_f32_16x16x32_bf16 a[20:23], v[72:75], v[100:103], a[20:23]
v_mfma_f32_16x16x32_bf16 a[52:55], v[76:79], v[100:103], a[52:55]
ds_read_b64 v[100:101], v22 offset:18432
ds_read_b64 v[102:103], v23 offset:18432
s_waitcnt lgkmcnt(6)
v_mfma_f32_16x16x32_bf16 a[24:27], v[72:75], v[104:107], a[24:27]
v_mfma_f32_16x16x32_bf16 a[56:59], v[76:79], v[104:107], a[56:59]
ds_read_b64 v[104:105], v22 offset:20480
ds_read_b64 v[106:107], v23 offset:20480
s_waitcnt lgkmcnt(6)
v_mfma_f32_16x16x32_bf16 a[28:31], v[72:75], v[108:111], a[28:31]
v_mfma_f32_16x16x32_bf16 a[60:63], v[76:79], v[108:111], a[60:63]
s_add_u32 s43, s48, 12288
buffer_load_dwordx4 v[72:75], v1, s[8:11], s43 offen offset:3072 sc1
s_add_u32 s43, s48, 77824
buffer_load_dwordx4 v[76:79], v1, s[8:11], s43 offen offset:3072 sc1
ds_read_b64 v[108:109], v22 offset:22528
ds_read_b64 v[110:111], v23 offset:22528
s_waitcnt vmcnt(22)
s_waitcnt lgkmcnt(6)
v_mfma_f32_16x16x32_bf16 a[0:3], v[80:83], v[96:99], a[0:3]
v_mfma_f32_16x16x32_bf16 a[32:35], v[84:87], v[96:99], a[32:35]
ds_read_b64 v[96:97], v22 offset:24576
ds_read_b64 v[98:99], v23 offset:24576
s_waitcnt lgkmcnt(6)
v_mfma_f32_16x16x32_bf16 a[4:7], v[80:83], v[100:103], a[4:7]
v_mfma_f32_16x16x32_bf16 a[36:39], v[84:87], v[100:103], a[36:39]
ds_read_b64 v[100:101], v22 offset:26624
ds_read_b64 v[102:103], v23 offset:26624
s_waitcnt lgkmcnt(6)
v_mfma_f32_16x16x32_bf16 a[8:11], v[80:83], v[104:107], a[8:11]
v_mfma_f32_16x16x32_bf16 a[40:43], v[84:87], v[104:107], a[40:43]
ds_read_b64 v[104:105], v22 offset:28672
ds_read_b64 v[106:107], v23 offset:28672
s_waitcnt lgkmcnt(6)
v_mfma_f32_16x16x32_bf16 a[12:15], v[80:83], v[108:111], a[12:15]
v_mfma_f32_16x16x32_bf16 a[44:47], v[84:87], v[108:111], a[44:47]
ds_read_b64 v[108:109], v22 offset:30720
ds_read_b64 v[110:111], v23 offset:30720
s_waitcnt lgkmcnt(6)
v_mfma_f32_16x16x32_bf16 a[16:19], v[80:83], v[96:99], a[16:19]
v_mfma_f32_16x16x32_bf16 a[48:51], v[84:87], v[96:99], a[48:51]
ds_read_b64 v[96:97], v24 offset:16384
ds_read_b64 v[98:99], v25 offset:16384
s_waitcnt lgkmcnt(6)
v_mfma_f32_16x16x32_bf16 a[20:23], v[80:83], v[100:103], a[20:23]
v_mfma_f32_16x16x32_bf16 a[52:55], v[84:87], v[100:103], a[52:55]
ds_read_b64 v[100:101], v24 offset:18432
ds_read_b64 v[102:103], v25 offset:18432
s_waitcnt lgkmcnt(6)
v_mfma_f32_16x16x32_bf16 a[24:27], v[80:83], v[104:107], a[24:27]
v_mfma_f32_16x16x32_bf16 a[56:59], v[84:87], v[104:107], a[56:59]
ds_read_b64 v[104:105], v24 offset:20480
ds_read_b64 v[106:107], v25 offset:20480
s_waitcnt lgkmcnt(6)
v_mfma_f32_16x16x32_bf16 a[28:31], v[80:83], v[108:111], a[28:31]
v_mfma_f32_16x16x32_bf16 a[60:63], v[84:87], v[108:111], a[60:63]
s_add_u32 s43, s48, 16384
buffer_load_dwordx4 v[80:83], v1, s[8:11], s43 offen offset:0 sc1
s_add_u32 s43, s48, 81920
buffer_load_dwordx4 v[84:87], v1, s[8:11], s43 offen offset:0 sc1
ds_read_b64 v[108:109], v24 offset:22528
ds_read_b64 v[110:111], v25 offset:22528
s_waitcnt vmcnt(18)
s_waitcnt lgkmcnt(6)
v_mfma_f32_16x16x32_bf16 a[0:3], v[88:91], v[96:99], a[0:3]
v_mfma_f32_16x16x32_bf16 a[32:35], v[92:95], v[96:99], a[32:35]
ds_read_b64 v[96:97], v24 offset:24576
ds_read_b64 v[98:99], v25 offset:24576
s_waitcnt lgkmcnt(6)
v_mfma_f32_16x16x32_bf16 a[4:7], v[88:91], v[100:103], a[4:7]
v_mfma_f32_16x16x32_bf16 a[36:39], v[92:95], v[100:103], a[36:39]
ds_read_b64 v[100:101], v24 offset:26624
ds_read_b64 v[102:103], v25 offset:26624
s_waitcnt lgkmcnt(6)
v_mfma_f32_16x16x32_bf16 a[8:11], v[88:91], v[104:107], a[8:11]
v_mfma_f32_16x16x32_bf16 a[40:43], v[92:95], v[104:107], a[40:43]
ds_read_b64 v[104:105], v24 offset:28672
ds_read_b64 v[106:107], v25 offset:28672
s_waitcnt lgkmcnt(6)
v_mfma_f32_16x16x32_bf16 a[12:15], v[88:91], v[108:111], a[12:15]
v_mfma_f32_16x16x32_bf16 a[44:47], v[92:95], v[108:111], a[44:47]
ds_read_b64 v[108:109], v24 offset:30720
ds_read_b64 v[110:111], v25 offset:30720
s_waitcnt lgkmcnt(6)
v_mfma_f32_16x16x32_bf16 a[16:19], v[88:91], v[96:99], a[16:19]
v_mfma_f32_16x16x32_bf16 a[48:51], v[92:95], v[96:99], a[48:51]
s_barrier
s_add_u32 s42, s49, 1280
s_add_u32 m0, s51, 65536
s_nop 0
buffer_load_dwordx4 v2, s[12:15], s42 offen lds
s_add_u32 m0, s51, 66560
s_add_u32 s42, s42, 32768
buffer_load_dwordx4 v3, s[12:15], s42 offen lds
s_add_u32 m0, s51, 67584
s_add_u32 s42, s42, 32768
buffer_load_dwordx4 v2, s[12:15], s42 offen lds
s_add_u32 m0, s51, 68608
s_add_u32 s42, s42, 32768
buffer_load_dwordx4 v3, s[12:15], s42 offen lds
ds_read_b64 v[96:97], v18 offset:0
ds_read_b64 v[98:99], v19 offset:0
s_waitcnt lgkmcnt(6)
v_mfma_f32_16x16x32_bf16 a[20:23], v[88:91], v[100:103], a[20:23]
v_mfma_f32_16x16x32_bf16 a[52:55], v[92:95], v[100:103], a[52:55]
ds_read_b64 v[100:101], v18 offset:2048
ds_read_b64 v[102:103], v19 offset:2048
s_waitcnt lgkmcnt(6)
v_mfma_f32_16x16x32_bf16 a[24:27], v[88:91], v[104:107], a[24:27]
v_mfma_f32_16x16x32_bf16 a[56:59], v[92:95], v[104:107], a[56:59]
ds_read_b64 v[104:105], v18 offset:4096
ds_read_b64 v[106:107], v19 offset:4096
s_waitcnt lgkmcnt(6)
v_mfma_f32_16x16x32_bf16 a[28:31], v[88:91], v[108:111], a[28:31]
v_mfma_f32_16x16x32_bf16 a[60:63], v[92:95], v[108:111], a[60:63]
s_add_u32 s43, s48, 16384
buffer_load_dwordx4 v[88:91], v1, s[8:11], s43 offen offset:1024 sc1
s_add_u32 s43, s48, 81920
buffer_load_dwordx4 v[92:95], v1, s[8:11], s43 offen offset:1024 sc1
ds_read_b64 v[108:109], v18 offset:6144
ds_read_b64 v[110:111], v19 offset:6144
s_waitcnt vmcnt(22)
s_waitcnt lgkmcnt(6)
v_mfma_f32_16x16x32_bf16 a[0:3], v[48:51], v[96:99], a[0:3]
v_mfma_f32_16x16x32_bf16 a[32:35], v[52:55], v[96:99], a[32:35]
ds_read_b64 v[96:97], v18 offset:8192
ds_read_b64 v[98:99], v19 offset:8192
s_waitcnt lgkmcnt(6)
v_mfma_f32_16x16x32_bf16 a[4:7], v[48:51], v[100:103], a[4:7]
v_mfma_f32_16x16x32_bf16 a[36:39], v[52:55], v[100:103], a[36:39]
ds_read_b64 v[100:101], v18 offset:10240
ds_read_b64 v[102:103], v19 offset:10240
s_waitcnt lgkmcnt(6)
v_mfma_f32_16x16x32_bf16 a[8:11], v[48:51], v[104:107], a[8:11]
v_mfma_f32_16x16x32_bf16 a[40:43], v[52:55], v[104:107], a[40:43]
ds_read_b64 v[104:105], v18 offset:12288
ds_read_b64 v[106:107], v19 offset:12288
s_waitcnt lgkmcnt(6)
v_mfma_f32_16x16x32_bf16 a[12:15], v[48:51], v[108:111], a[12:15]
v_mfma_f32_16x16x32_bf16 a[44:47], v[52:55], v[108:111], a[44:47]
ds_read_b64 v[108:109], v18 offset:14336
ds_read_b64 v[110:111], v19 offset:14336
s_waitcnt lgkmcnt(6)
v_mfma_f32_16x16x32_bf16 a[16:19], v[48:51], v[96:99], a[16:19]
v_mfma_f32_16x16x32_bf16 a[48:51], v[52:55], v[96:99], a[48:51]
ds_read_b64 v[96:97], v20 offset:0
ds_read_b64 v[98:99], v21 offset:0
s_waitcnt lgkmcnt(6)
v_mfma_f32_16x16x32_bf16 a[20:23], v[48:51], v[100:103], a[20:23]
v_mfma_f32_16x16x32_bf16 a[52:55], v[52:55], v[100:103], a[52:55]
ds_read_b64 v[100:101], v20 offset:2048
ds_read_b64 v[102:103], v21 offset:2048
s_waitcnt lgkmcnt(6)
v_mfma_f32_16x16x32_bf16 a[24:27], v[48:51], v[104:107], a[24:27]
v_mfma_f32_16x16x32_bf16 a[56:59], v[52:55], v[104:107], a[56:59]
ds_read_b64 v[104:105], v20 offset:4096
ds_read_b64 v[106:107], v21 offset:4096
s_waitcnt lgkmcnt(6)
v_mfma_f32_16x16x32_bf16 a[28:31], v[48:51], v[108:111], a[28:31]
v_mfma_f32_16x16x32_bf16 a[60:63], v[52:55], v[108:111], a[60:63]
s_add_u32 s43, s48, 16384
buffer_load_dwordx4 v[48:51], v1, s[8:11], s43 offen offset:2048 sc1
s_add_u32 s43, s48, 81920
buffer_load_dwordx4 v[52:55], v1, s[8:11], s43 offen offset:2048 sc1
ds_read_b64 v[108:109], v20 offset:6144
ds_read_b64 v[110:111], v21 offset:6144
s_waitcnt vmcnt(18)
s_waitcnt lgkmcnt(6)
v_mfma_f32_16x16x32_bf16 a[0:3], v[56:59], v[96:99], a[0:3]
v_mfma_f32_16x16x32_bf16 a[32:35], v[60:63], v[96:99], a[32:35]
ds_read_b64 v[96:97], v20 offset:8192
ds_read_b64 v[98:99], v21 offset:8192
s_waitcnt lgkmcnt(6)
v_mfma_f32_16x16x32_bf16 a[4:7], v[56:59], v[100:103], a[4:7]
v_mfma_f32_16x16x32_bf16 a[36:39], v[60:63], v[100:103], a[36:39]
ds_read_b64 v[100:101], v20 offset:10240
ds_read_b64 v[102:103], v21 offset:10240
s_waitcnt lgkmcnt(6)
v_mfma_f32_16x16x32_bf16 a[8:11], v[56:59], v[104:107], a[8:11]
v_mfma_f32_16x16x32_bf16 a[40:43], v[60:63], v[104:107], a[40:43]
ds_read_b64 v[104:105], v20 offset:12288
ds_read_b64 v[106:107], v21 offset:12288
s_waitcnt lgkmcnt(6)
v_mfma_f32_16x16x32_bf16 a[12:15], v[56:59], v[108:111], a[12:15]
v_mfma_f32_16x16x32_bf16 a[44:47], v[60:63], v[108:111], a[44:47]
ds_read_b64 v[108:109], v20 offset:14336
ds_read_b64 v[110:111], v21 offset:14336
s_waitcnt lgkmcnt(6)
v_mfma_f32_16x16x32_bf16 a[16:19], v[56:59], v[96:99], a[16:19]
v_mfma_f32_16x16x32_bf16 a[48:51], v[60:63], v[96:99], a[48:51]
s_barrier
s_add_u32 s42, s49, 1408
s_add_u32 m0, s51, 81920
s_nop 0
buffer_load_dwordx4 v2, s[12:15], s42 offen lds
s_add_u32 m0, s51, 82944
s_add_u32 s42, s42, 32768
buffer_load_dwordx4 v3, s[12:15], s42 offen lds
s_add_u32 m0, s51, 83968
s_add_u32 s42, s42, 32768
buffer_load_dwordx4 v2, s[12:15], s42 offen lds
s_add_u32 m0, s51, 84992
s_add_u32 s42, s42, 32768
buffer_load_dwordx4 v3, s[12:15], s42 offen lds
ds_read_b64 v[96:97], v18 offset:16384
ds_read_b64 v[98:99], v19 offset:16384
s_waitcnt lgkmcnt(6)
v_mfma_f32_16x16x32_bf16 a[20:23], v[56:59], v[100:103], a[20:23]
v_mfma_f32_16x16x32_bf16 a[52:55], v[60:63], v[100:103], a[52:55]
ds_read_b64 v[100:101], v18 offset:18432
ds_read_b64 v[102:103], v19 offset:18432
s_waitcnt lgkmcnt(6)
v_mfma_f32_16x16x32_bf16 a[24:27], v[56:59], v[104:107], a[24:27]
v_mfma_f32_16x16x32_bf16 a[56:59], v[60:63], v[104:107], a[56:59]
ds_read_b64 v[104:105], v18 offset:20480
ds_read_b64 v[106:107], v19 offset:20480
s_waitcnt lgkmcnt(6)
v_mfma_f32_16x16x32_bf16 a[28:31], v[56:59], v[108:111], a[28:31]
v_mfma_f32_16x16x32_bf16 a[60:63], v[60:63], v[108:111], a[60:63]
s_add_u32 s43, s48, 16384
buffer_load_dwordx4 v[56:59], v1, s[8:11], s43 offen offset:3072 sc1
s_add_u32 s43, s48, 81920
buffer_load_dwordx4 v[60:63], v1, s[8:11], s43 offen offset:3072 sc1
ds_read_b64 v[108:109], v18 offset:22528
ds_read_b64 v[110:111], v19 offset:22528
s_waitcnt vmcnt(22)
s_waitcnt lgkmcnt(6)
v_mfma_f32_16x16x32_bf16 a[0:3], v[64:67], v[96:99], a[0:3]
v_mfma_f32_16x16x32_bf16 a[32:35], v[68:71], v[96:99], a[32:35]
ds_read_b64 v[96:97], v18 offset:24576
ds_read_b64 v[98:99], v19 offset:24576
s_waitcnt lgkmcnt(6)
v_mfma_f32_16x16x32_bf16 a[4:7], v[64:67], v[100:103], a[4:7]
v_mfma_f32_16x16x32_bf16 a[36:39], v[68:71], v[100:103], a[36:39]
ds_read_b64 v[100:101], v18 offset:26624
ds_read_b64 v[102:103], v19 offset:26624
s_waitcnt lgkmcnt(6)
v_mfma_f32_16x16x32_bf16 a[8:11], v[64:67], v[104:107], a[8:11]
v_mfma_f32_16x16x32_bf16 a[40:43], v[68:71], v[104:107], a[40:43]
ds_read_b64 v[104:105], v18 offset:28672
ds_read_b64 v[106:107], v19 offset:28672
s_waitcnt lgkmcnt(6)
v_mfma_f32_16x16x32_bf16 a[12:15], v[64:67], v[108:111], a[12:15]
v_mfma_f32_16x16x32_bf16 a[44:47], v[68:71], v[108:111], a[44:47]
ds_read_b64 v[108:109], v18 offset:30720
ds_read_b64 v[110:111], v19 offset:30720
s_waitcnt lgkmcnt(6)
v_mfma_f32_16x16x32_bf16 a[16:19], v[64:67], v[96:99], a[16:19]
v_mfma_f32_16x16x32_bf16 a[48:51], v[68:71], v[96:99], a[48:51]
ds_read_b64 v[96:97], v20 offset:16384
ds_read_b64 v[98:99], v21 offset:16384
s_waitcnt lgkmcnt(6)
v_mfma_f32_16x16x32_bf16 a[20:23], v[64:67], v[100:103], a[20:23]
v_mfma_f32_16x16x32_bf16 a[52:55], v[68:71], v[100:103], a[52:55]
ds_read_b64 v[100:101], v20 offset:18432
ds_read_b64 v[102:103], v21 offset:18432
s_waitcnt lgkmcnt(6)
v_mfma_f32_16x16x32_bf16 a[24:27], v[64:67], v[104:107], a[24:27]
v_mfma_f32_16x16x32_bf16 a[56:59], v[68:71], v[104:107], a[56:59]
ds_read_b64 v[104:105], v20 offset:20480
ds_read_b64 v[106:107], v21 offset:20480
s_waitcnt lgkmcnt(6)
v_mfma_f32_16x16x32_bf16 a[28:31], v[64:67], v[108:111], a[28:31]
v_mfma_f32_16x16x32_bf16 a[60:63], v[68:71], v[108:111], a[60:63]
s_add_u32 s43, s48, 20480
buffer_load_dwordx4 v[64:67], v1, s[8:11], s43 offen offset:0 sc1
s_add_u32 s43, s48, 86016
buffer_load_dwordx4 v[68:71], v1, s[8:11], s43 offen offset:0 sc1
ds_read_b64 v[108:109], v20 offset:22528
ds_read_b64 v[110:111], v21 offset:22528
s_waitcnt vmcnt(18)
s_waitcnt lgkmcnt(6)
v_mfma_f32_16x16x32_bf16 a[0:3], v[72:75], v[96:99], a[0:3]
v_mfma_f32_16x16x32_bf16 a[32:35], v[76:79], v[96:99], a[32:35]
ds_read_b64 v[96:97], v20 offset:24576
ds_read_b64 v[98:99], v21 offset:24576
s_waitcnt lgkmcnt(6)
v_mfma_f32_16x16x32_bf16 a[4:7], v[72:75], v[100:103], a[4:7]
v_mfma_f32_16x16x32_bf16 a[36:39], v[76:79], v[100:103], a[36:39]
ds_read_b64 v[100:101], v20 offset:26624
ds_read_b64 v[102:103], v21 offset:26624
s_waitcnt lgkmcnt(6)
v_mfma_f32_16x16x32_bf16 a[8:11], v[72:75], v[104:107], a[8:11]
v_mfma_f32_16x16x32_bf16 a[40:43], v[76:79], v[104:107], a[40:43]
ds_read_b64 v[104:105], v20 offset:28672
ds_read_b64 v[106:107], v21 offset:28672
s_waitcnt lgkmcnt(6)
v_mfma_f32_16x16x32_bf16 a[12:15], v[72:75], v[108:111], a[12:15]
v_mfma_f32_16x16x32_bf16 a[44:47], v[76:79], v[108:111], a[44:47]
ds_read_b64 v[108:109], v20 offset:30720
ds_read_b64 v[110:111], v21 offset:30720
s_waitcnt lgkmcnt(6)
v_mfma_f32_16x16x32_bf16 a[16:19], v[72:75], v[96:99], a[16:19]
v_mfma_f32_16x16x32_bf16 a[48:51], v[76:79], v[96:99], a[48:51]
s_barrier
s_add_u32 s42, s49, 1536
s_add_u32 m0, s51, 0
s_nop 0
buffer_load_dwordx4 v2, s[12:15], s42 offen lds
s_add_u32 m0, s51, 1024
s_add_u32 s42, s42, 32768
buffer_load_dwordx4 v3, s[12:15], s42 offen lds
s_add_u32 m0, s51, 2048
s_add_u32 s42, s42, 32768
buffer_load_dwordx4 v2, s[12:15], s42 offen lds
s_add_u32 m0, s51, 3072
s_add_u32 s42, s42, 32768
buffer_load_dwordx4 v3, s[12:15], s42 offen lds
ds_read_b64 v[96:97], v18 offset:32768
ds_read_b64 v[98:99], v19 offset:32768
s_waitcnt lgkmcnt(6)
v_mfma_f32_16x16x32_bf16 a[20:23], v[72:75], v[100:103], a[20:23]
v_mfma_f32_16x16x32_bf16 a[52:55], v[76:79], v[100:103], a[52:55]
ds_read_b64 v[100:101], v18 offset:34816
ds_read_b64 v[102:103], v19 offset:34816
s_waitcnt lgkmcnt(6)
v_mfma_f32_16x16x32_bf16 a[24:27], v[72:75], v[104:107], a[24:27]
v_mfma_f32_16x16x32_bf16 a[56:59], v[76:79], v[104:107], a[56:59]
ds_read_b64 v[104:105], v18 offset:36864
ds_read_b64 v[106:107], v19 offset:36864
s_waitcnt lgkmcnt(6)
v_mfma_f32_16x16x32_bf16 a[28:31], v[72:75], v[108:111], a[28:31]
v_mfma_f32_16x16x32_bf16 a[60:63], v[76:79], v[108:111], a[60:63]
s_add_u32 s43, s48, 20480
buffer_load_dwordx4 v[72:75], v1, s[8:11], s43 offen offset:1024 sc1
s_add_u32 s43, s48, 86016
buffer_load_dwordx4 v[76:79], v1, s[8:11], s43 offen offset:1024 sc1
ds_read_b64 v[108:109], v18 offset:38912
ds_read_b64 v[110:111], v19 offset:38912
s_waitcnt vmcnt(22)
s_waitcnt lgkmcnt(6)
v_mfma_f32_16x16x32_bf16 a[0:3], v[80:83], v[96:99], a[0:3]
v_mfma_f32_16x16x32_bf16 a[32:35], v[84:87], v[96:99], a[32:35]
ds_read_b64 v[96:97], v18 offset:40960
ds_read_b64 v[98:99], v19 offset:40960
s_waitcnt lgkmcnt(6)
v_mfma_f32_16x16x32_bf16 a[4:7], v[80:83], v[100:103], a[4:7]
v_mfma_f32_16x16x32_bf16 a[36:39], v[84:87], v[100:103], a[36:39]
ds_read_b64 v[100:101], v18 offset:43008
ds_read_b64 v[102:103], v19 offset:43008
s_waitcnt lgkmcnt(6)
v_mfma_f32_16x16x32_bf16 a[8:11], v[80:83], v[104:107], a[8:11]
v_mfma_f32_16x16x32_bf16 a[40:43], v[84:87], v[104:107], a[40:43]
ds_read_b64 v[104:105], v18 offset:45056
ds_read_b64 v[106:107], v19 offset:45056
s_waitcnt lgkmcnt(6)
v_mfma_f32_16x16x32_bf16 a[12:15], v[80:83], v[108:111], a[12:15]
v_mfma_f32_16x16x32_bf16 a[44:47], v[84:87], v[108:111], a[44:47]
ds_read_b64 v[108:109], v18 offset:47104
ds_read_b64 v[110:111], v19 offset:47104
s_waitcnt lgkmcnt(6)
v_mfma_f32_16x16x32_bf16 a[16:19], v[80:83], v[96:99], a[16:19]
v_mfma_f32_16x16x32_bf16 a[48:51], v[84:87], v[96:99], a[48:51]
ds_read_b64 v[96:97], v20 offset:32768
ds_read_b64 v[98:99], v21 offset:32768
s_waitcnt lgkmcnt(6)
v_mfma_f32_16x16x32_bf16 a[20:23], v[80:83], v[100:103], a[20:23]
v_mfma_f32_16x16x32_bf16 a[52:55], v[84:87], v[100:103], a[52:55]
ds_read_b64 v[100:101], v20 offset:34816
ds_read_b64 v[102:103], v21 offset:34816
s_waitcnt lgkmcnt(6)
v_mfma_f32_16x16x32_bf16 a[24:27], v[80:83], v[104:107], a[24:27]
v_mfma_f32_16x16x32_bf16 a[56:59], v[84:87], v[104:107], a[56:59]
ds_read_b64 v[104:105], v20 offset:36864
ds_read_b64 v[106:107], v21 offset:36864
s_waitcnt lgkmcnt(6)
v_mfma_f32_16x16x32_bf16 a[28:31], v[80:83], v[108:111], a[28:31]
v_mfma_f32_16x16x32_bf16 a[60:63], v[84:87], v[108:111], a[60:63]
s_add_u32 s43, s48, 20480
buffer_load_dwordx4 v[80:83], v1, s[8:11], s43 offen offset:2048 sc1
s_add_u32 s43, s48, 86016
buffer_load_dwordx4 v[84:87], v1, s[8:11], s43 offen offset:2048 sc1
ds_read_b64 v[108:109], v20 offset:38912
ds_read_b64 v[110:111], v21 offset:38912
s_waitcnt vmcnt(18)
s_waitcnt lgkmcnt(6)
v_mfma_f32_16x16x32_bf16 a[0:3], v[88:91], v[96:99], a[0:3]
v_mfma_f32_16x16x32_bf16 a[32:35], v[92:95], v[96:99], a[32:35]
ds_read_b64 v[96:97], v20 offset:40960
ds_read_b64 v[98:99], v21 offset:40960
s_waitcnt lgkmcnt(6)
v_mfma_f32_16x16x32_bf16 a[4:7], v[88:91], v[100:103], a[4:7]
v_mfma_f32_16x16x32_bf16 a[36:39], v[92:95], v[100:103], a[36:39]
ds_read_b64 v[100:101], v20 offset:43008
ds_read_b64 v[102:103], v21 offset:43008
s_waitcnt lgkmcnt(6)
v_mfma_f32_16x16x32_bf16 a[8:11], v[88:91], v[104:107], a[8:11]
v_mfma_f32_16x16x32_bf16 a[40:43], v[92:95], v[104:107], a[40:43]
ds_read_b64 v[104:105], v20 offset:45056
ds_read_b64 v[106:107], v21 offset:45056
s_waitcnt lgkmcnt(6)
v_mfma_f32_16x16x32_bf16 a[12:15], v[88:91], v[108:111], a[12:15]
v_mfma_f32_16x16x32_bf16 a[44:47], v[92:95], v[108:111], a[44:47]
ds_read_b64 v[108:109], v20 offset:47104
ds_read_b64 v[110:111], v21 offset:47104
s_waitcnt lgkmcnt(6)
v_mfma_f32_16x16x32_bf16 a[16:19], v[88:91], v[96:99], a[16:19]
v_mfma_f32_16x16x32_bf16 a[48:51], v[92:95], v[96:99], a[48:51]
s_barrier
s_add_u32 s42, s49, 1664
s_add_u32 m0, s51, 16384
s_nop 0
buffer_load_dwordx4 v2, s[12:15], s42 offen lds
s_add_u32 m0, s51, 17408
s_add_u32 s42, s42, 32768
buffer_load_dwordx4 v3, s[12:15], s42 offen lds
s_add_u32 m0, s51, 18432
s_add_u32 s42, s42, 32768
buffer_load_dwordx4 v2, s[12:15], s42 offen lds
s_add_u32 m0, s51, 19456
s_add_u32 s42, s42, 32768
buffer_load_dwordx4 v3, s[12:15], s42 offen lds
ds_read_b64 v[96:97], v18 offset:49152
ds_read_b64 v[98:99], v19 offset:49152
s_waitcnt lgkmcnt(6)
v_mfma_f32_16x16x32_bf16 a[20:23], v[88:91], v[100:103], a[20:23]
v_mfma_f32_16x16x32_bf16 a[52:55], v[92:95], v[100:103], a[52:55]
ds_read_b64 v[100:101], v18 offset:51200
ds_read_b64 v[102:103], v19 offset:51200
s_waitcnt lgkmcnt(6)
v_mfma_f32_16x16x32_bf16 a[24:27], v[88:91], v[104:107], a[24:27]
v_mfma_f32_16x16x32_bf16 a[56:59], v[92:95], v[104:107], a[56:59]
ds_read_b64 v[104:105], v18 offset:53248
ds_read_b64 v[106:107], v19 offset:53248
s_waitcnt lgkmcnt(6)
v_mfma_f32_16x16x32_bf16 a[28:31], v[88:91], v[108:111], a[28:31]
v_mfma_f32_16x16x32_bf16 a[60:63], v[92:95], v[108:111], a[60:63]
s_add_u32 s43, s48, 20480
buffer_load_dwordx4 v[88:91], v1, s[8:11], s43 offen offset:3072 sc1
s_add_u32 s43, s48, 86016
buffer_load_dwordx4 v[92:95], v1, s[8:11], s43 offen offset:3072 sc1
ds_read_b64 v[108:109], v18 offset:55296
ds_read_b64 v[110:111], v19 offset:55296
s_waitcnt vmcnt(22)
s_waitcnt lgkmcnt(6)
v_mfma_f32_16x16x32_bf16 a[0:3], v[48:51], v[96:99], a[0:3]
v_mfma_f32_16x16x32_bf16 a[32:35], v[52:55], v[96:99], a[32:35]
ds_read_b64 v[96:97], v18 offset:57344
ds_read_b64 v[98:99], v19 offset:57344
s_waitcnt lgkmcnt(6)
v_mfma_f32_16x16x32_bf16 a[4:7], v[48:51], v[100:103], a[4:7]
v_mfma_f32_16x16x32_bf16 a[36:39], v[52:55], v[100:103], a[36:39]
ds_read_b64 v[100:101], v18 offset:59392
ds_read_b64 v[102:103], v19 offset:59392
s_waitcnt lgkmcnt(6)
v_mfma_f32_16x16x32_bf16 a[8:11], v[48:51], v[104:107], a[8:11]
v_mfma_f32_16x16x32_bf16 a[40:43], v[52:55], v[104:107], a[40:43]
ds_read_b64 v[104:105], v18 offset:61440
ds_read_b64 v[106:107], v19 offset:61440
s_waitcnt lgkmcnt(6)
v_mfma_f32_16x16x32_bf16 a[12:15], v[48:51], v[108:111], a[12:15]
v_mfma_f32_16x16x32_bf16 a[44:47], v[52:55], v[108:111], a[44:47]
ds_read_b64 v[108:109], v18 offset:63488
ds_read_b64 v[110:111], v19 offset:63488
s_waitcnt lgkmcnt(6)
v_mfma_f32_16x16x32_bf16 a[16:19], v[48:51], v[96:99], a[16:19]
v_mfma_f32_16x16x32_bf16 a[48:51], v[52:55], v[96:99], a[48:51]
ds_read_b64 v[96:97], v20 offset:49152
ds_read_b64 v[98:99], v21 offset:49152
s_waitcnt lgkmcnt(6)
v_mfma_f32_16x16x32_bf16 a[20:23], v[48:51], v[100:103], a[20:23]
v_mfma_f32_16x16x32_bf16 a[52:55], v[52:55], v[100:103], a[52:55]
ds_read_b64 v[100:101], v20 offset:51200
ds_read_b64 v[102:103], v21 offset:51200
s_waitcnt lgkmcnt(6)
v_mfma_f32_16x16x32_bf16 a[24:27], v[48:51], v[104:107], a[24:27]
v_mfma_f32_16x16x32_bf16 a[56:59], v[52:55], v[104:107], a[56:59]
ds_read_b64 v[104:105], v20 offset:53248
ds_read_b64 v[106:107], v21 offset:53248
s_waitcnt lgkmcnt(6)
v_mfma_f32_16x16x32_bf16 a[28:31], v[48:51], v[108:111], a[28:31]
v_mfma_f32_16x16x32_bf16 a[60:63], v[52:55], v[108:111], a[60:63]
s_add_u32 s43, s48, 24576
buffer_load_dwordx4 v[48:51], v1, s[8:11], s43 offen offset:0 sc1
s_add_u32 s43, s48, 90112
buffer_load_dwordx4 v[52:55], v1, s[8:11], s43 offen offset:0 sc1
ds_read_b64 v[108:109], v20 offset:55296
ds_read_b64 v[110:111], v21 offset:55296
s_waitcnt vmcnt(18)
s_waitcnt lgkmcnt(6)
v_mfma_f32_16x16x32_bf16 a[0:3], v[56:59], v[96:99], a[0:3]
v_mfma_f32_16x16x32_bf16 a[32:35], v[60:63], v[96:99], a[32:35]
ds_read_b64 v[96:97], v20 offset:57344
ds_read_b64 v[98:99], v21 offset:57344
s_waitcnt lgkmcnt(6)
v_mfma_f32_16x16x32_bf16 a[4:7], v[56:59], v[100:103], a[4:7]
v_mfma_f32_16x16x32_bf16 a[36:39], v[60:63], v[100:103], a[36:39]
ds_read_b64 v[100:101], v20 offset:59392
ds_read_b64 v[102:103], v21 offset:59392
s_waitcnt lgkmcnt(6)
v_mfma_f32_16x16x32_bf16 a[8:11], v[56:59], v[104:107], a[8:11]
v_mfma_f32_16x16x32_bf16 a[40:43], v[60:63], v[104:107], a[40:43]
ds_read_b64 v[104:105], v20 offset:61440
ds_read_b64 v[106:107], v21 offset:61440
s_waitcnt lgkmcnt(6)
v_mfma_f32_16x16x32_bf16 a[12:15], v[56:59], v[108:111], a[12:15]
v_mfma_f32_16x16x32_bf16 a[44:47], v[60:63], v[108:111], a[44:47]
ds_read_b64 v[108:109], v20 offset:63488
ds_read_b64 v[110:111], v21 offset:63488
s_waitcnt lgkmcnt(6)
v_mfma_f32_16x16x32_bf16 a[16:19], v[56:59], v[96:99], a[16:19]
v_mfma_f32_16x16x32_bf16 a[48:51], v[60:63], v[96:99], a[48:51]
s_barrier
ds_read_b64 v[96:97], v22 offset:0
ds_read_b64 v[98:99], v23 offset:0
s_waitcnt lgkmcnt(6)
v_mfma_f32_16x16x32_bf16 a[20:23], v[56:59], v[100:103], a[20:23]
v_mfma_f32_16x16x32_bf16 a[52:55], v[60:63], v[100:103], a[52:55]
ds_read_b64 v[100:101], v22 offset:2048
ds_read_b64 v[102:103], v23 offset:2048
s_waitcnt lgkmcnt(6)
v_mfma_f32_16x16x32_bf16 a[24:27], v[56:59], v[104:107], a[24:27]
v_mfma_f32_16x16x32_bf16 a[56:59], v[60:63], v[104:107], a[56:59]
ds_read_b64 v[104:105], v22 offset:4096
ds_read_b64 v[106:107], v23 offset:4096
s_waitcnt lgkmcnt(6)
v_mfma_f32_16x16x32_bf16 a[28:31], v[56:59], v[108:111], a[28:31]
v_mfma_f32_16x16x32_bf16 a[60:63], v[60:63], v[108:111], a[60:63]
s_add_u32 s43, s48, 24576
buffer_load_dwordx4 v[56:59], v1, s[8:11], s43 offen offset:1024 sc1
s_add_u32 s43, s48, 90112
buffer_load_dwordx4 v[60:63], v1, s[8:11], s43 offen offset:1024 sc1
ds_read_b64 v[108:109], v22 offset:6144
ds_read_b64 v[110:111], v23 offset:6144
s_waitcnt vmcnt(18)
s_waitcnt lgkmcnt(6)
v_mfma_f32_16x16x32_bf16 a[0:3], v[64:67], v[96:99], a[0:3]
v_mfma_f32_16x16x32_bf16 a[32:35], v[68:71], v[96:99], a[32:35]
ds_read_b64 v[96:97], v22 offset:8192
ds_read_b64 v[98:99], v23 offset:8192
s_waitcnt lgkmcnt(6)
v_mfma_f32_16x16x32_bf16 a[4:7], v[64:67], v[100:103], a[4:7]
v_mfma_f32_16x16x32_bf16 a[36:39], v[68:71], v[100:103], a[36:39]
ds_read_b64 v[100:101], v22 offset:10240
ds_read_b64 v[102:103], v23 offset:10240
s_waitcnt lgkmcnt(6)
v_mfma_f32_16x16x32_bf16 a[8:11], v[64:67], v[104:107], a[8:11]
v_mfma_f32_16x16x32_bf16 a[40:43], v[68:71], v[104:107], a[40:43]
ds_read_b64 v[104:105], v22 offset:12288
ds_read_b64 v[106:107], v23 offset:12288
s_waitcnt lgkmcnt(6)
v_mfma_f32_16x16x32_bf16 a[12:15], v[64:67], v[108:111], a[12:15]
v_mfma_f32_16x16x32_bf16 a[44:47], v[68:71], v[108:111], a[44:47]
ds_read_b64 v[108:109], v22 offset:14336
ds_read_b64 v[110:111], v23 offset:14336
s_waitcnt lgkmcnt(6)
v_mfma_f32_16x16x32_bf16 a[16:19], v[64:67], v[96:99], a[16:19]
v_mfma_f32_16x16x32_bf16 a[48:51], v[68:71], v[96:99], a[48:51]
ds_read_b64 v[96:97], v24 offset:0
ds_read_b64 v[98:99], v25 offset:0
s_waitcnt lgkmcnt(6)
v_mfma_f32_16x16x32_bf16 a[20:23], v[64:67], v[100:103], a[20:23]
v_mfma_f32_16x16x32_bf16 a[52:55], v[68:71], v[100:103], a[52:55]
ds_read_b64 v[100:101], v24 offset:2048
ds_read_b64 v[102:103], v25 offset:2048
s_waitcnt lgkmcnt(6)
v_mfma_f32_16x16x32_bf16 a[24:27], v[64:67], v[104:107], a[24:27]
v_mfma_f32_16x16x32_bf16 a[56:59], v[68:71], v[104:107], a[56:59]
ds_read_b64 v[104:105], v24 offset:4096
ds_read_b64 v[106:107], v25 offset:4096
s_waitcnt lgkmcnt(6)
v_mfma_f32_16x16x32_bf16 a[28:31], v[64:67], v[108:111], a[28:31]
v_mfma_f32_16x16x32_bf16 a[60:63], v[68:71], v[108:111], a[60:63]
s_add_u32 s43, s48, 24576
buffer_load_dwordx4 v[64:67], v1, s[8:11], s43 offen offset:2048 sc1
s_add_u32 s43, s48, 90112
buffer_load_dwordx4 v[68:71], v1, s[8:11], s43 offen offset:2048 sc1
ds_read_b64 v[108:109], v24 offset:6144
ds_read_b64 v[110:111], v25 offset:6144
s_waitcnt vmcnt(14)
s_waitcnt lgkmcnt(6)
v_mfma_f32_16x16x32_bf16 a[0:3], v[72:75], v[96:99], a[0:3]
v_mfma_f32_16x16x32_bf16 a[32:35], v[76:79], v[96:99], a[32:35]
ds_read_b64 v[96:97], v24 offset:8192
ds_read_b64 v[98:99], v25 offset:8192
s_waitcnt lgkmcnt(6)
v_mfma_f32_16x16x32_bf16 a[4:7], v[72:75], v[100:103], a[4:7]
v_mfma_f32_16x16x32_bf16 a[36:39], v[76:79], v[100:103], a[36:39]
ds_read_b64 v[100:101], v24 offset:10240
ds_read_b64 v[102:103], v25 offset:10240
s_waitcnt lgkmcnt(6)
v_mfma_f32_16x16x32_bf16 a[8:11], v[72:75], v[104:107], a[8:11]
v_mfma_f32_16x16x32_bf16 a[40:43], v[76:79], v[104:107], a[40:43]
ds_read_b64 v[104:105], v24 offset:12288
ds_read_b64 v[106:107], v25 offset:12288
s_waitcnt lgkmcnt(6)
v_mfma_f32_16x16x32_bf16 a[12:15], v[72:75], v[108:111], a[12:15]
v_mfma_f32_16x16x32_bf16 a[44:47], v[76:79], v[108:111], a[44:47]
ds_read_b64 v[108:109], v24 offset:14336
ds_read_b64 v[110:111], v25 offset:14336
s_waitcnt lgkmcnt(6)
v_mfma_f32_16x16x32_bf16 a[16:19], v[72:75], v[96:99], a[16:19]
v_mfma_f32_16x16x32_bf16 a[48:51], v[76:79], v[96:99], a[48:51]
s_barrier
ds_read_b64 v[96:97], v22 offset:16384
ds_read_b64 v[98:99], v23 offset:16384
s_waitcnt lgkmcnt(6)
v_mfma_f32_16x16x32_bf16 a[20:23], v[72:75], v[100:103], a[20:23]
v_mfma_f32_16x16x32_bf16 a[52:55], v[76:79], v[100:103], a[52:55]
ds_read_b64 v[100:101], v22 offset:18432
ds_read_b64 v[102:103], v23 offset:18432
s_waitcnt lgkmcnt(6)
v_mfma_f32_16x16x32_bf16 a[24:27], v[72:75], v[104:107], a[24:27]
v_mfma_f32_16x16x32_bf16 a[56:59], v[76:79], v[104:107], a[56:59]
ds_read_b64 v[104:105], v22 offset:20480
ds_read_b64 v[106:107], v23 offset:20480
s_waitcnt lgkmcnt(6)
v_mfma_f32_16x16x32_bf16 a[28:31], v[72:75], v[108:111], a[28:31]
v_mfma_f32_16x16x32_bf16 a[60:63], v[76:79], v[108:111], a[60:63]
s_add_u32 s43, s48, 24576
buffer_load_dwordx4 v[72:75], v1, s[8:11], s43 offen offset:3072 sc1
s_add_u32 s43, s48, 90112
buffer_load_dwordx4 v[76:79], v1, s[8:11], s43 offen offset:3072 sc1
ds_read_b64 v[108:109], v22 offset:22528
ds_read_b64 v[110:111], v23 offset:22528
s_waitcnt vmcnt(14)
s_waitcnt lgkmcnt(6)
v_mfma_f32_16x16x32_bf16 a[0:3], v[80:83], v[96:99], a[0:3]
v_mfma_f32_16x16x32_bf16 a[32:35], v[84:87], v[96:99], a[32:35]
ds_read_b64 v[96:97], v22 offset:24576
ds_read_b64 v[98:99], v23 offset:24576
s_waitcnt lgkmcnt(6)
v_mfma_f32_16x16x32_bf16 a[4:7], v[80:83], v[100:103], a[4:7]
v_mfma_f32_16x16x32_bf16 a[36:39], v[84:87], v[100:103], a[36:39]
ds_read_b64 v[100:101], v22 offset:26624
ds_read_b64 v[102:103], v23 offset:26624
s_waitcnt lgkmcnt(6)
v_mfma_f32_16x16x32_bf16 a[8:11], v[80:83], v[104:107], a[8:11]
v_mfma_f32_16x16x32_bf16 a[40:43], v[84:87], v[104:107], a[40:43]
ds_read_b64 v[104:105], v22 offset:28672
ds_read_b64 v[106:107], v23 offset:28672
s_waitcnt lgkmcnt(6)
v_mfma_f32_16x16x32_bf16 a[12:15], v[80:83], v[108:111], a[12:15]
v_mfma_f32_16x16x32_bf16 a[44:47], v[84:87], v[108:111], a[44:47]
ds_read_b64 v[108:109], v22 offset:30720
ds_read_b64 v[110:111], v23 offset:30720
s_waitcnt lgkmcnt(6)
v_mfma_f32_16x16x32_bf16 a[16:19], v[80:83], v[96:99], a[16:19]
v_mfma_f32_16x16x32_bf16 a[48:51], v[84:87], v[96:99], a[48:51]
ds_read_b64 v[96:97], v24 offset:16384
ds_read_b64 v[98:99], v25 offset:16384
s_waitcnt lgkmcnt(6)
v_mfma_f32_16x16x32_bf16 a[20:23], v[80:83], v[100:103], a[20:23]
v_mfma_f32_16x16x32_bf16 a[52:55], v[84:87], v[100:103], a[52:55]
ds_read_b64 v[100:101], v24 offset:18432
ds_read_b64 v[102:103], v25 offset:18432
s_waitcnt lgkmcnt(6)
v_mfma_f32_16x16x32_bf16 a[24:27], v[80:83], v[104:107], a[24:27]
v_mfma_f32_16x16x32_bf16 a[56:59], v[84:87], v[104:107], a[56:59]
ds_read_b64 v[104:105], v24 offset:20480
ds_read_b64 v[106:107], v25 offset:20480
s_waitcnt lgkmcnt(6)
v_mfma_f32_16x16x32_bf16 a[28:31], v[80:83], v[108:111], a[28:31]
v_mfma_f32_16x16x32_bf16 a[60:63], v[84:87], v[108:111], a[60:63]
ds_read_b64 v[108:109], v24 offset:22528
ds_read_b64 v[110:111], v25 offset:22528
s_waitcnt vmcnt(8)
s_waitcnt lgkmcnt(6)
v_mfma_f32_16x16x32_bf16 a[0:3], v[88:91], v[96:99], a[0:3]
v_mfma_f32_16x16x32_bf16 a[32:35], v[92:95], v[96:99], a[32:35]
ds_read_b64 v[96:97], v24 offset:24576
ds_read_b64 v[98:99], v25 offset:24576
s_waitcnt lgkmcnt(6)
v_mfma_f32_16x16x32_bf16 a[4:7], v[88:91], v[100:103], a[4:7]
v_mfma_f32_16x16x32_bf16 a[36:39], v[92:95], v[100:103], a[36:39]
ds_read_b64 v[100:101], v24 offset:26624
ds_read_b64 v[102:103], v25 offset:26624
s_waitcnt lgkmcnt(6)
v_mfma_f32_16x16x32_bf16 a[8:11], v[88:91], v[104:107], a[8:11]
v_mfma_f32_16x16x32_bf16 a[40:43], v[92:95], v[104:107], a[40:43]
ds_read_b64 v[104:105], v24 offset:28672
ds_read_b64 v[106:107], v25 offset:28672
s_waitcnt lgkmcnt(6)
v_mfma_f32_16x16x32_bf16 a[12:15], v[88:91], v[108:111], a[12:15]
v_mfma_f32_16x16x32_bf16 a[44:47], v[92:95], v[108:111], a[44:47]
ds_read_b64 v[108:109], v24 offset:30720
ds_read_b64 v[110:111], v25 offset:30720
s_waitcnt lgkmcnt(6)
v_mfma_f32_16x16x32_bf16 a[16:19], v[88:91], v[96:99], a[16:19]
v_mfma_f32_16x16x32_bf16 a[48:51], v[92:95], v[96:99], a[48:51]
s_barrier
ds_read_b64 v[96:97], v18 offset:0
ds_read_b64 v[98:99], v19 offset:0
s_waitcnt lgkmcnt(6)
v_mfma_f32_16x16x32_bf16 a[20:23], v[88:91], v[100:103], a[20:23]
v_mfma_f32_16x16x32_bf16 a[52:55], v[92:95], v[100:103], a[52:55]
ds_read_b64 v[100:101], v18 offset:2048
ds_read_b64 v[102:103], v19 offset:2048
s_waitcnt lgkmcnt(6)
v_mfma_f32_16x16x32_bf16 a[24:27], v[88:91], v[104:107], a[24:27]
v_mfma_f32_16x16x32_bf16 a[56:59], v[92:95], v[104:107], a[56:59]
ds_read_b64 v[104:105], v18 offset:4096
ds_read_b64 v[106:107], v19 offset:4096
s_waitcnt lgkmcnt(6)
v_mfma_f32_16x16x32_bf16 a[28:31], v[88:91], v[108:111], a[28:31]
v_mfma_f32_16x16x32_bf16 a[60:63], v[92:95], v[108:111], a[60:63]
ds_read_b64 v[108:109], v18 offset:6144
ds_read_b64 v[110:111], v19 offset:6144
s_waitcnt vmcnt(6)
s_waitcnt lgkmcnt(6)
v_mfma_f32_16x16x32_bf16 a[0:3], v[48:51], v[96:99], a[0:3]
v_mfma_f32_16x16x32_bf16 a[32:35], v[52:55], v[96:99], a[32:35]
ds_read_b64 v[96:97], v18 offset:8192
ds_read_b64 v[98:99], v19 offset:8192
s_waitcnt lgkmcnt(6)
v_mfma_f32_16x16x32_bf16 a[4:7], v[48:51], v[100:103], a[4:7]
v_mfma_f32_16x16x32_bf16 a[36:39], v[52:55], v[100:103], a[36:39]
ds_read_b64 v[100:101], v18 offset:10240
ds_read_b64 v[102:103], v19 offset:10240
s_waitcnt lgkmcnt(6)
v_mfma_f32_16x16x32_bf16 a[8:11], v[48:51], v[104:107], a[8:11]
v_mfma_f32_16x16x32_bf16 a[40:43], v[52:55], v[104:107], a[40:43]
ds_read_b64 v[104:105], v18 offset:12288
ds_read_b64 v[106:107], v19 offset:12288
s_waitcnt lgkmcnt(6)
v_mfma_f32_16x16x32_bf16 a[12:15], v[48:51], v[108:111], a[12:15]
v_mfma_f32_16x16x32_bf16 a[44:47], v[52:55], v[108:111], a[44:47]
ds_read_b64 v[108:109], v18 offset:14336
ds_read_b64 v[110:111], v19 offset:14336
s_waitcnt lgkmcnt(6)
v_mfma_f32_16x16x32_bf16 a[16:19], v[48:51], v[96:99], a[16:19]
v_mfma_f32_16x16x32_bf16 a[48:51], v[52:55], v[96:99], a[48:51]
ds_read_b64 v[96:97], v20 offset:0
ds_read_b64 v[98:99], v21 offset:0
s_waitcnt lgkmcnt(6)
v_mfma_f32_16x16x32_bf16 a[20:23], v[48:51], v[100:103], a[20:23]
v_mfma_f32_16x16x32_bf16 a[52:55], v[52:55], v[100:103], a[52:55]
ds_read_b64 v[100:101], v20 offset:2048
ds_read_b64 v[102:103], v21 offset:2048
s_waitcnt lgkmcnt(6)
v_mfma_f32_16x16x32_bf16 a[24:27], v[48:51], v[104:107], a[24:27]
v_mfma_f32_16x16x32_bf16 a[56:59], v[52:55], v[104:107], a[56:59]
ds_read_b64 v[104:105], v20 offset:4096
ds_read_b64 v[106:107], v21 offset:4096
s_waitcnt lgkmcnt(6)
v_mfma_f32_16x16x32_bf16 a[28:31], v[48:51], v[108:111], a[28:31]
v_mfma_f32_16x16x32_bf16 a[60:63], v[52:55], v[108:111], a[60:63]
ds_read_b64 v[108:109], v20 offset:6144
ds_read_b64 v[110:111], v21 offset:6144
s_waitcnt vmcnt(4)
s_waitcnt lgkmcnt(6)
v_mfma_f32_16x16x32_bf16 a[0:3], v[56:59], v[96:99], a[0:3]
v_mfma_f32_16x16x32_bf16 a[32:35], v[60:63], v[96:99], a[32:35]
ds_read_b64 v[96:97], v20 offset:8192
ds_read_b64 v[98:99], v21 offset:8192
s_waitcnt lgkmcnt(6)
v_mfma_f32_16x16x32_bf16 a[4:7], v[56:59], v[100:103], a[4:7]
v_mfma_f32_16x16x32_bf16 a[36:39], v[60:63], v[100:103], a[36:39]
ds_read_b64 v[100:101], v20 offset:10240
ds_read_b64 v[102:103], v21 offset:10240
s_waitcnt lgkmcnt(6)
v_mfma_f32_16x16x32_bf16 a[8:11], v[56:59], v[104:107], a[8:11]
v_mfma_f32_16x16x32_bf16 a[40:43], v[60:63], v[104:107], a[40:43]
ds_read_b64 v[104:105], v20 offset:12288
ds_read_b64 v[106:107], v21 offset:12288
s_waitcnt lgkmcnt(6)
v_mfma_f32_16x16x32_bf16 a[12:15], v[56:59], v[108:111], a[12:15]
v_mfma_f32_16x16x32_bf16 a[44:47], v[60:63], v[108:111], a[44:47]
ds_read_b64 v[108:109], v20 offset:14336
ds_read_b64 v[110:111], v21 offset:14336
s_waitcnt lgkmcnt(6)
v_mfma_f32_16x16x32_bf16 a[16:19], v[56:59], v[96:99], a[16:19]
v_mfma_f32_16x16x32_bf16 a[48:51], v[60:63], v[96:99], a[48:51]
s_barrier
ds_read_b64 v[96:97], v18 offset:16384
ds_read_b64 v[98:99], v19 offset:16384
s_waitcnt lgkmcnt(6)
v_mfma_f32_16x16x32_bf16 a[20:23], v[56:59], v[100:103], a[20:23]
v_mfma_f32_16x16x32_bf16 a[52:55], v[60:63], v[100:103], a[52:55]
ds_read_b64 v[100:101], v18 offset:18432
ds_read_b64 v[102:103], v19 offset:18432
s_waitcnt lgkmcnt(6)
v_mfma_f32_16x16x32_bf16 a[24:27], v[56:59], v[104:107], a[24:27]
v_mfma_f32_16x16x32_bf16 a[56:59], v[60:63], v[104:107], a[56:59]
ds_read_b64 v[104:105], v18 offset:20480
ds_read_b64 v[106:107], v19 offset:20480
s_waitcnt lgkmcnt(6)
v_mfma_f32_16x16x32_bf16 a[28:31], v[56:59], v[108:111], a[28:31]
v_mfma_f32_16x16x32_bf16 a[60:63], v[60:63], v[108:111], a[60:63]
ds_read_b64 v[108:109], v18 offset:22528
ds_read_b64 v[110:111], v19 offset:22528
s_waitcnt vmcnt(2)
s_waitcnt lgkmcnt(6)
v_mfma_f32_16x16x32_bf16 a[0:3], v[64:67], v[96:99], a[0:3]
v_mfma_f32_16x16x32_bf16 a[32:35], v[68:71], v[96:99], a[32:35]
ds_read_b64 v[96:97], v18 offset:24576
ds_read_b64 v[98:99], v19 offset:24576
s_waitcnt lgkmcnt(6)
v_mfma_f32_16x16x32_bf16 a[4:7], v[64:67], v[100:103], a[4:7]
v_mfma_f32_16x16x32_bf16 a[36:39], v[68:71], v[100:103], a[36:39]
ds_read_b64 v[100:101], v18 offset:26624
ds_read_b64 v[102:103], v19 offset:26624
s_waitcnt lgkmcnt(6)
v_mfma_f32_16x16x32_bf16 a[8:11], v[64:67], v[104:107], a[8:11]
v_mfma_f32_16x16x32_bf16 a[40:43], v[68:71], v[104:107], a[40:43]
ds_read_b64 v[104:105], v18 offset:28672
ds_read_b64 v[106:107], v19 offset:28672
s_waitcnt lgkmcnt(6)
v_mfma_f32_16x16x32_bf16 a[12:15], v[64:67], v[108:111], a[12:15]
v_mfma_f32_16x16x32_bf16 a[44:47], v[68:71], v[108:111], a[44:47]
ds_read_b64 v[108:109], v18 offset:30720
ds_read_b64 v[110:111], v19 offset:30720
s_waitcnt lgkmcnt(6)
v_mfma_f32_16x16x32_bf16 a[16:19], v[64:67], v[96:99], a[16:19]
v_mfma_f32_16x16x32_bf16 a[48:51], v[68:71], v[96:99], a[48:51]
ds_read_b64 v[96:97], v20 offset:16384
ds_read_b64 v[98:99], v21 offset:16384
s_waitcnt lgkmcnt(6)
v_mfma_f32_16x16x32_bf16 a[20:23], v[64:67], v[100:103], a[20:23]
v_mfma_f32_16x16x32_bf16 a[52:55], v[68:71], v[100:103], a[52:55]
ds_read_b64 v[100:101], v20 offset:18432
ds_read_b64 v[102:103], v21 offset:18432
s_waitcnt lgkmcnt(6)
v_mfma_f32_16x16x32_bf16 a[24:27], v[64:67], v[104:107], a[24:27]
v_mfma_f32_16x16x32_bf16 a[56:59], v[68:71], v[104:107], a[56:59]
ds_read_b64 v[104:105], v20 offset:20480
ds_read_b64 v[106:107], v21 offset:20480
s_waitcnt lgkmcnt(6)
v_mfma_f32_16x16x32_bf16 a[28:31], v[64:67], v[108:111], a[28:31]
v_mfma_f32_16x16x32_bf16 a[60:63], v[68:71], v[108:111], a[60:63]
ds_read_b64 v[108:109], v20 offset:22528
ds_read_b64 v[110:111], v21 offset:22528
s_waitcnt vmcnt(0)
s_waitcnt lgkmcnt(6)
v_mfma_f32_16x16x32_bf16 a[0:3], v[72:75], v[96:99], a[0:3]
v_mfma_f32_16x16x32_bf16 a[32:35], v[76:79], v[96:99], a[32:35]
ds_read_b64 v[96:97], v20 offset:24576
ds_read_b64 v[98:99], v21 offset:24576
s_waitcnt lgkmcnt(6)
v_mfma_f32_16x16x32_bf16 a[4:7], v[72:75], v[100:103], a[4:7]
v_mfma_f32_16x16x32_bf16 a[36:39], v[76:79], v[100:103], a[36:39]
ds_read_b64 v[100:101], v20 offset:26624
ds_read_b64 v[102:103], v21 offset:26624
s_waitcnt lgkmcnt(6)
v_mfma_f32_16x16x32_bf16 a[8:11], v[72:75], v[104:107], a[8:11]
v_mfma_f32_16x16x32_bf16 a[40:43], v[76:79], v[104:107], a[40:43]
ds_read_b64 v[104:105], v20 offset:28672
ds_read_b64 v[106:107], v21 offset:28672
s_waitcnt lgkmcnt(6)
v_mfma_f32_16x16x32_bf16 a[12:15], v[72:75], v[108:111], a[12:15]
v_mfma_f32_16x16x32_bf16 a[44:47], v[76:79], v[108:111], a[44:47]
ds_read_b64 v[108:109], v20 offset:30720
ds_read_b64 v[110:111], v21 offset:30720
s_waitcnt lgkmcnt(6)
v_mfma_f32_16x16x32_bf16 a[16:19], v[72:75], v[96:99], a[16:19]
v_mfma_f32_16x16x32_bf16 a[48:51], v[76:79], v[96:99], a[48:51]
s_waitcnt lgkmcnt(4)
v_mfma_f32_16x16x32_bf16 a[20:23], v[72:75], v[100:103], a[20:23]
v_mfma_f32_16x16x32_bf16 a[52:55], v[76:79], v[100:103], a[52:55]
s_waitcnt lgkmcnt(2)
v_mfma_f32_16x16x32_bf16 a[24:27], v[72:75], v[104:107], a[24:27]
v_mfma_f32_16x16x32_bf16 a[56:59], v[76:79], v[104:107], a[56:59]
s_waitcnt lgkmcnt(0)
v_mfma_f32_16x16x32_bf16 a[28:31], v[72:75], v[108:111], a[28:31]
v_mfma_f32_16x16x32_bf16 a[60:63], v[76:79], v[108:111], a[60:63]
s_mul_i32 s42, s52, 229376
s_lshl_b32 s43, s53, 2
s_add_u32 s43, s43, s29
s_lshl_b32 s43, s43, 10
s_add_u32 s42, s42, s43
v_and_b32 v34, 15, v0
v_lshlrev_b32 v34, 1, v34
s_mul_i32 s44, s52, 256
s_mov_b32 s45, 0xffff0000
s_add_u32 s43, s42, 100663296
buffer_load_dwordx4 v[48:51], v1, s[8:11], s43 offen sc1
buffer_load_ushort v112, v34, s[56:59], s44 offen offset:0
s_add_u32 s43, s42, 100691968
buffer_load_dwordx4 v[52:55], v1, s[8:11], s43 offen sc1
buffer_load_ushort v113, v34, s[56:59], s44 offen offset:32
s_add_u32 s43, s42, 100720640
buffer_load_dwordx4 v[56:59], v1, s[8:11], s43 offen sc1
buffer_load_ushort v114, v34, s[56:59], s44 offen offset:64
s_add_u32 s43, s42, 100749312
buffer_load_dwordx4 v[60:63], v1, s[8:11], s43 offen sc1
buffer_load_ushort v115, v34, s[56:59], s44 offen offset:96
s_add_u32 s43, s42, 100777984
buffer_load_dwordx4 v[64:67], v1, s[8:11], s43 offen sc1
buffer_load_ushort v116, v34, s[56:59], s44 offen offset:128
s_add_u32 s43, s42, 100806656
buffer_load_dwordx4 v[68:71], v1, s[8:11], s43 offen sc1
buffer_load_ushort v117, v34, s[56:59], s44 offen offset:160
s_add_u32 s43, s42, 100835328
buffer_load_dwordx4 v[72:75], v1, s[8:11], s43 offen sc1
buffer_load_ushort v118, v34, s[56:59], s44 offen offset:192
s_add_u32 s43, s42, 100864000
buffer_load_dwordx4 v[76:79], v1, s[8:11], s43 offen sc1
buffer_load_ushort v119, v34, s[56:59], s44 offen offset:224
s_waitcnt vmcnt(14)
v_accvgpr_read_b32 v128, a0
v_accvgpr_read_b32 v132, a32
v_accvgpr_read_b32 v129, a1
v_accvgpr_read_b32 v133, a33
v_accvgpr_read_b32 v130, a2
v_accvgpr_read_b32 v134, a34
v_accvgpr_read_b32 v131, a3
v_accvgpr_read_b32 v135, a35
v_lshlrev_b32 v112, 16, v112
v_lshlrev_b32 v136, 16, v48
v_and_b32 v137, s45, v48
v_lshlrev_b32 v138, 16, v49
v_and_b32 v139, s45, v49
v_lshlrev_b32 v140, 16, v50
v_and_b32 v141, s45, v50
v_lshlrev_b32 v142, 16, v51
v_and_b32 v143, s45, v51
v_add_f32 v128, v128, v112
v_add_f32 v129, v129, v112
v_add_f32 v130, v130, v112
v_add_f32 v131, v131, v112
v_add_f32 v132, v132, v112
v_add_f32 v133, v133, v112
v_add_f32 v134, v134, v112
v_add_f32 v135, v135, v112
v_mul_f32 v128, v128, v136
v_mul_f32 v129, v129, v137
v_mul_f32 v130, v130, v138
v_mul_f32 v131, v131, v139
v_mul_f32 v132, v132, v140
v_mul_f32 v133, v133, v141
v_mul_f32 v134, v134, v142
v_mul_f32 v135, v135, v143
v_cvt_pk_bf16_f32 v144, v128, v129
v_cvt_pk_bf16_f32 v145, v130, v131
v_cvt_pk_bf16_f32 v146, v132, v133
v_cvt_pk_bf16_f32 v147, v134, v135
s_add_u32 s43, s42, 109051904
buffer_store_dwordx4 v[144:147], v1, s[8:11], s43 offen sc1
s_waitcnt vmcnt(13)
v_accvgpr_read_b32 v148, a4
v_accvgpr_read_b32 v152, a36
v_accvgpr_read_b32 v149, a5
v_accvgpr_read_b32 v153, a37
v_accvgpr_read_b32 v150, a6
v_accvgpr_read_b32 v154, a38
v_accvgpr_read_b32 v151, a7
v_accvgpr_read_b32 v155, a39
v_lshlrev_b32 v113, 16, v113
v_lshlrev_b32 v156, 16, v52
v_and_b32 v157, s45, v52
v_lshlrev_b32 v158, 16, v53
v_and_b32 v159, s45, v53
v_lshlrev_b32 v160, 16, v54
v_and_b32 v161, s45, v54
v_lshlrev_b32 v162, 16, v55
v_and_b32 v163, s45, v55
v_add_f32 v148, v148, v113
v_add_f32 v149, v149, v113
v_add_f32 v150, v150, v113
v_add_f32 v151, v151, v113
v_add_f32 v152, v152, v113
v_add_f32 v153, v153, v113
v_add_f32 v154, v154, v113
v_add_f32 v155, v155, v113
v_mul_f32 v148, v148, v156
v_mul_f32 v149, v149, v157
v_mul_f32 v150, v150, v158
v_mul_f32 v151, v151, v159
v_mul_f32 v152, v152, v160
v_mul_f32 v153, v153, v161
v_mul_f32 v154, v154, v162
v_mul_f32 v155, v155, v163
v_cvt_pk_bf16_f32 v164, v148, v149
v_cvt_pk_bf16_f32 v165, v150, v151
v_cvt_pk_bf16_f32 v166, v152, v153
v_cvt_pk_bf16_f32 v167, v154, v155
s_add_u32 s43, s42, 109080576
buffer_store_dwordx4 v[164:167], v1, s[8:11], s43 offen sc1
s_waitcnt vmcnt(12)
v_accvgpr_read_b32 v168, a8
v_accvgpr_read_b32 v172, a40
v_accvgpr_read_b32 v169, a9
v_accvgpr_read_b32 v173, a41
v_accvgpr_read_b32 v170, a10
v_accvgpr_read_b32 v174, a42
v_accvgpr_read_b32 v171, a11
v_accvgpr_read_b32 v175, a43
v_lshlrev_b32 v114, 16, v114
v_lshlrev_b32 v176, 16, v56
v_and_b32 v177, s45, v56
v_lshlrev_b32 v178, 16, v57
v_and_b32 v179, s45, v57
v_lshlrev_b32 v180, 16, v58
v_and_b32 v181, s45, v58
v_lshlrev_b32 v182, 16, v59
v_and_b32 v183, s45, v59
v_add_f32 v168, v168, v114
v_add_f32 v169, v169, v114
v_add_f32 v170, v170, v114
v_add_f32 v171, v171, v114
v_add_f32 v172, v172, v114
v_add_f32 v173, v173, v114
v_add_f32 v174, v174, v114
v_add_f32 v175, v175, v114
v_mul_f32 v168, v168, v176
v_mul_f32 v169, v169, v177
v_mul_f32 v170, v170, v178
v_mul_f32 v171, v171, v179
v_mul_f32 v172, v172, v180
v_mul_f32 v173, v173, v181
v_mul_f32 v174, v174, v182
v_mul_f32 v175, v175, v183
v_cvt_pk_bf16_f32 v184, v168, v169
v_cvt_pk_bf16_f32 v185, v170, v171
v_cvt_pk_bf16_f32 v186, v172, v173
v_cvt_pk_bf16_f32 v187, v174, v175
s_add_u32 s43, s42, 109109248
buffer_store_dwordx4 v[184:187], v1, s[8:11], s43 offen sc1
s_waitcnt vmcnt(11)
v_accvgpr_read_b32 v128, a12
v_accvgpr_read_b32 v132, a44
v_accvgpr_read_b32 v129, a13
v_accvgpr_read_b32 v133, a45
v_accvgpr_read_b32 v130, a14
v_accvgpr_read_b32 v134, a46
v_accvgpr_read_b32 v131, a15
v_accvgpr_read_b32 v135, a47
v_lshlrev_b32 v115, 16, v115
v_lshlrev_b32 v136, 16, v60
v_and_b32 v137, s45, v60
v_lshlrev_b32 v138, 16, v61
v_and_b32 v139, s45, v61
v_lshlrev_b32 v140, 16, v62
v_and_b32 v141, s45, v62
v_lshlrev_b32 v142, 16, v63
v_and_b32 v143, s45, v63
v_add_f32 v128, v128, v115
v_add_f32 v129, v129, v115
v_add_f32 v130, v130, v115
v_add_f32 v131, v131, v115
v_add_f32 v132, v132, v115
v_add_f32 v133, v133, v115
v_add_f32 v134, v134, v115
v_add_f32 v135, v135, v115
v_mul_f32 v128, v128, v136
v_mul_f32 v129, v129, v137
v_mul_f32 v130, v130, v138
v_mul_f32 v131, v131, v139
v_mul_f32 v132, v132, v140
v_mul_f32 v133, v133, v141
v_mul_f32 v134, v134, v142
v_mul_f32 v135, v135, v143
v_cvt_pk_bf16_f32 v144, v128, v129
v_cvt_pk_bf16_f32 v145, v130, v131
v_cvt_pk_bf16_f32 v146, v132, v133
v_cvt_pk_bf16_f32 v147, v134, v135
s_add_u32 s43, s42, 109137920
buffer_store_dwordx4 v[144:147], v1, s[8:11], s43 offen sc1
s_waitcnt vmcnt(10)
v_accvgpr_read_b32 v148, a16
v_accvgpr_read_b32 v152, a48
v_accvgpr_read_b32 v149, a17
v_accvgpr_read_b32 v153, a49
v_accvgpr_read_b32 v150, a18
v_accvgpr_read_b32 v154, a50
v_accvgpr_read_b32 v151, a19
v_accvgpr_read_b32 v155, a51
v_lshlrev_b32 v116, 16, v116
v_lshlrev_b32 v156, 16, v64
v_and_b32 v157, s45, v64
v_lshlrev_b32 v158, 16, v65
v_and_b32 v159, s45, v65
v_lshlrev_b32 v160, 16, v66
v_and_b32 v161, s45, v66
v_lshlrev_b32 v162, 16, v67
v_and_b32 v163, s45, v67
v_add_f32 v148, v148, v116
v_add_f32 v149, v149, v116
v_add_f32 v150, v150, v116
v_add_f32 v151, v151, v116
v_add_f32 v152, v152, v116
v_add_f32 v153, v153, v116
v_add_f32 v154, v154, v116
v_add_f32 v155, v155, v116
v_mul_f32 v148, v148, v156
v_mul_f32 v149, v149, v157
v_mul_f32 v150, v150, v158
v_mul_f32 v151, v151, v159
v_mul_f32 v152, v152, v160
v_mul_f32 v153, v153, v161
v_mul_f32 v154, v154, v162
v_mul_f32 v155, v155, v163
v_cvt_pk_bf16_f32 v164, v148, v149
v_cvt_pk_bf16_f32 v165, v150, v151
v_cvt_pk_bf16_f32 v166, v152, v153
v_cvt_pk_bf16_f32 v167, v154, v155
s_add_u32 s43, s42, 109166592
buffer_store_dwordx4 v[164:167], v1, s[8:11], s43 offen sc1
s_waitcnt vmcnt(9)
v_accvgpr_read_b32 v168, a20
v_accvgpr_read_b32 v172, a52
v_accvgpr_read_b32 v169, a21
v_accvgpr_read_b32 v173, a53
v_accvgpr_read_b32 v170, a22
v_accvgpr_read_b32 v174, a54
v_accvgpr_read_b32 v171, a23
v_accvgpr_read_b32 v175, a55
v_lshlrev_b32 v117, 16, v117
v_lshlrev_b32 v176, 16, v68
v_and_b32 v177, s45, v68
v_lshlrev_b32 v178, 16, v69
v_and_b32 v179, s45, v69
v_lshlrev_b32 v180, 16, v70
v_and_b32 v181, s45, v70
v_lshlrev_b32 v182, 16, v71
v_and_b32 v183, s45, v71
v_add_f32 v168, v168, v117
v_add_f32 v169, v169, v117
v_add_f32 v170, v170, v117
v_add_f32 v171, v171, v117
v_add_f32 v172, v172, v117
v_add_f32 v173, v173, v117
v_add_f32 v174, v174, v117
v_add_f32 v175, v175, v117
v_mul_f32 v168, v168, v176
v_mul_f32 v169, v169, v177
v_mul_f32 v170, v170, v178
v_mul_f32 v171, v171, v179
v_mul_f32 v172, v172, v180
v_mul_f32 v173, v173, v181
v_mul_f32 v174, v174, v182
v_mul_f32 v175, v175, v183
v_cvt_pk_bf16_f32 v184, v168, v169
v_cvt_pk_bf16_f32 v185, v170, v171
v_cvt_pk_bf16_f32 v186, v172, v173
v_cvt_pk_bf16_f32 v187, v174, v175
s_add_u32 s43, s42, 109195264
buffer_store_dwordx4 v[184:187], v1, s[8:11], s43 offen sc1
s_waitcnt vmcnt(8)
v_accvgpr_read_b32 v128, a24
v_accvgpr_read_b32 v132, a56
v_accvgpr_read_b32 v129, a25
v_accvgpr_read_b32 v133, a57
v_accvgpr_read_b32 v130, a26
v_accvgpr_read_b32 v134, a58
v_accvgpr_read_b32 v131, a27
v_accvgpr_read_b32 v135, a59
v_lshlrev_b32 v118, 16, v118
v_lshlrev_b32 v136, 16, v72
v_and_b32 v137, s45, v72
v_lshlrev_b32 v138, 16, v73
v_and_b32 v139, s45, v73
v_lshlrev_b32 v140, 16, v74
v_and_b32 v141, s45, v74
v_lshlrev_b32 v142, 16, v75
v_and_b32 v143, s45, v75
v_add_f32 v128, v128, v118
v_add_f32 v129, v129, v118
v_add_f32 v130, v130, v118
v_add_f32 v131, v131, v118
v_add_f32 v132, v132, v118
v_add_f32 v133, v133, v118
v_add_f32 v134, v134, v118
v_add_f32 v135, v135, v118
v_mul_f32 v128, v128, v136
v_mul_f32 v129, v129, v137
v_mul_f32 v130, v130, v138
v_mul_f32 v131, v131, v139
v_mul_f32 v132, v132, v140
v_mul_f32 v133, v133, v141
v_mul_f32 v134, v134, v142
v_mul_f32 v135, v135, v143
v_cvt_pk_bf16_f32 v144, v128, v129
v_cvt_pk_bf16_f32 v145, v130, v131
v_cvt_pk_bf16_f32 v146, v132, v133
v_cvt_pk_bf16_f32 v147, v134, v135
s_add_u32 s43, s42, 109223936
buffer_store_dwordx4 v[144:147], v1, s[8:11], s43 offen sc1
s_waitcnt vmcnt(7)
v_accvgpr_read_b32 v148, a28
v_accvgpr_read_b32 v152, a60
v_accvgpr_read_b32 v149, a29
v_accvgpr_read_b32 v153, a61
v_accvgpr_read_b32 v150, a30
v_accvgpr_read_b32 v154, a62
v_accvgpr_read_b32 v151, a31
v_accvgpr_read_b32 v155, a63
v_lshlrev_b32 v119, 16, v119
v_lshlrev_b32 v156, 16, v76
v_and_b32 v157, s45, v76
v_lshlrev_b32 v158, 16, v77
v_and_b32 v159, s45, v77
v_lshlrev_b32 v160, 16, v78
v_and_b32 v161, s45, v78
v_lshlrev_b32 v162, 16, v79
v_and_b32 v163, s45, v79
v_add_f32 v148, v148, v119
v_add_f32 v149, v149, v119
v_add_f32 v150, v150, v119
v_add_f32 v151, v151, v119
v_add_f32 v152, v152, v119
v_add_f32 v153, v153, v119
v_add_f32 v154, v154, v119
v_add_f32 v155, v155, v119
v_mul_f32 v148, v148, v156
v_mul_f32 v149, v149, v157
v_mul_f32 v150, v150, v158
v_mul_f32 v151, v151, v159
v_mul_f32 v152, v152, v160
v_mul_f32 v153, v153, v161
v_mul_f32 v154, v154, v162
v_mul_f32 v155, v155, v163
v_cvt_pk_bf16_f32 v164, v148, v149
v_cvt_pk_bf16_f32 v165, v150, v151
v_cvt_pk_bf16_f32 v166, v152, v153
v_cvt_pk_bf16_f32 v167, v154, v155
s_add_u32 s43, s42, 109252608
buffer_store_dwordx4 v[164:167], v1, s[8:11], s43 offen sc1
s_lshl_b32 s3, s52, 7
s_add_u32 s3, s3, 58368
s_waitcnt vmcnt(0)
s_barrier
s_cmp_lg_u32 s29, 0
s_cbranch_scc1 SG_78
v_mov_b32 v2, s3
v_mov_b32 v4, 1
s_mov_b32 s42, 4194304
s_mov_b64 exec, 1
buffer_atomic_add v4, v2, s[84:87], s42 offen sc1
s_mov_b64 exec, -1
SG_78:
s_getpc_b64 s[90:91]
LJ_79:
s_add_u32 s90, s90, L_m_next-LJ_79
s_addc_u32 s91, s91, -1
s_setpc_b64 s[90:91]
L_w_PO:
s_mul_i32 s30, s3, 1366
s_lshr_b32 s30, s30, 16
s_mul_i32 s31, s30, 48
s_sub_u32 s31, s3, s31
s_cmp_ge_u32 s31, 16
s_cbranch_scc1 L_w_PO2
s_add_u32 s30, s30, 12
s_branch L_w_AT2
L_w_PO2:
s_mov_b32 s52, s30
s_branch L_w_FIN
L_w_FS:
s_lshr_b32 s52, s3, 5
s_and_b32 s31, s3, 31
s_add_u32 s31, s31, 16
s_branch L_w_FIN
L_w_AT:
s_lshr_b32 s30, s3, 4
s_and_b32 s31, s3, 15
L_w_AT2:
s_mov_b32 s52, s30
v_and_b32 v3, 63, v0
v_lshlrev_b32 v1, 4, v3
v_bfe_u32 v4, v0, 2, 2
v_and_b32 v5, 1, v0
v_lshl_add_u32 v4, v4, 1, v5
v_bfe_u32 v5, v0, 4, 2
v_lshlrev_b32 v2, 6, v4
v_lshl_add_u32 v2, v5, 4, v2
v_and_b32 v4, 15, v0
v_lshlrev_b32 v5, 2, v5
s_mov_b32 s68, 0x3e0293ee
v_add_u32 v6, 0, v5
v_cmp_le_u32 s[60:61], v6, v4
v_add_u32 v6, 1, v5
v_cmp_le_u32 s[62:63], v6, v4
v_add_u32 v6, 2, v5
v_cmp_le_u32 s[64:65], v6, v4
v_add_u32 v6, 3, v5
v_cmp_le_u32 s[66:67], v6, v4
s_lshr_b32 s3, s30, 2
s_lshl_b32 s3, s3, 7
s_add_u32 s3, s3, 4196352
s_cmp_lg_u32 s29, 0
s_cbranch_scc1 WWd_81
v_mov_b32 v8, s3
s_mov_b32 s43, 0
WW_80:
buffer_load_dword v9, v8, s[84:87], 0 offen sc1
s_add_u32 s43, s43, 1
s_waitcnt vmcnt(0)
v_readfirstlane_b32 s42, v9
s_cmp_ge_u32 s42, 64
s_cbranch_scc1 WWd_81
s_cmp_gt_u32 s43, 400000
s_cbranch_scc1 WWd_81
s_cmp_lg_u32 s42, 0
s_cbranch_scc1 WWs_82
s_sleep 32
s_branch WW_80
WWs_82:
s_sleep 16
s_branch WW_80
WWd_81:
s_waitcnt vmcnt(0)
s_barrier
s_add_u32 s3, s3, 1024
s_cmp_lg_u32 s29, 0
s_cbranch_scc1 WWd_84
v_mov_b32 v8, s3
s_mov_b32 s43, 0
WW_83:
buffer_load_dword v9, v8, s[84:87], 0 offen sc1
s_add_u32 s43, s43, 1
s_waitcnt vmcnt(0)
v_readfirstlane_b32 s42, v9
s_cmp_ge_u32 s42, 32
s_cbranch_scc1 WWd_84
s_cmp_gt_u32 s43, 400000
s_cbranch_scc1 WWd_84
s_cmp_lg_u32 s42, 0
s_cbranch_scc1 WWs_85
s_sleep 32
s_branch WW_83
WWs_85:
s_sleep 16
s_branch WW_83
WWd_84:
s_waitcnt vmcnt(0)
s_barrier
s_lshl_b32 s30, s30, 1
s_bfe_u32 s3, s31, 0x10001
s_add_u32 s30, s30, s3
s_lshr_b32 s53, s31, 2
s_and_b32 s31, s31, 1
s_lshl_b32 s3, s53, 1
s_add_u32 s31, s31, s3
s_lshl_b32 s31, s31, 2
s_add_u32 s31, s31, s29
s_lshl_b32 s42, s30, 5
s_add_u32 s42, s42, s31
s_lshl_b32 s43, s42, 13
s_add_u32 s43, s43, 67108864
s_add_u32 s44, s43, 4096
s_lshl_b32 s45, s42, 14
s_add_u32 s45, s45, 33554432
s_add_u32 s46, s45, 4096
s_lshl_b32 s47, s42, 11
s_add_u32 s47, s47, 5242880
buffer_load_dwordx4 v[8:11], v1, s[8:11], s43 offen offset:0 sc1
buffer_load_dwordx4 v[12:15], v1, s[8:11], s43 offen offset:1024 sc1
buffer_load_dwordx4 v[16:19], v1, s[8:11], s43 offen offset:2048 sc1
buffer_load_dwordx4 v[20:23], v1, s[8:11], s43 offen offset:3072 sc1
buffer_load_dwordx4 v[24:27], v1, s[8:11], s44 offen offset:0 sc1
buffer_load_dwordx4 v[28:31], v1, s[8:11], s44 offen offset:1024 sc1
buffer_load_dwordx4 v[32:35], v1, s[8:11], s44 offen offset:2048 sc1
buffer_load_dwordx4 v[36:39], v1, s[8:11], s44 offen offset:3072 sc1
buffer_load_dwordx4 v[40:43], v1, s[8:11], s45 offen offset:0 sc1
buffer_load_dwordx4 v[44:47], v1, s[8:11], s45 offen offset:1024 sc1
buffer_load_dwordx4 v[48:51], v1, s[8:11], s45 offen offset:2048 sc1
buffer_load_dwordx4 v[52:55], v1, s[8:11], s45 offen offset:3072 sc1
buffer_load_dwordx4 v[56:59], v1, s[8:11], s46 offen offset:0 sc1
buffer_load_dwordx4 v[60:63], v1, s[8:11], s46 offen offset:1024 sc1
buffer_load_dwordx4 v[64:67], v1, s[8:11], s46 offen offset:2048 sc1
buffer_load_dwordx4 v[68:71], v1, s[8:11], s46 offen offset:3072 sc1
s_add_u32 s45, s45, 8192
s_add_u32 s46, s46, 8192
s_lshl_b32 s44, s42, 12
s_add_u32 s44, s44, 9437184
buffer_load_dwordx4 v[88:91], v1, s[8:11], s45 offen offset:0 sc1
buffer_load_dwordx4 v[92:95], v1, s[8:11], s45 offen offset:1024 sc1
buffer_load_dwordx4 v[96:99], v1, s[8:11], s45 offen offset:2048 sc1
buffer_load_dwordx4 v[100:103], v1, s[8:11], s45 offen offset:3072 sc1
buffer_load_dwordx4 v[104:107], v1, s[8:11], s46 offen offset:0 sc1
buffer_load_dwordx4 v[108:111], v1, s[8:11], s46 offen offset:1024 sc1
buffer_load_dwordx4 v[112:115], v1, s[8:11], s46 offen offset:2048 sc1
buffer_load_dwordx4 v[116:119], v1, s[8:11], s46 offen offset:3072 sc1
s_waitcnt vmcnt(8)
v_mfma_f32_16x16x32_bf16 v[140:143], v[40:43], v[8:11], 0
v_mfma_f32_16x16x32_bf16 v[152:155], v[40:43], v[24:27], 0
v_mfma_f32_16x16x32_bf16 v[156:159], v[56:59], v[24:27], 0
v_mfma_f32_16x16x32_bf16 v[140:143], v[44:47], v[12:15], v[140:143]
v_mfma_f32_16x16x32_bf16 v[152:155], v[44:47], v[28:31], v[152:155]
v_mfma_f32_16x16x32_bf16 v[156:159], v[60:63], v[28:31], v[156:159]
v_mfma_f32_16x16x32_bf16 v[140:143], v[48:51], v[16:19], v[140:143]
v_mfma_f32_16x16x32_bf16 v[152:155], v[48:51], v[32:35], v[152:155]
v_mfma_f32_16x16x32_bf16 v[156:159], v[64:67], v[32:35], v[156:159]
v_mfma_f32_16x16x32_bf16 v[140:143], v[52:55], v[20:23], v[140:143]
v_mfma_f32_16x16x32_bf16 v[152:155], v[52:55], v[36:39], v[152:155]
v_mfma_f32_16x16x32_bf16 v[156:159], v[68:71], v[36:39], v[156:159]
s_lshl_b32 s3, s52, 7
s_add_u32 s3, s3, 4199424
s_cmp_lg_u32 s29, 0
s_cbranch_scc1 WWd_87
v_mov_b32 v220, s3
s_mov_b32 s51, 0
WW_86:
buffer_load_dword v221, v220, s[84:87], 0 offen sc1
s_add_u32 s51, s51, 1
s_waitcnt vmcnt(0)
v_readfirstlane_b32 s50, v221
s_cmp_ge_u32 s50, 64
s_cbranch_scc1 WWd_87
s_cmp_gt_u32 s51, 400000
s_cbranch_scc1 WWd_87
s_cmp_lg_u32 s50, 0
s_cbranch_scc1 WWs_88
s_sleep 24
s_branch WW_86
WWs_88:
s_sleep 2
s_branch WW_86
WWd_87:
s_waitcnt vmcnt(0)
s_barrier
buffer_load_dwordx4 v[72:75], v2, s[8:11], s47 offen offset:0 sc1
buffer_load_dwordx4 v[76:79], v2, s[8:11], s47 offen offset:512 sc1
buffer_load_dwordx4 v[80:83], v2, s[8:11], s47 offen offset:1024 sc1
buffer_load_dwordx4 v[84:87], v2, s[8:11], s47 offen offset:1536 sc1
buffer_load_dwordx4 v[120:123], v1, s[8:11], s44 offen offset:0 sc1
buffer_load_dwordx4 v[124:127], v1, s[8:11], s44 offen offset:1024 sc1
buffer_load_dwordx4 v[128:131], v1, s[8:11], s44 offen offset:2048 sc1
buffer_load_dwordx4 v[132:135], v1, s[8:11], s44 offen offset:3072 sc1
s_waitcnt vmcnt(7)
v_mfma_f32_16x16x32_bf16 v[136:139], v[72:75], v[8:11], 0
v_mfma_f32_16x16x32_bf16 v[148:151], v[72:75], v[24:27], 0
s_waitcnt vmcnt(6)
v_mfma_f32_16x16x32_bf16 v[136:139], v[76:79], v[12:15], v[136:139]
v_mfma_f32_16x16x32_bf16 v[148:151], v[76:79], v[28:31], v[148:151]
s_waitcnt vmcnt(5)
v_mfma_f32_16x16x32_bf16 v[136:139], v[80:83], v[16:19], v[136:139]
v_mfma_f32_16x16x32_bf16 v[148:151], v[80:83], v[32:35], v[148:151]
s_waitcnt vmcnt(4)
v_mfma_f32_16x16x32_bf16 v[136:139], v[84:87], v[20:23], v[136:139]
v_mfma_f32_16x16x32_bf16 v[148:151], v[84:87], v[36:39], v[148:151]
v_mov_b32 v200, 0xf149f2ca
s_nop 7
s_lshl_b32 s43, s30, 18
s_lshl_b32 s44, s31, 12
s_add_u32 s43, s43, s44
s_add_u32 s43, s43, 83886080
v_cndmask_b32 v140, v200, v140, s[60:61]
v_cndmask_b32 v141, v200, v141, s[62:63]
v_cndmask_b32 v142, v200, v142, s[64:65]
v_cndmask_b32 v143, v200, v143, s[66:67]
v_max3_f32 v192, v136, v137, v138
v_max3_f32 v193, v139, v140, v141
v_max3_f32 v192, v192, v142, v143
v_max_f32 v192, v192, v193
v_mov_b32 v193, v192
s_nop 1
v_permlane16_swap_b32 v192, v193
v_max_f32 v192, v192, v193
v_mov_b32 v193, v192
s_nop 1
v_permlane32_swap_b32 v192, v193
v_max_f32 v192, v192, v193
v_mul_f32 v192, s68, v192
v_fma_f32 v136, v136, s68, -v192
v_fma_f32 v137, v137, s68, -v192
v_fma_f32 v138, v138, s68, -v192
v_fma_f32 v139, v139, s68, -v192
v_fma_f32 v140, v140, s68, -v192
v_fma_f32 v141, v141, s68, -v192
v_fma_f32 v142, v142, s68, -v192
v_fma_f32 v143, v143, s68, -v192
v_exp_f32 v136, v136
v_exp_f32 v137, v137
v_exp_f32 v138, v138
v_exp_f32 v139, v139
v_exp_f32 v140, v140
v_exp_f32 v141, v141
v_exp_f32 v142, v142
v_exp_f32 v143, v143
s_nop 0
v_add_f32 v194, v136, v137
v_add_f32 v195, v138, v139
v_add_f32 v194, v194, v195
v_mul_f32 v194, 0.5, v194
v_add_f32 v194, v194, v140
v_add_f32 v194, v194, v141
v_add_f32 v194, v194, v142
v_add_f32 v194, v194, v143
v_mov_b32 v195, v194
s_nop 1
v_permlane16_swap_b32 v194, v195
v_add_f32 v194, v194, v195
v_mov_b32 v195, v194
s_nop 1
v_permlane32_swap_b32 v194, v195
v_add_f32 v194, v194, v195
v_rcp_f32 v194, v194
s_nop 0
v_mul_f32 v136, v136, v194
v_mul_f32 v137, v137, v194
v_mul_f32 v138, v138, v194
v_mul_f32 v139, v139, v194
v_mul_f32 v140, v140, v194
v_mul_f32 v141, v141, v194
v_mul_f32 v142, v142, v194
v_mul_f32 v143, v143, v194
v_cvt_pk_bf16_f32 v196, v136, v137
v_cvt_pk_bf16_f32 v197, v138, v139
v_cvt_pk_bf16_f32 v204, v140, v141
v_cvt_pk_bf16_f32 v205, v142, v143
v_mov_b32 v206, 0
v_mov_b32 v207, 0
s_waitcnt vmcnt(0)
v_mfma_f32_16x16x32_bf16 v[160:163], v[88:91], v[204:207], 0
v_mfma_f32_16x16x32_bf16 v[164:167], v[92:95], v[204:207], 0
v_mfma_f32_16x16x32_bf16 v[168:171], v[96:99], v[204:207], 0
v_mfma_f32_16x16x32_bf16 v[172:175], v[100:103], v[204:207], 0
v_mfma_f32_16x16x32_bf16 v[176:179], v[104:107], v[204:207], 0
v_mfma_f32_16x16x32_bf16 v[180:183], v[108:111], v[204:207], 0
v_mfma_f32_16x16x32_bf16 v[184:187], v[112:115], v[204:207], 0
v_mfma_f32_16x16x32_bf16 v[188:191], v[116:119], v[204:207], 0
v_mfma_f32_16x16x16_bf16 v[160:163], v[120:121], v[196:197], v[160:163]
v_mfma_f32_16x16x16_bf16 v[164:167], v[122:123], v[196:197], v[164:167]
v_mfma_f32_16x16x16_bf16 v[168:171], v[124:125], v[196:197], v[168:171]
v_mfma_f32_16x16x16_bf16 v[172:175], v[126:127], v[196:197], v[172:175]
v_mfma_f32_16x16x16_bf16 v[176:179], v[128:129], v[196:197], v[176:179]
v_mfma_f32_16x16x16_bf16 v[180:183], v[130:131], v[196:197], v[180:183]
v_mfma_f32_16x16x16_bf16 v[184:187], v[132:133], v[196:197], v[184:187]
v_mfma_f32_16x16x16_bf16 v[188:191], v[134:135], v[196:197], v[188:191]
s_nop 7
v_cvt_pk_bf16_f32 v208, v160, v164
v_cvt_pk_bf16_f32 v209, v161, v165
v_cvt_pk_bf16_f32 v210, v162, v166
v_cvt_pk_bf16_f32 v211, v163, v167
buffer_store_dwordx4 v[208:211], v1, s[8:11], s43 offen offset:0 sc1
v_cvt_pk_bf16_f32 v212, v168, v172
v_cvt_pk_bf16_f32 v213, v169, v173
v_cvt_pk_bf16_f32 v214, v170, v174
v_cvt_pk_bf16_f32 v215, v171, v175
buffer_store_dwordx4 v[212:215], v1, s[8:11], s43 offen offset:1024 sc1
v_cvt_pk_bf16_f32 v216, v176, v180
v_cvt_pk_bf16_f32 v217, v177, v181
v_cvt_pk_bf16_f32 v218, v178, v182
v_cvt_pk_bf16_f32 v219, v179, v183
buffer_store_dwordx4 v[216:219], v1, s[8:11], s43 offen offset:2048 sc1
v_cvt_pk_bf16_f32 v220, v184, v188
v_cvt_pk_bf16_f32 v221, v185, v189
v_cvt_pk_bf16_f32 v222, v186, v190
v_cvt_pk_bf16_f32 v223, v187, v191
buffer_store_dwordx4 v[220:223], v1, s[8:11], s43 offen offset:3072 sc1
s_add_u32 s43, s43, 131072
v_cndmask_b32 v156, v200, v156, s[60:61]
v_cndmask_b32 v157, v200, v157, s[62:63]
v_cndmask_b32 v158, v200, v158, s[64:65]
v_cndmask_b32 v159, v200, v159, s[66:67]
v_max3_f32 v192, v148, v149, v150
v_max3_f32 v193, v151, v152, v153
v_max3_f32 v192, v192, v154, v155
v_max3_f32 v193, v193, v156, v157
v_max3_f32 v192, v192, v158, v159
v_max_f32 v192, v192, v193
v_mov_b32 v193, v192
s_nop 1
v_permlane16_swap_b32 v192, v193
v_max_f32 v192, v192, v193
v_mov_b32 v193, v192
s_nop 1
v_permlane32_swap_b32 v192, v193
v_max_f32 v192, v192, v193
v_mul_f32 v192, s68, v192
v_fma_f32 v148, v148, s68, -v192
v_fma_f32 v149, v149, s68, -v192
v_fma_f32 v150, v150, s68, -v192
v_fma_f32 v151, v151, s68, -v192
v_fma_f32 v152, v152, s68, -v192
v_fma_f32 v153, v153, s68, -v192
v_fma_f32 v154, v154, s68, -v192
v_fma_f32 v155, v155, s68, -v192
v_fma_f32 v156, v156, s68, -v192
v_fma_f32 v157, v157, s68, -v192
v_fma_f32 v158, v158, s68, -v192
v_fma_f32 v159, v159, s68, -v192
v_exp_f32 v148, v148
v_exp_f32 v149, v149
v_exp_f32 v150, v150
v_exp_f32 v151, v151
v_exp_f32 v152, v152
v_exp_f32 v153, v153
v_exp_f32 v154, v154
v_exp_f32 v155, v155
v_exp_f32 v156, v156
v_exp_f32 v157, v157
v_exp_f32 v158, v158
v_exp_f32 v159, v159
s_nop 0
v_add_f32 v194, v148, v149
v_add_f32 v195, v150, v151
v_add_f32 v194, v194, v195
v_mul_f32 v194, 0.5, v194
v_add_f32 v194, v194, v152
v_add_f32 v194, v194, v153
v_add_f32 v194, v194, v154
v_add_f32 v194, v194, v155
v_add_f32 v194, v194, v156
v_add_f32 v194, v194, v157
v_add_f32 v194, v194, v158
v_add_f32 v194, v194, v159
v_mov_b32 v195, v194
s_nop 1
v_permlane16_swap_b32 v194, v195
v_add_f32 v194, v194, v195
v_mov_b32 v195, v194
s_nop 1
v_permlane32_swap_b32 v194, v195
v_add_f32 v194, v194, v195
v_rcp_f32 v194, v194
s_nop 0
v_mul_f32 v148, v148, v194
v_mul_f32 v149, v149, v194
v_mul_f32 v150, v150, v194
v_mul_f32 v151, v151, v194
v_mul_f32 v152, v152, v194
v_mul_f32 v153, v153, v194
v_mul_f32 v154, v154, v194
v_mul_f32 v155, v155, v194
v_mul_f32 v156, v156, v194
v_mul_f32 v157, v157, v194
v_mul_f32 v158, v158, v194
v_mul_f32 v159, v159, v194
v_cvt_pk_bf16_f32 v196, v148, v149
v_cvt_pk_bf16_f32 v197, v150, v151
v_cvt_pk_bf16_f32 v204, v152, v153
v_cvt_pk_bf16_f32 v205, v154, v155
v_cvt_pk_bf16_f32 v206, v156, v157
v_cvt_pk_bf16_f32 v207, v158, v159
s_nop 1
v_mfma_f32_16x16x32_bf16 v[160:163], v[88:91], v[204:207], 0
v_mfma_f32_16x16x32_bf16 v[164:167], v[92:95], v[204:207], 0
v_mfma_f32_16x16x32_bf16 v[168:171], v[96:99], v[204:207], 0
v_mfma_f32_16x16x32_bf16 v[172:175], v[100:103], v[204:207], 0
v_mfma_f32_16x16x32_bf16 v[176:179], v[104:107], v[204:207], 0
v_mfma_f32_16x16x32_bf16 v[180:183], v[108:111], v[204:207], 0
v_mfma_f32_16x16x32_bf16 v[184:187], v[112:115], v[204:207], 0
v_mfma_f32_16x16x32_bf16 v[188:191], v[116:119], v[204:207], 0
v_mfma_f32_16x16x16_bf16 v[160:163], v[120:121], v[196:197], v[160:163]
v_mfma_f32_16x16x16_bf16 v[164:167], v[122:123], v[196:197], v[164:167]
v_mfma_f32_16x16x16_bf16 v[168:171], v[124:125], v[196:197], v[168:171]
v_mfma_f32_16x16x16_bf16 v[172:175], v[126:127], v[196:197], v[172:175]
v_mfma_f32_16x16x16_bf16 v[176:179], v[128:129], v[196:197], v[176:179]
v_mfma_f32_16x16x16_bf16 v[180:183], v[130:131], v[196:197], v[180:183]
v_mfma_f32_16x16x16_bf16 v[184:187], v[132:133], v[196:197], v[184:187]
v_mfma_f32_16x16x16_bf16 v[188:191], v[134:135], v[196:197], v[188:191]
s_nop 7
v_cvt_pk_bf16_f32 v208, v160, v164
v_cvt_pk_bf16_f32 v209, v161, v165
v_cvt_pk_bf16_f32 v210, v162, v166
v_cvt_pk_bf16_f32 v211, v163, v167
buffer_store_dwordx4 v[208:211], v1, s[8:11], s43 offen offset:0 sc1
v_cvt_pk_bf16_f32 v212, v168, v172
v_cvt_pk_bf16_f32 v213, v169, v173
v_cvt_pk_bf16_f32 v214, v170, v174
v_cvt_pk_bf16_f32 v215, v171, v175
buffer_store_dwordx4 v[212:215], v1, s[8:11], s43 offen offset:1024 sc1
v_cvt_pk_bf16_f32 v216, v176, v180
v_cvt_pk_bf16_f32 v217, v177, v181
v_cvt_pk_bf16_f32 v218, v178, v182
v_cvt_pk_bf16_f32 v219, v179, v183
buffer_store_dwordx4 v[216:219], v1, s[8:11], s43 offen offset:2048 sc1
v_cvt_pk_bf16_f32 v220, v184, v188
v_cvt_pk_bf16_f32 v221, v185, v189
v_cvt_pk_bf16_f32 v222, v186, v190
v_cvt_pk_bf16_f32 v223, v187, v191
buffer_store_dwordx4 v[220:223], v1, s[8:11], s43 offen offset:3072 sc1
s_lshl_b32 s3, s52, 2
s_add_u32 s3, s3, s53
s_lshl_b32 s3, s3, 7
s_add_u32 s3, s3, 9216
s_waitcnt vmcnt(0)
s_barrier
s_cmp_lg_u32 s29, 0
s_cbranch_scc1 SG_89
v_mov_b32 v2, s3
v_mov_b32 v4, 1
s_mov_b32 s42, 4194304
s_mov_b64 exec, 1
buffer_atomic_add v4, v2, s[84:87], s42 offen sc1
s_mov_b64 exec, -1
SG_89:
s_getpc_b64 s[90:91]
LJ_90:
s_add_u32 s90, s90, L_m_next-LJ_90
s_addc_u32 s91, s91, -1
s_setpc_b64 s[90:91]
L_w_FIN:
s_load_dwordx2 s[16:17], s[0:1], 40
s_load_dwordx2 s[18:19], s[0:1], 88
s_load_dwordx2 s[20:21], s[0:1], 0
s_load_dwordx2 s[22:23], s[0:1], 96
s_sub_u32 s31, s31, 16
s_and_b32 s53, s31, 7
s_lshr_b32 s63, s31, 3
s_waitcnt lgkmcnt(0)
s_lshl_b32 s60, s52, 2
s_add_u32 s60, s60, s29
s_mov_b32 s12, s16
s_and_b32 s13, s17, 0xffff
s_mov_b32 s14, 0x400000
s_mov_b32 s15, 0x00020000
v_and_b32 v34, 63, v0
v_lshlrev_b32 v1, 4, v34
s_mul_i32 s42, s29, 256
s_add_u32 s42, s42, 0
v_add_u32 v35, s42, v34
v_lshrrev_b32 v36, 3, v35
v_and_b32 v37, 7, v35
v_lshrrev_b32 v38, 2, v36
v_lshrrev_b32 v39, 3, v36
v_xor_b32 v38, v38, v39
v_and_b32 v38, 1, v38
v_and_b32 v39, 3, v36
v_lshl_or_b32 v38, v38, 2, v39
v_lshrrev_b32 v38, 1, v38
v_lshlrev_b32 v38, 1, v38
v_xor_b32 v37, v37, v38
s_mov_b32 s42, 1024
v_mul_lo_u32 v36, v36, s42
v_lshl_add_u32 v2, v37, 4, v36
s_mul_i32 s42, s29, 256
s_add_u32 s42, s42, 64
v_add_u32 v35, s42, v34
v_lshrrev_b32 v36, 3, v35
v_and_b32 v37, 7, v35
v_lshrrev_b32 v38, 2, v36
v_lshrrev_b32 v39, 3, v36
v_xor_b32 v38, v38, v39
v_and_b32 v38, 1, v38
v_and_b32 v39, 3, v36
v_lshl_or_b32 v38, v38, 2, v39
v_lshrrev_b32 v38, 1, v38
v_lshlrev_b32 v38, 1, v38
v_xor_b32 v37, v37, v38
s_mov_b32 s42, 1024
v_mul_lo_u32 v36, v36, s42
v_lshl_add_u32 v3, v37, 4, v36
s_mul_i32 s42, s29, 256
s_add_u32 s42, s42, 128
v_add_u32 v35, s42, v34
v_lshrrev_b32 v36, 3, v35
v_and_b32 v37, 7, v35
v_lshrrev_b32 v38, 2, v36
v_lshrrev_b32 v39, 3, v36
v_xor_b32 v38, v38, v39
v_and_b32 v38, 1, v38
v_and_b32 v39, 3, v36
v_lshl_or_b32 v38, v38, 2, v39
v_lshrrev_b32 v38, 1, v38
v_lshlrev_b32 v38, 1, v38
v_xor_b32 v37, v37, v38
s_mov_b32 s42, 1024
v_mul_lo_u32 v36, v36, s42
v_lshl_add_u32 v4, v37, 4, v36
s_mul_i32 s42, s29, 256
s_add_u32 s42, s42, 192
v_add_u32 v35, s42, v34
v_lshrrev_b32 v36, 3, v35
v_and_b32 v37, 7, v35
v_lshrrev_b32 v38, 2, v36
v_lshrrev_b32 v39, 3, v36
v_xor_b32 v38, v38, v39
v_and_b32 v38, 1, v38
v_and_b32 v39, 3, v36
v_lshl_or_b32 v38, v38, 2, v39
v_lshrrev_b32 v38, 1, v38
v_lshlrev_b32 v38, 1, v38
v_xor_b32 v37, v37, v38
s_mov_b32 s42, 1024
v_mul_lo_u32 v36, v36, s42
v_lshl_add_u32 v5, v37, 4, v36
v_bfe_u32 v35, v34, 2, 2
v_lshrrev_b32 v36, 4, v34
v_lshl_add_u32 v37, v36, 3, v35
v_lshrrev_b32 v38, 2, v37
v_lshrrev_b32 v39, 3, v37
v_xor_b32 v38, v38, v39
v_and_b32 v38, 1, v38
v_and_b32 v39, 3, v37
v_lshl_or_b32 v38, v38, 2, v39
v_lshrrev_b32 v38, 1, v38
v_mul_u32_u24 v37, 128, v37
v_and_b32 v39, 3, v34
v_lshl_add_u32 v37, v39, 3, v37
v_xor_b32 v39, 0, v38
v_lshl_add_u32 v18, v39, 5, v37
v_add_u32 v22, 0x10000, v18
v_xor_b32 v39, 1, v38
v_lshl_add_u32 v19, v39, 5, v37
v_add_u32 v23, 0x10000, v19
v_xor_b32 v39, 2, v38
v_lshl_add_u32 v20, v39, 5, v37
v_add_u32 v24, 0x10000, v20
v_xor_b32 v39, 3, v38
v_lshl_add_u32 v21, v39, 5, v37
v_add_u32 v25, 0x10000, v21
v_lshl_add_u32 v37, v36, 3, v35
v_add_u32 v37, 4, v37
v_lshrrev_b32 v38, 2, v37
v_lshrrev_b32 v39, 3, v37
v_xor_b32 v38, v38, v39
v_and_b32 v38, 1, v38
v_and_b32 v39, 3, v37
v_lshl_or_b32 v38, v38, 2, v39
v_lshrrev_b32 v38, 1, v38
v_mul_u32_u24 v37, 128, v37
v_and_b32 v39, 3, v34
v_lshl_add_u32 v37, v39, 3, v37
v_xor_b32 v39, 0, v38
v_lshl_add_u32 v26, v39, 5, v37
v_add_u32 v30, 0x10000, v26
v_xor_b32 v39, 1, v38
v_lshl_add_u32 v27, v39, 5, v37
v_add_u32 v31, 0x10000, v27
v_xor_b32 v39, 2, v38
v_lshl_add_u32 v28, v39, 5, v37
v_add_u32 v32, 0x10000, v28
v_xor_b32 v39, 3, v38
v_lshl_add_u32 v29, v39, 5, v37
v_add_u32 v33, 0x10000, v29
s_lshl_b32 s48, s60, 17
s_lshl_b32 s61, s63, 15
s_add_u32 s48, s48, s61
s_add_u32 s48, s48, 83886080
s_lshl_b32 s49, s53, 7
s_lshl_b32 s61, s63, 20
s_add_u32 s49, s49, s61
s_mul_i32 s51, s29, 4096
s_add_u32 s42, s49, 0
s_add_u32 m0, s51, 0
s_nop 0
buffer_load_dwordx4 v2, s[12:15], s42 offen lds
s_add_u32 m0, s51, 1024
s_nop 0
buffer_load_dwordx4 v3, s[12:15], s42 offen lds
s_add_u32 m0, s51, 2048
s_nop 0
buffer_load_dwordx4 v4, s[12:15], s42 offen lds
s_add_u32 m0, s51, 3072
s_nop 0
buffer_load_dwordx4 v5, s[12:15], s42 offen lds
s_add_u32 s42, s49, 131072
s_add_u32 m0, s51, 16384
s_nop 0
buffer_load_dwordx4 v2, s[12:15], s42 offen lds
s_add_u32 m0, s51, 17408
s_nop 0
buffer_load_dwordx4 v3, s[12:15], s42 offen lds
s_add_u32 m0, s51, 18432
s_nop 0
buffer_load_dwordx4 v4, s[12:15], s42 offen lds
s_add_u32 m0, s51, 19456
s_nop 0
buffer_load_dwordx4 v5, s[12:15], s42 offen lds
s_add_u32 s42, s49, 262144
s_add_u32 m0, s51, 32768
s_nop 0
buffer_load_dwordx4 v2, s[12:15], s42 offen lds
s_add_u32 m0, s51, 33792
s_nop 0
buffer_load_dwordx4 v3, s[12:15], s42 offen lds
s_add_u32 m0, s51, 34816
s_nop 0
buffer_load_dwordx4 v4, s[12:15], s42 offen lds
s_add_u32 m0, s51, 35840
s_nop 0
buffer_load_dwordx4 v5, s[12:15], s42 offen lds
s_add_u32 s42, s49, 393216
s_add_u32 m0, s51, 49152
s_nop 0
buffer_load_dwordx4 v2, s[12:15], s42 offen lds
s_add_u32 m0, s51, 50176
s_nop 0
buffer_load_dwordx4 v3, s[12:15], s42 offen lds
s_add_u32 m0, s51, 51200
s_nop 0
buffer_load_dwordx4 v4, s[12:15], s42 offen lds
s_add_u32 m0, s51, 52224
s_nop 0
buffer_load_dwordx4 v5, s[12:15], s42 offen lds
s_add_u32 s42, s49, 524288
s_add_u32 m0, s51, 65536
s_nop 0
buffer_load_dwordx4 v2, s[12:15], s42 offen lds
s_add_u32 m0, s51, 66560
s_nop 0
buffer_load_dwordx4 v3, s[12:15], s42 offen lds
s_add_u32 m0, s51, 67584
s_nop 0
buffer_load_dwordx4 v4, s[12:15], s42 offen lds
s_add_u32 m0, s51, 68608
s_nop 0
buffer_load_dwordx4 v5, s[12:15], s42 offen lds
s_add_u32 s42, s49, 655360
s_add_u32 m0, s51, 81920
s_nop 0
buffer_load_dwordx4 v2, s[12:15], s42 offen lds
s_add_u32 m0, s51, 82944
s_nop 0
buffer_load_dwordx4 v3, s[12:15], s42 offen lds
s_add_u32 m0, s51, 83968
s_nop 0
buffer_load_dwordx4 v4, s[12:15], s42 offen lds
s_add_u32 m0, s51, 84992
s_nop 0
buffer_load_dwordx4 v5, s[12:15], s42 offen lds
s_add_u32 s42, s49, 786432
s_add_u32 m0, s51, 98304
s_nop 0
buffer_load_dwordx4 v2, s[12:15], s42 offen lds
s_add_u32 m0, s51, 99328
s_nop 0
buffer_load_dwordx4 v3, s[12:15], s42 offen lds
s_add_u32 m0, s51, 100352
s_nop 0
buffer_load_dwordx4 v4, s[12:15], s42 offen lds
s_add_u32 m0, s51, 101376
s_nop 0
buffer_load_dwordx4 v5, s[12:15], s42 offen lds
s_lshl_b32 s3, s52, 3
s_add_u32 s3, s3, s53
s_lshl_b32 s3, s3, 7
s_add_u32 s3, s3, 4219904
s_cmp_lg_u32 s29, 0
s_cbranch_scc1 WWd_92
v_mov_b32 v34, s3
s_mov_b32 s45, 0
WW_91:
buffer_load_dword v35, v34, s[84:87], 0 offen sc1
s_add_u32 s45, s45, 1
s_waitcnt vmcnt(0)
v_readfirstlane_b32 s44, v35
s_cmp_ge_u32 s44, 1
s_cbranch_scc1 WWd_92
s_cmp_gt_u32 s45, 400000
s_cbranch_scc1 WWd_92
s_cmp_lg_u32 s44, 0
s_cbranch_scc1 WWs_93
s_sleep 16
s_branch WW_91
WWs_93:
s_sleep 16
s_branch WW_91
WWd_92:
s_waitcnt vmcnt(0)
s_barrier
s_lshl_b32 s3, s52, 2
s_add_u32 s3, s3, s63
s_lshl_b32 s3, s3, 7
s_add_u32 s3, s3, 4203520
s_cmp_lg_u32 s29, 0
s_cbranch_scc1 WWd_95
v_mov_b32 v34, s3
s_mov_b32 s45, 0
WW_94:
buffer_load_dword v35, v34, s[84:87], 0 offen sc1
s_add_u32 s45, s45, 1
s_waitcnt vmcnt(0)
v_readfirstlane_b32 s44, v35
s_cmp_ge_u32 s44, 4
s_cbranch_scc1 WWd_95
s_cmp_gt_u32 s45, 400000
s_cbranch_scc1 WWd_95
s_cmp_lg_u32 s44, 0
s_cbranch_scc1 WWs_96
s_sleep 8
s_branch WW_94
WWs_96:
s_sleep 2
s_branch WW_94
WWd_95:
s_waitcnt vmcnt(0)
s_barrier
buffer_load_dwordx4 v[48:51], v1, s[8:11], s48 offen offset:0 sc1
buffer_load_dwordx4 v[52:55], v1, s[8:11], s48 offen offset:1024 sc1
buffer_load_dwordx4 v[56:59], v1, s[8:11], s48 offen offset:2048 sc1
buffer_load_dwordx4 v[60:63], v1, s[8:11], s48 offen offset:3072 sc1
s_add_u32 s43, s48, 4096
buffer_load_dwordx4 v[64:67], v1, s[8:11], s43 offen offset:0 sc1
s_add_u32 s43, s48, 4096
buffer_load_dwordx4 v[68:71], v1, s[8:11], s43 offen offset:1024 sc1
s_add_u32 s43, s48, 4096
buffer_load_dwordx4 v[72:75], v1, s[8:11], s43 offen offset:2048 sc1
s_add_u32 s43, s48, 4096
buffer_load_dwordx4 v[76:79], v1, s[8:11], s43 offen offset:3072 sc1
s_add_u32 s43, s48, 8192
buffer_load_dwordx4 v[80:83], v1, s[8:11], s43 offen offset:0 sc1
s_add_u32 s43, s48, 8192
buffer_load_dwordx4 v[84:87], v1, s[8:11], s43 offen offset:1024 sc1
s_add_u32 s43, s48, 8192
buffer_load_dwordx4 v[88:91], v1, s[8:11], s43 offen offset:2048 sc1
s_add_u32 s43, s48, 8192
buffer_load_dwordx4 v[92:95], v1, s[8:11], s43 offen offset:3072 sc1
s_add_u32 s43, s48, 12288
buffer_load_dwordx4 v[96:99], v1, s[8:11], s43 offen offset:0 sc1
s_add_u32 s43, s48, 12288
buffer_load_dwordx4 v[100:103], v1, s[8:11], s43 offen offset:1024 sc1
s_add_u32 s43, s48, 12288
buffer_load_dwordx4 v[104:107], v1, s[8:11], s43 offen offset:2048 sc1
s_add_u32 s43, s48, 12288
buffer_load_dwordx4 v[108:111], v1, s[8:11], s43 offen offset:3072 sc1
s_add_u32 s43, s48, 16384
buffer_load_dwordx4 v[112:115], v1, s[8:11], s43 offen offset:0 sc1
s_add_u32 s43, s48, 16384
buffer_load_dwordx4 v[116:119], v1, s[8:11], s43 offen offset:1024 sc1
s_add_u32 s43, s48, 16384
buffer_load_dwordx4 v[120:123], v1, s[8:11], s43 offen offset:2048 sc1
s_add_u32 s43, s48, 16384
buffer_load_dwordx4 v[124:127], v1, s[8:11], s43 offen offset:3072 sc1
s_add_u32 s43, s48, 20480
buffer_load_dwordx4 v[128:131], v1, s[8:11], s43 offen offset:0 sc1
s_add_u32 s43, s48, 20480
buffer_load_dwordx4 v[132:135], v1, s[8:11], s43 offen offset:1024 sc1
s_add_u32 s43, s48, 20480
buffer_load_dwordx4 v[136:139], v1, s[8:11], s43 offen offset:2048 sc1
s_add_u32 s43, s48, 20480
buffer_load_dwordx4 v[140:143], v1, s[8:11], s43 offen offset:3072 sc1
s_add_u32 s43, s48, 24576
buffer_load_dwordx4 v[144:147], v1, s[8:11], s43 offen offset:0 sc1
s_add_u32 s43, s48, 24576
buffer_load_dwordx4 v[148:151], v1, s[8:11], s43 offen offset:1024 sc1
s_add_u32 s43, s48, 24576
buffer_load_dwordx4 v[152:155], v1, s[8:11], s43 offen offset:2048 sc1
s_add_u32 s43, s48, 24576
buffer_load_dwordx4 v[156:159], v1, s[8:11], s43 offen offset:3072 sc1
s_add_u32 s43, s48, 28672
buffer_load_dwordx4 v[160:163], v1, s[8:11], s43 offen offset:0 sc1
s_add_u32 s43, s48, 28672
buffer_load_dwordx4 v[164:167], v1, s[8:11], s43 offen offset:1024 sc1
s_add_u32 s43, s48, 28672
buffer_load_dwordx4 v[168:171], v1, s[8:11], s43 offen offset:2048 sc1
s_add_u32 s43, s48, 28672
buffer_load_dwordx4 v[172:175], v1, s[8:11], s43 offen offset:3072 sc1
s_barrier
s_add_u32 s42, s49, 917504
s_add_u32 m0, s51, 114688
s_nop 0
buffer_load_dwordx4 v2, s[12:15], s42 offen lds
s_add_u32 m0, s51, 115712
s_nop 0
buffer_load_dwordx4 v3, s[12:15], s42 offen lds
s_add_u32 m0, s51, 116736
s_nop 0
buffer_load_dwordx4 v4, s[12:15], s42 offen lds
s_add_u32 m0, s51, 117760
s_nop 0
buffer_load_dwordx4 v5, s[12:15], s42 offen lds
ds_read_b64_tr_b16 v[176:177], v18 offset:0
ds_read_b64_tr_b16 v[178:179], v26 offset:0
ds_read_b64_tr_b16 v[180:181], v19 offset:0
ds_read_b64_tr_b16 v[182:183], v27 offset:0
ds_read_b64_tr_b16 v[184:185], v20 offset:0
ds_read_b64_tr_b16 v[186:187], v28 offset:0
ds_read_b64_tr_b16 v[188:189], v21 offset:0
ds_read_b64_tr_b16 v[190:191], v29 offset:0
s_waitcnt vmcnt(35)
s_waitcnt lgkmcnt(6)
v_mfma_f32_16x16x32_bf16 a[0:3], v[48:51], v[176:179], 0
ds_read_b64_tr_b16 v[176:177], v18 offset:4096
ds_read_b64_tr_b16 v[178:179], v26 offset:4096
s_waitcnt lgkmcnt(6)
v_mfma_f32_16x16x32_bf16 a[4:7], v[48:51], v[180:183], 0
ds_read_b64_tr_b16 v[180:181], v19 offset:4096
ds_read_b64_tr_b16 v[182:183], v27 offset:4096
s_waitcnt lgkmcnt(6)
v_mfma_f32_16x16x32_bf16 a[8:11], v[48:51], v[184:187], 0
ds_read_b64_tr_b16 v[184:185], v20 offset:4096
ds_read_b64_tr_b16 v[186:187], v28 offset:4096
s_waitcnt lgkmcnt(6)
v_mfma_f32_16x16x32_bf16 a[12:15], v[48:51], v[188:191], 0
ds_read_b64_tr_b16 v[188:189], v21 offset:4096
ds_read_b64_tr_b16 v[190:191], v29 offset:4096
s_waitcnt vmcnt(34)
s_waitcnt lgkmcnt(6)
v_mfma_f32_16x16x32_bf16 a[0:3], v[52:55], v[176:179], a[0:3]
ds_read_b64_tr_b16 v[176:177], v18 offset:8192
ds_read_b64_tr_b16 v[178:179], v26 offset:8192
s_waitcnt lgkmcnt(6)
v_mfma_f32_16x16x32_bf16 a[4:7], v[52:55], v[180:183], a[4:7]
ds_read_b64_tr_b16 v[180:181], v19 offset:8192
ds_read_b64_tr_b16 v[182:183], v27 offset:8192
s_waitcnt lgkmcnt(6)
v_mfma_f32_16x16x32_bf16 a[8:11], v[52:55], v[184:187], a[8:11]
ds_read_b64_tr_b16 v[184:185], v20 offset:8192
ds_read_b64_tr_b16 v[186:187], v28 offset:8192
s_waitcnt lgkmcnt(6)
v_mfma_f32_16x16x32_bf16 a[12:15], v[52:55], v[188:191], a[12:15]
ds_read_b64_tr_b16 v[188:189], v21 offset:8192
ds_read_b64_tr_b16 v[190:191], v29 offset:8192
s_waitcnt vmcnt(33)
s_waitcnt lgkmcnt(6)
v_mfma_f32_16x16x32_bf16 a[0:3], v[56:59], v[176:179], a[0:3]
ds_read_b64_tr_b16 v[176:177], v18 offset:12288
ds_read_b64_tr_b16 v[178:179], v26 offset:12288
s_waitcnt lgkmcnt(6)
v_mfma_f32_16x16x32_bf16 a[4:7], v[56:59], v[180:183], a[4:7]
ds_read_b64_tr_b16 v[180:181], v19 offset:12288
ds_read_b64_tr_b16 v[182:183], v27 offset:12288
s_waitcnt lgkmcnt(6)
v_mfma_f32_16x16x32_bf16 a[8:11], v[56:59], v[184:187], a[8:11]
ds_read_b64_tr_b16 v[184:185], v20 offset:12288
ds_read_b64_tr_b16 v[186:187], v28 offset:12288
s_waitcnt lgkmcnt(6)
v_mfma_f32_16x16x32_bf16 a[12:15], v[56:59], v[188:191], a[12:15]
ds_read_b64_tr_b16 v[188:189], v21 offset:12288
ds_read_b64_tr_b16 v[190:191], v29 offset:12288
s_waitcnt vmcnt(32)
s_waitcnt lgkmcnt(6)
v_mfma_f32_16x16x32_bf16 a[0:3], v[60:63], v[176:179], a[0:3]
s_waitcnt lgkmcnt(4)
v_mfma_f32_16x16x32_bf16 a[4:7], v[60:63], v[180:183], a[4:7]
s_waitcnt lgkmcnt(2)
v_mfma_f32_16x16x32_bf16 a[8:11], v[60:63], v[184:187], a[8:11]
s_waitcnt lgkmcnt(0)
v_mfma_f32_16x16x32_bf16 a[12:15], v[60:63], v[188:191], a[12:15]
s_barrier
ds_read_b64_tr_b16 v[176:177], v18 offset:16384
ds_read_b64_tr_b16 v[178:179], v26 offset:16384
ds_read_b64_tr_b16 v[180:181], v19 offset:16384
ds_read_b64_tr_b16 v[182:183], v27 offset:16384
ds_read_b64_tr_b16 v[184:185], v20 offset:16384
ds_read_b64_tr_b16 v[186:187], v28 offset:16384
ds_read_b64_tr_b16 v[188:189], v21 offset:16384
ds_read_b64_tr_b16 v[190:191], v29 offset:16384
s_waitcnt vmcnt(31)
s_waitcnt lgkmcnt(6)
v_mfma_f32_16x16x32_bf16 a[0:3], v[64:67], v[176:179], a[0:3]
ds_read_b64_tr_b16 v[176:177], v18 offset:20480
ds_read_b64_tr_b16 v[178:179], v26 offset:20480
s_waitcnt lgkmcnt(6)
v_mfma_f32_16x16x32_bf16 a[4:7], v[64:67], v[180:183], a[4:7]
ds_read_b64_tr_b16 v[180:181], v19 offset:20480
ds_read_b64_tr_b16 v[182:183], v27 offset:20480
s_waitcnt lgkmcnt(6)
v_mfma_f32_16x16x32_bf16 a[8:11], v[64:67], v[184:187], a[8:11]
ds_read_b64_tr_b16 v[184:185], v20 offset:20480
ds_read_b64_tr_b16 v[186:187], v28 offset:20480
s_waitcnt lgkmcnt(6)
v_mfma_f32_16x16x32_bf16 a[12:15], v[64:67], v[188:191], a[12:15]
ds_read_b64_tr_b16 v[188:189], v21 offset:20480
ds_read_b64_tr_b16 v[190:191], v29 offset:20480
s_waitcnt vmcnt(30)
s_waitcnt lgkmcnt(6)
v_mfma_f32_16x16x32_bf16 a[0:3], v[68:71], v[176:179], a[0:3]
ds_read_b64_tr_b16 v[176:177], v18 offset:24576
ds_read_b64_tr_b16 v[178:179], v26 offset:24576
s_waitcnt lgkmcnt(6)
v_mfma_f32_16x16x32_bf16 a[4:7], v[68:71], v[180:183], a[4:7]
ds_read_b64_tr_b16 v[180:181], v19 offset:24576
ds_read_b64_tr_b16 v[182:183], v27 offset:24576
s_waitcnt lgkmcnt(6)
v_mfma_f32_16x16x32_bf16 a[8:11], v[68:71], v[184:187], a[8:11]
ds_read_b64_tr_b16 v[184:185], v20 offset:24576
ds_read_b64_tr_b16 v[186:187], v28 offset:24576
s_waitcnt lgkmcnt(6)
v_mfma_f32_16x16x32_bf16 a[12:15], v[68:71], v[188:191], a[12:15]
ds_read_b64_tr_b16 v[188:189], v21 offset:24576
ds_read_b64_tr_b16 v[190:191], v29 offset:24576
s_waitcnt vmcnt(29)
s_waitcnt lgkmcnt(6)
v_mfma_f32_16x16x32_bf16 a[0:3], v[72:75], v[176:179], a[0:3]
ds_read_b64_tr_b16 v[176:177], v18 offset:28672
ds_read_b64_tr_b16 v[178:179], v26 offset:28672
s_waitcnt lgkmcnt(6)
v_mfma_f32_16x16x32_bf16 a[4:7], v[72:75], v[180:183], a[4:7]
ds_read_b64_tr_b16 v[180:181], v19 offset:28672
ds_read_b64_tr_b16 v[182:183], v27 offset:28672
s_waitcnt lgkmcnt(6)
v_mfma_f32_16x16x32_bf16 a[8:11], v[72:75], v[184:187], a[8:11]
ds_read_b64_tr_b16 v[184:185], v20 offset:28672
ds_read_b64_tr_b16 v[186:187], v28 offset:28672
s_waitcnt lgkmcnt(6)
v_mfma_f32_16x16x32_bf16 a[12:15], v[72:75], v[188:191], a[12:15]
ds_read_b64_tr_b16 v[188:189], v21 offset:28672
ds_read_b64_tr_b16 v[190:191], v29 offset:28672
s_waitcnt vmcnt(28)
s_waitcnt lgkmcnt(6)
v_mfma_f32_16x16x32_bf16 a[0:3], v[76:79], v[176:179], a[0:3]
s_waitcnt lgkmcnt(4)
v_mfma_f32_16x16x32_bf16 a[4:7], v[76:79], v[180:183], a[4:7]
s_waitcnt lgkmcnt(2)
v_mfma_f32_16x16x32_bf16 a[8:11], v[76:79], v[184:187], a[8:11]
s_waitcnt lgkmcnt(0)
v_mfma_f32_16x16x32_bf16 a[12:15], v[76:79], v[188:191], a[12:15]
s_barrier
ds_read_b64_tr_b16 v[176:177], v18 offset:32768
ds_read_b64_tr_b16 v[178:179], v26 offset:32768
ds_read_b64_tr_b16 v[180:181], v19 offset:32768
ds_read_b64_tr_b16 v[182:183], v27 offset:32768
ds_read_b64_tr_b16 v[184:185], v20 offset:32768
ds_read_b64_tr_b16 v[186:187], v28 offset:32768
ds_read_b64_tr_b16 v[188:189], v21 offset:32768
ds_read_b64_tr_b16 v[190:191], v29 offset:32768
s_waitcnt vmcnt(27)
s_waitcnt lgkmcnt(6)
v_mfma_f32_16x16x32_bf16 a[0:3], v[80:83], v[176:179], a[0:3]
ds_read_b64_tr_b16 v[176:177], v18 offset:36864
ds_read_b64_tr_b16 v[178:179], v26 offset:36864
s_waitcnt lgkmcnt(6)
v_mfma_f32_16x16x32_bf16 a[4:7], v[80:83], v[180:183], a[4:7]
ds_read_b64_tr_b16 v[180:181], v19 offset:36864
ds_read_b64_tr_b16 v[182:183], v27 offset:36864
s_waitcnt lgkmcnt(6)
v_mfma_f32_16x16x32_bf16 a[8:11], v[80:83], v[184:187], a[8:11]
ds_read_b64_tr_b16 v[184:185], v20 offset:36864
ds_read_b64_tr_b16 v[186:187], v28 offset:36864
s_waitcnt lgkmcnt(6)
v_mfma_f32_16x16x32_bf16 a[12:15], v[80:83], v[188:191], a[12:15]
ds_read_b64_tr_b16 v[188:189], v21 offset:36864
ds_read_b64_tr_b16 v[190:191], v29 offset:36864
s_waitcnt vmcnt(26)
s_waitcnt lgkmcnt(6)
v_mfma_f32_16x16x32_bf16 a[0:3], v[84:87], v[176:179], a[0:3]
ds_read_b64_tr_b16 v[176:177], v18 offset:40960
ds_read_b64_tr_b16 v[178:179], v26 offset:40960
s_waitcnt lgkmcnt(6)
v_mfma_f32_16x16x32_bf16 a[4:7], v[84:87], v[180:183], a[4:7]
ds_read_b64_tr_b16 v[180:181], v19 offset:40960
ds_read_b64_tr_b16 v[182:183], v27 offset:40960
s_waitcnt lgkmcnt(6)
v_mfma_f32_16x16x32_bf16 a[8:11], v[84:87], v[184:187], a[8:11]
ds_read_b64_tr_b16 v[184:185], v20 offset:40960
ds_read_b64_tr_b16 v[186:187], v28 offset:40960
s_waitcnt lgkmcnt(6)
v_mfma_f32_16x16x32_bf16 a[12:15], v[84:87], v[188:191], a[12:15]
ds_read_b64_tr_b16 v[188:189], v21 offset:40960
ds_read_b64_tr_b16 v[190:191], v29 offset:40960
s_waitcnt vmcnt(25)
s_waitcnt lgkmcnt(6)
v_mfma_f32_16x16x32_bf16 a[0:3], v[88:91], v[176:179], a[0:3]
ds_read_b64_tr_b16 v[176:177], v18 offset:45056
ds_read_b64_tr_b16 v[178:179], v26 offset:45056
s_waitcnt lgkmcnt(6)
v_mfma_f32_16x16x32_bf16 a[4:7], v[88:91], v[180:183], a[4:7]
ds_read_b64_tr_b16 v[180:181], v19 offset:45056
ds_read_b64_tr_b16 v[182:183], v27 offset:45056
s_waitcnt lgkmcnt(6)
v_mfma_f32_16x16x32_bf16 a[8:11], v[88:91], v[184:187], a[8:11]
ds_read_b64_tr_b16 v[184:185], v20 offset:45056
ds_read_b64_tr_b16 v[186:187], v28 offset:45056
s_waitcnt lgkmcnt(6)
v_mfma_f32_16x16x32_bf16 a[12:15], v[88:91], v[188:191], a[12:15]
ds_read_b64_tr_b16 v[188:189], v21 offset:45056
ds_read_b64_tr_b16 v[190:191], v29 offset:45056
s_waitcnt vmcnt(24)
s_waitcnt lgkmcnt(6)
v_mfma_f32_16x16x32_bf16 a[0:3], v[92:95], v[176:179], a[0:3]
s_waitcnt lgkmcnt(4)
v_mfma_f32_16x16x32_bf16 a[4:7], v[92:95], v[180:183], a[4:7]
s_waitcnt lgkmcnt(2)
v_mfma_f32_16x16x32_bf16 a[8:11], v[92:95], v[184:187], a[8:11]
s_waitcnt lgkmcnt(0)
v_mfma_f32_16x16x32_bf16 a[12:15], v[92:95], v[188:191], a[12:15]
s_barrier
ds_read_b64_tr_b16 v[176:177], v18 offset:49152
ds_read_b64_tr_b16 v[178:179], v26 offset:49152
ds_read_b64_tr_b16 v[180:181], v19 offset:49152
ds_read_b64_tr_b16 v[182:183], v27 offset:49152
ds_read_b64_tr_b16 v[184:185], v20 offset:49152
ds_read_b64_tr_b16 v[186:187], v28 offset:49152
ds_read_b64_tr_b16 v[188:189], v21 offset:49152
ds_read_b64_tr_b16 v[190:191], v29 offset:49152
s_waitcnt vmcnt(23)
s_waitcnt lgkmcnt(6)
v_mfma_f32_16x16x32_bf16 a[0:3], v[96:99], v[176:179], a[0:3]
ds_read_b64_tr_b16 v[176:177], v18 offset:53248
ds_read_b64_tr_b16 v[178:179], v26 offset:53248
s_waitcnt lgkmcnt(6)
v_mfma_f32_16x16x32_bf16 a[4:7], v[96:99], v[180:183], a[4:7]
ds_read_b64_tr_b16 v[180:181], v19 offset:53248
ds_read_b64_tr_b16 v[182:183], v27 offset:53248
s_waitcnt lgkmcnt(6)
v_mfma_f32_16x16x32_bf16 a[8:11], v[96:99], v[184:187], a[8:11]
ds_read_b64_tr_b16 v[184:185], v20 offset:53248
ds_read_b64_tr_b16 v[186:187], v28 offset:53248
s_waitcnt lgkmcnt(6)
v_mfma_f32_16x16x32_bf16 a[12:15], v[96:99], v[188:191], a[12:15]
ds_read_b64_tr_b16 v[188:189], v21 offset:53248
ds_read_b64_tr_b16 v[190:191], v29 offset:53248
s_waitcnt vmcnt(22)
s_waitcnt lgkmcnt(6)
v_mfma_f32_16x16x32_bf16 a[0:3], v[100:103], v[176:179], a[0:3]
ds_read_b64_tr_b16 v[176:177], v18 offset:57344
ds_read_b64_tr_b16 v[178:179], v26 offset:57344
s_waitcnt lgkmcnt(6)
v_mfma_f32_16x16x32_bf16 a[4:7], v[100:103], v[180:183], a[4:7]
ds_read_b64_tr_b16 v[180:181], v19 offset:57344
ds_read_b64_tr_b16 v[182:183], v27 offset:57344
s_waitcnt lgkmcnt(6)
v_mfma_f32_16x16x32_bf16 a[8:11], v[100:103], v[184:187], a[8:11]
ds_read_b64_tr_b16 v[184:185], v20 offset:57344
ds_read_b64_tr_b16 v[186:187], v28 offset:57344
s_waitcnt lgkmcnt(6)
v_mfma_f32_16x16x32_bf16 a[12:15], v[100:103], v[188:191], a[12:15]
ds_read_b64_tr_b16 v[188:189], v21 offset:57344
ds_read_b64_tr_b16 v[190:191], v29 offset:57344
s_waitcnt vmcnt(21)
s_waitcnt lgkmcnt(6)
v_mfma_f32_16x16x32_bf16 a[0:3], v[104:107], v[176:179], a[0:3]
ds_read_b64_tr_b16 v[176:177], v18 offset:61440
ds_read_b64_tr_b16 v[178:179], v26 offset:61440
s_waitcnt lgkmcnt(6)
v_mfma_f32_16x16x32_bf16 a[4:7], v[104:107], v[180:183], a[4:7]
ds_read_b64_tr_b16 v[180:181], v19 offset:61440
ds_read_b64_tr_b16 v[182:183], v27 offset:61440
s_waitcnt lgkmcnt(6)
v_mfma_f32_16x16x32_bf16 a[8:11], v[104:107], v[184:187], a[8:11]
ds_read_b64_tr_b16 v[184:185], v20 offset:61440
ds_read_b64_tr_b16 v[186:187], v28 offset:61440
s_waitcnt lgkmcnt(6)
v_mfma_f32_16x16x32_bf16 a[12:15], v[104:107], v[188:191], a[12:15]
ds_read_b64_tr_b16 v[188:189], v21 offset:61440
ds_read_b64_tr_b16 v[190:191], v29 offset:61440
s_waitcnt vmcnt(20)
s_waitcnt lgkmcnt(6)
v_mfma_f32_16x16x32_bf16 a[0:3], v[108:111], v[176:179], a[0:3]
s_waitcnt lgkmcnt(4)
v_mfma_f32_16x16x32_bf16 a[4:7], v[108:111], v[180:183], a[4:7]
s_waitcnt lgkmcnt(2)
v_mfma_f32_16x16x32_bf16 a[8:11], v[108:111], v[184:187], a[8:11]
s_waitcnt lgkmcnt(0)
v_mfma_f32_16x16x32_bf16 a[12:15], v[108:111], v[188:191], a[12:15]
s_barrier
ds_read_b64_tr_b16 v[176:177], v22 offset:0
ds_read_b64_tr_b16 v[178:179], v30 offset:0
ds_read_b64_tr_b16 v[180:181], v23 offset:0
ds_read_b64_tr_b16 v[182:183], v31 offset:0
ds_read_b64_tr_b16 v[184:185], v24 offset:0
ds_read_b64_tr_b16 v[186:187], v32 offset:0
ds_read_b64_tr_b16 v[188:189], v25 offset:0
ds_read_b64_tr_b16 v[190:191], v33 offset:0
s_waitcnt vmcnt(19)
s_waitcnt lgkmcnt(6)
v_mfma_f32_16x16x32_bf16 a[0:3], v[112:115], v[176:179], a[0:3]
ds_read_b64_tr_b16 v[176:177], v22 offset:4096
ds_read_b64_tr_b16 v[178:179], v30 offset:4096
s_waitcnt lgkmcnt(6)
v_mfma_f32_16x16x32_bf16 a[4:7], v[112:115], v[180:183], a[4:7]
ds_read_b64_tr_b16 v[180:181], v23 offset:4096
ds_read_b64_tr_b16 v[182:183], v31 offset:4096
s_waitcnt lgkmcnt(6)
v_mfma_f32_16x16x32_bf16 a[8:11], v[112:115], v[184:187], a[8:11]
ds_read_b64_tr_b16 v[184:185], v24 offset:4096
ds_read_b64_tr_b16 v[186:187], v32 offset:4096
s_waitcnt lgkmcnt(6)
v_mfma_f32_16x16x32_bf16 a[12:15], v[112:115], v[188:191], a[12:15]
ds_read_b64_tr_b16 v[188:189], v25 offset:4096
ds_read_b64_tr_b16 v[190:191], v33 offset:4096
s_waitcnt vmcnt(18)
s_waitcnt lgkmcnt(6)
v_mfma_f32_16x16x32_bf16 a[0:3], v[116:119], v[176:179], a[0:3]
ds_read_b64_tr_b16 v[176:177], v22 offset:8192
ds_read_b64_tr_b16 v[178:179], v30 offset:8192
s_waitcnt lgkmcnt(6)
v_mfma_f32_16x16x32_bf16 a[4:7], v[116:119], v[180:183], a[4:7]
ds_read_b64_tr_b16 v[180:181], v23 offset:8192
ds_read_b64_tr_b16 v[182:183], v31 offset:8192
s_waitcnt lgkmcnt(6)
v_mfma_f32_16x16x32_bf16 a[8:11], v[116:119], v[184:187], a[8:11]
ds_read_b64_tr_b16 v[184:185], v24 offset:8192
ds_read_b64_tr_b16 v[186:187], v32 offset:8192
s_waitcnt lgkmcnt(6)
v_mfma_f32_16x16x32_bf16 a[12:15], v[116:119], v[188:191], a[12:15]
ds_read_b64_tr_b16 v[188:189], v25 offset:8192
ds_read_b64_tr_b16 v[190:191], v33 offset:8192
s_waitcnt vmcnt(17)
s_waitcnt lgkmcnt(6)
v_mfma_f32_16x16x32_bf16 a[0:3], v[120:123], v[176:179], a[0:3]
ds_read_b64_tr_b16 v[176:177], v22 offset:12288
ds_read_b64_tr_b16 v[178:179], v30 offset:12288
s_waitcnt lgkmcnt(6)
v_mfma_f32_16x16x32_bf16 a[4:7], v[120:123], v[180:183], a[4:7]
ds_read_b64_tr_b16 v[180:181], v23 offset:12288
ds_read_b64_tr_b16 v[182:183], v31 offset:12288
s_waitcnt lgkmcnt(6)
v_mfma_f32_16x16x32_bf16 a[8:11], v[120:123], v[184:187], a[8:11]
ds_read_b64_tr_b16 v[184:185], v24 offset:12288
ds_read_b64_tr_b16 v[186:187], v32 offset:12288
s_waitcnt lgkmcnt(6)
v_mfma_f32_16x16x32_bf16 a[12:15], v[120:123], v[188:191], a[12:15]
ds_read_b64_tr_b16 v[188:189], v25 offset:12288
ds_read_b64_tr_b16 v[190:191], v33 offset:12288
s_waitcnt vmcnt(16)
s_waitcnt lgkmcnt(6)
v_mfma_f32_16x16x32_bf16 a[0:3], v[124:127], v[176:179], a[0:3]
s_waitcnt lgkmcnt(4)
v_mfma_f32_16x16x32_bf16 a[4:7], v[124:127], v[180:183], a[4:7]
s_waitcnt lgkmcnt(2)
v_mfma_f32_16x16x32_bf16 a[8:11], v[124:127], v[184:187], a[8:11]
s_waitcnt lgkmcnt(0)
v_mfma_f32_16x16x32_bf16 a[12:15], v[124:127], v[188:191], a[12:15]
s_barrier
ds_read_b64_tr_b16 v[176:177], v22 offset:16384
ds_read_b64_tr_b16 v[178:179], v30 offset:16384
ds_read_b64_tr_b16 v[180:181], v23 offset:16384
ds_read_b64_tr_b16 v[182:183], v31 offset:16384
ds_read_b64_tr_b16 v[184:185], v24 offset:16384
ds_read_b64_tr_b16 v[186:187], v32 offset:16384
ds_read_b64_tr_b16 v[188:189], v25 offset:16384
ds_read_b64_tr_b16 v[190:191], v33 offset:16384
s_waitcnt vmcnt(15)
s_waitcnt lgkmcnt(6)
v_mfma_f32_16x16x32_bf16 a[0:3], v[128:131], v[176:179], a[0:3]
ds_read_b64_tr_b16 v[176:177], v22 offset:20480
ds_read_b64_tr_b16 v[178:179], v30 offset:20480
s_waitcnt lgkmcnt(6)
v_mfma_f32_16x16x32_bf16 a[4:7], v[128:131], v[180:183], a[4:7]
ds_read_b64_tr_b16 v[180:181], v23 offset:20480
ds_read_b64_tr_b16 v[182:183], v31 offset:20480
s_waitcnt lgkmcnt(6)
v_mfma_f32_16x16x32_bf16 a[8:11], v[128:131], v[184:187], a[8:11]
ds_read_b64_tr_b16 v[184:185], v24 offset:20480
ds_read_b64_tr_b16 v[186:187], v32 offset:20480
s_waitcnt lgkmcnt(6)
v_mfma_f32_16x16x32_bf16 a[12:15], v[128:131], v[188:191], a[12:15]
ds_read_b64_tr_b16 v[188:189], v25 offset:20480
ds_read_b64_tr_b16 v[190:191], v33 offset:20480
s_waitcnt vmcnt(14)
s_waitcnt lgkmcnt(6)
v_mfma_f32_16x16x32_bf16 a[0:3], v[132:135], v[176:179], a[0:3]
ds_read_b64_tr_b16 v[176:177], v22 offset:24576
ds_read_b64_tr_b16 v[178:179], v30 offset:24576
s_waitcnt lgkmcnt(6)
v_mfma_f32_16x16x32_bf16 a[4:7], v[132:135], v[180:183], a[4:7]
ds_read_b64_tr_b16 v[180:181], v23 offset:24576
ds_read_b64_tr_b16 v[182:183], v31 offset:24576
s_waitcnt lgkmcnt(6)
v_mfma_f32_16x16x32_bf16 a[8:11], v[132:135], v[184:187], a[8:11]
ds_read_b64_tr_b16 v[184:185], v24 offset:24576
ds_read_b64_tr_b16 v[186:187], v32 offset:24576
s_waitcnt lgkmcnt(6)
v_mfma_f32_16x16x32_bf16 a[12:15], v[132:135], v[188:191], a[12:15]
ds_read_b64_tr_b16 v[188:189], v25 offset:24576
ds_read_b64_tr_b16 v[190:191], v33 offset:24576
s_waitcnt vmcnt(13)
s_waitcnt lgkmcnt(6)
v_mfma_f32_16x16x32_bf16 a[0:3], v[136:139], v[176:179], a[0:3]
ds_read_b64_tr_b16 v[176:177], v22 offset:28672
ds_read_b64_tr_b16 v[178:179], v30 offset:28672
s_waitcnt lgkmcnt(6)
v_mfma_f32_16x16x32_bf16 a[4:7], v[136:139], v[180:183], a[4:7]
ds_read_b64_tr_b16 v[180:181], v23 offset:28672
ds_read_b64_tr_b16 v[182:183], v31 offset:28672
s_waitcnt lgkmcnt(6)
v_mfma_f32_16x16x32_bf16 a[8:11], v[136:139], v[184:187], a[8:11]
ds_read_b64_tr_b16 v[184:185], v24 offset:28672
ds_read_b64_tr_b16 v[186:187], v32 offset:28672
s_waitcnt lgkmcnt(6)
v_mfma_f32_16x16x32_bf16 a[12:15], v[136:139], v[188:191], a[12:15]
ds_read_b64_tr_b16 v[188:189], v25 offset:28672
ds_read_b64_tr_b16 v[190:191], v33 offset:28672
s_waitcnt vmcnt(12)
s_waitcnt lgkmcnt(6)
v_mfma_f32_16x16x32_bf16 a[0:3], v[140:143], v[176:179], a[0:3]
s_waitcnt lgkmcnt(4)
v_mfma_f32_16x16x32_bf16 a[4:7], v[140:143], v[180:183], a[4:7]
s_waitcnt lgkmcnt(2)
v_mfma_f32_16x16x32_bf16 a[8:11], v[140:143], v[184:187], a[8:11]
s_waitcnt lgkmcnt(0)
v_mfma_f32_16x16x32_bf16 a[12:15], v[140:143], v[188:191], a[12:15]
s_barrier
ds_read_b64_tr_b16 v[176:177], v22 offset:32768
ds_read_b64_tr_b16 v[178:179], v30 offset:32768
ds_read_b64_tr_b16 v[180:181], v23 offset:32768
ds_read_b64_tr_b16 v[182:183], v31 offset:32768
ds_read_b64_tr_b16 v[184:185], v24 offset:32768
ds_read_b64_tr_b16 v[186:187], v32 offset:32768
ds_read_b64_tr_b16 v[188:189], v25 offset:32768
ds_read_b64_tr_b16 v[190:191], v33 offset:32768
s_waitcnt vmcnt(11)
s_waitcnt lgkmcnt(6)
v_mfma_f32_16x16x32_bf16 a[0:3], v[144:147], v[176:179], a[0:3]
ds_read_b64_tr_b16 v[176:177], v22 offset:36864
ds_read_b64_tr_b16 v[178:179], v30 offset:36864
s_waitcnt lgkmcnt(6)
v_mfma_f32_16x16x32_bf16 a[4:7], v[144:147], v[180:183], a[4:7]
ds_read_b64_tr_b16 v[180:181], v23 offset:36864
ds_read_b64_tr_b16 v[182:183], v31 offset:36864
s_waitcnt lgkmcnt(6)
v_mfma_f32_16x16x32_bf16 a[8:11], v[144:147], v[184:187], a[8:11]
ds_read_b64_tr_b16 v[184:185], v24 offset:36864
ds_read_b64_tr_b16 v[186:187], v32 offset:36864
s_waitcnt lgkmcnt(6)
v_mfma_f32_16x16x32_bf16 a[12:15], v[144:147], v[188:191], a[12:15]
ds_read_b64_tr_b16 v[188:189], v25 offset:36864
ds_read_b64_tr_b16 v[190:191], v33 offset:36864
s_waitcnt vmcnt(10)
s_waitcnt lgkmcnt(6)
v_mfma_f32_16x16x32_bf16 a[0:3], v[148:151], v[176:179], a[0:3]
ds_read_b64_tr_b16 v[176:177], v22 offset:40960
ds_read_b64_tr_b16 v[178:179], v30 offset:40960
s_waitcnt lgkmcnt(6)
v_mfma_f32_16x16x32_bf16 a[4:7], v[148:151], v[180:183], a[4:7]
ds_read_b64_tr_b16 v[180:181], v23 offset:40960
ds_read_b64_tr_b16 v[182:183], v31 offset:40960
s_waitcnt lgkmcnt(6)
v_mfma_f32_16x16x32_bf16 a[8:11], v[148:151], v[184:187], a[8:11]
ds_read_b64_tr_b16 v[184:185], v24 offset:40960
ds_read_b64_tr_b16 v[186:187], v32 offset:40960
s_waitcnt lgkmcnt(6)
v_mfma_f32_16x16x32_bf16 a[12:15], v[148:151], v[188:191], a[12:15]
ds_read_b64_tr_b16 v[188:189], v25 offset:40960
ds_read_b64_tr_b16 v[190:191], v33 offset:40960
s_waitcnt vmcnt(9)
s_waitcnt lgkmcnt(6)
v_mfma_f32_16x16x32_bf16 a[0:3], v[152:155], v[176:179], a[0:3]
ds_read_b64_tr_b16 v[176:177], v22 offset:45056
ds_read_b64_tr_b16 v[178:179], v30 offset:45056
s_waitcnt lgkmcnt(6)
v_mfma_f32_16x16x32_bf16 a[4:7], v[152:155], v[180:183], a[4:7]
ds_read_b64_tr_b16 v[180:181], v23 offset:45056
ds_read_b64_tr_b16 v[182:183], v31 offset:45056
s_waitcnt lgkmcnt(6)
v_mfma_f32_16x16x32_bf16 a[8:11], v[152:155], v[184:187], a[8:11]
ds_read_b64_tr_b16 v[184:185], v24 offset:45056
ds_read_b64_tr_b16 v[186:187], v32 offset:45056
s_waitcnt lgkmcnt(6)
v_mfma_f32_16x16x32_bf16 a[12:15], v[152:155], v[188:191], a[12:15]
ds_read_b64_tr_b16 v[188:189], v25 offset:45056
ds_read_b64_tr_b16 v[190:191], v33 offset:45056
s_waitcnt vmcnt(8)
s_waitcnt lgkmcnt(6)
v_mfma_f32_16x16x32_bf16 a[0:3], v[156:159], v[176:179], a[0:3]
s_waitcnt lgkmcnt(4)
v_mfma_f32_16x16x32_bf16 a[4:7], v[156:159], v[180:183], a[4:7]
s_waitcnt lgkmcnt(2)
v_mfma_f32_16x16x32_bf16 a[8:11], v[156:159], v[184:187], a[8:11]
s_waitcnt lgkmcnt(0)
v_mfma_f32_16x16x32_bf16 a[12:15], v[156:159], v[188:191], a[12:15]
s_waitcnt vmcnt(0)
s_barrier
ds_read_b64_tr_b16 v[176:177], v22 offset:49152
ds_read_b64_tr_b16 v[178:179], v30 offset:49152
ds_read_b64_tr_b16 v[180:181], v23 offset:49152
ds_read_b64_tr_b16 v[182:183], v31 offset:49152
ds_read_b64_tr_b16 v[184:185], v24 offset:49152
ds_read_b64_tr_b16 v[186:187], v32 offset:49152
ds_read_b64_tr_b16 v[188:189], v25 offset:49152
ds_read_b64_tr_b16 v[190:191], v33 offset:49152
s_waitcnt lgkmcnt(6)
v_mfma_f32_16x16x32_bf16 a[0:3], v[160:163], v[176:179], a[0:3]
ds_read_b64_tr_b16 v[176:177], v22 offset:53248
ds_read_b64_tr_b16 v[178:179], v30 offset:53248
s_waitcnt lgkmcnt(6)
v_mfma_f32_16x16x32_bf16 a[4:7], v[160:163], v[180:183], a[4:7]
ds_read_b64_tr_b16 v[180:181], v23 offset:53248
ds_read_b64_tr_b16 v[182:183], v31 offset:53248
s_waitcnt lgkmcnt(6)
v_mfma_f32_16x16x32_bf16 a[8:11], v[160:163], v[184:187], a[8:11]
ds_read_b64_tr_b16 v[184:185], v24 offset:53248
ds_read_b64_tr_b16 v[186:187], v32 offset:53248
s_waitcnt lgkmcnt(6)
v_mfma_f32_16x16x32_bf16 a[12:15], v[160:163], v[188:191], a[12:15]
ds_read_b64_tr_b16 v[188:189], v25 offset:53248
ds_read_b64_tr_b16 v[190:191], v33 offset:53248
s_waitcnt lgkmcnt(6)
v_mfma_f32_16x16x32_bf16 a[0:3], v[164:167], v[176:179], a[0:3]
ds_read_b64_tr_b16 v[176:177], v22 offset:57344
ds_read_b64_tr_b16 v[178:179], v30 offset:57344
s_waitcnt lgkmcnt(6)
v_mfma_f32_16x16x32_bf16 a[4:7], v[164:167], v[180:183], a[4:7]
ds_read_b64_tr_b16 v[180:181], v23 offset:57344
ds_read_b64_tr_b16 v[182:183], v31 offset:57344
s_waitcnt lgkmcnt(6)
v_mfma_f32_16x16x32_bf16 a[8:11], v[164:167], v[184:187], a[8:11]
ds_read_b64_tr_b16 v[184:185], v24 offset:57344
ds_read_b64_tr_b16 v[186:187], v32 offset:57344
s_waitcnt lgkmcnt(6)
v_mfma_f32_16x16x32_bf16 a[12:15], v[164:167], v[188:191], a[12:15]
ds_read_b64_tr_b16 v[188:189], v25 offset:57344
ds_read_b64_tr_b16 v[190:191], v33 offset:57344
s_waitcnt lgkmcnt(6)
v_mfma_f32_16x16x32_bf16 a[0:3], v[168:171], v[176:179], a[0:3]
ds_read_b64_tr_b16 v[176:177], v22 offset:61440
ds_read_b64_tr_b16 v[178:179], v30 offset:61440
s_waitcnt lgkmcnt(6)
v_mfma_f32_16x16x32_bf16 a[4:7], v[168:171], v[180:183], a[4:7]
ds_read_b64_tr_b16 v[180:181], v23 offset:61440
ds_read_b64_tr_b16 v[182:183], v31 offset:61440
s_waitcnt lgkmcnt(6)
v_mfma_f32_16x16x32_bf16 a[8:11], v[168:171], v[184:187], a[8:11]
ds_read_b64_tr_b16 v[184:185], v24 offset:61440
ds_read_b64_tr_b16 v[186:187], v32 offset:61440
s_waitcnt lgkmcnt(6)
v_mfma_f32_16x16x32_bf16 a[12:15], v[168:171], v[188:191], a[12:15]
ds_read_b64_tr_b16 v[188:189], v25 offset:61440
ds_read_b64_tr_b16 v[190:191], v33 offset:61440
s_waitcnt lgkmcnt(6)
v_mfma_f32_16x16x32_bf16 a[0:3], v[172:175], v[176:179], a[0:3]
s_waitcnt lgkmcnt(4)
v_mfma_f32_16x16x32_bf16 a[4:7], v[172:175], v[180:183], a[4:7]
s_waitcnt lgkmcnt(2)
v_mfma_f32_16x16x32_bf16 a[8:11], v[172:175], v[184:187], a[8:11]
s_waitcnt lgkmcnt(0)
v_mfma_f32_16x16x32_bf16 a[12:15], v[172:175], v[188:191], a[12:15]
v_and_b32 v34, 15, v0
v_bfe_u32 v35, v0, 4, 2
v_lshlrev_b32 v34, 2, v34
v_lshl_add_u32 v34, v35, 13, v34
s_lshl_b32 s61, s60, 15
s_lshl_b32 s62, s53, 8
s_add_u32 s61, s61, s62
s_add_u32 s61, s61, 117440512
s_add_u32 s62, s61, 4096
s_nop 3
buffer_atomic_add_f32 a0, v34, s[8:11], s61 offen offset:0
buffer_atomic_add_f32 a4, v34, s[8:11], s61 offen offset:64
buffer_atomic_add_f32 a8, v34, s[8:11], s61 offen offset:128
buffer_atomic_add_f32 a12, v34, s[8:11], s61 offen offset:192
buffer_atomic_add_f32 a1, v34, s[8:11], s61 offen offset:2048
buffer_atomic_add_f32 a5, v34, s[8:11], s61 offen offset:2112
buffer_atomic_add_f32 a9, v34, s[8:11], s61 offen offset:2176
buffer_atomic_add_f32 a13, v34, s[8:11], s61 offen offset:2240
buffer_atomic_add_f32 a2, v34, s[8:11], s62 offen offset:0
buffer_atomic_add_f32 a6, v34, s[8:11], s62 offen offset:64
buffer_atomic_add_f32 a10, v34, s[8:11], s62 offen offset:128
buffer_atomic_add_f32 a14, v34, s[8:11], s62 offen offset:192
buffer_atomic_add_f32 a3, v34, s[8:11], s62 offen offset:2048
buffer_atomic_add_f32 a7, v34, s[8:11], s62 offen offset:2112
buffer_atomic_add_f32 a11, v34, s[8:11], s62 offen offset:2176
buffer_atomic_add_f32 a15, v34, s[8:11], s62 offen offset:2240
s_branch L_w_FD
L_w_FU:
s_load_dwordx2 s[16:17], s[0:1], 40
s_load_dwordx2 s[18:19], s[0:1], 88
s_load_dwordx2 s[20:21], s[0:1], 0
s_load_dwordx2 s[22:23], s[0:1], 96
s_and_b32 s53, s3, 7
s_lshr_b32 s52, s3, 3
s_waitcnt lgkmcnt(0)
s_lshl_b32 s60, s52, 2
s_add_u32 s60, s60, s29
s_mov_b32 s12, s18
s_and_b32 s13, s19, 0xffff
s_mov_b32 s14, 0xe0000
s_mov_b32 s15, 0x00020000
v_and_b32 v34, 63, v0
v_lshlrev_b32 v1, 4, v34
s_mul_i32 s42, s29, 256
s_add_u32 s42, s42, 0
v_add_u32 v35, s42, v34
v_lshrrev_b32 v36, 3, v35
v_and_b32 v37, 7, v35
v_lshrrev_b32 v38, 2, v36
v_lshrrev_b32 v39, 3, v36
v_xor_b32 v38, v38, v39
v_and_b32 v38, 1, v38
v_and_b32 v39, 3, v36
v_lshl_or_b32 v38, v38, 2, v39
v_lshrrev_b32 v38, 1, v38
v_lshlrev_b32 v38, 1, v38
v_xor_b32 v37, v37, v38
s_mov_b32 s42, 1024
v_mul_lo_u32 v36, v36, s42
v_lshl_add_u32 v2, v37, 4, v36
s_mul_i32 s42, s29, 256
s_add_u32 s42, s42, 64
v_add_u32 v35, s42, v34
v_lshrrev_b32 v36, 3, v35
v_and_b32 v37, 7, v35
v_lshrrev_b32 v38, 2, v36
v_lshrrev_b32 v39, 3, v36
v_xor_b32 v38, v38, v39
v_and_b32 v38, 1, v38
v_and_b32 v39, 3, v36
v_lshl_or_b32 v38, v38, 2, v39
v_lshrrev_b32 v38, 1, v38
v_lshlrev_b32 v38, 1, v38
v_xor_b32 v37, v37, v38
s_mov_b32 s42, 1024
v_mul_lo_u32 v36, v36, s42
v_lshl_add_u32 v3, v37, 4, v36
s_mul_i32 s42, s29, 256
s_add_u32 s42, s42, 128
v_add_u32 v35, s42, v34
v_lshrrev_b32 v36, 3, v35
v_and_b32 v37, 7, v35
v_lshrrev_b32 v38, 2, v36
v_lshrrev_b32 v39, 3, v36
v_xor_b32 v38, v38, v39
v_and_b32 v38, 1, v38
v_and_b32 v39, 3, v36
v_lshl_or_b32 v38, v38, 2, v39
v_lshrrev_b32 v38, 1, v38
v_lshlrev_b32 v38, 1, v38
v_xor_b32 v37, v37, v38
s_mov_b32 s42, 1024
v_mul_lo_u32 v36, v36, s42
v_lshl_add_u32 v4, v37, 4, v36
s_mul_i32 s42, s29, 256
s_add_u32 s42, s42, 192
v_add_u32 v35, s42, v34
v_lshrrev_b32 v36, 3, v35
v_and_b32 v37, 7, v35
v_lshrrev_b32 v38, 2, v36
v_lshrrev_b32 v39, 3, v36
v_xor_b32 v38, v38, v39
v_and_b32 v38, 1, v38
v_and_b32 v39, 3, v36
v_lshl_or_b32 v38, v38, 2, v39
v_lshrrev_b32 v38, 1, v38
v_lshlrev_b32 v38, 1, v38
v_xor_b32 v37, v37, v38
s_mov_b32 s42, 1024
v_mul_lo_u32 v36, v36, s42
v_lshl_add_u32 v5, v37, 4, v36
v_bfe_u32 v35, v34, 2, 2
v_lshrrev_b32 v36, 4, v34
v_lshl_add_u32 v37, v36, 2, v35
v_lshrrev_b32 v38, 2, v37
v_lshrrev_b32 v39, 3, v37
v_xor_b32 v38, v38, v39
v_and_b32 v38, 1, v38
v_and_b32 v39, 3, v37
v_lshl_or_b32 v38, v38, 2, v39
v_lshrrev_b32 v38, 1, v38
v_mul_u32_u24 v37, 128, v37
v_and_b32 v39, 3, v34
v_lshl_add_u32 v37, v39, 3, v37
v_xor_b32 v39, 0, v38
v_lshl_add_u32 v18, v39, 5, v37
v_add_u32 v22, 0x10000, v18
v_xor_b32 v39, 1, v38
v_lshl_add_u32 v19, v39, 5, v37
v_add_u32 v23, 0x10000, v19
v_xor_b32 v39, 2, v38
v_lshl_add_u32 v20, v39, 5, v37
v_add_u32 v24, 0x10000, v20
v_xor_b32 v39, 3, v38
v_lshl_add_u32 v21, v39, 5, v37
v_add_u32 v25, 0x10000, v21
v_lshl_add_u32 v37, v36, 2, v35
v_add_u32 v37, 16, v37
v_lshrrev_b32 v38, 2, v37
v_lshrrev_b32 v39, 3, v37
v_xor_b32 v38, v38, v39
v_and_b32 v38, 1, v38
v_and_b32 v39, 3, v37
v_lshl_or_b32 v38, v38, 2, v39
v_lshrrev_b32 v38, 1, v38
v_mul_u32_u24 v37, 128, v37
v_and_b32 v39, 3, v34
v_lshl_add_u32 v37, v39, 3, v37
v_xor_b32 v39, 0, v38
v_lshl_add_u32 v26, v39, 5, v37
v_add_u32 v30, 0x10000, v26
v_xor_b32 v39, 1, v38
v_lshl_add_u32 v27, v39, 5, v37
v_add_u32 v31, 0x10000, v27
v_xor_b32 v39, 2, v38
v_lshl_add_u32 v28, v39, 5, v37
v_add_u32 v32, 0x10000, v28
v_xor_b32 v39, 3, v38
v_lshl_add_u32 v29, v39, 5, v37
v_add_u32 v33, 0x10000, v29
s_lshr_b32 s3, s52, 1
s_lshl_b32 s3, s3, 7
s_add_u32 s3, s3, 4252672
s_cmp_lg_u32 s29, 0
s_cbranch_scc1 WWd_98
v_mov_b32 v34, s3
s_mov_b32 s43, 0
WW_97:
buffer_load_dword v35, v34, s[84:87], 0 offen sc1
s_add_u32 s43, s43, 1
s_waitcnt vmcnt(0)
v_readfirstlane_b32 s42, v35
s_cmp_ge_u32 s42, 7
s_cbranch_scc1 WWd_98
s_cmp_gt_u32 s43, 400000
s_cbranch_scc1 WWd_98
s_cmp_lg_u32 s42, 0
s_cbranch_scc1 WWs_99
s_sleep 32
s_branch WW_97
WWs_99:
s_sleep 16
s_branch WW_97
WWd_98:
s_waitcnt vmcnt(0)
s_barrier
s_mul_i32 s48, s60, 28672
s_add_u32 s48, s48, 109051904
s_lshl_b32 s49, s53, 7
s_mul_i32 s51, s29, 4096
s_add_u32 s42, s49, 0
s_add_u32 m0, s51, 0
s_nop 0
buffer_load_dwordx4 v2, s[12:15], s42 offen lds
s_add_u32 m0, s51, 1024
s_nop 0
buffer_load_dwordx4 v3, s[12:15], s42 offen lds
s_add_u32 m0, s51, 2048
s_nop 0
buffer_load_dwordx4 v4, s[12:15], s42 offen lds
s_add_u32 m0, s51, 3072
s_nop 0
buffer_load_dwordx4 v5, s[12:15], s42 offen lds
s_add_u32 s42, s49, 131072
s_add_u32 m0, s51, 16384
s_nop 0
buffer_load_dwordx4 v2, s[12:15], s42 offen lds
s_add_u32 m0, s51, 17408
s_nop 0
buffer_load_dwordx4 v3, s[12:15], s42 offen lds
s_add_u32 m0, s51, 18432
s_nop 0
buffer_load_dwordx4 v4, s[12:15], s42 offen lds
s_add_u32 m0, s51, 19456
s_nop 0
buffer_load_dwordx4 v5, s[12:15], s42 offen lds
s_add_u32 s42, s49, 262144
s_add_u32 m0, s51, 32768
s_nop 0
buffer_load_dwordx4 v2, s[12:15], s42 offen lds
s_add_u32 m0, s51, 33792
s_nop 0
buffer_load_dwordx4 v3, s[12:15], s42 offen lds
s_add_u32 m0, s51, 34816
s_nop 0
buffer_load_dwordx4 v4, s[12:15], s42 offen lds
s_add_u32 m0, s51, 35840
s_nop 0
buffer_load_dwordx4 v5, s[12:15], s42 offen lds
s_add_u32 s42, s49, 393216
s_add_u32 m0, s51, 49152
s_nop 0
buffer_load_dwordx4 v2, s[12:15], s42 offen lds
s_add_u32 m0, s51, 50176
s_nop 0
buffer_load_dwordx4 v3, s[12:15], s42 offen lds
s_add_u32 m0, s51, 51200
s_nop 0
buffer_load_dwordx4 v4, s[12:15], s42 offen lds
s_add_u32 m0, s51, 52224
s_nop 0
buffer_load_dwordx4 v5, s[12:15], s42 offen lds
s_add_u32 s42, s49, 524288
s_add_u32 m0, s51, 65536
s_nop 0
buffer_load_dwordx4 v2, s[12:15], s42 offen lds
s_add_u32 m0, s51, 66560
s_nop 0
buffer_load_dwordx4 v3, s[12:15], s42 offen lds
s_add_u32 m0, s51, 67584
s_nop 0
buffer_load_dwordx4 v4, s[12:15], s42 offen lds
s_add_u32 m0, s51, 68608
s_nop 0
buffer_load_dwordx4 v5, s[12:15], s42 offen lds
s_add_u32 s42, s49, 655360
s_add_u32 m0, s51, 81920
s_nop 0
buffer_load_dwordx4 v2, s[12:15], s42 offen lds
s_add_u32 m0, s51, 82944
s_nop 0
buffer_load_dwordx4 v3, s[12:15], s42 offen lds
s_add_u32 m0, s51, 83968
s_nop 0
buffer_load_dwordx4 v4, s[12:15], s42 offen lds
s_add_u32 m0, s51, 84992
s_nop 0
buffer_load_dwordx4 v5, s[12:15], s42 offen lds
s_add_u32 s42, s49, 786432
s_add_u32 m0, s51, 98304
s_nop 0
buffer_load_dwordx4 v2, s[12:15], s42 offen lds
s_add_u32 m0, s51, 99328
s_nop 0
buffer_load_dwordx4 v3, s[12:15], s42 offen lds
s_add_u32 m0, s51, 100352
s_nop 0
buffer_load_dwordx4 v4, s[12:15], s42 offen lds
s_add_u32 m0, s51, 101376
s_nop 0
buffer_load_dwordx4 v5, s[12:15], s42 offen lds
buffer_load_dwordx4 v[48:51], v1, s[8:11], s48 offen offset:0 sc1
buffer_load_dwordx4 v[52:55], v1, s[8:11], s48 offen offset:1024 sc1
buffer_load_dwordx4 v[56:59], v1, s[8:11], s48 offen offset:2048 sc1
buffer_load_dwordx4 v[60:63], v1, s[8:11], s48 offen offset:3072 sc1
s_add_u32 s43, s48, 4096
buffer_load_dwordx4 v[64:67], v1, s[8:11], s43 offen offset:0 sc1
s_add_u32 s43, s48, 4096
buffer_load_dwordx4 v[68:71], v1, s[8:11], s43 offen offset:1024 sc1
s_add_u32 s43, s48, 4096
buffer_load_dwordx4 v[72:75], v1, s[8:11], s43 offen offset:2048 sc1
s_add_u32 s43, s48, 4096
buffer_load_dwordx4 v[76:79], v1, s[8:11], s43 offen offset:3072 sc1
s_add_u32 s43, s48, 8192
buffer_load_dwordx4 v[80:83], v1, s[8:11], s43 offen offset:0 sc1
s_add_u32 s43, s48, 8192
buffer_load_dwordx4 v[84:87], v1, s[8:11], s43 offen offset:1024 sc1
s_add_u32 s43, s48, 8192
buffer_load_dwordx4 v[88:91], v1, s[8:11], s43 offen offset:2048 sc1
s_add_u32 s43, s48, 8192
buffer_load_dwordx4 v[92:95], v1, s[8:11], s43 offen offset:3072 sc1
s_add_u32 s43, s48, 12288
buffer_load_dwordx4 v[96:99], v1, s[8:11], s43 offen offset:0 sc1
s_add_u32 s43, s48, 12288
buffer_load_dwordx4 v[100:103], v1, s[8:11], s43 offen offset:1024 sc1
s_add_u32 s43, s48, 12288
buffer_load_dwordx4 v[104:107], v1, s[8:11], s43 offen offset:2048 sc1
s_add_u32 s43, s48, 12288
buffer_load_dwordx4 v[108:111], v1, s[8:11], s43 offen offset:3072 sc1
s_waitcnt vmcnt(40)
s_barrier
ds_read_b64_tr_b16 v[112:113], v18 offset:0
ds_read_b64_tr_b16 v[114:115], v26 offset:0
ds_read_b64_tr_b16 v[116:117], v19 offset:0
ds_read_b64_tr_b16 v[118:119], v27 offset:0
ds_read_b64_tr_b16 v[120:121], v20 offset:0
ds_read_b64_tr_b16 v[122:123], v28 offset:0
ds_read_b64_tr_b16 v[124:125], v21 offset:0
ds_read_b64_tr_b16 v[126:127], v29 offset:0
s_waitcnt vmcnt(15)
s_waitcnt lgkmcnt(6)
v_mfma_f32_16x16x32_bf16 a[0:3], v[48:51], v[112:115], 0
ds_read_b64_tr_b16 v[112:113], v18 offset:4096
ds_read_b64_tr_b16 v[114:115], v26 offset:4096
s_waitcnt lgkmcnt(6)
v_mfma_f32_16x16x32_bf16 a[4:7], v[48:51], v[116:119], 0
ds_read_b64_tr_b16 v[116:117], v19 offset:4096
ds_read_b64_tr_b16 v[118:119], v27 offset:4096
s_waitcnt lgkmcnt(6)
v_mfma_f32_16x16x32_bf16 a[8:11], v[48:51], v[120:123], 0
ds_read_b64_tr_b16 v[120:121], v20 offset:4096
ds_read_b64_tr_b16 v[122:123], v28 offset:4096
s_waitcnt lgkmcnt(6)
v_mfma_f32_16x16x32_bf16 a[12:15], v[48:51], v[124:127], 0
s_add_u32 s43, s48, 16384
buffer_load_dwordx4 v[48:51], v1, s[8:11], s43 offen offset:0 sc1
ds_read_b64_tr_b16 v[124:125], v21 offset:4096
ds_read_b64_tr_b16 v[126:127], v29 offset:4096
s_waitcnt vmcnt(15)
s_waitcnt lgkmcnt(6)
v_mfma_f32_16x16x32_bf16 a[0:3], v[52:55], v[112:115], a[0:3]
ds_read_b64_tr_b16 v[112:113], v18 offset:8192
ds_read_b64_tr_b16 v[114:115], v26 offset:8192
s_waitcnt lgkmcnt(6)
v_mfma_f32_16x16x32_bf16 a[4:7], v[52:55], v[116:119], a[4:7]
ds_read_b64_tr_b16 v[116:117], v19 offset:8192
ds_read_b64_tr_b16 v[118:119], v27 offset:8192
s_waitcnt lgkmcnt(6)
v_mfma_f32_16x16x32_bf16 a[8:11], v[52:55], v[120:123], a[8:11]
ds_read_b64_tr_b16 v[120:121], v20 offset:8192
ds_read_b64_tr_b16 v[122:123], v28 offset:8192
s_waitcnt lgkmcnt(6)
v_mfma_f32_16x16x32_bf16 a[12:15], v[52:55], v[124:127], a[12:15]
s_add_u32 s43, s48, 16384
buffer_load_dwordx4 v[52:55], v1, s[8:11], s43 offen offset:1024 sc1
ds_read_b64_tr_b16 v[124:125], v21 offset:8192
ds_read_b64_tr_b16 v[126:127], v29 offset:8192
s_waitcnt vmcnt(15)
s_waitcnt lgkmcnt(6)
v_mfma_f32_16x16x32_bf16 a[0:3], v[56:59], v[112:115], a[0:3]
ds_read_b64_tr_b16 v[112:113], v18 offset:12288
ds_read_b64_tr_b16 v[114:115], v26 offset:12288
s_waitcnt lgkmcnt(6)
v_mfma_f32_16x16x32_bf16 a[4:7], v[56:59], v[116:119], a[4:7]
ds_read_b64_tr_b16 v[116:117], v19 offset:12288
ds_read_b64_tr_b16 v[118:119], v27 offset:12288
s_waitcnt lgkmcnt(6)
v_mfma_f32_16x16x32_bf16 a[8:11], v[56:59], v[120:123], a[8:11]
ds_read_b64_tr_b16 v[120:121], v20 offset:12288
ds_read_b64_tr_b16 v[122:123], v28 offset:12288
s_waitcnt lgkmcnt(6)
v_mfma_f32_16x16x32_bf16 a[12:15], v[56:59], v[124:127], a[12:15]
s_add_u32 s43, s48, 16384
buffer_load_dwordx4 v[56:59], v1, s[8:11], s43 offen offset:2048 sc1
ds_read_b64_tr_b16 v[124:125], v21 offset:12288
ds_read_b64_tr_b16 v[126:127], v29 offset:12288
s_waitcnt vmcnt(15)
s_waitcnt lgkmcnt(6)
v_mfma_f32_16x16x32_bf16 a[0:3], v[60:63], v[112:115], a[0:3]
s_waitcnt lgkmcnt(4)
v_mfma_f32_16x16x32_bf16 a[4:7], v[60:63], v[116:119], a[4:7]
s_waitcnt lgkmcnt(2)
v_mfma_f32_16x16x32_bf16 a[8:11], v[60:63], v[120:123], a[8:11]
s_waitcnt lgkmcnt(0)
v_mfma_f32_16x16x32_bf16 a[12:15], v[60:63], v[124:127], a[12:15]
s_add_u32 s43, s48, 16384
buffer_load_dwordx4 v[60:63], v1, s[8:11], s43 offen offset:3072 sc1
s_barrier
ds_read_b64_tr_b16 v[112:113], v18 offset:16384
ds_read_b64_tr_b16 v[114:115], v26 offset:16384
ds_read_b64_tr_b16 v[116:117], v19 offset:16384
ds_read_b64_tr_b16 v[118:119], v27 offset:16384
ds_read_b64_tr_b16 v[120:121], v20 offset:16384
ds_read_b64_tr_b16 v[122:123], v28 offset:16384
ds_read_b64_tr_b16 v[124:125], v21 offset:16384
ds_read_b64_tr_b16 v[126:127], v29 offset:16384
s_waitcnt vmcnt(15)
s_waitcnt lgkmcnt(6)
v_mfma_f32_16x16x32_bf16 a[0:3], v[64:67], v[112:115], a[0:3]
ds_read_b64_tr_b16 v[112:113], v18 offset:20480
ds_read_b64_tr_b16 v[114:115], v26 offset:20480
s_waitcnt lgkmcnt(6)
v_mfma_f32_16x16x32_bf16 a[4:7], v[64:67], v[116:119], a[4:7]
ds_read_b64_tr_b16 v[116:117], v19 offset:20480
ds_read_b64_tr_b16 v[118:119], v27 offset:20480
s_waitcnt lgkmcnt(6)
v_mfma_f32_16x16x32_bf16 a[8:11], v[64:67], v[120:123], a[8:11]
ds_read_b64_tr_b16 v[120:121], v20 offset:20480
ds_read_b64_tr_b16 v[122:123], v28 offset:20480
s_waitcnt lgkmcnt(6)
v_mfma_f32_16x16x32_bf16 a[12:15], v[64:67], v[124:127], a[12:15]
s_add_u32 s43, s48, 20480
buffer_load_dwordx4 v[64:67], v1, s[8:11], s43 offen offset:0 sc1
ds_read_b64_tr_b16 v[124:125], v21 offset:20480
ds_read_b64_tr_b16 v[126:127], v29 offset:20480
s_waitcnt vmcnt(15)
s_waitcnt lgkmcnt(6)
v_mfma_f32_16x16x32_bf16 a[0:3], v[68:71], v[112:115], a[0:3]
ds_read_b64_tr_b16 v[112:113], v18 offset:24576
ds_read_b64_tr_b16 v[114:115], v26 offset:24576
s_waitcnt lgkmcnt(6)
v_mfma_f32_16x16x32_bf16 a[4:7], v[68:71], v[116:119], a[4:7]
ds_read_b64_tr_b16 v[116:117], v19 offset:24576
ds_read_b64_tr_b16 v[118:119], v27 offset:24576
s_waitcnt lgkmcnt(6)
v_mfma_f32_16x16x32_bf16 a[8:11], v[68:71], v[120:123], a[8:11]
ds_read_b64_tr_b16 v[120:121], v20 offset:24576
ds_read_b64_tr_b16 v[122:123], v28 offset:24576
s_waitcnt lgkmcnt(6)
v_mfma_f32_16x16x32_bf16 a[12:15], v[68:71], v[124:127], a[12:15]
s_add_u32 s43, s48, 20480
buffer_load_dwordx4 v[68:71], v1, s[8:11], s43 offen offset:1024 sc1
ds_read_b64_tr_b16 v[124:125], v21 offset:24576
ds_read_b64_tr_b16 v[126:127], v29 offset:24576
s_waitcnt vmcnt(15)
s_waitcnt lgkmcnt(6)
v_mfma_f32_16x16x32_bf16 a[0:3], v[72:75], v[112:115], a[0:3]
ds_read_b64_tr_b16 v[112:113], v18 offset:28672
ds_read_b64_tr_b16 v[114:115], v26 offset:28672
s_waitcnt lgkmcnt(6)
v_mfma_f32_16x16x32_bf16 a[4:7], v[72:75], v[116:119], a[4:7]
ds_read_b64_tr_b16 v[116:117], v19 offset:28672
ds_read_b64_tr_b16 v[118:119], v27 offset:28672
s_waitcnt lgkmcnt(6)
v_mfma_f32_16x16x32_bf16 a[8:11], v[72:75], v[120:123], a[8:11]
ds_read_b64_tr_b16 v[120:121], v20 offset:28672
ds_read_b64_tr_b16 v[122:123], v28 offset:28672
s_waitcnt lgkmcnt(6)
v_mfma_f32_16x16x32_bf16 a[12:15], v[72:75], v[124:127], a[12:15]
s_add_u32 s43, s48, 20480
buffer_load_dwordx4 v[72:75], v1, s[8:11], s43 offen offset:2048 sc1
ds_read_b64_tr_b16 v[124:125], v21 offset:28672
ds_read_b64_tr_b16 v[126:127], v29 offset:28672
s_waitcnt vmcnt(15)
s_waitcnt lgkmcnt(6)
v_mfma_f32_16x16x32_bf16 a[0:3], v[76:79], v[112:115], a[0:3]
s_waitcnt lgkmcnt(4)
v_mfma_f32_16x16x32_bf16 a[4:7], v[76:79], v[116:119], a[4:7]
s_waitcnt lgkmcnt(2)
v_mfma_f32_16x16x32_bf16 a[8:11], v[76:79], v[120:123], a[8:11]
s_waitcnt lgkmcnt(0)
v_mfma_f32_16x16x32_bf16 a[12:15], v[76:79], v[124:127], a[12:15]
s_add_u32 s43, s48, 20480
buffer_load_dwordx4 v[76:79], v1, s[8:11], s43 offen offset:3072 sc1
s_barrier
ds_read_b64_tr_b16 v[112:113], v18 offset:32768
ds_read_b64_tr_b16 v[114:115], v26 offset:32768
ds_read_b64_tr_b16 v[116:117], v19 offset:32768
ds_read_b64_tr_b16 v[118:119], v27 offset:32768
ds_read_b64_tr_b16 v[120:121], v20 offset:32768
ds_read_b64_tr_b16 v[122:123], v28 offset:32768
ds_read_b64_tr_b16 v[124:125], v21 offset:32768
ds_read_b64_tr_b16 v[126:127], v29 offset:32768
s_waitcnt vmcnt(15)
s_waitcnt lgkmcnt(6)
v_mfma_f32_16x16x32_bf16 a[0:3], v[80:83], v[112:115], a[0:3]
ds_read_b64_tr_b16 v[112:113], v18 offset:36864
ds_read_b64_tr_b16 v[114:115], v26 offset:36864
s_waitcnt lgkmcnt(6)
v_mfma_f32_16x16x32_bf16 a[4:7], v[80:83], v[116:119], a[4:7]
ds_read_b64_tr_b16 v[116:117], v19 offset:36864
ds_read_b64_tr_b16 v[118:119], v27 offset:36864
s_waitcnt lgkmcnt(6)
v_mfma_f32_16x16x32_bf16 a[8:11], v[80:83], v[120:123], a[8:11]
ds_read_b64_tr_b16 v[120:121], v20 offset:36864
ds_read_b64_tr_b16 v[122:123], v28 offset:36864
s_waitcnt lgkmcnt(6)
v_mfma_f32_16x16x32_bf16 a[12:15], v[80:83], v[124:127], a[12:15]
s_add_u32 s43, s48, 24576
buffer_load_dwordx4 v[80:83], v1, s[8:11], s43 offen offset:0 sc1
ds_read_b64_tr_b16 v[124:125], v21 offset:36864
ds_read_b64_tr_b16 v[126:127], v29 offset:36864
s_waitcnt vmcnt(15)
s_waitcnt lgkmcnt(6)
v_mfma_f32_16x16x32_bf16 a[0:3], v[84:87], v[112:115], a[0:3]
ds_read_b64_tr_b16 v[112:113], v18 offset:40960
ds_read_b64_tr_b16 v[114:115], v26 offset:40960
s_waitcnt lgkmcnt(6)
v_mfma_f32_16x16x32_bf16 a[4:7], v[84:87], v[116:119], a[4:7]
ds_read_b64_tr_b16 v[116:117], v19 offset:40960
ds_read_b64_tr_b16 v[118:119], v27 offset:40960
s_waitcnt lgkmcnt(6)
v_mfma_f32_16x16x32_bf16 a[8:11], v[84:87], v[120:123], a[8:11]
ds_read_b64_tr_b16 v[120:121], v20 offset:40960
ds_read_b64_tr_b16 v[122:123], v28 offset:40960
s_waitcnt lgkmcnt(6)
v_mfma_f32_16x16x32_bf16 a[12:15], v[84:87], v[124:127], a[12:15]
s_add_u32 s43, s48, 24576
buffer_load_dwordx4 v[84:87], v1, s[8:11], s43 offen offset:1024 sc1
ds_read_b64_tr_b16 v[124:125], v21 offset:40960
ds_read_b64_tr_b16 v[126:127], v29 offset:40960
s_waitcnt vmcnt(15)
s_waitcnt lgkmcnt(6)
v_mfma_f32_16x16x32_bf16 a[0:3], v[88:91], v[112:115], a[0:3]
ds_read_b64_tr_b16 v[112:113], v18 offset:45056
ds_read_b64_tr_b16 v[114:115], v26 offset:45056
s_waitcnt lgkmcnt(6)
v_mfma_f32_16x16x32_bf16 a[4:7], v[88:91], v[116:119], a[4:7]
ds_read_b64_tr_b16 v[116:117], v19 offset:45056
ds_read_b64_tr_b16 v[118:119], v27 offset:45056
s_waitcnt lgkmcnt(6)
v_mfma_f32_16x16x32_bf16 a[8:11], v[88:91], v[120:123], a[8:11]
ds_read_b64_tr_b16 v[120:121], v20 offset:45056
ds_read_b64_tr_b16 v[122:123], v28 offset:45056
s_waitcnt lgkmcnt(6)
v_mfma_f32_16x16x32_bf16 a[12:15], v[88:91], v[124:127], a[12:15]
s_add_u32 s43, s48, 24576
buffer_load_dwordx4 v[88:91], v1, s[8:11], s43 offen offset:2048 sc1
ds_read_b64_tr_b16 v[124:125], v21 offset:45056
ds_read_b64_tr_b16 v[126:127], v29 offset:45056
s_waitcnt vmcnt(15)
s_waitcnt lgkmcnt(6)
v_mfma_f32_16x16x32_bf16 a[0:3], v[92:95], v[112:115], a[0:3]
s_waitcnt lgkmcnt(4)
v_mfma_f32_16x16x32_bf16 a[4:7], v[92:95], v[116:119], a[4:7]
s_waitcnt lgkmcnt(2)
v_mfma_f32_16x16x32_bf16 a[8:11], v[92:95], v[120:123], a[8:11]
s_waitcnt lgkmcnt(0)
v_mfma_f32_16x16x32_bf16 a[12:15], v[92:95], v[124:127], a[12:15]
s_add_u32 s43, s48, 24576
buffer_load_dwordx4 v[92:95], v1, s[8:11], s43 offen offset:3072 sc1
s_barrier
ds_read_b64_tr_b16 v[112:113], v18 offset:49152
ds_read_b64_tr_b16 v[114:115], v26 offset:49152
ds_read_b64_tr_b16 v[116:117], v19 offset:49152
ds_read_b64_tr_b16 v[118:119], v27 offset:49152
ds_read_b64_tr_b16 v[120:121], v20 offset:49152
ds_read_b64_tr_b16 v[122:123], v28 offset:49152
ds_read_b64_tr_b16 v[124:125], v21 offset:49152
ds_read_b64_tr_b16 v[126:127], v29 offset:49152
s_waitcnt vmcnt(15)
s_waitcnt lgkmcnt(6)
v_mfma_f32_16x16x32_bf16 a[0:3], v[96:99], v[112:115], a[0:3]
ds_read_b64_tr_b16 v[112:113], v18 offset:53248
ds_read_b64_tr_b16 v[114:115], v26 offset:53248
s_waitcnt lgkmcnt(6)
v_mfma_f32_16x16x32_bf16 a[4:7], v[96:99], v[116:119], a[4:7]
ds_read_b64_tr_b16 v[116:117], v19 offset:53248
ds_read_b64_tr_b16 v[118:119], v27 offset:53248
s_waitcnt lgkmcnt(6)
v_mfma_f32_16x16x32_bf16 a[8:11], v[96:99], v[120:123], a[8:11]
ds_read_b64_tr_b16 v[120:121], v20 offset:53248
ds_read_b64_tr_b16 v[122:123], v28 offset:53248
s_waitcnt lgkmcnt(6)
v_mfma_f32_16x16x32_bf16 a[12:15], v[96:99], v[124:127], a[12:15]
ds_read_b64_tr_b16 v[124:125], v21 offset:53248
ds_read_b64_tr_b16 v[126:127], v29 offset:53248
s_waitcnt vmcnt(14)
s_waitcnt lgkmcnt(6)
v_mfma_f32_16x16x32_bf16 a[0:3], v[100:103], v[112:115], a[0:3]
ds_read_b64_tr_b16 v[112:113], v18 offset:57344
ds_read_b64_tr_b16 v[114:115], v26 offset:57344
s_waitcnt lgkmcnt(6)
v_mfma_f32_16x16x32_bf16 a[4:7], v[100:103], v[116:119], a[4:7]
ds_read_b64_tr_b16 v[116:117], v19 offset:57344
ds_read_b64_tr_b16 v[118:119], v27 offset:57344
s_waitcnt lgkmcnt(6)
v_mfma_f32_16x16x32_bf16 a[8:11], v[100:103], v[120:123], a[8:11]
ds_read_b64_tr_b16 v[120:121], v20 offset:57344
ds_read_b64_tr_b16 v[122:123], v28 offset:57344
s_waitcnt lgkmcnt(6)
v_mfma_f32_16x16x32_bf16 a[12:15], v[100:103], v[124:127], a[12:15]
ds_read_b64_tr_b16 v[124:125], v21 offset:57344
ds_read_b64_tr_b16 v[126:127], v29 offset:57344
s_waitcnt vmcnt(13)
s_waitcnt lgkmcnt(6)
v_mfma_f32_16x16x32_bf16 a[0:3], v[104:107], v[112:115], a[0:3]
ds_read_b64_tr_b16 v[112:113], v18 offset:61440
ds_read_b64_tr_b16 v[114:115], v26 offset:61440
s_waitcnt lgkmcnt(6)
v_mfma_f32_16x16x32_bf16 a[4:7], v[104:107], v[116:119], a[4:7]
ds_read_b64_tr_b16 v[116:117], v19 offset:61440
ds_read_b64_tr_b16 v[118:119], v27 offset:61440
s_waitcnt lgkmcnt(6)
v_mfma_f32_16x16x32_bf16 a[8:11], v[104:107], v[120:123], a[8:11]
ds_read_b64_tr_b16 v[120:121], v20 offset:61440
ds_read_b64_tr_b16 v[122:123], v28 offset:61440
s_waitcnt lgkmcnt(6)
v_mfma_f32_16x16x32_bf16 a[12:15], v[104:107], v[124:127], a[12:15]
ds_read_b64_tr_b16 v[124:125], v21 offset:61440
ds_read_b64_tr_b16 v[126:127], v29 offset:61440
s_waitcnt vmcnt(12)
s_waitcnt lgkmcnt(6)
v_mfma_f32_16x16x32_bf16 a[0:3], v[108:111], v[112:115], a[0:3]
s_waitcnt lgkmcnt(4)
v_mfma_f32_16x16x32_bf16 a[4:7], v[108:111], v[116:119], a[4:7]
s_waitcnt lgkmcnt(2)
v_mfma_f32_16x16x32_bf16 a[8:11], v[108:111], v[120:123], a[8:11]
s_waitcnt lgkmcnt(0)
v_mfma_f32_16x16x32_bf16 a[12:15], v[108:111], v[124:127], a[12:15]
s_barrier
ds_read_b64_tr_b16 v[112:113], v22 offset:0
ds_read_b64_tr_b16 v[114:115], v30 offset:0
ds_read_b64_tr_b16 v[116:117], v23 offset:0
ds_read_b64_tr_b16 v[118:119], v31 offset:0
ds_read_b64_tr_b16 v[120:121], v24 offset:0
ds_read_b64_tr_b16 v[122:123], v32 offset:0
ds_read_b64_tr_b16 v[124:125], v25 offset:0
ds_read_b64_tr_b16 v[126:127], v33 offset:0
s_waitcnt vmcnt(11)
s_waitcnt lgkmcnt(6)
v_mfma_f32_16x16x32_bf16 a[0:3], v[48:51], v[112:115], a[0:3]
ds_read_b64_tr_b16 v[112:113], v22 offset:4096
ds_read_b64_tr_b16 v[114:115], v30 offset:4096
s_waitcnt lgkmcnt(6)
v_mfma_f32_16x16x32_bf16 a[4:7], v[48:51], v[116:119], a[4:7]
ds_read_b64_tr_b16 v[116:117], v23 offset:4096
ds_read_b64_tr_b16 v[118:119], v31 offset:4096
s_waitcnt lgkmcnt(6)
v_mfma_f32_16x16x32_bf16 a[8:11], v[48:51], v[120:123], a[8:11]
ds_read_b64_tr_b16 v[120:121], v24 offset:4096
ds_read_b64_tr_b16 v[122:123], v32 offset:4096
s_waitcnt lgkmcnt(6)
v_mfma_f32_16x16x32_bf16 a[12:15], v[48:51], v[124:127], a[12:15]
ds_read_b64_tr_b16 v[124:125], v25 offset:4096
ds_read_b64_tr_b16 v[126:127], v33 offset:4096
s_waitcnt vmcnt(10)
s_waitcnt lgkmcnt(6)
v_mfma_f32_16x16x32_bf16 a[0:3], v[52:55], v[112:115], a[0:3]
ds_read_b64_tr_b16 v[112:113], v22 offset:8192
ds_read_b64_tr_b16 v[114:115], v30 offset:8192
s_waitcnt lgkmcnt(6)
v_mfma_f32_16x16x32_bf16 a[4:7], v[52:55], v[116:119], a[4:7]
ds_read_b64_tr_b16 v[116:117], v23 offset:8192
ds_read_b64_tr_b16 v[118:119], v31 offset:8192
s_waitcnt lgkmcnt(6)
v_mfma_f32_16x16x32_bf16 a[8:11], v[52:55], v[120:123], a[8:11]
ds_read_b64_tr_b16 v[120:121], v24 offset:8192
ds_read_b64_tr_b16 v[122:123], v32 offset:8192
s_waitcnt lgkmcnt(6)
v_mfma_f32_16x16x32_bf16 a[12:15], v[52:55], v[124:127], a[12:15]
ds_read_b64_tr_b16 v[124:125], v25 offset:8192
ds_read_b64_tr_b16 v[126:127], v33 offset:8192
s_waitcnt vmcnt(9)
s_waitcnt lgkmcnt(6)
v_mfma_f32_16x16x32_bf16 a[0:3], v[56:59], v[112:115], a[0:3]
ds_read_b64_tr_b16 v[112:113], v22 offset:12288
ds_read_b64_tr_b16 v[114:115], v30 offset:12288
s_waitcnt lgkmcnt(6)
v_mfma_f32_16x16x32_bf16 a[4:7], v[56:59], v[116:119], a[4:7]
ds_read_b64_tr_b16 v[116:117], v23 offset:12288
ds_read_b64_tr_b16 v[118:119], v31 offset:12288
s_waitcnt lgkmcnt(6)
v_mfma_f32_16x16x32_bf16 a[8:11], v[56:59], v[120:123], a[8:11]
ds_read_b64_tr_b16 v[120:121], v24 offset:12288
ds_read_b64_tr_b16 v[122:123], v32 offset:12288
s_waitcnt lgkmcnt(6)
v_mfma_f32_16x16x32_bf16 a[12:15], v[56:59], v[124:127], a[12:15]
ds_read_b64_tr_b16 v[124:125], v25 offset:12288
ds_read_b64_tr_b16 v[126:127], v33 offset:12288
s_waitcnt vmcnt(8)
s_waitcnt lgkmcnt(6)
v_mfma_f32_16x16x32_bf16 a[0:3], v[60:63], v[112:115], a[0:3]
s_waitcnt lgkmcnt(4)
v_mfma_f32_16x16x32_bf16 a[4:7], v[60:63], v[116:119], a[4:7]
s_waitcnt lgkmcnt(2)
v_mfma_f32_16x16x32_bf16 a[8:11], v[60:63], v[120:123], a[8:11]
s_waitcnt lgkmcnt(0)
v_mfma_f32_16x16x32_bf16 a[12:15], v[60:63], v[124:127], a[12:15]
s_barrier
ds_read_b64_tr_b16 v[112:113], v22 offset:16384
ds_read_b64_tr_b16 v[114:115], v30 offset:16384
ds_read_b64_tr_b16 v[116:117], v23 offset:16384
ds_read_b64_tr_b16 v[118:119], v31 offset:16384
ds_read_b64_tr_b16 v[120:121], v24 offset:16384
ds_read_b64_tr_b16 v[122:123], v32 offset:16384
ds_read_b64_tr_b16 v[124:125], v25 offset:16384
ds_read_b64_tr_b16 v[126:127], v33 offset:16384
s_waitcnt vmcnt(7)
s_waitcnt lgkmcnt(6)
v_mfma_f32_16x16x32_bf16 a[0:3], v[64:67], v[112:115], a[0:3]
ds_read_b64_tr_b16 v[112:113], v22 offset:20480
ds_read_b64_tr_b16 v[114:115], v30 offset:20480
s_waitcnt lgkmcnt(6)
v_mfma_f32_16x16x32_bf16 a[4:7], v[64:67], v[116:119], a[4:7]
ds_read_b64_tr_b16 v[116:117], v23 offset:20480
ds_read_b64_tr_b16 v[118:119], v31 offset:20480
s_waitcnt lgkmcnt(6)
v_mfma_f32_16x16x32_bf16 a[8:11], v[64:67], v[120:123], a[8:11]
ds_read_b64_tr_b16 v[120:121], v24 offset:20480
ds_read_b64_tr_b16 v[122:123], v32 offset:20480
s_waitcnt lgkmcnt(6)
v_mfma_f32_16x16x32_bf16 a[12:15], v[64:67], v[124:127], a[12:15]
ds_read_b64_tr_b16 v[124:125], v25 offset:20480
ds_read_b64_tr_b16 v[126:127], v33 offset:20480
s_waitcnt vmcnt(6)
s_waitcnt lgkmcnt(6)
v_mfma_f32_16x16x32_bf16 a[0:3], v[68:71], v[112:115], a[0:3]
ds_read_b64_tr_b16 v[112:113], v22 offset:24576
ds_read_b64_tr_b16 v[114:115], v30 offset:24576
s_waitcnt lgkmcnt(6)
v_mfma_f32_16x16x32_bf16 a[4:7], v[68:71], v[116:119], a[4:7]
ds_read_b64_tr_b16 v[116:117], v23 offset:24576
ds_read_b64_tr_b16 v[118:119], v31 offset:24576
s_waitcnt lgkmcnt(6)
v_mfma_f32_16x16x32_bf16 a[8:11], v[68:71], v[120:123], a[8:11]
ds_read_b64_tr_b16 v[120:121], v24 offset:24576
ds_read_b64_tr_b16 v[122:123], v32 offset:24576
s_waitcnt lgkmcnt(6)
v_mfma_f32_16x16x32_bf16 a[12:15], v[68:71], v[124:127], a[12:15]
ds_read_b64_tr_b16 v[124:125], v25 offset:24576
ds_read_b64_tr_b16 v[126:127], v33 offset:24576
s_waitcnt vmcnt(5)
s_waitcnt lgkmcnt(6)
v_mfma_f32_16x16x32_bf16 a[0:3], v[72:75], v[112:115], a[0:3]
ds_read_b64_tr_b16 v[112:113], v22 offset:28672
ds_read_b64_tr_b16 v[114:115], v30 offset:28672
s_waitcnt lgkmcnt(6)
v_mfma_f32_16x16x32_bf16 a[4:7], v[72:75], v[116:119], a[4:7]
ds_read_b64_tr_b16 v[116:117], v23 offset:28672
ds_read_b64_tr_b16 v[118:119], v31 offset:28672
s_waitcnt lgkmcnt(6)
v_mfma_f32_16x16x32_bf16 a[8:11], v[72:75], v[120:123], a[8:11]
ds_read_b64_tr_b16 v[120:121], v24 offset:28672
ds_read_b64_tr_b16 v[122:123], v32 offset:28672
s_waitcnt lgkmcnt(6)
v_mfma_f32_16x16x32_bf16 a[12:15], v[72:75], v[124:127], a[12:15]
ds_read_b64_tr_b16 v[124:125], v25 offset:28672
ds_read_b64_tr_b16 v[126:127], v33 offset:28672
s_waitcnt vmcnt(4)
s_waitcnt lgkmcnt(6)
v_mfma_f32_16x16x32_bf16 a[0:3], v[76:79], v[112:115], a[0:3]
s_waitcnt lgkmcnt(4)
v_mfma_f32_16x16x32_bf16 a[4:7], v[76:79], v[116:119], a[4:7]
s_waitcnt lgkmcnt(2)
v_mfma_f32_16x16x32_bf16 a[8:11], v[76:79], v[120:123], a[8:11]
s_waitcnt lgkmcnt(0)
v_mfma_f32_16x16x32_bf16 a[12:15], v[76:79], v[124:127], a[12:15]
s_barrier
ds_read_b64_tr_b16 v[112:113], v22 offset:32768
ds_read_b64_tr_b16 v[114:115], v30 offset:32768
ds_read_b64_tr_b16 v[116:117], v23 offset:32768
ds_read_b64_tr_b16 v[118:119], v31 offset:32768
ds_read_b64_tr_b16 v[120:121], v24 offset:32768
ds_read_b64_tr_b16 v[122:123], v32 offset:32768
ds_read_b64_tr_b16 v[124:125], v25 offset:32768
ds_read_b64_tr_b16 v[126:127], v33 offset:32768
s_waitcnt vmcnt(3)
s_waitcnt lgkmcnt(6)
v_mfma_f32_16x16x32_bf16 a[0:3], v[80:83], v[112:115], a[0:3]
ds_read_b64_tr_b16 v[112:113], v22 offset:36864
ds_read_b64_tr_b16 v[114:115], v30 offset:36864
s_waitcnt lgkmcnt(6)
v_mfma_f32_16x16x32_bf16 a[4:7], v[80:83], v[116:119], a[4:7]
ds_read_b64_tr_b16 v[116:117], v23 offset:36864
ds_read_b64_tr_b16 v[118:119], v31 offset:36864
s_waitcnt lgkmcnt(6)
v_mfma_f32_16x16x32_bf16 a[8:11], v[80:83], v[120:123], a[8:11]
ds_read_b64_tr_b16 v[120:121], v24 offset:36864
ds_read_b64_tr_b16 v[122:123], v32 offset:36864
s_waitcnt lgkmcnt(6)
v_mfma_f32_16x16x32_bf16 a[12:15], v[80:83], v[124:127], a[12:15]
ds_read_b64_tr_b16 v[124:125], v25 offset:36864
ds_read_b64_tr_b16 v[126:127], v33 offset:36864
s_waitcnt vmcnt(2)
s_waitcnt lgkmcnt(6)
v_mfma_f32_16x16x32_bf16 a[0:3], v[84:87], v[112:115], a[0:3]
ds_read_b64_tr_b16 v[112:113], v22 offset:40960
ds_read_b64_tr_b16 v[114:115], v30 offset:40960
s_waitcnt lgkmcnt(6)
v_mfma_f32_16x16x32_bf16 a[4:7], v[84:87], v[116:119], a[4:7]
ds_read_b64_tr_b16 v[116:117], v23 offset:40960
ds_read_b64_tr_b16 v[118:119], v31 offset:40960
s_waitcnt lgkmcnt(6)
v_mfma_f32_16x16x32_bf16 a[8:11], v[84:87], v[120:123], a[8:11]
ds_read_b64_tr_b16 v[120:121], v24 offset:40960
ds_read_b64_tr_b16 v[122:123], v32 offset:40960
s_waitcnt lgkmcnt(6)
v_mfma_f32_16x16x32_bf16 a[12:15], v[84:87], v[124:127], a[12:15]
ds_read_b64_tr_b16 v[124:125], v25 offset:40960
ds_read_b64_tr_b16 v[126:127], v33 offset:40960
s_waitcnt vmcnt(1)
s_waitcnt lgkmcnt(6)
v_mfma_f32_16x16x32_bf16 a[0:3], v[88:91], v[112:115], a[0:3]
ds_read_b64_tr_b16 v[112:113], v22 offset:45056
ds_read_b64_tr_b16 v[114:115], v30 offset:45056
s_waitcnt lgkmcnt(6)
v_mfma_f32_16x16x32_bf16 a[4:7], v[88:91], v[116:119], a[4:7]
ds_read_b64_tr_b16 v[116:117], v23 offset:45056
ds_read_b64_tr_b16 v[118:119], v31 offset:45056
s_waitcnt lgkmcnt(6)
v_mfma_f32_16x16x32_bf16 a[8:11], v[88:91], v[120:123], a[8:11]
ds_read_b64_tr_b16 v[120:121], v24 offset:45056
ds_read_b64_tr_b16 v[122:123], v32 offset:45056
s_waitcnt lgkmcnt(6)
v_mfma_f32_16x16x32_bf16 a[12:15], v[88:91], v[124:127], a[12:15]
ds_read_b64_tr_b16 v[124:125], v25 offset:45056
ds_read_b64_tr_b16 v[126:127], v33 offset:45056
s_waitcnt vmcnt(0)
s_waitcnt lgkmcnt(6)
v_mfma_f32_16x16x32_bf16 a[0:3], v[92:95], v[112:115], a[0:3]
s_waitcnt lgkmcnt(4)
v_mfma_f32_16x16x32_bf16 a[4:7], v[92:95], v[116:119], a[4:7]
s_waitcnt lgkmcnt(2)
v_mfma_f32_16x16x32_bf16 a[8:11], v[92:95], v[120:123], a[8:11]
s_waitcnt lgkmcnt(0)
v_mfma_f32_16x16x32_bf16 a[12:15], v[92:95], v[124:127], a[12:15]
v_and_b32 v34, 15, v0
v_bfe_u32 v35, v0, 4, 2
v_lshlrev_b32 v34, 2, v34
v_lshl_add_u32 v34, v35, 13, v34
s_lshl_b32 s61, s60, 15
s_lshl_b32 s62, s53, 8
s_add_u32 s61, s61, s62
s_add_u32 s61, s61, 117440512
s_add_u32 s62, s61, 4096
s_nop 3
buffer_store_dword a0, v34, s[8:11], s61 offen offset:0 sc1
buffer_store_dword a4, v34, s[8:11], s61 offen offset:64 sc1
buffer_store_dword a8, v34, s[8:11], s61 offen offset:128 sc1
buffer_store_dword a12, v34, s[8:11], s61 offen offset:192 sc1
buffer_store_dword a1, v34, s[8:11], s61 offen offset:2048 sc1
buffer_store_dword a5, v34, s[8:11], s61 offen offset:2112 sc1
buffer_store_dword a9, v34, s[8:11], s61 offen offset:2176 sc1
buffer_store_dword a13, v34, s[8:11], s61 offen offset:2240 sc1
buffer_store_dword a2, v34, s[8:11], s62 offen offset:0 sc1
buffer_store_dword a6, v34, s[8:11], s62 offen offset:64 sc1
buffer_store_dword a10, v34, s[8:11], s62 offen offset:128 sc1
buffer_store_dword a14, v34, s[8:11], s62 offen offset:192 sc1
buffer_store_dword a3, v34, s[8:11], s62 offen offset:2048 sc1
buffer_store_dword a7, v34, s[8:11], s62 offen offset:2112 sc1
buffer_store_dword a11, v34, s[8:11], s62 offen offset:2176 sc1
buffer_store_dword a15, v34, s[8:11], s62 offen offset:2240 sc1
L_w_FD:
s_waitcnt vmcnt(0)
s_barrier
s_lshl_b32 s3, s52, 3
s_add_u32 s3, s3, s53
s_lshl_b32 s3, s3, 7
s_add_u32 s3, s3, 25600
s_cmp_lg_u32 s29, 0
s_cbranch_scc1 AT_100
v_mov_b32 v2, s3
v_mov_b32 v4, 1
s_mov_b32 s63, 4194304
s_mov_b64 exec, 1
buffer_atomic_add v4, v2, s[84:87], s63 offen sc0 sc1
v_mov_b32 v3, 162304
s_waitcnt vmcnt(0)
ds_write_b32 v3, v4
s_mov_b64 exec, -1
s_waitcnt lgkmcnt(0)
AT_100:
s_barrier
v_mov_b32 v3, 162304
ds_read_b32 v4, v3
s_waitcnt lgkmcnt(0)
v_readfirstlane_b32 s63, v4
s_barrier
s_cmp_lg_u32 s63, 4
s_cbranch_scc1 L_w_FE
s_mov_b32 s64, s20
s_and_b32 s65, s21, 0xffff
s_mov_b32 s66, 0x200000
s_mov_b32 s67, 0x00020000
s_mov_b32 s68, s22
s_and_b32 s69, s23, 0xffff
s_mov_b32 s70, 0x200000
s_mov_b32 s71, 0x00020000
v_lshrrev_b32 v34, 2, v0
v_and_b32 v35, 3, v0
v_lshlrev_b32 v34, 10, v34
v_lshl_add_u32 v35, v35, 5, v34
v_lshlrev_b32 v34, 1, v35
s_lshl_b32 s62, s52, 16
s_lshl_b32 s61, s53, 7
s_add_u32 s62, s62, s61
s_lshl_b32 s61, s62, 1
s_add_u32 s61, s61, 117440512
s_mov_b32 s63, 0xffff0000
buffer_load_dwordx4 v[64:67], v34, s[8:11], s61 offen offset:0 sc1
buffer_load_dwordx4 v[68:71], v34, s[8:11], s61 offen offset:16 sc1
buffer_load_dwordx4 v[72:75], v34, s[8:11], s61 offen offset:32 sc1
buffer_load_dwordx4 v[76:79], v34, s[8:11], s61 offen offset:48 sc1
buffer_load_dwordx4 v[48:51], v35, s[64:67], s62 offen offset:0
buffer_load_dwordx4 v[52:55], v35, s[64:67], s62 offen offset:16
s_waitcnt vmcnt(0)
v_lshlrev_b32 v96, 16, v48
v_and_b32 v97, s63, v48
v_add_f32 v96, v96, v64
v_add_f32 v97, v97, v65
v_cvt_pk_bf16_f32 v48, v96, v97
v_lshlrev_b32 v96, 16, v49
v_and_b32 v97, s63, v49
v_add_f32 v96, v96, v66
v_add_f32 v97, v97, v67
v_cvt_pk_bf16_f32 v49, v96, v97
v_lshlrev_b32 v96, 16, v50
v_and_b32 v97, s63, v50
v_add_f32 v96, v96, v68
v_add_f32 v97, v97, v69
v_cvt_pk_bf16_f32 v50, v96, v97
v_lshlrev_b32 v96, 16, v51
v_and_b32 v97, s63, v51
v_add_f32 v96, v96, v70
v_add_f32 v97, v97, v71
v_cvt_pk_bf16_f32 v51, v96, v97
v_lshlrev_b32 v96, 16, v52
v_and_b32 v97, s63, v52
v_add_f32 v96, v96, v72
v_add_f32 v97, v97, v73
v_cvt_pk_bf16_f32 v52, v96, v97
v_lshlrev_b32 v96, 16, v53
v_and_b32 v97, s63, v53
v_add_f32 v96, v96, v74
v_add_f32 v97, v97, v75
v_cvt_pk_bf16_f32 v53, v96, v97
v_lshlrev_b32 v96, 16, v54
v_and_b32 v97, s63, v54
v_add_f32 v96, v96, v76
v_add_f32 v97, v97, v77
v_cvt_pk_bf16_f32 v54, v96, v97
v_lshlrev_b32 v96, 16, v55
v_and_b32 v97, s63, v55
v_add_f32 v96, v96, v78
v_add_f32 v97, v97, v79
v_cvt_pk_bf16_f32 v55, v96, v97
buffer_store_dwordx4 v[48:51], v35, s[68:71], s62 offen offset:0
buffer_store_dwordx4 v[52:55], v35, s[68:71], s62 offen offset:16
L_w_FE:
s_getpc_b64 s[90:91]
LJ_101:
s_add_u32 s90, s90, L_m_next-LJ_101
s_addc_u32 s91, s91, -1
s_setpc_b64 s[90:91]

.section .rodata,"a"
.p2align 6
.amdhsa_kernel prep_kernel
  .amdhsa_next_free_vgpr 64
  .amdhsa_next_free_sgpr 32
  .amdhsa_accum_offset 64
  .amdhsa_group_segment_fixed_size 0
  .amdhsa_kernarg_size 120
  .amdhsa_user_sgpr_count 2
  .amdhsa_user_sgpr_kernarg_segment_ptr 1
  .amdhsa_system_sgpr_workgroup_id_x 1
.end_amdhsa_kernel
.text

.section .rodata,"a"
.p2align 6
.amdhsa_kernel main_kernel
  .amdhsa_next_free_vgpr 512
  .amdhsa_next_free_sgpr 102
  .amdhsa_accum_offset 256
  .amdhsa_group_segment_fixed_size 0
  .amdhsa_kernarg_size 120
  .amdhsa_user_sgpr_count 2
  .amdhsa_user_sgpr_kernarg_segment_ptr 1
  .amdhsa_system_sgpr_workgroup_id_x 1
.end_amdhsa_kernel
.text
```
